```python
import torch

def _softmax(x, axis=-1):
    return torch.softmax(x, dim=axis)
def _gelu(x):
    return torch.nn.functional.gelu(x, approximate="tanh")
def _silu(x):
    return torch.nn.functional.silu(x)
def _sigmoid(x):
    return torch.sigmoid(x)
def _layernorm(x, axis=-1, eps=1e-5):
    m = x.mean(dim=axis, keepdim=True)
    v = x.var(dim=axis, keepdim=True, unbiased=False)
    return (x - m) / torch.sqrt(v + eps)
def _scatter_add(tgt, idx, src, axis=0):
    return tgt.clone().index_add_(axis, idx, src)
def _segment_sum(src, seg, n):
    out = torch.zeros((n,) + src.shape[1:], dtype=src.dtype)
    return out.index_add_(0, seg, src)
def _pad(x, pw):
    flat = tuple(v for pair in reversed(pw) for v in pair)
    return torch.nn.functional.pad(x, flat)

kernel_name = 'recurrent_scan__ssm_conv_s5__glu_gated_glu__prompt'

def setup_inputs():

    _w = (lambda a: (lambda t: t.to(torch.bfloat16) if t.is_floating_point() else t)(torch.as_tensor(a)))
    def _A_setup():
        B, S, D = 1, 2048, 640
        P = D
        Lambda_re = -0.5 * (lambda _x: torch.exp(torch.as_tensor(_x)))((lambda *s: torch.randn(*s, dtype=torch.bfloat16) * 0.2)(P))
        Lambda_im = (lambda *s: torch.randn(*s, dtype=torch.bfloat16) * 0.8)(P) * 1.0
        B_re = (lambda *s: torch.randn(*s, dtype=torch.bfloat16) * 0.2)(P, D) * (D ** -0.5)
        B_im = (lambda *s: torch.randn(*s, dtype=torch.bfloat16) * 0.2)(P, D) * (D ** -0.5)
        C_re = (lambda *s: torch.randn(*s, dtype=torch.bfloat16) * 0.2)(D, P) * (P ** -0.5)
        C_im = (lambda *s: torch.randn(*s, dtype=torch.bfloat16) * 0.2)(D, P) * (P ** -0.5)
        log_dt = (lambda *s: torch.randn(*s, dtype=torch.bfloat16) * 0.2)(P) * 0.3 - 2.0
        Dskip = (lambda *s: torch.randn(*s, dtype=torch.bfloat16) * 0.05)(D)
        return {
            "x": _w((lambda *s: torch.randn(*s, dtype=torch.bfloat16) * 0.05)(B, S, D)),
            "Lambda_re": _w(Lambda_re),
            "Lambda_im": _w(Lambda_im),
            "B_re": _w(B_re),
            "B_im": _w(B_im),
            "C_re": _w(C_re),
            "C_im": _w(C_im),
            "log_dt": _w(log_dt),
            "Dskip": _w(Dskip),
        }
    _A_in = _A_setup()

    def _B_setup():
        B, S, D, F = 1, 2048, 640, 1536
        return {
            "x": _w((lambda *s: torch.randn(*s, dtype=torch.bfloat16) * 0.05)(B, S, D)),
            "w_gate": _w((lambda *s: torch.randn(*s, dtype=torch.bfloat16) * 0.05)(D, F)),
            "w_up": _w((lambda *s: torch.randn(*s, dtype=torch.bfloat16) * 0.05)(D, F)),
            "w_down": _w((lambda *s: torch.randn(*s, dtype=torch.bfloat16) * 0.05)(F, D)),
        }
    _B_in = _B_setup()

    return {
        "A_x": _A_in["x"],
        "A_Lambda_re": _A_in["Lambda_re"],
        "A_Lambda_im": _A_in["Lambda_im"],
        "A_B_re": _A_in["B_re"],
        "A_B_im": _A_in["B_im"],
        "A_C_re": _A_in["C_re"],
        "A_C_im": _A_in["C_im"],
        "A_log_dt": _A_in["log_dt"],
        "A_Dskip": _A_in["Dskip"],
        "B_x": _B_in["x"],
        "B_w_gate": _B_in["w_gate"],
        "B_w_up": _B_in["w_up"],
        "B_w_down": _B_in["w_down"],
    }

def reference(A_x, A_Lambda_re, A_Lambda_im, A_B_re, A_B_im, A_C_re, A_C_im, A_log_dt, A_Dskip, B_x, B_w_gate, B_w_up, B_w_down):
    def _A_ref(x, Lambda_re, Lambda_im, B_re, B_im, C_re, C_im, log_dt, Dskip):
        Bsz, L, H = x.shape
        Lam = Lambda_re + 1j * Lambda_im
        Bmat = B_re + 1j * B_im
        Cmat = C_re + 1j * C_im
        dt = torch.exp(log_dt)
        Lam_bar = torch.exp(dt * Lam)
        B_bar = ((Lam_bar - 1.0) / Lam)[:, None] * Bmat
        Bu = torch.einsum("bld,pd->blp", x + 0j, B_bar)
        h = torch.zeros_like(Bu[:, 0, :])
        hs = []
        for t in range(L):
            h = Lam_bar[None, :] * h + Bu[:, t, :]
            hs.append(h)
        hseq = torch.stack(hs, 1)
        y = 2.0 * torch.einsum("blp,dp->bld", hseq, Cmat).real + x * Dskip[None, None, :]
        return y

    def _B_ref(x, w_gate, w_up, w_down):
        g = torch.einsum("bsd,df->bsf", x, w_gate)
        u = torch.einsum("bsd,df->bsf", x, w_up)
        h = _sigmoid(g) * u
        return torch.einsum("bsf,fd->bsd", h, w_down)

    x = A_x
    xn = _layernorm(x, axis=-1)
    s = _A_ref(xn, A_Lambda_re, A_Lambda_im, A_B_re, A_B_im, A_C_re, A_C_im, A_log_dt, A_Dskip)
    g = _silu(_B_ref(xn, B_w_gate, B_w_up, B_w_down))
    return x + s * g
```

```asm
; @launch grid=(256,1,1) block=(256,1,1) lds=163840
.amdgcn_target "amdgcn-amd-amdhsa--gfx950"
.text
.globl recurrent_scan__ssm_conv_s5__glu_gated_glu__prompt_kernel
.p2align 8
.type recurrent_scan__ssm_conv_s5__glu_gated_glu__prompt_kernel,@function
recurrent_scan__ssm_conv_s5__glu_gated_glu__prompt_kernel:
    s_cmp_ge_u32 s2, 256
    s_cbranch_scc1 L_end
    s_load_dwordx16 s[4:19], s[0:1], 0
    s_load_dwordx16 s[20:35], s[0:1], 64
    s_getpc_b64 s[84:85]
L_pc:
    s_lshr_b32 s74, s2, 3
    s_mul_i32 s73, s74, 1920
    v_min_u32 v1, 14, v0
    v_lshl_add_u32 v1, v1, 7, s73
    v_min_u32 v1, L_code_end-L_pc-4, v1
    v_lshrrev_b32 v2, 6, v0
    v_and_b32 v215, 63, v0
    global_load_dword a220, v1, s[84:85]
    v_readfirstlane_b32 s60, v2
    s_and_b32 s73, s2, 7
    s_lshl_b32 s73, s73, 5
    s_add_u32 s73, s73, s74
    s_and_b32 s64, s73, 7
    s_lshr_b32 s63, s73, 3
    s_mov_b32 s71, s73
    s_sub_u32 s74, s73, 136
    s_mul_i32 s75, s74, 147
    s_lshr_b32 s75, s75, 10
    s_mul_i32 s76, s75, 7
    s_sub_u32 s74, s74, s76
    s_add_u32 s74, s74, 8
    s_sub_u32 s75, 16, s75
    s_cmp_ge_u32 s73, 136
    s_cselect_b32 s61, s75, s63
    s_cselect_b32 s62, s74, s64
    s_cmp_eq_u32 s73, 255
    s_cselect_b32 s61, 0, s61
    s_cselect_b32 s62, 15, s62
    s_mul_i32 s83, s61, 1
    s_add_u32 s83, s83, s62
    s_bfm_b32 s73, s61, 0
    s_and_b32 s73, s73, 17698
    s_bcnt1_i32_b32 s74, s73
    s_sub_u32 s75, s61, s74
    s_bitcmp1_b32 17698, s61
    s_cselect_b32 s61, s74, s75
    s_cbranch_scc1 L_second
    s_mov_b32 s76, 1280
    s_lshl_b32 s3, s61, 2
    s_add_u32 s3, s3, s60
    s_mul_i32 s70, s61, 15
    s_add_u32 s70, s70, s62
    s_cmp_eq_u32 s62, 15
    s_cselect_b32 s70, 180, s70
    s_mul_i32 s74, s62, 13
    s_add_u32 s74, s74, s3
    s_sub_u32 s74, s74, 35
    s_lshl_b32 s74, s74, 2
    s_cmp_ge_u32 s74, 640
    s_cselect_b32 s72, 2, 1
    s_cselect_b32 s75, 640, 0
    s_sub_u32 s75, s74, s75
    s_mul_i32 s73, s62, 35
    s_add_u32 s73, s73, s3
    s_lshl_b32 s73, s73, 2
    s_cmp_lt_u32 s3, 35
    s_cselect_b32 s73, s73, s75
    s_cselect_b32 s72, 0, s72
    s_cmp_eq_u32 s72, 0
    s_cselect_b32 s54, 1802240, 0
    s_add_u32 s54, s54, 819200
    v_lshlrev_b32 v213, 4, v215
    v_lshrrev_b32 v7, 4, v215
    v_add_u32 v7, s73, v7
    v_and_b32 v0, 0xff, v213
    v_mad_u32_u24 v6, v7, s76, v0
    v_mov_b32 v11, 47104
    s_mul_i32 s73, s60, 181
    s_add_u32 s73, s73, s70
    s_mul_i32 s77, s73, 205
    s_lshr_b32 s77, s77, 11
    s_mul_i32 s74, s77, 10
    s_sub_u32 s78, s73, s74
    s_mul_i32 s73, s77, 40960
    s_lshl_b32 s74, s78, 7
    s_add_u32 s73, s73, s74
    v_lshrrev_b32 v0, 3, v215
    v_and_b32 v2, 0x70, v213
    v_mad_u32_u24 v8, v0, s76, v2
    v_add_u32 v8, s73, v8
    s_mov_b32 s38, 2621440
    s_mov_b32 s39, 0x20000
    s_mov_b32 s42, 1966080
    s_mov_b32 s43, 0x20000
    s_mov_b32 s46, 1966080
    s_mov_b32 s47, 0x20000
    s_mov_b32 s50, 15228928
    s_mov_b32 s51, 0x20000
    s_mov_b32 s58, 1966080
    s_mov_b32 s59, 0x20000
    s_mov_b32 s55, 0x20000
    s_waitcnt lgkmcnt(0)
    s_cmp_eq_u32 s72, 1
    s_cselect_b64 s[52:53], s[10:11], s[12:13]
    s_cmp_eq_u32 s72, 0
    s_cselect_b64 s[52:53], s[4:5], s[52:53]
    v_mul_u32_u24 v14, 20, v215
    s_mov_b64 s[56:57], s[28:29]
    s_mov_b64 s[36:37], s[4:5]
    s_mov_b64 s[48:49], s[34:35]
    s_mov_b64 s[40:41], s[24:25]
    s_mov_b64 s[44:45], s[26:27]
    buffer_load_dwordx4 v[16:19], v6, s[52:55], 0 offen offset:0
    buffer_load_dwordx4 v[20:23], v6, s[52:55], 0 offen offset:256
    buffer_load_dwordx4 v[24:27], v6, s[52:55], 0 offen offset:512
    buffer_load_dwordx4 v[28:31], v6, s[52:55], 0 offen offset:768
    buffer_load_dwordx4 v[32:35], v6, s[52:55], 0 offen offset:1024
    s_mul_i32 s75, s60, 4096
    s_add_u32 m0, s75, 102400
    s_mov_b32 s75, 0
    buffer_load_dwordx4 v8, s[56:59], s75 offen offset:0 lds
    s_mov_b32 s75, 9216
    buffer_load_dwordx4 v8, s[56:59], s75 offen offset:1024 lds
    s_mov_b32 s75, 18432
    buffer_load_dwordx4 v8, s[56:59], s75 offen offset:2048 lds
    s_mov_b32 s75, 27648
    buffer_load_dwordx4 v8, s[56:59], s75 offen offset:3072 lds
    buffer_load_dword v15, v11, s[48:51], 0 offen sc1
    global_load_dword a219, v14, s[20:21]
    s_mul_i32 s73, s60, 35
    s_mul_i32 s74, s62, 140
    v_lshrrev_b32 v0, 3, v215
    v_and_b32 v1, 7, v215
    v_add_u32 v0, s73, v0
    s_movk_i32 s75, 2016
    s_add_u32 s80, s74, 140
    s_and_b32 s73, s62, 1
    s_lshl_b32 s73, s73, 2
    s_add_u32 s74, s74, s73
    v_bfe_u32 v2, v0, 1, 3
    v_xor_b32 v2, v2, v1
    v_add_u32 v3, s74, v0
    v_lshrrev_b32 v4, 4, v3
    v_mul_u32_u24 v5, 57, v4
    v_lshrrev_b32 v5, 9, v5
    v_cmp_gt_u32 vcc, s75, v3
    v_mad_i32_i24 v4, v5, -9, v4
    v_and_b32 v5, 12, v3
    v_lshlrev_b32 v5, 3, v5
    v_mad_i32_i24 v4, v4, -12, v5
    v_cndmask_b32 v4, 0, v4, vcc
    v_add_u32 v3, v3, v4
    v_lshlrev_b32 v2, 4, v2
    v_mad_u32_u24 v200, v3, s76, v2
    v_add_u32 v0, 8, v0
    v_bfe_u32 v2, v0, 1, 3
    v_xor_b32 v2, v2, v1
    v_add_u32 v3, s74, v0
    v_lshrrev_b32 v4, 4, v3
    v_mul_u32_u24 v5, 57, v4
    v_lshrrev_b32 v5, 9, v5
    v_cmp_gt_u32 vcc, s75, v3
    v_mad_i32_i24 v4, v5, -9, v4
    v_and_b32 v5, 12, v3
    v_lshlrev_b32 v5, 3, v5
    v_mad_i32_i24 v4, v4, -12, v5
    v_cndmask_b32 v4, 0, v4, vcc
    v_add_u32 v3, v3, v4
    v_lshlrev_b32 v2, 4, v2
    v_mad_u32_u24 v201, v3, s76, v2
    v_subrev_u32 v201, 1024, v201
    v_add_u32 v0, 8, v0
    v_bfe_u32 v2, v0, 1, 3
    v_xor_b32 v2, v2, v1
    v_add_u32 v3, s74, v0
    v_lshrrev_b32 v4, 4, v3
    v_mul_u32_u24 v5, 57, v4
    v_lshrrev_b32 v5, 9, v5
    v_cmp_gt_u32 vcc, s75, v3
    v_mad_i32_i24 v4, v5, -9, v4
    v_and_b32 v5, 12, v3
    v_lshlrev_b32 v5, 3, v5
    v_mad_i32_i24 v4, v4, -12, v5
    v_cndmask_b32 v4, 0, v4, vcc
    v_add_u32 v3, v3, v4
    v_lshlrev_b32 v2, 4, v2
    v_mad_u32_u24 v202, v3, s76, v2
    v_subrev_u32 v202, 2048, v202
    v_add_u32 v0, 8, v0
    v_bfe_u32 v2, v0, 1, 3
    v_xor_b32 v2, v2, v1
    v_add_u32 v3, s74, v0
    v_cmp_le_u32 vcc, s80, v3
    v_subrev_u32 v4, 140, v3
    s_nop 0
    v_cndmask_b32 v3, v3, v4, vcc
    v_lshrrev_b32 v4, 4, v3
    v_mul_u32_u24 v5, 57, v4
    v_lshrrev_b32 v5, 9, v5
    v_cmp_gt_u32 vcc, s75, v3
    v_mad_i32_i24 v4, v5, -9, v4
    v_and_b32 v5, 12, v3
    v_lshlrev_b32 v5, 3, v5
    v_mad_i32_i24 v4, v4, -12, v5
    v_cndmask_b32 v4, 0, v4, vcc
    v_add_u32 v3, v3, v4
    v_lshlrev_b32 v2, 4, v2
    v_mad_u32_u24 v203, v3, s76, v2
    v_subrev_u32 v203, 3072, v203
    v_add_u32 v0, 3, v0
    v_bfe_u32 v2, v0, 1, 3
    v_xor_b32 v2, v2, v1
    v_add_u32 v3, s74, v0
    v_cmp_le_u32 vcc, s80, v3
    v_subrev_u32 v4, 140, v3
    s_nop 0
    v_cndmask_b32 v3, v3, v4, vcc
    v_lshrrev_b32 v4, 4, v3
    v_mul_u32_u24 v5, 57, v4
    v_lshrrev_b32 v5, 9, v5
    v_cmp_gt_u32 vcc, s75, v3
    v_mad_i32_i24 v4, v5, -9, v4
    v_and_b32 v5, 12, v3
    v_lshlrev_b32 v5, 3, v5
    v_mad_i32_i24 v4, v4, -12, v5
    v_cndmask_b32 v4, 0, v4, vcc
    v_add_u32 v3, v3, v4
    v_lshlrev_b32 v2, 4, v2
    v_mad_u32_u24 v204, v3, s76, v2
    v_subrev_u32 v204, 3456, v204
    s_mul_i32 s73, s60, 49152
    s_lshl_b32 s74, s61, 8
    s_add_u32 s73, s73, s74
    s_mov_b32 s75, 3072
    v_lshrrev_b32 v0, 4, v215
    v_and_b32 v2, 15, v215
    v_lshlrev_b32 v3, 1, v0
    v_xor_b32 v2, v2, v3
    v_lshlrev_b32 v2, 4, v2
    v_mad_u32_u24 v2, v0, s75, v2
    v_add_u32 v205, s73, v2
    v_add_u32 v206, 11264, v205
    v_xor_b32 v2, 128, v205
    v_add_u32 v207, 22528, v2
    v_add_u32 v208, 33792, v2
    s_mul_i32 s69, s60, 4096
    s_add_u32 s69, s69, 18432
    s_mul_i32 s68, s60, 4480
    s_and_b32 s67, s83, 1
    s_lshl_b32 s65, s67, 7
    s_mul_i32 s66, s67, 196608
    s_add_u32 m0, s68, 0
    s_nop 0
    buffer_load_dwordx4 v200, s[36:39], s65 offen offset:0 lds
    buffer_load_dwordx4 v201, s[36:39], s65 offen offset:1024 lds
    buffer_load_dwordx4 v202, s[36:39], s65 offen offset:2048 lds
    s_mov_b64 exec, 0
    s_cmp_eq_u32 s60, 0
    s_cbranch_scc1 L_padG0
    s_cmp_eq_u32 s60, 1
    s_cbranch_scc1 L_padG1
    s_cmp_eq_u32 s60, 2
    s_cbranch_scc1 L_padG2
    s_branch L_padG3
L_retG:
    s_mov_b64 exec, -1
    v_and_b32 v0, 15, v215
    v_lshrrev_b32 v1, 4, v215
    v_lshrrev_b32 v2, 1, v0
    v_xor_b32 v2, v2, v1
    v_lshlrev_b32 v2, 4, v2
    v_lshl_add_u32 v209, v0, 7, v2
    v_xor_b32 v210, 64, v209
    v_bfe_u32 v0, v215, 2, 3
    s_lshl_b32 s73, s60, 1
    v_xor_b32 v0, s73, v0
    v_lshlrev_b32 v0, 5, v0
    v_and_b32 v2, 3, v215
    v_lshl_add_u32 v0, v2, 3, v0
    v_bfe_u32 v2, v215, 2, 2
    v_lshl_add_u32 v2, v1, 3, v2
    v_lshl_add_u32 v0, v2, 8, v0
    v_add_u32 v211, 18432, v0
    v_xor_b32 v212, 32, v211
    buffer_load_dwordx4 v203, s[36:39], s65 offen offset:3072 lds
    v_mov_b32 v12, 0x3f803f80
    v_mov_b32 v13, 0x3f803f80
    v_lshlrev_b32 v0, 3, v215
    v_add_u32 v2, 51200, v0
    v_add_u32 v3, 102400, v0
    ds_write_b64 v0, v[12:13] offset:17920
    ds_write_b64 v2, v[12:13] offset:17920
    ds_write_b64 v3, v[12:13] offset:17920
    s_lshr_b32 s63, s71, 6
    s_lshl_b32 s63, s63, 3
    s_bfe_u32 s74, s71, 0x30002
    s_add_u32 s63, s63, s74
    s_bfe_u32 s64, s71, 0x10005
    s_lshl_b32 s64, s64, 2
    s_and_b32 s74, s71, 3
    s_add_u32 s64, s64, s74
    s_and_b32 s73, s64, 1
    s_mul_i32 s74, s73, 5120
    s_sub_u32 s74, 5120, s74
    v_add_u32 v214, s74, v213
    s_mul_i32 s97, s73, 102400
    s_sub_u32 s97, 20480, s97
    buffer_load_dwordx4 v204, s[36:39], s65 offen offset:3456 lds
    s_mul_i32 s73, s64, 102400
    v_lshrrev_b32 v0, 3, v215
    v_and_b32 v2, 7, v215
    v_lshrrev_b32 v3, 4, v215
    v_xor_b32 v2, v2, v3
    v_lshlrev_b32 v2, 4, v2
    v_mad_u32_u24 v0, v0, s76, v2
    v_add_u32 v253, s73, v0
    v_xor_b32 v0, 64, v253
    v_add_u32 v254, 9216, v0
    s_mul_i32 s81, s60, 10240
    v_add_u32 v249, s81, v209
    s_add_u32 m0, s69, 0
    s_nop 0
    buffer_load_dwordx4 v205, s[40:43], s66 offen offset:0 lds
    s_lshl_b32 s73, s63, 6
    s_add_u32 s74, s73, 63
    s_mul_i32 s73, s73, 1873
    s_lshr_b32 s73, s73, 18
    s_mul_i32 s74, s74, 1873
    s_lshr_b32 s74, s74, 18
    s_mul_i32 s73, s73, 48
    s_mul_i32 s74, s74, 48
    s_sub_u32 s74, s74, 12
    s_mul_i32 s75, s60, 12
    v_min_u32 v0, 23, v215
    v_mov_b32 v1, s73
    v_mov_b32 v2, s74
    v_cmp_gt_u32 vcc, 12, v0
    s_nop 1
    v_cndmask_b32 v1, v2, v1, vcc
    v_add3_u32 v0, v0, v1, s75
    v_lshlrev_b32 v0, 6, v0
    v_add_u32 v248, 68096, v0
    buffer_load_dwordx4 v206, s[40:43], s66 offen offset:1024 lds
    s_lshl_b32 s73, s63, 6
    s_add_u32 s74, s73, 63
    s_mul_i32 s73, s73, 1821
    s_lshr_b32 s73, s73, 18
    s_mul_i32 s74, s74, 1821
    s_lshr_b32 s74, s74, 18
    s_mul_i32 s73, s73, 20
    s_mul_i32 s74, s74, 20
    s_sub_u32 s74, s74, 10
    s_and_b32 s75, s60, 1
    s_mul_i32 s75, s75, 10
    v_min_u32 v0, 19, v215
    v_mov_b32 v1, s73
    v_mov_b32 v2, s74
    v_cmp_gt_u32 vcc, 10, v0
    s_nop 1
    v_cndmask_b32 v1, v2, v1, vcc
    v_add3_u32 v0, v0, v1, s75
    v_lshlrev_b32 v0, 6, v0
    v_add_u32 v250, 117248, v0
    buffer_load_dwordx4 v207, s[40:43], s66 offen offset:2048 lds
    s_and_b32 s96, s60, 1
    s_mul_i32 s96, s96, 640
    s_and_b32 s73, s64, 1
    s_mul_i32 s73, s73, 20480
    s_add_u32 s96, s96, s73
    s_mul_i32 s74, s62, 48
    s_add_u32 s74, s74, s3
    s_lshl_b32 s74, s74, 6
    s_add_u32 s95, s74, 68096
    s_mul_i32 s94, s3, 143360
    s_add_u32 s94, s94, 2351104
    s_cmp_eq_u32 s72, 0
    s_cselect_b32 s73, 0, 2146435072
    s_cselect_b64 s[84:85], 0, -1
    v_mov_b32 v40, s73
    v_mov_b32 v44, v7
    buffer_load_dwordx4 v208, s[40:43], s66 offen offset:3072 lds
    s_mov_b32 s73, 1821
    v_mul_u32_u24 v1, s73, v44
    v_lshrrev_b32 v1, 18, v1
    v_mul_u32_u24 v2, 144, v1
    v_sub_u32 v2, v44, v2
    v_mul_u32_u24 v3, 57, v2
    v_lshrrev_b32 v3, 10, v3
    v_mul_u32_u24 v4, 18, v3
    v_sub_u32 v4, v2, v4
    v_lshrrev_b32 v5, 1, v3
    v_cmp_gt_u32 vcc, 14, v1
    v_mul_u32_u24 v0, 36, v5
    v_sub_u32 v0, v2, v0
    v_and_b32 v0, 60, v0
    v_mul_u32_u24 v0, 3, v0
    v_lshlrev_b32 v2, 5, v5
    v_sub_u32 v0, v0, v2
    v_cndmask_b32 v0, 0, v0, vcc
    v_add_u32 v0, v0, v44
    v_lshl_add_u32 v40, v0, 4, v40
    s_add_u32 m0, s69, 16384
    s_nop 0
    buffer_load_dwordx4 v205, s[44:47], s66 offen offset:0 lds
    v_lshl_add_u32 v1, v1, 2, v5
    v_mul_u32_u24 v1, 72, v1
    v_and_b32 v3, 1, v3
    v_lshl_add_u32 v3, v4, 1, v3
    v_add_lshl_u32 v1, v1, v3, 2
    v_add_u32 v1, 47360, v1
    v_lshrrev_b32 v2, 3, v7
    v_and_b32 v3, 3, v7
    v_lshl_add_u32 v2, v2, 2, v3
    v_and_b32 v3, 4, v7
    v_lshl_add_u32 v2, v2, 4, v3
    s_lshl_b32 s73, s72, 3
    s_add_u32 s73, s73, 37880
    v_add_u32 v2, s73, v2
    v_mov_b32 v3, 2146435072
    buffer_load_dwordx4 v206, s[44:47], s66 offen offset:1024 lds
    v_cmp_le_u32 vcc, 2160, v7
    s_nop 1
    v_cndmask_b32 v1, v1, v3, vcc
    v_cndmask_b32 v40, v40, v3, vcc
    v_cndmask_b32 v41, v1, v2, s[84:85]
    v_cndmask_b32 v42, v1, v3, s[84:85]
    s_mul_i32 s73, s60, 4096
    s_add_u32 s73, s73, 102400
    v_lshrrev_b32 v0, 2, v215
    v_and_b32 v1, 3, v215
    v_lshlrev_b32 v1, 3, v1
    v_lshl_add_u32 v0, v0, 7, v1
    v_add_u32 v43, s73, v0
    s_min_u32 s77, s77, 48
    s_mul_i32 s77, s77, 5
    s_lshl_b32 s78, s78, 2
    s_add_u32 s73, s78, 0
    s_mul_i32 s74, s73, 205
    s_lshr_b32 s74, s74, 10
    s_mul_i32 s74, s74, 255
    s_add_u32 s73, s73, s74
    s_add_u32 s73, s73, s77
    s_lshl_b32 s73, s73, 10
    s_add_u32 s73, s73, 221184
    s_cmp_lt_u32 s77, 240
    s_cselect_b32 s98, s73, 2146435072
    buffer_load_dwordx4 v207, s[44:47], s66 offen offset:2048 lds
    s_add_u32 s73, s78, 1
    s_mul_i32 s74, s73, 205
    s_lshr_b32 s74, s74, 10
    s_mul_i32 s74, s74, 255
    s_add_u32 s73, s73, s74
    s_add_u32 s73, s73, s77
    s_lshl_b32 s73, s73, 10
    s_add_u32 s73, s73, 221184
    s_cmp_lt_u32 s77, 240
    s_cselect_b32 s99, s73, 2146435072
    buffer_load_dwordx4 v208, s[44:47], s66 offen offset:3072 lds
    s_add_u32 s73, s78, 2
    s_mul_i32 s74, s73, 205
    s_lshr_b32 s74, s74, 10
    s_mul_i32 s74, s74, 255
    s_add_u32 s73, s73, s74
    s_add_u32 s73, s73, s77
    s_lshl_b32 s73, s73, 10
    s_add_u32 s73, s73, 221184
    s_cmp_lt_u32 s77, 240
    s_cselect_b32 s92, s73, 2146435072
    s_add_u32 s73, s78, 3
    s_mul_i32 s74, s73, 205
    s_lshr_b32 s74, s74, 10
    s_mul_i32 s74, s74, 255
    s_add_u32 s73, s73, s74
    s_add_u32 s73, s73, s77
    s_lshl_b32 s73, s73, 10
    s_add_u32 s73, s73, 221184
    s_cmp_lt_u32 s77, 240
    s_cselect_b32 s93, s73, 2146435072
    s_and_b32 s67, s83, 1
    s_xor_b32 s67, s67, 1
    s_lshl_b32 s65, s67, 7
    s_mul_i32 s66, s67, 196608
    s_add_u32 m0, s68, 51200
    s_nop 0
    buffer_load_dwordx4 v200, s[36:39], s65 offen offset:0 lds
    v_mov_b32 v45, 0x3f803f80
    s_waitcnt vmcnt(24)
    v_dot2_f32_bf16 v46, v16, v45, 0
    v_dot2_f32_bf16 v48, v16, v16, 0
    v_dot2_f32_bf16 v47, v17, v45, 0
    v_dot2_f32_bf16 v49, v17, v17, 0
    v_dot2_f32_bf16 v46, v18, v45, v46
    v_dot2_f32_bf16 v48, v18, v18, v48
    v_dot2_f32_bf16 v47, v19, v45, v47
    v_dot2_f32_bf16 v49, v19, v19, v49
    s_waitcnt vmcnt(23)
    v_dot2_f32_bf16 v46, v20, v45, v46
    v_dot2_f32_bf16 v48, v20, v20, v48
    v_dot2_f32_bf16 v47, v21, v45, v47
    v_dot2_f32_bf16 v49, v21, v21, v49
    buffer_load_dwordx4 v201, s[36:39], s65 offen offset:1024 lds
    v_dot2_f32_bf16 v46, v22, v45, v46
    v_dot2_f32_bf16 v48, v22, v22, v48
    v_dot2_f32_bf16 v47, v23, v45, v47
    v_dot2_f32_bf16 v49, v23, v23, v49
    s_waitcnt vmcnt(23)
    v_dot2_f32_bf16 v46, v24, v45, v46
    v_dot2_f32_bf16 v48, v24, v24, v48
    v_dot2_f32_bf16 v47, v25, v45, v47
    v_dot2_f32_bf16 v49, v25, v25, v49
    v_dot2_f32_bf16 v46, v26, v45, v46
    v_dot2_f32_bf16 v48, v26, v26, v48
    v_dot2_f32_bf16 v47, v27, v45, v47
    v_dot2_f32_bf16 v49, v27, v27, v49
    s_waitcnt vmcnt(22)
    v_dot2_f32_bf16 v46, v28, v45, v46
    v_dot2_f32_bf16 v48, v28, v28, v48
    v_dot2_f32_bf16 v47, v29, v45, v47
    v_dot2_f32_bf16 v49, v29, v29, v49
    v_dot2_f32_bf16 v46, v30, v45, v46
    v_dot2_f32_bf16 v48, v30, v30, v48
    buffer_load_dwordx4 v202, s[36:39], s65 offen offset:2048 lds
    v_dot2_f32_bf16 v47, v31, v45, v47
    v_dot2_f32_bf16 v49, v31, v31, v49
    s_waitcnt vmcnt(22)
    v_dot2_f32_bf16 v46, v32, v45, v46
    v_dot2_f32_bf16 v48, v32, v32, v48
    v_dot2_f32_bf16 v47, v33, v45, v47
    v_dot2_f32_bf16 v49, v33, v33, v49
    v_dot2_f32_bf16 v46, v34, v45, v46
    v_dot2_f32_bf16 v48, v34, v34, v48
    v_dot2_f32_bf16 v47, v35, v45, v47
    v_dot2_f32_bf16 v49, v35, v35, v49
    s_waitcnt vmcnt(18)
    ds_read_b64_tr_b16 v[60:61], v43 offset:0
    ds_read_b64_tr_b16 v[62:63], v43 offset:2048
    ds_read_b64_tr_b16 v[64:65], v43 offset:32
    ds_read_b64_tr_b16 v[66:67], v43 offset:2080
    ds_read_b64_tr_b16 v[68:69], v43 offset:64
    buffer_load_dwordx4 v203, s[36:39], s65 offen offset:3072 lds
    ds_read_b64_tr_b16 v[70:71], v43 offset:2112
    ds_read_b64_tr_b16 v[72:73], v43 offset:96
    ds_read_b64_tr_b16 v[74:75], v43 offset:2144
    v_add_f32 v55, v46, v47
    v_add_f32 v48, v48, v49
    s_nop 0
    v_add_f32_dpp v55, v55, v55 row_ror:8 row_mask:0xf bank_mask:0xf
    v_add_f32_dpp v48, v48, v48 row_ror:8 row_mask:0xf bank_mask:0xf
    s_nop 0
    v_add_f32_dpp v55, v55, v55 row_ror:4 row_mask:0xf bank_mask:0xf
    v_add_f32_dpp v48, v48, v48 row_ror:4 row_mask:0xf bank_mask:0xf
    s_nop 0
    v_add_f32_dpp v55, v55, v55 row_ror:2 row_mask:0xf bank_mask:0xf
    v_add_f32_dpp v48, v48, v48 row_ror:2 row_mask:0xf bank_mask:0xf
    s_nop 0
    v_add_f32_dpp v55, v55, v55 row_ror:1 row_mask:0xf bank_mask:0xf
    v_add_f32_dpp v48, v48, v48 row_ror:1 row_mask:0xf bank_mask:0xf
    v_mul_f32 v46, 986500301, v55
    v_mul_f32 v48, 986500301, v48
    v_fma_f32 v48, -v46, v46, v48
    v_max_f32 v48, 0, v48
    buffer_load_dwordx4 v204, s[36:39], s65 offen offset:3456 lds
    v_cvt_pk_bf16_f32 v48, v48, v48
    v_lshlrev_b32 v48, 16, v48
    v_add_f32 v48, 925353388, v48
    v_cvt_pk_bf16_f32 v48, v48, v48
    v_lshlrev_b32 v48, 16, v48
    v_sqrt_f32 v48, v48
    v_cvt_pk_bf16_f32 v52, v46, v46
    v_lshlrev_b32 v52, 16, v52
    v_cvt_pk_bf16_f32 v53, v48, v48
    v_lshlrev_b32 v53, 16, v53
    v_rcp_f32 v54, v53
    s_nop 0
    v_mul_f32 v50, v52, v54
    v_cndmask_b32 v51, v54, v55, s[84:85]
    s_waitcnt vmcnt(19)
    v_readfirstlane_b32 s82, v15
    s_nop 1
    s_mul_i32 s82, s82, 1664525
    s_add_u32 s82, s82, 1013904223
    s_add_u32 m0, s69, 51200
    s_nop 0
    buffer_load_dwordx4 v205, s[40:43], s66 offen offset:0 lds
    s_waitcnt lgkmcnt(6)
    buffer_store_dwordx4 v[60:63], v213, s[48:51], s98 offen sc1
    s_waitcnt lgkmcnt(4)
    buffer_store_dwordx4 v[64:67], v213, s[48:51], s99 offen sc1
    s_waitcnt lgkmcnt(2)
    buffer_store_dwordx4 v[68:71], v213, s[48:51], s92 offen sc1
    s_waitcnt lgkmcnt(0)
    buffer_store_dwordx4 v[72:75], v213, s[48:51], s93 offen sc1
    s_mov_b32 exec_lo, 0x00010001
    s_mov_b32 exec_hi, 0x00010001
    buffer_store_dwordx4 v[52:55], v40, s[48:51], 0 offen sc1
    buffer_store_dword v51, v41, s[48:51], 0 offen sc1
    buffer_store_dword v50, v42, s[48:51], 0 offen offset:144 sc1
    s_mov_b64 exec, -1
    s_mov_b64 s[56:57], s[30:31]
    s_mov_b32 s58, 5242880
    s_cmp_lt_u32 s60, 2
    s_cselect_b64 s[52:53], s[14:15], s[16:17]
    s_mov_b32 s54, 819200
    s_branch L_mainG
L_second:
    s_mov_b32 s76, 1280
    s_lshl_b32 s3, s61, 2
    s_add_u32 s3, s3, s60
    s_mul_i32 s70, s61, 15
    s_add_u32 s70, s70, s62
    s_lshl_b32 s74, s70, 1
    s_add_u32 s74, s74, s60
    s_add_u32 s74, s74, 193
    s_cmp_ge_u32 s60, 2
    s_cselect_b32 s74, s74, 351
    s_lshl_b32 s74, s74, 2
    s_cmp_ge_u32 s74, 640
    s_cselect_b32 s72, 2, 1
    s_cselect_b32 s75, 640, 0
    s_sub_u32 s75, s74, s75
    s_add_u32 s73, s74, 836
    s_cmp_ge_u32 s74, 1280
    s_cselect_b32 s73, s73, s75
    s_cselect_b32 s72, 0, s72
    s_cmp_eq_u32 s72, 0
    s_cselect_b32 s54, 1802240, 0
    s_add_u32 s54, s54, 819200
    v_lshlrev_b32 v213, 4, v215
    v_lshrrev_b32 v7, 4, v215
    v_add_u32 v7, s73, v7
    v_and_b32 v0, 0xff, v213
    v_mad_u32_u24 v6, v7, s76, v0
    v_mov_b32 v11, 47104
    s_lshl_b32 s73, s3, 5
    v_bfe_u32 v0, v215, 2, 2
    v_and_b32 v2, 3, v215
    v_lshl_add_u32 v0, v0, 3, v2
    v_add_lshl_u32 v10, v0, s73, 1
    s_mov_b32 s38, 2621440
    s_mov_b32 s39, 0x20000
    s_mov_b32 s42, 819200
    s_mov_b32 s43, 0x20000
    s_mov_b32 s46, 819200
    s_mov_b32 s47, 0x20000
    s_mov_b32 s50, 15228928
    s_mov_b32 s51, 0x20000
    s_mov_b32 s58, 1966080
    s_mov_b32 s59, 0x20000
    s_mov_b32 s55, 0x20000
    s_mul_i32 s73, s60, 36
    s_mul_i32 s74, s62, 144
    v_lshrrev_b32 v0, 3, v215
    v_and_b32 v1, 7, v215
    v_add_u32 v0, s73, v0
    v_bfe_u32 v2, v0, 1, 3
    v_xor_b32 v2, v2, v1
    v_bfe_u32 v3, v0, 2, 2
    v_mul_u32_u24 v3, 36, v3
    v_and_b32 v4, 1, v0
    v_mad_u32_u24 v3, v4, 18, v3
    v_lshrrev_b32 v4, 4, v0
    v_lshl_add_u32 v3, v4, 1, v3
    v_bfe_u32 v4, v0, 1, 1
    v_add3_u32 v3, v3, v4, s74
    v_lshlrev_b32 v2, 4, v2
    v_mad_u32_u24 v200, v3, s76, v2
    v_add_u32 v0, 8, v0
    v_bfe_u32 v2, v0, 1, 3
    v_xor_b32 v2, v2, v1
    v_bfe_u32 v3, v0, 2, 2
    v_mul_u32_u24 v3, 36, v3
    v_and_b32 v4, 1, v0
    v_mad_u32_u24 v3, v4, 18, v3
    v_lshrrev_b32 v4, 4, v0
    v_lshl_add_u32 v3, v4, 1, v3
    v_bfe_u32 v4, v0, 1, 1
    v_add3_u32 v3, v3, v4, s74
    v_lshlrev_b32 v2, 4, v2
    v_mad_u32_u24 v201, v3, s76, v2
    v_add_u32 v0, 20, v0
    v_bfe_u32 v2, v0, 1, 3
    v_xor_b32 v2, v2, v1
    v_bfe_u32 v3, v0, 2, 2
    v_mul_u32_u24 v3, 36, v3
    v_and_b32 v4, 1, v0
    v_mad_u32_u24 v3, v4, 18, v3
    v_lshrrev_b32 v4, 4, v0
    v_lshl_add_u32 v3, v4, 1, v3
    v_bfe_u32 v4, v0, 1, 1
    v_add3_u32 v3, v3, v4, s74
    v_lshlrev_b32 v2, 4, v2
    v_mad_u32_u24 v204, v3, s76, v2
    v_subrev_u32 v201, 1024, v201
    v_add_u32 v202, 512, v200
    v_add_u32 v203, 512, v201
    v_subrev_u32 v204, 3584, v204
    s_lshl_b32 s73, s3, 5
    v_lshrrev_b32 v0, 5, v215
    v_lshlrev_b32 v0, 3, v0
    v_bfe_u32 v2, v215, 3, 2
    v_add3_u32 v0, v0, v2, s73
    v_lshrrev_b32 v2, 4, v215
    v_xor_b32 v2, v2, v1
    v_lshlrev_b32 v2, 4, v2
    v_mad_u32_u24 v205, v0, s76, v2
    v_xor_b32 v2, 64, v205
    v_add_u32 v206, 19456, v2
    v_add_u32 v207, 3072, v205
    v_add_u32 v208, 3072, v206
    s_mul_i32 s69, s60, 8192
    s_add_u32 s69, s69, 18432
    s_mul_i32 s68, s60, 4608
    s_waitcnt lgkmcnt(0)
    s_cmp_eq_u32 s72, 1
    s_cselect_b64 s[52:53], s[10:11], s[12:13]
    s_cmp_eq_u32 s72, 0
    s_cselect_b64 s[52:53], s[4:5], s[52:53]
    s_mov_b64 s[56:57], s[28:29]
    s_mov_b64 s[36:37], s[4:5]
    s_mov_b64 s[48:49], s[34:35]
    s_mov_b64 s[40:41], s[10:11]
    s_mov_b64 s[44:45], s[12:13]
    global_load_ushort v100, v10, s[6:7]
    global_load_ushort v101, v10, s[6:7] offset:8
    global_load_ushort v102, v10, s[8:9]
    global_load_ushort v103, v10, s[8:9] offset:8
    global_load_ushort v104, v10, s[18:19]
    global_load_ushort v105, v10, s[18:19] offset:8
    buffer_load_dwordx4 v[16:19], v6, s[52:55], 0 offen offset:0
    buffer_load_dwordx4 v[20:23], v6, s[52:55], 0 offen offset:256
    buffer_load_dwordx4 v[24:27], v6, s[52:55], 0 offen offset:512
    buffer_load_dwordx4 v[28:31], v6, s[52:55], 0 offen offset:768
    buffer_load_dwordx4 v[32:35], v6, s[52:55], 0 offen offset:1024
    buffer_load_dword v15, v11, s[48:51], 0 offen sc1
    s_and_b32 s67, s83, 1
    s_lshl_b32 s65, s67, 7
    s_mul_i32 s66, s67, 128
    s_add_u32 m0, s68, 0
    s_nop 0
    buffer_load_dwordx4 v200, s[36:39], s65 offen offset:0 lds
    buffer_load_dwordx4 v201, s[36:39], s65 offen offset:1024 lds
    buffer_load_dwordx4 v202, s[36:39], s65 offen offset:2048 lds
    s_mov_b64 exec, 0
    s_cmp_eq_u32 s60, 0
    s_cbranch_scc1 L_padS0
    s_cmp_eq_u32 s60, 1
    s_cbranch_scc1 L_padS1
    s_cmp_eq_u32 s60, 2
    s_cbranch_scc1 L_padS2
    s_branch L_padS3
L_retS:
    s_mov_b64 exec, -1
    v_and_b32 v0, 15, v215
    v_lshrrev_b32 v1, 4, v215
    v_lshrrev_b32 v2, 1, v0
    v_xor_b32 v2, v2, v1
    v_lshlrev_b32 v2, 4, v2
    v_lshl_add_u32 v209, v0, 7, v2
    v_xor_b32 v210, 64, v209
    v_add_u32 v211, s69, v209
    v_add_u32 v212, s69, v210
    s_lshr_b32 s63, s71, 6
    s_lshl_b32 s63, s63, 3
    s_bfe_u32 s74, s71, 0x30002
    s_add_u32 s63, s63, s74
    s_bfe_u32 s64, s71, 0x10005
    s_lshl_b32 s64, s64, 2
    s_and_b32 s74, s71, 3
    s_add_u32 s64, s64, s74
    s_and_b32 s73, s64, 1
    s_mul_i32 s74, s73, 5120
    s_sub_u32 s74, 5120, s74
    v_add_u32 v214, s74, v213
    s_mul_i32 s97, s73, 102400
    s_sub_u32 s97, 20480, s97
    buffer_load_dwordx4 v203, s[36:39], s65 offen offset:3072 lds
    s_mul_i32 s73, s64, 102400
    v_lshrrev_b32 v0, 3, v215
    v_and_b32 v2, 7, v215
    v_lshrrev_b32 v3, 4, v215
    v_xor_b32 v2, v2, v3
    v_lshlrev_b32 v2, 4, v2
    v_mad_u32_u24 v0, v0, s76, v2
    v_add_u32 v253, s73, v0
    v_xor_b32 v0, 64, v253
    v_add_u32 v254, 9216, v0
    s_mul_i32 s81, s60, 10240
    v_add_u32 v249, s81, v209
    s_lshl_b32 s73, s63, 6
    s_add_u32 s74, s73, 63
    s_mul_i32 s73, s73, 1873
    s_lshr_b32 s73, s73, 18
    s_mul_i32 s74, s74, 1873
    s_lshr_b32 s74, s74, 18
    buffer_load_dwordx4 v204, s[36:39], s65 offen offset:3584 lds
    s_mul_i32 s73, s73, 48
    s_mul_i32 s74, s74, 48
    s_sub_u32 s74, s74, 12
    s_mul_i32 s75, s60, 12
    v_min_u32 v0, 23, v215
    v_mov_b32 v1, s73
    v_mov_b32 v2, s74
    v_cmp_gt_u32 vcc, 12, v0
    s_nop 1
    v_cndmask_b32 v1, v2, v1, vcc
    v_add3_u32 v0, v0, v1, s75
    v_lshlrev_b32 v0, 6, v0
    v_add_u32 v248, 68096, v0
    s_lshl_b32 s73, s63, 6
    s_add_u32 s74, s73, 63
    s_mul_i32 s73, s73, 1821
    s_lshr_b32 s73, s73, 18
    s_mul_i32 s74, s74, 1821
    s_lshr_b32 s74, s74, 18
    s_add_u32 m0, s69, 0
    s_nop 0
    buffer_load_dwordx4 v205, s[40:43], s66 offen offset:0 lds
    s_mul_i32 s73, s73, 20
    s_mul_i32 s74, s74, 20
    s_sub_u32 s74, s74, 10
    s_and_b32 s75, s60, 1
    s_mul_i32 s75, s75, 10
    v_min_u32 v0, 19, v215
    v_mov_b32 v1, s73
    v_mov_b32 v2, s74
    v_cmp_gt_u32 vcc, 10, v0
    s_nop 1
    v_cndmask_b32 v1, v2, v1, vcc
    v_add3_u32 v0, v0, v1, s75
    v_lshlrev_b32 v0, 6, v0
    v_add_u32 v250, 117248, v0
    s_and_b32 s96, s60, 1
    s_mul_i32 s96, s96, 640
    s_and_b32 s73, s64, 1
    s_mul_i32 s73, s73, 20480
    s_add_u32 s96, s96, s73
    buffer_load_dwordx4 v206, s[40:43], s66 offen offset:1024 lds
    s_mul_i32 s74, s62, 20
    s_add_u32 s74, s74, s3
    s_lshl_b32 s74, s74, 6
    s_add_u32 s95, s74, 117248
    s_mul_i32 s94, s3, 143360
    s_add_u32 s94, s94, 9232384
    s_cmp_eq_u32 s72, 0
    s_cselect_b32 s73, 0, 2146435072
    s_cselect_b64 s[84:85], 0, -1
    v_mov_b32 v40, s73
    v_mov_b32 v44, v7
    s_mov_b32 s73, 1821
    v_mul_u32_u24 v1, s73, v44
    v_lshrrev_b32 v1, 18, v1
    v_mul_u32_u24 v2, 144, v1
    v_sub_u32 v2, v44, v2
    v_mul_u32_u24 v3, 57, v2
    v_lshrrev_b32 v3, 10, v3
    buffer_load_dwordx4 v207, s[40:43], s66 offen offset:2048 lds
    v_mul_u32_u24 v4, 18, v3
    v_sub_u32 v4, v2, v4
    v_lshrrev_b32 v5, 1, v3
    v_cmp_gt_u32 vcc, 14, v1
    v_mul_u32_u24 v0, 36, v5
    v_sub_u32 v0, v2, v0
    v_and_b32 v0, 60, v0
    v_mul_u32_u24 v0, 3, v0
    v_lshlrev_b32 v2, 5, v5
    v_sub_u32 v0, v0, v2
    v_cndmask_b32 v0, 0, v0, vcc
    v_add_u32 v0, v0, v44
    v_lshl_add_u32 v40, v0, 4, v40
    v_lshl_add_u32 v1, v1, 2, v5
    v_mul_u32_u24 v1, 72, v1
    v_and_b32 v3, 1, v3
    v_lshl_add_u32 v3, v4, 1, v3
    v_add_lshl_u32 v1, v1, v3, 2
    v_add_u32 v1, 47360, v1
    buffer_load_dwordx4 v208, s[40:43], s66 offen offset:3072 lds
    v_lshrrev_b32 v2, 3, v7
    v_and_b32 v3, 3, v7
    v_lshl_add_u32 v2, v2, 2, v3
    v_and_b32 v3, 4, v7
    v_lshl_add_u32 v2, v2, 4, v3
    s_lshl_b32 s73, s72, 3
    s_add_u32 s73, s73, 37880
    v_add_u32 v2, s73, v2
    v_mov_b32 v3, 2146435072
    v_cmp_le_u32 vcc, 2160, v7
    s_nop 1
    v_cndmask_b32 v1, v1, v3, vcc
    v_cndmask_b32 v40, v40, v3, vcc
    v_cndmask_b32 v41, v1, v2, s[84:85]
    v_cndmask_b32 v42, v1, v3, s[84:85]
    s_waitcnt vmcnt(20)
    v_lshlrev_b32 v100, 16, v100
    s_waitcnt vmcnt(19)
    v_lshlrev_b32 v101, 16, v101
    s_waitcnt vmcnt(18)
    v_lshlrev_b32 v102, 16, v102
    s_waitcnt vmcnt(17)
    v_lshlrev_b32 v103, 16, v103
    s_add_u32 m0, s69, 4096
    s_nop 0
    buffer_load_dwordx4 v205, s[44:47], s66 offen offset:0 lds
    s_waitcnt vmcnt(17)
    v_lshlrev_b32 v104, 16, v104
    s_waitcnt vmcnt(16)
    v_lshlrev_b32 v105, 16, v105
    v_mul_f32 v104, 1069066811, v104
    v_exp_f32 v104, v104
    v_mul_f32 v105, 1069066811, v105
    v_exp_f32 v105, v105
    v_cvt_pk_bf16_f32 v104, v104, v104
    v_lshlrev_b32 v104, 16, v104
    v_cvt_pk_bf16_f32 v105, v105, v105
    v_lshlrev_b32 v105, 16, v105
    v_pk_mul_f32 v[106:107], v[104:105], v[100:101]
    v_pk_mul_f32 v[108:109], v[104:105], v[102:103]
    v_mul_f32 v106, 1069066811, v106
    v_exp_f32 v106, v106
    v_mul_f32 v108, 1042479491, v108
    v_rndne_f32 v110, v108
    v_sub_f32 v108, v108, v110
    v_cos_f32 v112, v108
    v_sin_f32 v114, v108
    buffer_load_dwordx4 v206, s[44:47], s66 offen offset:1024 lds
    v_mul_f32 v107, 1069066811, v107
    v_exp_f32 v107, v107
    v_mul_f32 v109, 1042479491, v109
    v_rndne_f32 v110, v109
    v_sub_f32 v109, v109, v110
    v_cos_f32 v113, v109
    v_sin_f32 v115, v109
    v_pk_mul_f32 v[216:217], v[106:107], v[112:113]
    v_pk_mul_f32 v[218:219], v[106:107], v[114:115]
    v_pk_mul_f32 v[106:107], v[100:101], v[100:101]
    v_pk_fma_f32 v[106:107], v[102:103], v[102:103], v[106:107]
    v_rcp_f32 v106, v106
    v_rcp_f32 v107, v107
    v_add_f32 v112, -1.0, v216
    v_add_f32 v113, -1.0, v217
    v_mov_b32 v114, v218
    v_mov_b32 v115, v219
    v_mul_f32 v106, 1068593688, v106
    v_mul_f32 v107, 1068593688, v107
    buffer_load_dwordx4 v207, s[44:47], s66 offen offset:2048 lds
    v_pk_mul_f32 v[100:101], v[100:101], v[106:107]
    v_pk_mul_f32 v[102:103], v[102:103], v[106:107] neg_lo:[1,0] neg_hi:[1,0]
    v_pk_mul_f32 v[220:221], v[112:113], v[100:101]
    v_pk_mul_f32 v[222:223], v[112:113], v[102:103]
    v_pk_fma_f32 v[220:221], v[114:115], v[102:103], v[220:221] neg_lo:[1,0,0] neg_hi:[1,0,0]
    v_pk_fma_f32 v[222:223], v[114:115], v[100:101], v[222:223]
    v_pk_mul_f32 v[100:101], v[216:217], v[216:217]
    v_pk_mul_f32 v[102:103], v[216:217], v[218:219]
    v_pk_fma_f32 v[100:101], v[218:219], v[218:219], v[100:101] neg_lo:[1,0,0] neg_hi:[1,0,0]
    v_pk_fma_f32 v[102:103], v[218:219], v[216:217], v[102:103]
    v_pk_mul_f32 v[104:105], v[100:101], v[100:101]
    v_pk_mul_f32 v[106:107], v[100:101], v[102:103]
    v_pk_fma_f32 v[104:105], v[102:103], v[102:103], v[104:105] neg_lo:[1,0,0] neg_hi:[1,0,0]
    v_pk_fma_f32 v[106:107], v[102:103], v[100:101], v[106:107]
    v_pk_mul_f32 v[108:109], v[104:105], v[104:105]
    v_pk_mul_f32 v[110:111], v[104:105], v[106:107]
    v_pk_fma_f32 v[108:109], v[106:107], v[106:107], v[108:109] neg_lo:[1,0,0] neg_hi:[1,0,0]
    v_pk_fma_f32 v[110:111], v[106:107], v[104:105], v[110:111]
    buffer_load_dwordx4 v208, s[44:47], s66 offen offset:3072 lds
    v_pk_mul_f32 v[104:105], v[108:109], v[108:109]
    v_pk_mul_f32 v[106:107], v[108:109], v[110:111]
    v_pk_fma_f32 v[104:105], v[110:111], v[110:111], v[104:105] neg_lo:[1,0,0] neg_hi:[1,0,0]
    v_pk_fma_f32 v[106:107], v[110:111], v[108:109], v[106:107]
    v_pk_mul_f32 v[224:225], v[104:105], v[100:101]
    v_pk_mul_f32 v[226:227], v[104:105], v[102:103]
    v_pk_fma_f32 v[224:225], v[106:107], v[102:103], v[224:225] neg_lo:[1,0,0] neg_hi:[1,0,0]
    v_pk_fma_f32 v[226:227], v[106:107], v[100:101], v[226:227]
    v_pk_mul_f32 v[228:229], v[224:225], v[224:225]
    v_pk_mul_f32 v[230:231], v[224:225], v[226:227]
    v_pk_fma_f32 v[228:229], v[226:227], v[226:227], v[228:229] neg_lo:[1,0,0] neg_hi:[1,0,0]
    v_pk_fma_f32 v[230:231], v[226:227], v[224:225], v[230:231]
    v_pk_mul_f32 v[100:101], v[228:229], v[228:229]
    v_pk_mul_f32 v[102:103], v[228:229], v[230:231]
    v_pk_fma_f32 v[100:101], v[230:231], v[230:231], v[100:101] neg_lo:[1,0,0] neg_hi:[1,0,0]
    v_pk_fma_f32 v[102:103], v[230:231], v[228:229], v[102:103]
    v_pk_mul_f32 v[104:105], v[100:101], v[228:229]
    v_pk_mul_f32 v[106:107], v[100:101], v[230:231]
    v_pk_fma_f32 v[104:105], v[102:103], v[230:231], v[104:105] neg_lo:[1,0,0] neg_hi:[1,0,0]
    v_pk_fma_f32 v[106:107], v[102:103], v[228:229], v[106:107]
    s_and_b32 s67, s83, 1
    s_xor_b32 s67, s67, 1
    s_lshl_b32 s65, s67, 7
    s_mul_i32 s66, s67, 128
    s_add_u32 m0, s68, 51200
    s_nop 0
    buffer_load_dwordx4 v200, s[36:39], s65 offen offset:0 lds
    v_cmp_le_u32 s[86:87], 16, v215
    v_cmp_le_u32 s[88:89], 32, v215
    v_cmp_le_u32 s[90:91], 48, v215
    v_mov_b32 v108, 1.0
    v_mov_b32 v109, 1.0
    v_mov_b32 v110, 0
    v_mov_b32 v111, 0
    v_cndmask_b32 v232, v104, v100, s[86:87]
    v_cndmask_b32 v233, v105, v101, s[86:87]
    v_cndmask_b32 v234, v106, v102, s[86:87]
    v_cndmask_b32 v235, v107, v103, s[86:87]
    v_cndmask_b32 v232, v232, v228, s[88:89]
    v_cndmask_b32 v233, v233, v229, s[88:89]
    v_cndmask_b32 v234, v234, v230, s[88:89]
    v_cndmask_b32 v235, v235, v231, s[88:89]
    v_cndmask_b32 v232, v232, v108, s[90:91]
    v_cndmask_b32 v233, v233, v109, s[90:91]
    v_cndmask_b32 v234, v234, v110, s[90:91]
    v_cndmask_b32 v235, v235, v111, s[90:91]
    buffer_load_dwordx4 v201, s[36:39], s65 offen offset:1024 lds
    v_mov_b32 v45, 0x3f803f80
    s_waitcnt vmcnt(20)
    v_dot2_f32_bf16 v46, v16, v45, 0
    v_dot2_f32_bf16 v48, v16, v16, 0
    v_dot2_f32_bf16 v47, v17, v45, 0
    v_dot2_f32_bf16 v49, v17, v17, 0
    v_dot2_f32_bf16 v46, v18, v45, v46
    v_dot2_f32_bf16 v48, v18, v18, v48
    v_dot2_f32_bf16 v47, v19, v45, v47
    v_dot2_f32_bf16 v49, v19, v19, v49
    s_waitcnt vmcnt(19)
    v_dot2_f32_bf16 v46, v20, v45, v46
    v_dot2_f32_bf16 v48, v20, v20, v48
    v_dot2_f32_bf16 v47, v21, v45, v47
    v_dot2_f32_bf16 v49, v21, v21, v49
    v_dot2_f32_bf16 v46, v22, v45, v46
    v_dot2_f32_bf16 v48, v22, v22, v48
    v_dot2_f32_bf16 v47, v23, v45, v47
    v_dot2_f32_bf16 v49, v23, v23, v49
    buffer_load_dwordx4 v202, s[36:39], s65 offen offset:2048 lds
    s_waitcnt vmcnt(19)
    v_dot2_f32_bf16 v46, v24, v45, v46
    v_dot2_f32_bf16 v48, v24, v24, v48
    v_dot2_f32_bf16 v47, v25, v45, v47
    v_dot2_f32_bf16 v49, v25, v25, v49
    v_dot2_f32_bf16 v46, v26, v45, v46
    v_dot2_f32_bf16 v48, v26, v26, v48
    v_dot2_f32_bf16 v47, v27, v45, v47
    v_dot2_f32_bf16 v49, v27, v27, v49
    s_waitcnt vmcnt(18)
    v_dot2_f32_bf16 v46, v28, v45, v46
    v_dot2_f32_bf16 v48, v28, v28, v48
    v_dot2_f32_bf16 v47, v29, v45, v47
    v_dot2_f32_bf16 v49, v29, v29, v49
    v_dot2_f32_bf16 v46, v30, v45, v46
    v_dot2_f32_bf16 v48, v30, v30, v48
    v_dot2_f32_bf16 v47, v31, v45, v47
    v_dot2_f32_bf16 v49, v31, v31, v49
    s_waitcnt vmcnt(17)
    v_dot2_f32_bf16 v46, v32, v45, v46
    v_dot2_f32_bf16 v48, v32, v32, v48
    v_dot2_f32_bf16 v47, v33, v45, v47
    v_dot2_f32_bf16 v49, v33, v33, v49
    buffer_load_dwordx4 v203, s[36:39], s65 offen offset:3072 lds
    v_dot2_f32_bf16 v46, v34, v45, v46
    v_dot2_f32_bf16 v48, v34, v34, v48
    v_dot2_f32_bf16 v47, v35, v45, v47
    v_dot2_f32_bf16 v49, v35, v35, v49
    s_nop 1
    v_add_f32 v55, v46, v47
    v_add_f32 v48, v48, v49
    s_nop 0
    v_add_f32_dpp v55, v55, v55 row_ror:8 row_mask:0xf bank_mask:0xf
    v_add_f32_dpp v48, v48, v48 row_ror:8 row_mask:0xf bank_mask:0xf
    s_nop 0
    v_add_f32_dpp v55, v55, v55 row_ror:4 row_mask:0xf bank_mask:0xf
    v_add_f32_dpp v48, v48, v48 row_ror:4 row_mask:0xf bank_mask:0xf
    s_nop 0
    v_add_f32_dpp v55, v55, v55 row_ror:2 row_mask:0xf bank_mask:0xf
    v_add_f32_dpp v48, v48, v48 row_ror:2 row_mask:0xf bank_mask:0xf
    s_nop 0
    v_add_f32_dpp v55, v55, v55 row_ror:1 row_mask:0xf bank_mask:0xf
    v_add_f32_dpp v48, v48, v48 row_ror:1 row_mask:0xf bank_mask:0xf
    v_mul_f32 v46, 986500301, v55
    v_mul_f32 v48, 986500301, v48
    v_fma_f32 v48, -v46, v46, v48
    v_max_f32 v48, 0, v48
    buffer_load_dwordx4 v204, s[36:39], s65 offen offset:3584 lds
    v_cvt_pk_bf16_f32 v48, v48, v48
    v_lshlrev_b32 v48, 16, v48
    v_add_f32 v48, 925353388, v48
    v_cvt_pk_bf16_f32 v48, v48, v48
    v_lshlrev_b32 v48, 16, v48
    v_sqrt_f32 v48, v48
    v_cvt_pk_bf16_f32 v52, v46, v46
    v_lshlrev_b32 v52, 16, v52
    v_cvt_pk_bf16_f32 v53, v48, v48
    v_lshlrev_b32 v53, 16, v53
    v_rcp_f32 v54, v53
    s_nop 0
    v_mul_f32 v50, v52, v54
    v_cndmask_b32 v51, v54, v55, s[84:85]
    s_waitcnt vmcnt(18)
    v_readfirstlane_b32 s82, v15
    s_nop 1
    s_mul_i32 s82, s82, 1664525
    s_add_u32 s82, s82, 1013904223
    s_add_u32 m0, s69, 51200
    s_nop 0
    buffer_load_dwordx4 v205, s[40:43], s66 offen offset:0 lds
    s_lshl_b32 s74, s3, 4
    s_add_u32 s74, s74, s62
    s_lshl_b32 s74, s74, 8
    s_add_u32 s79, s74, 137728
    v_mov_b32 v13, -1
    v_lshlrev_b32 v14, 2, v215
    buffer_store_dword v13, v14, s[48:51], s79 offen sc1
    s_mov_b32 exec_lo, 0x00010001
    s_mov_b32 exec_hi, 0x00010001
    buffer_store_dwordx4 v[52:55], v40, s[48:51], 0 offen sc1
    buffer_store_dword v51, v41, s[48:51], 0 offen sc1
    buffer_store_dword v50, v42, s[48:51], 0 offen offset:144 sc1
    s_mov_b64 exec, -1
    s_mov_b64 s[56:57], s[30:31]
    s_mov_b32 s58, 5242880
    s_cmp_lt_u32 s60, 2
    s_cselect_b64 s[52:53], s[14:15], s[16:17]
    s_mov_b32 s54, 819200
    s_branch L_mainS
L_end:
    s_endpgm
.p2align 12
L_mainG:
L_padG0:
    s_cbranch_execz L_padG4
    s_waitcnt vmcnt(13)
    s_barrier
    ds_read_b64_tr_b16 v[168:169], v211 offset:0
    ds_read_b64_tr_b16 v[170:171], v211 offset:1024
    ds_read_b128 v[144:147], v209 offset:0
    ds_read_b64_tr_b16 v[172:173], v211 offset:8192
    ds_read_b64_tr_b16 v[174:175], v211 offset:9216
    ds_read_b128 v[148:151], v210 offset:0
    ds_read_b64_tr_b16 v[180:181], v211 offset:24576
    ds_read_b64_tr_b16 v[182:183], v211 offset:25600
    ds_read_b64_tr_b16 v[176:177], v211 offset:16384
    ds_read_b64_tr_b16 v[178:179], v211 offset:17408
    ds_read_b64_tr_b16 v[184:185], v212 offset:0
    ds_read_b64_tr_b16 v[186:187], v212 offset:1024
    ds_read_b64_tr_b16 v[188:189], v212 offset:8192
    ds_read_b64_tr_b16 v[190:191], v212 offset:9216
    ds_read_b64_tr_b16 v[196:197], v212 offset:24576
    ds_read_b64_tr_b16 v[198:199], v212 offset:25600
    ds_read_b64_tr_b16 v[192:193], v212 offset:16384
    ds_read_b64_tr_b16 v[194:195], v212 offset:17408
    ds_read_b128 v[152:155], v209 offset:2048
    ds_read_b128 v[156:159], v210 offset:2048
    s_waitcnt lgkmcnt(15)
    v_mfma_f32_16x16x32_bf16 v[0:3], v[168:171], v[144:147], 0
    s_waitcnt lgkmcnt(14)
    ds_read_b128 v[160:163], v209 offset:4096
    buffer_load_dwordx4 v206, s[40:43], s66 offen offset:1024 lds
    v_mfma_f32_16x16x32_bf16 v[0:3], v[172:175], v[148:151], v[0:3]
    s_waitcnt lgkmcnt(13)
    ds_read_b128 v[164:167], v210 offset:4096
    v_mfma_f32_16x16x32_bf16 v[4:7], v[180:183], v[148:151], 0
    s_waitcnt lgkmcnt(12)
    buffer_load_dwordx4 v207, s[40:43], s66 offen offset:2048 lds
    v_mfma_f32_16x16x32_bf16 v[4:7], v[176:179], v[144:147], v[4:7]
    s_waitcnt lgkmcnt(10)
    v_mfma_f32_16x16x32_bf16 v[8:11], v[184:187], v[144:147], 0
    s_waitcnt lgkmcnt(8)
    v_mfma_f32_16x16x32_bf16 v[8:11], v[188:191], v[148:151], v[8:11]
    s_waitcnt lgkmcnt(6)
    v_mfma_f32_16x16x32_bf16 v[12:15], v[196:199], v[148:151], 0
    s_waitcnt lgkmcnt(4)
    buffer_load_dwordx4 v208, s[40:43], s66 offen offset:3072 lds
    v_mfma_f32_16x16x32_bf16 v[12:15], v[192:195], v[144:147], v[12:15]
    s_waitcnt lgkmcnt(3)
    v_mfma_f32_16x16x32_bf16 v[28:31], v[192:195], v[152:155], 0
    s_waitcnt lgkmcnt(2)
    ds_read_b128 v[144:147], v209 offset:6144
    v_mfma_f32_16x16x32_bf16 v[28:31], v[196:199], v[156:159], v[28:31]
    s_add_u32 m0, s69, 67584
    ds_read_b128 v[148:151], v210 offset:6144
    v_mfma_f32_16x16x32_bf16 v[24:27], v[188:191], v[156:159], 0
    buffer_load_dwordx4 v205, s[44:47], s66 offen offset:0 lds
    v_mfma_f32_16x16x32_bf16 v[24:27], v[184:187], v[152:155], v[24:27]
    v_mfma_f32_16x16x32_bf16 v[20:23], v[176:179], v[152:155], 0
    v_mfma_f32_16x16x32_bf16 v[20:23], v[180:183], v[156:159], v[20:23]
    v_mfma_f32_16x16x32_bf16 v[16:19], v[172:175], v[156:159], 0
    buffer_load_dwordx4 v206, s[44:47], s66 offen offset:1024 lds
    v_mfma_f32_16x16x32_bf16 v[16:19], v[168:171], v[152:155], v[16:19]
    s_waitcnt lgkmcnt(3)
    v_mfma_f32_16x16x32_bf16 v[32:35], v[168:171], v[160:163], 0
    s_waitcnt lgkmcnt(2)
    ds_read_b128 v[152:155], v209 offset:8192
    v_mfma_f32_16x16x32_bf16 v[32:35], v[172:175], v[164:167], v[32:35]
    ds_read_b128 v[156:159], v210 offset:8192
    v_mfma_f32_16x16x32_bf16 v[36:39], v[180:183], v[164:167], 0
    buffer_load_dwordx4 v207, s[44:47], s66 offen offset:2048 lds
    v_mfma_f32_16x16x32_bf16 v[36:39], v[176:179], v[160:163], v[36:39]
    v_mfma_f32_16x16x32_bf16 v[40:43], v[184:187], v[160:163], 0
    v_mfma_f32_16x16x32_bf16 v[40:43], v[188:191], v[164:167], v[40:43]
    v_mfma_f32_16x16x32_bf16 v[44:47], v[196:199], v[164:167], 0
    buffer_load_dwordx4 v208, s[44:47], s66 offen offset:3072 lds
    v_mfma_f32_16x16x32_bf16 v[44:47], v[192:195], v[160:163], v[44:47]
    s_and_b32 s67, s83, 3
    s_add_u32 s67, s67, 2
    s_waitcnt lgkmcnt(3)
    v_mfma_f32_16x16x32_bf16 v[60:63], v[192:195], v[144:147], 0
    s_lshl_b32 s65, s67, 7
    s_waitcnt lgkmcnt(2)
    ds_read_b128 v[160:163], v209 offset:10240
    v_mfma_f32_16x16x32_bf16 v[60:63], v[196:199], v[148:151], v[60:63]
    s_mul_i32 s66, s67, 196608
    s_add_u32 m0, s68, 102400
    ds_read_b128 v[164:167], v210 offset:10240
    v_mfma_f32_16x16x32_bf16 v[56:59], v[188:191], v[148:151], 0
    buffer_load_dwordx4 v200, s[36:39], s65 offen offset:0 lds
    v_mfma_f32_16x16x32_bf16 v[56:59], v[184:187], v[144:147], v[56:59]
    v_mfma_f32_16x16x32_bf16 v[52:55], v[176:179], v[144:147], 0
    v_mfma_f32_16x16x32_bf16 v[52:55], v[180:183], v[148:151], v[52:55]
    v_mfma_f32_16x16x32_bf16 v[48:51], v[172:175], v[148:151], 0
    buffer_load_dwordx4 v201, s[36:39], s65 offen offset:1024 lds
    v_mfma_f32_16x16x32_bf16 v[48:51], v[168:171], v[144:147], v[48:51]
    s_waitcnt lgkmcnt(3)
    v_mfma_f32_16x16x32_bf16 v[64:67], v[168:171], v[152:155], 0
    s_waitcnt lgkmcnt(2)
    ds_read_b128 v[144:147], v209 offset:12288
    v_mfma_f32_16x16x32_bf16 v[64:67], v[172:175], v[156:159], v[64:67]
    ds_read_b128 v[148:151], v210 offset:12288
    v_mfma_f32_16x16x32_bf16 v[68:71], v[180:183], v[156:159], 0
    buffer_load_dwordx4 v202, s[36:39], s65 offen offset:2048 lds
    v_mfma_f32_16x16x32_bf16 v[68:71], v[176:179], v[152:155], v[68:71]
    v_mfma_f32_16x16x32_bf16 v[72:75], v[184:187], v[152:155], 0
    buffer_load_dwordx4 v203, s[36:39], s65 offen offset:3072 lds
    v_mfma_f32_16x16x32_bf16 v[72:75], v[188:191], v[156:159], v[72:75]
    v_mfma_f32_16x16x32_bf16 v[76:79], v[196:199], v[156:159], 0
    buffer_load_dwordx4 v204, s[36:39], s65 offen offset:3456 lds
    v_mfma_f32_16x16x32_bf16 v[76:79], v[192:195], v[152:155], v[76:79]
    s_waitcnt lgkmcnt(3)
    v_mfma_f32_16x16x32_bf16 v[92:95], v[192:195], v[160:163], 0
    s_waitcnt lgkmcnt(2)
    ds_read_b128 v[152:155], v209 offset:14336
    v_mfma_f32_16x16x32_bf16 v[92:95], v[196:199], v[164:167], v[92:95]
    s_add_u32 m0, s69, 102400
    ds_read_b128 v[156:159], v210 offset:14336
    v_mfma_f32_16x16x32_bf16 v[88:91], v[188:191], v[164:167], 0
    buffer_load_dwordx4 v205, s[40:43], s66 offen offset:0 lds
    v_mfma_f32_16x16x32_bf16 v[88:91], v[184:187], v[160:163], v[88:91]
    v_mfma_f32_16x16x32_bf16 v[84:87], v[176:179], v[160:163], 0
    v_mfma_f32_16x16x32_bf16 v[84:87], v[180:183], v[164:167], v[84:87]
    v_mov_b32 v240, s82
    v_and_b32 v241, 0, v215
    v_mfma_f32_16x16x32_bf16 v[80:83], v[172:175], v[164:167], 0
    buffer_load_dwordx4 v206, s[40:43], s66 offen offset:1024 lds
    v_mfma_f32_16x16x32_bf16 v[80:83], v[168:171], v[160:163], v[80:83]
    s_waitcnt lgkmcnt(3)
    v_mfma_f32_16x16x32_bf16 v[96:99], v[168:171], v[144:147], 0
    s_waitcnt lgkmcnt(2)
    ds_read_b128 v[160:163], v209 offset:16384
    v_mfma_f32_16x16x32_bf16 v[96:99], v[172:175], v[148:151], v[96:99]
    ds_read_b128 v[164:167], v210 offset:16384
    v_mfma_f32_16x16x32_bf16 v[100:103], v[180:183], v[148:151], 0
    buffer_load_dwordx4 v207, s[40:43], s66 offen offset:2048 lds
    v_mfma_f32_16x16x32_bf16 v[100:103], v[176:179], v[144:147], v[100:103]
    v_add_u32 v211, 51200, v211
    v_add_u32 v209, 51200, v209
    v_mfma_f32_16x16x32_bf16 v[104:107], v[184:187], v[144:147], 0
    v_add_u32 v212, 51200, v212
    v_add_u32 v210, 51200, v210
    v_mfma_f32_16x16x32_bf16 v[104:107], v[188:191], v[148:151], v[104:107]
    v_mfma_f32_16x16x32_bf16 v[108:111], v[196:199], v[148:151], 0
    buffer_load_dwordx4 v208, s[40:43], s66 offen offset:3072 lds
    v_mfma_f32_16x16x32_bf16 v[108:111], v[192:195], v[144:147], v[108:111]
    s_waitcnt vmcnt(9) lgkmcnt(0)
    s_barrier
    ds_read_b64_tr_b16 a[224:225], v211 offset:0
    v_mfma_f32_16x16x32_bf16 v[124:127], v[192:195], v[152:155], 0
    s_add_u32 m0, s69, 118784
    s_lshl_b32 s74, s2, 4
    ds_read_b64_tr_b16 a[226:227], v211 offset:1024
    v_mfma_f32_16x16x32_bf16 v[124:127], v[196:199], v[156:159], v[124:127]
    s_add_u32 s74, s74, 43008
    s_cmp_eq_u32 s60, 0
    ds_read_b128 v[144:147], v209 offset:0
    v_mfma_f32_16x16x32_bf16 v[120:123], v[188:191], v[156:159], 0
    s_cselect_b32 s74, s74, 2146435072
    ds_read_b64_tr_b16 a[228:229], v211 offset:8192
    buffer_load_dwordx4 v205, s[44:47], s66 offen offset:0 lds
    v_mfma_f32_16x16x32_bf16 v[120:123], v[184:187], v[152:155], v[120:123]
    ds_read_b64_tr_b16 a[230:231], v211 offset:9216
    buffer_store_dword v240, v241, s[48:51], s74 offen sc1
    v_mfma_f32_16x16x32_bf16 v[116:119], v[176:179], v[152:155], 0
    ds_read_b128 v[148:151], v210 offset:0
    v_mfma_f32_16x16x32_bf16 v[116:119], v[180:183], v[156:159], v[116:119]
    ds_read_b64_tr_b16 a[236:237], v211 offset:24576
    v_mfma_f32_16x16x32_bf16 v[112:115], v[172:175], v[156:159], 0
    ds_read_b64_tr_b16 a[238:239], v211 offset:25600
    buffer_load_dwordx4 v206, s[44:47], s66 offen offset:1024 lds
    v_mfma_f32_16x16x32_bf16 v[112:115], v[168:171], v[152:155], v[112:115]
    ds_read_b64_tr_b16 a[232:233], v211 offset:16384
    v_mfma_f32_16x16x32_bf16 v[128:131], v[168:171], v[160:163], 0
    ds_read_b64_tr_b16 a[234:235], v211 offset:17408
    v_mfma_f32_16x16x32_bf16 v[128:131], v[172:175], v[164:167], v[128:131]
    ds_read_b64_tr_b16 a[240:241], v212 offset:0
    v_mfma_f32_16x16x32_bf16 v[132:135], v[180:183], v[164:167], 0
    ds_read_b64_tr_b16 a[242:243], v212 offset:1024
    buffer_load_dwordx4 v207, s[44:47], s66 offen offset:2048 lds
    v_mfma_f32_16x16x32_bf16 v[132:135], v[176:179], v[160:163], v[132:135]
    ds_read_b64_tr_b16 a[244:245], v212 offset:8192
    v_mfma_f32_16x16x32_bf16 v[136:139], v[184:187], v[160:163], 0
    ds_read_b64_tr_b16 a[246:247], v212 offset:9216
    v_mfma_f32_16x16x32_bf16 v[136:139], v[188:191], v[164:167], v[136:139]
    s_and_b32 s67, s83, 3
    s_xor_b32 s67, s67, 1
    ds_read_b64_tr_b16 a[252:253], v212 offset:24576
    v_mfma_f32_16x16x32_bf16 v[140:143], v[196:199], v[164:167], 0
    s_add_u32 s67, s67, 2
    ds_read_b64_tr_b16 a[254:255], v212 offset:25600
    buffer_load_dwordx4 v208, s[44:47], s66 offen offset:3072 lds
    v_mfma_f32_16x16x32_bf16 v[140:143], v[192:195], v[160:163], v[140:143]
    s_lshl_b32 s65, s67, 7
    s_waitcnt lgkmcnt(13)
    ds_read_b64_tr_b16 a[248:249], v212 offset:16384
    v_mfma_f32_16x16x32_bf16 v[0:3], a[224:227], v[144:147], v[0:3]
    s_mul_i32 s66, s67, 196608
    s_waitcnt lgkmcnt(11)
    ds_read_b64_tr_b16 a[250:251], v212 offset:17408
    v_mfma_f32_16x16x32_bf16 v[0:3], a[228:231], v[148:151], v[0:3]
    s_add_u32 m0, s68, 0
    s_waitcnt lgkmcnt(10)
    ds_read_b128 v[152:155], v209 offset:2048
    v_mfma_f32_16x16x32_bf16 v[4:7], a[236:239], v[148:151], v[4:7]
    s_waitcnt lgkmcnt(9)
    ds_read_b128 v[156:159], v210 offset:2048
    buffer_load_dwordx4 v200, s[36:39], s65 offen offset:0 lds
    v_mfma_f32_16x16x32_bf16 v[4:7], a[232:235], v[144:147], v[4:7]
    s_waitcnt lgkmcnt(8)
    v_mfma_f32_16x16x32_bf16 v[8:11], a[240:243], v[144:147], v[8:11]
    s_waitcnt lgkmcnt(6)
    ds_read_b128 v[160:163], v209 offset:4096
    v_mfma_f32_16x16x32_bf16 v[8:11], a[244:247], v[148:151], v[8:11]
    s_waitcnt lgkmcnt(5)
    ds_read_b128 v[164:167], v210 offset:4096
    v_mfma_f32_16x16x32_bf16 v[12:15], a[252:255], v[148:151], v[12:15]
    s_waitcnt lgkmcnt(4)
    buffer_load_dwordx4 v201, s[36:39], s65 offen offset:1024 lds
    v_mfma_f32_16x16x32_bf16 v[12:15], a[248:251], v[144:147], v[12:15]
    s_waitcnt lgkmcnt(3)
    v_mfma_f32_16x16x32_bf16 v[28:31], a[248:251], v[152:155], v[28:31]
    s_waitcnt lgkmcnt(2)
    ds_read_b128 v[144:147], v209 offset:6144
    v_mfma_f32_16x16x32_bf16 v[28:31], a[252:255], v[156:159], v[28:31]
    ds_read_b128 v[148:151], v210 offset:6144
    v_mfma_f32_16x16x32_bf16 v[24:27], a[244:247], v[156:159], v[24:27]
    buffer_load_dwordx4 v202, s[36:39], s65 offen offset:2048 lds
    v_mfma_f32_16x16x32_bf16 v[24:27], a[240:243], v[152:155], v[24:27]
    v_mfma_f32_16x16x32_bf16 v[20:23], a[232:235], v[152:155], v[20:23]
    v_mfma_f32_16x16x32_bf16 v[20:23], a[236:239], v[156:159], v[20:23]
    v_mfma_f32_16x16x32_bf16 v[16:19], a[228:231], v[156:159], v[16:19]
    buffer_load_dwordx4 v203, s[36:39], s65 offen offset:3072 lds
    v_mfma_f32_16x16x32_bf16 v[16:19], a[224:227], v[152:155], v[16:19]
    s_waitcnt lgkmcnt(3)
    v_mfma_f32_16x16x32_bf16 v[32:35], a[224:227], v[160:163], v[32:35]
    s_waitcnt lgkmcnt(2)
    ds_read_b128 v[152:155], v209 offset:8192
    v_mfma_f32_16x16x32_bf16 v[32:35], a[228:231], v[164:167], v[32:35]
    ds_read_b128 v[156:159], v210 offset:8192
    v_mfma_f32_16x16x32_bf16 v[36:39], a[236:239], v[164:167], v[36:39]
    buffer_load_dwordx4 v204, s[36:39], s65 offen offset:3456 lds
    v_mfma_f32_16x16x32_bf16 v[36:39], a[232:235], v[160:163], v[36:39]
    v_mfma_f32_16x16x32_bf16 v[40:43], a[240:243], v[160:163], v[40:43]
    v_mfma_f32_16x16x32_bf16 v[40:43], a[244:247], v[164:167], v[40:43]
    s_add_u32 m0, s69, 0
    v_mfma_f32_16x16x32_bf16 v[44:47], a[252:255], v[164:167], v[44:47]
    buffer_load_dwordx4 v205, s[40:43], s66 offen offset:0 lds
    v_mfma_f32_16x16x32_bf16 v[44:47], a[248:251], v[160:163], v[44:47]
    s_waitcnt lgkmcnt(3)
    v_mfma_f32_16x16x32_bf16 v[60:63], a[248:251], v[144:147], v[60:63]
    s_waitcnt lgkmcnt(2)
    ds_read_b128 v[160:163], v209 offset:10240
    v_mfma_f32_16x16x32_bf16 v[60:63], a[252:255], v[148:151], v[60:63]
    ds_read_b128 v[164:167], v210 offset:10240
    v_mfma_f32_16x16x32_bf16 v[56:59], a[244:247], v[148:151], v[56:59]
    buffer_load_dwordx4 v206, s[40:43], s66 offen offset:1024 lds
    v_mfma_f32_16x16x32_bf16 v[56:59], a[240:243], v[144:147], v[56:59]
    v_mfma_f32_16x16x32_bf16 v[52:55], a[232:235], v[144:147], v[52:55]
    v_mfma_f32_16x16x32_bf16 v[52:55], a[236:239], v[148:151], v[52:55]
    v_mfma_f32_16x16x32_bf16 v[48:51], a[228:231], v[148:151], v[48:51]
    buffer_load_dwordx4 v207, s[40:43], s66 offen offset:2048 lds
    v_mfma_f32_16x16x32_bf16 v[48:51], a[224:227], v[144:147], v[48:51]
    s_waitcnt lgkmcnt(3)
    v_mfma_f32_16x16x32_bf16 v[64:67], a[224:227], v[152:155], v[64:67]
    s_waitcnt lgkmcnt(2)
    ds_read_b128 v[144:147], v209 offset:12288
    v_mfma_f32_16x16x32_bf16 v[64:67], a[228:231], v[156:159], v[64:67]
    ds_read_b128 v[148:151], v210 offset:12288
    v_mfma_f32_16x16x32_bf16 v[68:71], a[236:239], v[156:159], v[68:71]
    buffer_load_dwordx4 v208, s[40:43], s66 offen offset:3072 lds
    v_mfma_f32_16x16x32_bf16 v[68:71], a[232:235], v[152:155], v[68:71]
    v_mfma_f32_16x16x32_bf16 v[72:75], a[240:243], v[152:155], v[72:75]
    v_mfma_f32_16x16x32_bf16 v[72:75], a[244:247], v[156:159], v[72:75]
    s_add_u32 m0, s69, 16384
    v_mfma_f32_16x16x32_bf16 v[76:79], a[252:255], v[156:159], v[76:79]
    buffer_load_dwordx4 v205, s[44:47], s66 offen offset:0 lds
    v_mfma_f32_16x16x32_bf16 v[76:79], a[248:251], v[152:155], v[76:79]
    s_waitcnt lgkmcnt(3)
    v_mfma_f32_16x16x32_bf16 v[92:95], a[248:251], v[160:163], v[92:95]
    s_waitcnt lgkmcnt(2)
    ds_read_b128 v[152:155], v209 offset:14336
    v_mfma_f32_16x16x32_bf16 v[92:95], a[252:255], v[164:167], v[92:95]
    ds_read_b128 v[156:159], v210 offset:14336
    v_mfma_f32_16x16x32_bf16 v[88:91], a[244:247], v[164:167], v[88:91]
    buffer_load_dwordx4 v206, s[44:47], s66 offen offset:1024 lds
    v_mfma_f32_16x16x32_bf16 v[88:91], a[240:243], v[160:163], v[88:91]
    v_mfma_f32_16x16x32_bf16 v[84:87], a[232:235], v[160:163], v[84:87]
    v_mfma_f32_16x16x32_bf16 v[84:87], a[236:239], v[164:167], v[84:87]
    v_mfma_f32_16x16x32_bf16 v[80:83], a[228:231], v[164:167], v[80:83]
    buffer_load_dwordx4 v207, s[44:47], s66 offen offset:2048 lds
    v_mfma_f32_16x16x32_bf16 v[80:83], a[224:227], v[160:163], v[80:83]
    s_waitcnt lgkmcnt(3)
    v_mfma_f32_16x16x32_bf16 v[96:99], a[224:227], v[144:147], v[96:99]
    s_waitcnt lgkmcnt(2)
    ds_read_b128 v[160:163], v209 offset:16384
    v_mfma_f32_16x16x32_bf16 v[96:99], a[228:231], v[148:151], v[96:99]
    ds_read_b128 v[164:167], v210 offset:16384
    v_mfma_f32_16x16x32_bf16 v[100:103], a[236:239], v[148:151], v[100:103]
    buffer_load_dwordx4 v208, s[44:47], s66 offen offset:3072 lds
    v_mfma_f32_16x16x32_bf16 v[100:103], a[232:235], v[144:147], v[100:103]
    v_add_u32 v211, 51200, v211
    v_add_u32 v209, 51200, v209
    v_mfma_f32_16x16x32_bf16 v[104:107], a[240:243], v[144:147], v[104:107]
    v_add_u32 v212, 51200, v212
    v_add_u32 v210, 51200, v210
    v_mfma_f32_16x16x32_bf16 v[104:107], a[244:247], v[148:151], v[104:107]
    v_mfma_f32_16x16x32_bf16 v[108:111], a[252:255], v[148:151], v[108:111]
    v_mfma_f32_16x16x32_bf16 v[108:111], a[248:251], v[144:147], v[108:111]
    s_waitcnt vmcnt(13) lgkmcnt(0)
    s_barrier
    ds_read_b64_tr_b16 v[168:169], v211 offset:0
    v_mfma_f32_16x16x32_bf16 v[124:127], a[248:251], v[152:155], v[124:127]
    ds_read_b64_tr_b16 v[170:171], v211 offset:1024
    v_mfma_f32_16x16x32_bf16 v[124:127], a[252:255], v[156:159], v[124:127]
    ds_read_b128 v[144:147], v209 offset:0
    v_mfma_f32_16x16x32_bf16 v[120:123], a[244:247], v[156:159], v[120:123]
    ds_read_b64_tr_b16 v[172:173], v211 offset:8192
    v_mfma_f32_16x16x32_bf16 v[120:123], a[240:243], v[152:155], v[120:123]
    ds_read_b64_tr_b16 v[174:175], v211 offset:9216
    v_mfma_f32_16x16x32_bf16 v[116:119], a[232:235], v[152:155], v[116:119]
    ds_read_b128 v[148:151], v210 offset:0
    v_mfma_f32_16x16x32_bf16 v[116:119], a[236:239], v[156:159], v[116:119]
    ds_read_b64_tr_b16 v[180:181], v211 offset:24576
    v_mfma_f32_16x16x32_bf16 v[112:115], a[228:231], v[156:159], v[112:115]
    ds_read_b64_tr_b16 v[182:183], v211 offset:25600
    v_mfma_f32_16x16x32_bf16 v[112:115], a[224:227], v[152:155], v[112:115]
    ds_read_b64_tr_b16 v[176:177], v211 offset:16384
    v_mfma_f32_16x16x32_bf16 v[128:131], a[224:227], v[160:163], v[128:131]
    ds_read_b64_tr_b16 v[178:179], v211 offset:17408
    v_mfma_f32_16x16x32_bf16 v[128:131], a[228:231], v[164:167], v[128:131]
    ds_read_b64_tr_b16 v[184:185], v212 offset:0
    v_mfma_f32_16x16x32_bf16 v[132:135], a[236:239], v[164:167], v[132:135]
    ds_read_b64_tr_b16 v[186:187], v212 offset:1024
    v_mfma_f32_16x16x32_bf16 v[132:135], a[232:235], v[160:163], v[132:135]
    ds_read_b64_tr_b16 v[188:189], v212 offset:8192
    v_mfma_f32_16x16x32_bf16 v[136:139], a[240:243], v[160:163], v[136:139]
    ds_read_b64_tr_b16 v[190:191], v212 offset:9216
    v_mfma_f32_16x16x32_bf16 v[136:139], a[244:247], v[164:167], v[136:139]
    s_and_b32 s67, s83, 3
    ds_read_b64_tr_b16 v[196:197], v212 offset:24576
    v_mfma_f32_16x16x32_bf16 v[140:143], a[252:255], v[164:167], v[140:143]
    s_xor_b32 s67, s67, 2
    s_add_u32 s67, s67, 2
    ds_read_b64_tr_b16 v[198:199], v212 offset:25600
    v_mfma_f32_16x16x32_bf16 v[140:143], a[248:251], v[160:163], v[140:143]
    s_lshl_b32 s65, s67, 7
    s_waitcnt lgkmcnt(13)
    ds_read_b64_tr_b16 v[192:193], v212 offset:16384
    v_mfma_f32_16x16x32_bf16 v[0:3], v[168:171], v[144:147], v[0:3]
    s_mul_i32 s66, s67, 196608
    s_waitcnt lgkmcnt(11)
    ds_read_b64_tr_b16 v[194:195], v212 offset:17408
    v_mfma_f32_16x16x32_bf16 v[0:3], v[172:175], v[148:151], v[0:3]
    s_add_u32 m0, s68, 51200
    s_waitcnt lgkmcnt(10)
    ds_read_b128 v[152:155], v209 offset:2048
    v_mfma_f32_16x16x32_bf16 v[4:7], v[180:183], v[148:151], v[4:7]
    s_waitcnt lgkmcnt(9)
    ds_read_b128 v[156:159], v210 offset:2048
    buffer_load_dwordx4 v200, s[36:39], s65 offen offset:0 lds
    v_mfma_f32_16x16x32_bf16 v[4:7], v[176:179], v[144:147], v[4:7]
    s_waitcnt lgkmcnt(8)
    v_mfma_f32_16x16x32_bf16 v[8:11], v[184:187], v[144:147], v[8:11]
    s_waitcnt lgkmcnt(6)
    ds_read_b128 v[160:163], v209 offset:4096
    v_mfma_f32_16x16x32_bf16 v[8:11], v[188:191], v[148:151], v[8:11]
    s_waitcnt lgkmcnt(5)
    ds_read_b128 v[164:167], v210 offset:4096
    v_mfma_f32_16x16x32_bf16 v[12:15], v[196:199], v[148:151], v[12:15]
    s_waitcnt lgkmcnt(4)
    buffer_load_dwordx4 v201, s[36:39], s65 offen offset:1024 lds
    v_mfma_f32_16x16x32_bf16 v[12:15], v[192:195], v[144:147], v[12:15]
    s_waitcnt lgkmcnt(3)
    v_mfma_f32_16x16x32_bf16 v[28:31], v[192:195], v[152:155], v[28:31]
    s_waitcnt lgkmcnt(2)
    ds_read_b128 v[144:147], v209 offset:6144
    v_mfma_f32_16x16x32_bf16 v[28:31], v[196:199], v[156:159], v[28:31]
    ds_read_b128 v[148:151], v210 offset:6144
    v_mfma_f32_16x16x32_bf16 v[24:27], v[188:191], v[156:159], v[24:27]
    buffer_load_dwordx4 v202, s[36:39], s65 offen offset:2048 lds
    v_mfma_f32_16x16x32_bf16 v[24:27], v[184:187], v[152:155], v[24:27]
    v_mfma_f32_16x16x32_bf16 v[20:23], v[176:179], v[152:155], v[20:23]
    v_mfma_f32_16x16x32_bf16 v[20:23], v[180:183], v[156:159], v[20:23]
    v_mfma_f32_16x16x32_bf16 v[16:19], v[172:175], v[156:159], v[16:19]
    buffer_load_dwordx4 v203, s[36:39], s65 offen offset:3072 lds
    v_mfma_f32_16x16x32_bf16 v[16:19], v[168:171], v[152:155], v[16:19]
    s_waitcnt lgkmcnt(3)
    v_mfma_f32_16x16x32_bf16 v[32:35], v[168:171], v[160:163], v[32:35]
    s_waitcnt lgkmcnt(2)
    ds_read_b128 v[152:155], v209 offset:8192
    v_mfma_f32_16x16x32_bf16 v[32:35], v[172:175], v[164:167], v[32:35]
    ds_read_b128 v[156:159], v210 offset:8192
    v_mfma_f32_16x16x32_bf16 v[36:39], v[180:183], v[164:167], v[36:39]
    buffer_load_dwordx4 v204, s[36:39], s65 offen offset:3456 lds
    v_mfma_f32_16x16x32_bf16 v[36:39], v[176:179], v[160:163], v[36:39]
    v_mfma_f32_16x16x32_bf16 v[40:43], v[184:187], v[160:163], v[40:43]
    v_mfma_f32_16x16x32_bf16 v[40:43], v[188:191], v[164:167], v[40:43]
    s_add_u32 m0, s69, 51200
    v_mfma_f32_16x16x32_bf16 v[44:47], v[196:199], v[164:167], v[44:47]
    buffer_load_dwordx4 v205, s[40:43], s66 offen offset:0 lds
    v_mfma_f32_16x16x32_bf16 v[44:47], v[192:195], v[160:163], v[44:47]
    s_waitcnt lgkmcnt(3)
    v_mfma_f32_16x16x32_bf16 v[60:63], v[192:195], v[144:147], v[60:63]
    s_waitcnt lgkmcnt(2)
    ds_read_b128 v[160:163], v209 offset:10240
    v_mfma_f32_16x16x32_bf16 v[60:63], v[196:199], v[148:151], v[60:63]
    ds_read_b128 v[164:167], v210 offset:10240
    v_mfma_f32_16x16x32_bf16 v[56:59], v[188:191], v[148:151], v[56:59]
    buffer_load_dwordx4 v206, s[40:43], s66 offen offset:1024 lds
    v_mfma_f32_16x16x32_bf16 v[56:59], v[184:187], v[144:147], v[56:59]
    v_mfma_f32_16x16x32_bf16 v[52:55], v[176:179], v[144:147], v[52:55]
    v_mfma_f32_16x16x32_bf16 v[52:55], v[180:183], v[148:151], v[52:55]
    v_mfma_f32_16x16x32_bf16 v[48:51], v[172:175], v[148:151], v[48:51]
    buffer_load_dwordx4 v207, s[40:43], s66 offen offset:2048 lds
    v_mfma_f32_16x16x32_bf16 v[48:51], v[168:171], v[144:147], v[48:51]
    s_waitcnt lgkmcnt(3)
    v_mfma_f32_16x16x32_bf16 v[64:67], v[168:171], v[152:155], v[64:67]
    s_waitcnt lgkmcnt(2)
    ds_read_b128 v[144:147], v209 offset:12288
    v_mfma_f32_16x16x32_bf16 v[64:67], v[172:175], v[156:159], v[64:67]
    ds_read_b128 v[148:151], v210 offset:12288
    v_mfma_f32_16x16x32_bf16 v[68:71], v[180:183], v[156:159], v[68:71]
    buffer_load_dwordx4 v208, s[40:43], s66 offen offset:3072 lds
    v_mfma_f32_16x16x32_bf16 v[68:71], v[176:179], v[152:155], v[68:71]
    v_mfma_f32_16x16x32_bf16 v[72:75], v[184:187], v[152:155], v[72:75]
    v_mfma_f32_16x16x32_bf16 v[72:75], v[188:191], v[156:159], v[72:75]
    s_add_u32 m0, s69, 67584
    v_mfma_f32_16x16x32_bf16 v[76:79], v[196:199], v[156:159], v[76:79]
    buffer_load_dwordx4 v205, s[44:47], s66 offen offset:0 lds
    v_mfma_f32_16x16x32_bf16 v[76:79], v[192:195], v[152:155], v[76:79]
    s_waitcnt lgkmcnt(3)
    v_mfma_f32_16x16x32_bf16 v[92:95], v[192:195], v[160:163], v[92:95]
    s_waitcnt lgkmcnt(2)
    ds_read_b128 v[152:155], v209 offset:14336
    v_mfma_f32_16x16x32_bf16 v[92:95], v[196:199], v[164:167], v[92:95]
    ds_read_b128 v[156:159], v210 offset:14336
    v_mfma_f32_16x16x32_bf16 v[88:91], v[188:191], v[164:167], v[88:91]
    buffer_load_dwordx4 v206, s[44:47], s66 offen offset:1024 lds
    v_mfma_f32_16x16x32_bf16 v[88:91], v[184:187], v[160:163], v[88:91]
    v_mfma_f32_16x16x32_bf16 v[84:87], v[176:179], v[160:163], v[84:87]
    v_mfma_f32_16x16x32_bf16 v[84:87], v[180:183], v[164:167], v[84:87]
    v_mfma_f32_16x16x32_bf16 v[80:83], v[172:175], v[164:167], v[80:83]
    buffer_load_dwordx4 v207, s[44:47], s66 offen offset:2048 lds
    v_mfma_f32_16x16x32_bf16 v[80:83], v[168:171], v[160:163], v[80:83]
    s_waitcnt lgkmcnt(3)
    v_mfma_f32_16x16x32_bf16 v[96:99], v[168:171], v[144:147], v[96:99]
    s_waitcnt lgkmcnt(2)
    ds_read_b128 v[160:163], v209 offset:16384
    v_mfma_f32_16x16x32_bf16 v[96:99], v[172:175], v[148:151], v[96:99]
    ds_read_b128 v[164:167], v210 offset:16384
    v_mfma_f32_16x16x32_bf16 v[100:103], v[180:183], v[148:151], v[100:103]
    buffer_load_dwordx4 v208, s[44:47], s66 offen offset:3072 lds
    v_mfma_f32_16x16x32_bf16 v[100:103], v[176:179], v[144:147], v[100:103]
    v_subrev_u32 v211, 102400, v211
    v_subrev_u32 v209, 102400, v209
    v_mfma_f32_16x16x32_bf16 v[104:107], v[184:187], v[144:147], v[104:107]
    v_subrev_u32 v212, 102400, v212
    v_subrev_u32 v210, 102400, v210
    v_mfma_f32_16x16x32_bf16 v[104:107], v[188:191], v[148:151], v[104:107]
    v_mfma_f32_16x16x32_bf16 v[108:111], v[196:199], v[148:151], v[108:111]
    v_mfma_f32_16x16x32_bf16 v[108:111], v[192:195], v[144:147], v[108:111]
    s_waitcnt vmcnt(13) lgkmcnt(0)
    s_barrier
    ds_read_b64_tr_b16 a[224:225], v211 offset:0
    v_mfma_f32_16x16x32_bf16 v[124:127], v[192:195], v[152:155], v[124:127]
    ds_read_b64_tr_b16 a[226:227], v211 offset:1024
    v_mfma_f32_16x16x32_bf16 v[124:127], v[196:199], v[156:159], v[124:127]
    ds_read_b128 v[144:147], v209 offset:0
    v_mfma_f32_16x16x32_bf16 v[120:123], v[188:191], v[156:159], v[120:123]
    ds_read_b64_tr_b16 a[228:229], v211 offset:8192
    v_mfma_f32_16x16x32_bf16 v[120:123], v[184:187], v[152:155], v[120:123]
    ds_read_b64_tr_b16 a[230:231], v211 offset:9216
    v_mfma_f32_16x16x32_bf16 v[116:119], v[176:179], v[152:155], v[116:119]
    ds_read_b128 v[148:151], v210 offset:0
    v_mfma_f32_16x16x32_bf16 v[116:119], v[180:183], v[156:159], v[116:119]
    ds_read_b64_tr_b16 a[236:237], v211 offset:24576
    v_mfma_f32_16x16x32_bf16 v[112:115], v[172:175], v[156:159], v[112:115]
    ds_read_b64_tr_b16 a[238:239], v211 offset:25600
    v_mfma_f32_16x16x32_bf16 v[112:115], v[168:171], v[152:155], v[112:115]
    ds_read_b64_tr_b16 a[232:233], v211 offset:16384
    v_mfma_f32_16x16x32_bf16 v[128:131], v[168:171], v[160:163], v[128:131]
    ds_read_b64_tr_b16 a[234:235], v211 offset:17408
    v_mfma_f32_16x16x32_bf16 v[128:131], v[172:175], v[164:167], v[128:131]
    ds_read_b64_tr_b16 a[240:241], v212 offset:0
    v_mfma_f32_16x16x32_bf16 v[132:135], v[180:183], v[164:167], v[132:135]
    ds_read_b64_tr_b16 a[242:243], v212 offset:1024
    v_mfma_f32_16x16x32_bf16 v[132:135], v[176:179], v[160:163], v[132:135]
    ds_read_b64_tr_b16 a[244:245], v212 offset:8192
    v_mfma_f32_16x16x32_bf16 v[136:139], v[184:187], v[160:163], v[136:139]
    ds_read_b64_tr_b16 a[246:247], v212 offset:9216
    v_mfma_f32_16x16x32_bf16 v[136:139], v[188:191], v[164:167], v[136:139]
    s_and_b32 s67, s83, 3
    ds_read_b64_tr_b16 a[252:253], v212 offset:24576
    v_mfma_f32_16x16x32_bf16 v[140:143], v[196:199], v[164:167], v[140:143]
    s_xor_b32 s67, s67, 3
    s_add_u32 s67, s67, 2
    ds_read_b64_tr_b16 a[254:255], v212 offset:25600
    v_mfma_f32_16x16x32_bf16 v[140:143], v[192:195], v[160:163], v[140:143]
    s_lshl_b32 s65, s67, 7
    s_waitcnt lgkmcnt(13)
    ds_read_b64_tr_b16 a[248:249], v212 offset:16384
    v_mfma_f32_16x16x32_bf16 v[0:3], a[224:227], v[144:147], v[0:3]
    s_mul_i32 s66, s67, 196608
    s_waitcnt lgkmcnt(11)
    ds_read_b64_tr_b16 a[250:251], v212 offset:17408
    v_mfma_f32_16x16x32_bf16 v[0:3], a[228:231], v[148:151], v[0:3]
    s_add_u32 m0, s68, 102400
    s_waitcnt lgkmcnt(10)
    ds_read_b128 v[152:155], v209 offset:2048
    v_mfma_f32_16x16x32_bf16 v[4:7], a[236:239], v[148:151], v[4:7]
    s_waitcnt lgkmcnt(9)
    ds_read_b128 v[156:159], v210 offset:2048
    buffer_load_dwordx4 v200, s[36:39], s65 offen offset:0 lds
    v_mfma_f32_16x16x32_bf16 v[4:7], a[232:235], v[144:147], v[4:7]
    s_waitcnt lgkmcnt(8)
    v_mfma_f32_16x16x32_bf16 v[8:11], a[240:243], v[144:147], v[8:11]
    s_waitcnt lgkmcnt(6)
    ds_read_b128 v[160:163], v209 offset:4096
    v_mfma_f32_16x16x32_bf16 v[8:11], a[244:247], v[148:151], v[8:11]
    s_waitcnt lgkmcnt(5)
    ds_read_b128 v[164:167], v210 offset:4096
    v_mfma_f32_16x16x32_bf16 v[12:15], a[252:255], v[148:151], v[12:15]
    s_waitcnt lgkmcnt(4)
    buffer_load_dwordx4 v201, s[36:39], s65 offen offset:1024 lds
    v_mfma_f32_16x16x32_bf16 v[12:15], a[248:251], v[144:147], v[12:15]
    s_waitcnt lgkmcnt(3)
    v_mfma_f32_16x16x32_bf16 v[28:31], a[248:251], v[152:155], v[28:31]
    s_waitcnt lgkmcnt(2)
    ds_read_b128 v[144:147], v209 offset:6144
    v_mfma_f32_16x16x32_bf16 v[28:31], a[252:255], v[156:159], v[28:31]
    ds_read_b128 v[148:151], v210 offset:6144
    v_mfma_f32_16x16x32_bf16 v[24:27], a[244:247], v[156:159], v[24:27]
    buffer_load_dwordx4 v202, s[36:39], s65 offen offset:2048 lds
    v_mfma_f32_16x16x32_bf16 v[24:27], a[240:243], v[152:155], v[24:27]
    v_mfma_f32_16x16x32_bf16 v[20:23], a[232:235], v[152:155], v[20:23]
    v_mfma_f32_16x16x32_bf16 v[20:23], a[236:239], v[156:159], v[20:23]
    v_mfma_f32_16x16x32_bf16 v[16:19], a[228:231], v[156:159], v[16:19]
    buffer_load_dwordx4 v203, s[36:39], s65 offen offset:3072 lds
    v_mfma_f32_16x16x32_bf16 v[16:19], a[224:227], v[152:155], v[16:19]
    s_waitcnt lgkmcnt(3)
    v_mfma_f32_16x16x32_bf16 v[32:35], a[224:227], v[160:163], v[32:35]
    s_waitcnt lgkmcnt(2)
    ds_read_b128 v[152:155], v209 offset:8192
    v_mfma_f32_16x16x32_bf16 v[32:35], a[228:231], v[164:167], v[32:35]
    ds_read_b128 v[156:159], v210 offset:8192
    v_mfma_f32_16x16x32_bf16 v[36:39], a[236:239], v[164:167], v[36:39]
    buffer_load_dwordx4 v204, s[36:39], s65 offen offset:3456 lds
    v_mfma_f32_16x16x32_bf16 v[36:39], a[232:235], v[160:163], v[36:39]
    v_mfma_f32_16x16x32_bf16 v[40:43], a[240:243], v[160:163], v[40:43]
    v_mfma_f32_16x16x32_bf16 v[40:43], a[244:247], v[164:167], v[40:43]
    s_lshl_b32 s73, s60, 10
    s_add_u32 s73, s73, 43008
    v_mfma_f32_16x16x32_bf16 v[44:47], a[252:255], v[164:167], v[44:47]
    buffer_load_dword v252, v213, s[48:51], s73 offen sc1
    v_mfma_f32_16x16x32_bf16 v[44:47], a[248:251], v[160:163], v[44:47]
    s_waitcnt lgkmcnt(3)
    v_mfma_f32_16x16x32_bf16 v[60:63], a[248:251], v[144:147], v[60:63]
    s_waitcnt lgkmcnt(2)
    ds_read_b128 v[160:163], v209 offset:10240
    v_mfma_f32_16x16x32_bf16 v[60:63], a[252:255], v[148:151], v[60:63]
    s_add_u32 m0, s69, 102400
    ds_read_b128 v[164:167], v210 offset:10240
    v_mfma_f32_16x16x32_bf16 v[56:59], a[244:247], v[148:151], v[56:59]
    buffer_load_dwordx4 v205, s[40:43], s66 offen offset:0 lds
    v_mfma_f32_16x16x32_bf16 v[56:59], a[240:243], v[144:147], v[56:59]
    v_mfma_f32_16x16x32_bf16 v[52:55], a[232:235], v[144:147], v[52:55]
    s_mul_i32 s98, s62, 2240
    s_mul_i32 s99, s60, 576
L_padG1:
    s_cbranch_execz L_padG5
    v_mfma_f32_16x16x32_bf16 v[52:55], a[236:239], v[148:151], v[52:55]
    s_add_u32 s98, s98, s99
    s_add_u32 s98, s98, 0
    v_mfma_f32_16x16x32_bf16 v[48:51], a[228:231], v[148:151], v[48:51]
    buffer_load_dwordx4 v206, s[40:43], s66 offen offset:1024 lds
    v_mfma_f32_16x16x32_bf16 v[48:51], a[224:227], v[144:147], v[48:51]
    s_waitcnt lgkmcnt(3)
    v_mfma_f32_16x16x32_bf16 v[64:67], a[224:227], v[152:155], v[64:67]
    s_waitcnt lgkmcnt(2)
    ds_read_b128 v[144:147], v209 offset:12288
    v_mfma_f32_16x16x32_bf16 v[64:67], a[228:231], v[156:159], v[64:67]
    ds_read_b128 v[148:151], v210 offset:12288
    v_mfma_f32_16x16x32_bf16 v[68:71], a[236:239], v[156:159], v[68:71]
    buffer_load_dwordx4 v207, s[40:43], s66 offen offset:2048 lds
    v_mfma_f32_16x16x32_bf16 v[68:71], a[232:235], v[152:155], v[68:71]
    v_mfma_f32_16x16x32_bf16 v[72:75], a[240:243], v[152:155], v[72:75]
    v_mfma_f32_16x16x32_bf16 v[72:75], a[244:247], v[156:159], v[72:75]
    s_mov_b32 s75, 47104
    s_or_b32 s74, s60, s2
    s_cselect_b32 s74, 2146435072, s75
    v_mfma_f32_16x16x32_bf16 v[76:79], a[252:255], v[156:159], v[76:79]
    buffer_load_dwordx4 v208, s[40:43], s66 offen offset:3072 lds
    v_mfma_f32_16x16x32_bf16 v[76:79], a[248:251], v[152:155], v[76:79]
    s_waitcnt lgkmcnt(3)
    v_mfma_f32_16x16x32_bf16 v[92:95], a[248:251], v[160:163], v[92:95]
    s_waitcnt lgkmcnt(2)
    ds_read_b128 v[152:155], v209 offset:14336
    v_mfma_f32_16x16x32_bf16 v[92:95], a[252:255], v[164:167], v[92:95]
    s_add_u32 m0, s69, 118784
    ds_read_b128 v[156:159], v210 offset:14336
    v_mfma_f32_16x16x32_bf16 v[88:91], a[244:247], v[164:167], v[88:91]
    buffer_load_dwordx4 v205, s[44:47], s66 offen offset:0 lds
    v_mfma_f32_16x16x32_bf16 v[88:91], a[240:243], v[160:163], v[88:91]
    v_mfma_f32_16x16x32_bf16 v[84:87], a[232:235], v[160:163], v[84:87]
    v_mfma_f32_16x16x32_bf16 v[84:87], a[236:239], v[164:167], v[84:87]
    v_mov_b32 v240, s82
    v_and_b32 v241, 0, v215
    v_mfma_f32_16x16x32_bf16 v[80:83], a[228:231], v[164:167], v[80:83]
    buffer_load_dwordx4 v206, s[44:47], s66 offen offset:1024 lds
    v_mfma_f32_16x16x32_bf16 v[80:83], a[224:227], v[160:163], v[80:83]
    s_waitcnt lgkmcnt(3)
    v_mfma_f32_16x16x32_bf16 v[96:99], a[224:227], v[144:147], v[96:99]
    s_waitcnt lgkmcnt(2)
    ds_read_b128 v[160:163], v209 offset:16384
    v_mfma_f32_16x16x32_bf16 v[96:99], a[228:231], v[148:151], v[96:99]
    ds_read_b128 v[164:167], v210 offset:16384
    v_mfma_f32_16x16x32_bf16 v[100:103], a[236:239], v[148:151], v[100:103]
    buffer_load_dwordx4 v207, s[44:47], s66 offen offset:2048 lds
    v_mfma_f32_16x16x32_bf16 v[100:103], a[232:235], v[144:147], v[100:103]
    v_add_u32 v211, 51200, v211
    v_add_u32 v209, 51200, v209
    v_mfma_f32_16x16x32_bf16 v[104:107], a[240:243], v[144:147], v[104:107]
    v_add_u32 v212, 51200, v212
    v_add_u32 v210, 51200, v210
    v_mfma_f32_16x16x32_bf16 v[104:107], a[244:247], v[148:151], v[104:107]
    s_waitcnt vmcnt(7)
    v_cmp_ne_u32 vcc, s82, v252
    v_mfma_f32_16x16x32_bf16 v[108:111], a[252:255], v[148:151], v[108:111]
    buffer_load_dwordx4 v208, s[44:47], s66 offen offset:3072 lds
    v_mfma_f32_16x16x32_bf16 v[108:111], a[248:251], v[144:147], v[108:111]
    s_cbranch_vccnz L_slow_3
L_ok_1:
    s_waitcnt lgkmcnt(0)
    s_barrier
    ds_read_b64_tr_b16 v[168:169], v211 offset:0
    v_mfma_f32_16x16x32_bf16 v[124:127], a[248:251], v[152:155], v[124:127]
    ds_read_b64_tr_b16 v[170:171], v211 offset:1024
    buffer_store_dword v240, v241, s[48:51], s74 offen sc1
    v_mfma_f32_16x16x32_bf16 v[124:127], a[252:255], v[156:159], v[124:127]
    s_add_u32 m0, s99, 153600
    s_mul_i32 s76, s64, 52
    ds_read_b128 v[144:147], v209 offset:0
    v_mfma_f32_16x16x32_bf16 v[120:123], a[244:247], v[156:159], v[120:123]
    s_mul_i32 s75, s60, 12
    ds_read_b64_tr_b16 v[172:173], v211 offset:8192
    buffer_load_dwordx4 v213, s[48:51], s98 offen sc1 lds
    v_mfma_f32_16x16x32_bf16 v[120:123], a[240:243], v[152:155], v[120:123]
    s_add_u32 s76, s76, s75
    s_mul_i32 s76, s76, 5
    ds_read_b64_tr_b16 v[174:175], v211 offset:9216
    v_mfma_f32_16x16x32_bf16 v[116:119], a[232:235], v[152:155], v[116:119]
    s_and_b32 s75, s64, 1
    s_add_u32 s76, s76, s75
    ds_read_b128 v[148:151], v210 offset:0
    v_mfma_f32_16x16x32_bf16 v[116:119], a[236:239], v[156:159], v[116:119]
    s_lshl_b32 s76, s76, 10
    s_add_u32 s78, s76, 221184
    ds_read_b64_tr_b16 v[180:181], v211 offset:24576
    v_mfma_f32_16x16x32_bf16 v[112:115], a[228:231], v[156:159], v[112:115]
    ds_read_b64_tr_b16 v[182:183], v211 offset:25600
    buffer_load_dwordx4 a[0:3], v213, s[48:51], s78 offen offset:0 sc1
    v_mfma_f32_16x16x32_bf16 v[112:115], a[224:227], v[152:155], v[112:115]
    ds_read_b64_tr_b16 v[176:177], v211 offset:16384
    v_mfma_f32_16x16x32_bf16 v[128:131], a[224:227], v[160:163], v[128:131]
    ds_read_b64_tr_b16 v[178:179], v211 offset:17408
    v_mfma_f32_16x16x32_bf16 v[128:131], a[228:231], v[164:167], v[128:131]
    ds_read_b64_tr_b16 v[184:185], v212 offset:0
    v_mfma_f32_16x16x32_bf16 v[132:135], a[236:239], v[164:167], v[132:135]
    ds_read_b64_tr_b16 v[186:187], v212 offset:1024
    buffer_load_dwordx4 a[4:7], v213, s[48:51], s78 offen offset:1024 sc1
    v_mfma_f32_16x16x32_bf16 v[132:135], a[232:235], v[160:163], v[132:135]
    ds_read_b64_tr_b16 v[188:189], v212 offset:8192
    v_mfma_f32_16x16x32_bf16 v[136:139], a[240:243], v[160:163], v[136:139]
    ds_read_b64_tr_b16 v[190:191], v212 offset:9216
    v_mfma_f32_16x16x32_bf16 v[136:139], a[244:247], v[164:167], v[136:139]
    s_and_b32 s67, s83, 3
    ds_read_b64_tr_b16 v[196:197], v212 offset:24576
    v_mfma_f32_16x16x32_bf16 v[140:143], a[252:255], v[164:167], v[140:143]
    s_add_u32 s67, s67, 6
    ds_read_b64_tr_b16 v[198:199], v212 offset:25600
    buffer_load_dwordx4 a[8:11], v213, s[48:51], s78 offen offset:2048 sc1
    v_mfma_f32_16x16x32_bf16 v[140:143], a[248:251], v[160:163], v[140:143]
    s_lshl_b32 s65, s67, 7
    s_waitcnt lgkmcnt(13)
    ds_read_b64_tr_b16 v[192:193], v212 offset:16384
    v_mfma_f32_16x16x32_bf16 v[0:3], v[168:171], v[144:147], v[0:3]
    s_mul_i32 s66, s67, 196608
    s_waitcnt lgkmcnt(11)
    ds_read_b64_tr_b16 v[194:195], v212 offset:17408
    v_mfma_f32_16x16x32_bf16 v[0:3], v[172:175], v[148:151], v[0:3]
    s_add_u32 m0, s68, 0
    s_waitcnt lgkmcnt(10)
    ds_read_b128 v[152:155], v209 offset:2048
    v_mfma_f32_16x16x32_bf16 v[4:7], v[180:183], v[148:151], v[4:7]
    s_waitcnt lgkmcnt(9)
    ds_read_b128 v[156:159], v210 offset:2048
    buffer_load_dwordx4 v200, s[36:39], s65 offen offset:0 lds
    v_mfma_f32_16x16x32_bf16 v[4:7], v[176:179], v[144:147], v[4:7]
    s_waitcnt lgkmcnt(8)
    v_mfma_f32_16x16x32_bf16 v[8:11], v[184:187], v[144:147], v[8:11]
    s_waitcnt lgkmcnt(6)
    ds_read_b128 v[160:163], v209 offset:4096
    v_mfma_f32_16x16x32_bf16 v[8:11], v[188:191], v[148:151], v[8:11]
    s_waitcnt lgkmcnt(5)
    ds_read_b128 v[164:167], v210 offset:4096
    v_mfma_f32_16x16x32_bf16 v[12:15], v[196:199], v[148:151], v[12:15]
    s_waitcnt lgkmcnt(4)
    buffer_load_dwordx4 v201, s[36:39], s65 offen offset:1024 lds
    v_mfma_f32_16x16x32_bf16 v[12:15], v[192:195], v[144:147], v[12:15]
    s_waitcnt lgkmcnt(3)
    v_min_u32 v255, 17, v215
    v_lshlrev_b32 v255, 7, v255
    v_mfma_f32_16x16x32_bf16 v[28:31], v[192:195], v[152:155], v[28:31]
    s_waitcnt lgkmcnt(2)
    ds_read_b128 v[144:147], v209 offset:6144
    v_mfma_f32_16x16x32_bf16 v[28:31], v[196:199], v[156:159], v[28:31]
    ds_read_b128 v[148:151], v210 offset:6144
    v_mfma_f32_16x16x32_bf16 v[24:27], v[188:191], v[156:159], v[24:27]
    buffer_load_dwordx4 v202, s[36:39], s65 offen offset:2048 lds
    v_mfma_f32_16x16x32_bf16 v[24:27], v[184:187], v[152:155], v[24:27]
    v_mfma_f32_16x16x32_bf16 v[20:23], v[176:179], v[152:155], v[20:23]
    v_mfma_f32_16x16x32_bf16 v[20:23], v[180:183], v[156:159], v[20:23]
    v_mfma_f32_16x16x32_bf16 v[16:19], v[172:175], v[156:159], v[16:19]
    buffer_load_dwordx4 v203, s[36:39], s65 offen offset:3072 lds
    v_mfma_f32_16x16x32_bf16 v[16:19], v[168:171], v[152:155], v[16:19]
    s_waitcnt lgkmcnt(3)
    v_mfma_f32_16x16x32_bf16 v[32:35], v[168:171], v[160:163], v[32:35]
    s_waitcnt lgkmcnt(2)
    ds_read_b128 v[152:155], v209 offset:8192
    v_mfma_f32_16x16x32_bf16 v[32:35], v[172:175], v[164:167], v[32:35]
    ds_read_b128 v[156:159], v210 offset:8192
    v_mfma_f32_16x16x32_bf16 v[36:39], v[180:183], v[164:167], v[36:39]
    buffer_load_dwordx4 v204, s[36:39], s65 offen offset:3456 lds
    v_mfma_f32_16x16x32_bf16 v[36:39], v[176:179], v[160:163], v[36:39]
    v_mfma_f32_16x16x32_bf16 v[40:43], v[184:187], v[160:163], v[40:43]
    v_mfma_f32_16x16x32_bf16 v[40:43], v[188:191], v[164:167], v[40:43]
    s_add_u32 m0, s69, 0
    v_mfma_f32_16x16x32_bf16 v[44:47], v[196:199], v[164:167], v[44:47]
    buffer_load_dwordx4 v205, s[40:43], s66 offen offset:0 lds
    v_mfma_f32_16x16x32_bf16 v[44:47], v[192:195], v[160:163], v[44:47]
    s_waitcnt lgkmcnt(3)
    v_mfma_f32_16x16x32_bf16 v[60:63], v[192:195], v[144:147], v[60:63]
    s_waitcnt lgkmcnt(2)
    ds_read_b128 v[160:163], v209 offset:10240
    v_mfma_f32_16x16x32_bf16 v[60:63], v[196:199], v[148:151], v[60:63]
    ds_read_b128 v[164:167], v210 offset:10240
    v_mfma_f32_16x16x32_bf16 v[56:59], v[188:191], v[148:151], v[56:59]
    buffer_load_dwordx4 v206, s[40:43], s66 offen offset:1024 lds
    v_mfma_f32_16x16x32_bf16 v[56:59], v[184:187], v[144:147], v[56:59]
    v_mfma_f32_16x16x32_bf16 v[52:55], v[176:179], v[144:147], v[52:55]
    v_mfma_f32_16x16x32_bf16 v[52:55], v[180:183], v[148:151], v[52:55]
    v_mfma_f32_16x16x32_bf16 v[48:51], v[172:175], v[148:151], v[48:51]
    buffer_load_dwordx4 v207, s[40:43], s66 offen offset:2048 lds
    v_mfma_f32_16x16x32_bf16 v[48:51], v[168:171], v[144:147], v[48:51]
    s_waitcnt lgkmcnt(3)
    v_mfma_f32_16x16x32_bf16 v[64:67], v[168:171], v[152:155], v[64:67]
    s_waitcnt lgkmcnt(2)
    ds_read_b128 v[144:147], v209 offset:12288
    v_mfma_f32_16x16x32_bf16 v[64:67], v[172:175], v[156:159], v[64:67]
    ds_read_b128 v[148:151], v210 offset:12288
    v_mfma_f32_16x16x32_bf16 v[68:71], v[180:183], v[156:159], v[68:71]
    buffer_load_dwordx4 v208, s[40:43], s66 offen offset:3072 lds
    v_mfma_f32_16x16x32_bf16 v[68:71], v[176:179], v[152:155], v[68:71]
    v_mfma_f32_16x16x32_bf16 v[72:75], v[184:187], v[152:155], v[72:75]
    s_mul_i32 s73, s70, 36
    s_and_b32 s74, s60, 1
    v_mfma_f32_16x16x32_bf16 v[72:75], v[188:191], v[156:159], v[72:75]
    s_mul_i32 s74, s74, 18
    s_add_u32 s73, s73, s74
    s_lshl_b32 s73, s73, 7
    v_mfma_f32_16x16x32_bf16 v[76:79], v[196:199], v[156:159], v[76:79]
    buffer_load_dword a222, v255, s[52:55], s73 offen
    v_mfma_f32_16x16x32_bf16 v[76:79], v[192:195], v[152:155], v[76:79]
    s_waitcnt lgkmcnt(3)
    v_mfma_f32_16x16x32_bf16 v[92:95], v[192:195], v[160:163], v[92:95]
    s_waitcnt lgkmcnt(2)
    ds_read_b128 v[152:155], v209 offset:14336
    v_mfma_f32_16x16x32_bf16 v[92:95], v[196:199], v[164:167], v[92:95]
    s_add_u32 m0, s69, 16384
    ds_read_b128 v[156:159], v210 offset:14336
    v_mfma_f32_16x16x32_bf16 v[88:91], v[188:191], v[164:167], v[88:91]
    buffer_load_dwordx4 v205, s[44:47], s66 offen offset:0 lds
    v_mfma_f32_16x16x32_bf16 v[88:91], v[184:187], v[160:163], v[88:91]
    v_mfma_f32_16x16x32_bf16 v[84:87], v[176:179], v[160:163], v[84:87]
    v_mfma_f32_16x16x32_bf16 v[84:87], v[180:183], v[164:167], v[84:87]
    v_mfma_f32_16x16x32_bf16 v[80:83], v[172:175], v[164:167], v[80:83]
    buffer_load_dwordx4 v206, s[44:47], s66 offen offset:1024 lds
    v_mfma_f32_16x16x32_bf16 v[80:83], v[168:171], v[160:163], v[80:83]
    s_waitcnt lgkmcnt(3)
    v_mfma_f32_16x16x32_bf16 v[96:99], v[168:171], v[144:147], v[96:99]
    s_waitcnt lgkmcnt(2)
    ds_read_b128 v[160:163], v209 offset:16384
    v_mfma_f32_16x16x32_bf16 v[96:99], v[172:175], v[148:151], v[96:99]
    ds_read_b128 v[164:167], v210 offset:16384
    v_mfma_f32_16x16x32_bf16 v[100:103], v[180:183], v[148:151], v[100:103]
    buffer_load_dwordx4 v207, s[44:47], s66 offen offset:2048 lds
    v_mfma_f32_16x16x32_bf16 v[100:103], v[176:179], v[144:147], v[100:103]
    v_add_u32 v211, 51200, v211
    v_add_u32 v209, 51200, v209
    v_mfma_f32_16x16x32_bf16 v[104:107], v[184:187], v[144:147], v[104:107]
    v_add_u32 v212, 51200, v212
    v_add_u32 v210, 51200, v210
    v_mfma_f32_16x16x32_bf16 v[104:107], v[188:191], v[148:151], v[104:107]
    v_mfma_f32_16x16x32_bf16 v[108:111], v[196:199], v[148:151], v[108:111]
    buffer_load_dwordx4 v208, s[44:47], s66 offen offset:3072 lds
    v_mfma_f32_16x16x32_bf16 v[108:111], v[192:195], v[144:147], v[108:111]
    s_waitcnt vmcnt(19) lgkmcnt(0)
    s_barrier
    ds_read_b64_tr_b16 a[224:225], v211 offset:0
    v_mfma_f32_16x16x32_bf16 v[124:127], v[192:195], v[152:155], v[124:127]
    ds_read_b64_tr_b16 a[226:227], v211 offset:1024
    v_mfma_f32_16x16x32_bf16 v[124:127], v[196:199], v[156:159], v[124:127]
    ds_read_b128 v[144:147], v209 offset:0
    v_mfma_f32_16x16x32_bf16 v[120:123], v[188:191], v[156:159], v[120:123]
    ds_read_b64_tr_b16 a[228:229], v211 offset:8192
    buffer_load_dwordx4 a[12:15], v213, s[48:51], s78 offen offset:3072 sc1
    v_mfma_f32_16x16x32_bf16 v[120:123], v[184:187], v[152:155], v[120:123]
    ds_read_b64_tr_b16 a[230:231], v211 offset:9216
    v_mfma_f32_16x16x32_bf16 v[116:119], v[176:179], v[152:155], v[116:119]
    ds_read_b128 v[148:151], v210 offset:0
    v_mfma_f32_16x16x32_bf16 v[116:119], v[180:183], v[156:159], v[116:119]
    s_sub_u32 s78, s78, 1024
    ds_read_b64_tr_b16 a[236:237], v211 offset:24576
    v_mfma_f32_16x16x32_bf16 v[112:115], v[172:175], v[156:159], v[112:115]
    ds_read_b64_tr_b16 a[238:239], v211 offset:25600
    buffer_load_dwordx4 a[16:19], v214, s[48:51], s78 offen sc1
    v_mfma_f32_16x16x32_bf16 v[112:115], v[168:171], v[152:155], v[112:115]
    ds_read_b64_tr_b16 a[232:233], v211 offset:16384
    v_mfma_f32_16x16x32_bf16 v[128:131], v[168:171], v[160:163], v[128:131]
    ds_read_b64_tr_b16 a[234:235], v211 offset:17408
    v_mfma_f32_16x16x32_bf16 v[128:131], v[172:175], v[164:167], v[128:131]
    s_add_u32 s78, s78, 6144
    ds_read_b64_tr_b16 a[240:241], v212 offset:0
    v_mfma_f32_16x16x32_bf16 v[132:135], v[180:183], v[164:167], v[132:135]
    ds_read_b64_tr_b16 a[242:243], v212 offset:1024
    buffer_load_dwordx4 a[20:23], v213, s[48:51], s78 offen offset:0 sc1
    v_mfma_f32_16x16x32_bf16 v[132:135], v[176:179], v[160:163], v[132:135]
    ds_read_b64_tr_b16 a[244:245], v212 offset:8192
    v_mfma_f32_16x16x32_bf16 v[136:139], v[184:187], v[160:163], v[136:139]
    ds_read_b64_tr_b16 a[246:247], v212 offset:9216
    v_mfma_f32_16x16x32_bf16 v[136:139], v[188:191], v[164:167], v[136:139]
    s_and_b32 s67, s83, 3
    s_xor_b32 s67, s67, 1
    ds_read_b64_tr_b16 a[252:253], v212 offset:24576
    v_mfma_f32_16x16x32_bf16 v[140:143], v[196:199], v[164:167], v[140:143]
    s_add_u32 s67, s67, 6
    ds_read_b64_tr_b16 a[254:255], v212 offset:25600
    buffer_load_dwordx4 a[24:27], v213, s[48:51], s78 offen offset:1024 sc1
    v_mfma_f32_16x16x32_bf16 v[140:143], v[192:195], v[160:163], v[140:143]
    s_lshl_b32 s65, s67, 7
    s_waitcnt lgkmcnt(13)
    ds_read_b64_tr_b16 a[248:249], v212 offset:16384
    v_mfma_f32_16x16x32_bf16 v[0:3], a[224:227], v[144:147], v[0:3]
    s_mul_i32 s66, s67, 196608
    s_waitcnt lgkmcnt(11)
    ds_read_b64_tr_b16 a[250:251], v212 offset:17408
    v_mfma_f32_16x16x32_bf16 v[0:3], a[228:231], v[148:151], v[0:3]
    s_add_u32 m0, s68, 51200
    s_waitcnt lgkmcnt(10)
    ds_read_b128 v[152:155], v209 offset:2048
    v_mfma_f32_16x16x32_bf16 v[4:7], a[236:239], v[148:151], v[4:7]
    s_waitcnt lgkmcnt(9)
    ds_read_b128 v[156:159], v210 offset:2048
    buffer_load_dwordx4 v200, s[36:39], s65 offen offset:0 lds
    v_mfma_f32_16x16x32_bf16 v[4:7], a[232:235], v[144:147], v[4:7]
    s_waitcnt lgkmcnt(8)
    v_mfma_f32_16x16x32_bf16 v[8:11], a[240:243], v[144:147], v[8:11]
    s_waitcnt lgkmcnt(6)
    ds_read_b128 v[160:163], v209 offset:4096
    v_mfma_f32_16x16x32_bf16 v[8:11], a[244:247], v[148:151], v[8:11]
    s_waitcnt lgkmcnt(5)
    ds_read_b128 v[164:167], v210 offset:4096
    v_mfma_f32_16x16x32_bf16 v[12:15], a[252:255], v[148:151], v[12:15]
    s_waitcnt lgkmcnt(4)
    buffer_load_dwordx4 v201, s[36:39], s65 offen offset:1024 lds
    v_mfma_f32_16x16x32_bf16 v[12:15], a[248:251], v[144:147], v[12:15]
    s_waitcnt lgkmcnt(3)
    v_mfma_f32_16x16x32_bf16 v[28:31], a[248:251], v[152:155], v[28:31]
    s_waitcnt lgkmcnt(2)
    ds_read_b128 v[144:147], v209 offset:6144
    v_mfma_f32_16x16x32_bf16 v[28:31], a[252:255], v[156:159], v[28:31]
    ds_read_b128 v[148:151], v210 offset:6144
    v_mfma_f32_16x16x32_bf16 v[24:27], a[244:247], v[156:159], v[24:27]
    buffer_load_dwordx4 v202, s[36:39], s65 offen offset:2048 lds
    v_mfma_f32_16x16x32_bf16 v[24:27], a[240:243], v[152:155], v[24:27]
    v_mfma_f32_16x16x32_bf16 v[20:23], a[232:235], v[152:155], v[20:23]
    v_mfma_f32_16x16x32_bf16 v[20:23], a[236:239], v[156:159], v[20:23]
    v_mfma_f32_16x16x32_bf16 v[16:19], a[228:231], v[156:159], v[16:19]
    buffer_load_dwordx4 v203, s[36:39], s65 offen offset:3072 lds
    v_mfma_f32_16x16x32_bf16 v[16:19], a[224:227], v[152:155], v[16:19]
    s_waitcnt lgkmcnt(3)
    v_mfma_f32_16x16x32_bf16 v[32:35], a[224:227], v[160:163], v[32:35]
    s_waitcnt lgkmcnt(2)
    ds_read_b128 v[152:155], v209 offset:8192
    v_mfma_f32_16x16x32_bf16 v[32:35], a[228:231], v[164:167], v[32:35]
    ds_read_b128 v[156:159], v210 offset:8192
    v_mfma_f32_16x16x32_bf16 v[36:39], a[236:239], v[164:167], v[36:39]
    buffer_load_dwordx4 v204, s[36:39], s65 offen offset:3456 lds
    v_mfma_f32_16x16x32_bf16 v[36:39], a[232:235], v[160:163], v[36:39]
    v_mfma_f32_16x16x32_bf16 v[40:43], a[240:243], v[160:163], v[40:43]
    v_mfma_f32_16x16x32_bf16 v[40:43], a[244:247], v[164:167], v[40:43]
    s_add_u32 m0, s69, 51200
    v_mfma_f32_16x16x32_bf16 v[44:47], a[252:255], v[164:167], v[44:47]
    buffer_load_dwordx4 v205, s[40:43], s66 offen offset:0 lds
    v_mfma_f32_16x16x32_bf16 v[44:47], a[248:251], v[160:163], v[44:47]
    s_waitcnt lgkmcnt(3)
    v_mfma_f32_16x16x32_bf16 v[60:63], a[248:251], v[144:147], v[60:63]
    s_waitcnt lgkmcnt(2)
    ds_read_b128 v[160:163], v209 offset:10240
    v_mfma_f32_16x16x32_bf16 v[60:63], a[252:255], v[148:151], v[60:63]
    ds_read_b128 v[164:167], v210 offset:10240
    v_mfma_f32_16x16x32_bf16 v[56:59], a[244:247], v[148:151], v[56:59]
    buffer_load_dwordx4 v206, s[40:43], s66 offen offset:1024 lds
    v_mfma_f32_16x16x32_bf16 v[56:59], a[240:243], v[144:147], v[56:59]
    v_mfma_f32_16x16x32_bf16 v[52:55], a[232:235], v[144:147], v[52:55]
    v_mfma_f32_16x16x32_bf16 v[52:55], a[236:239], v[148:151], v[52:55]
    v_mfma_f32_16x16x32_bf16 v[48:51], a[228:231], v[148:151], v[48:51]
    buffer_load_dwordx4 v207, s[40:43], s66 offen offset:2048 lds
    v_mfma_f32_16x16x32_bf16 v[48:51], a[224:227], v[144:147], v[48:51]
    s_waitcnt lgkmcnt(3)
    v_mfma_f32_16x16x32_bf16 v[64:67], a[224:227], v[152:155], v[64:67]
    s_waitcnt lgkmcnt(2)
    ds_read_b128 v[144:147], v209 offset:12288
    v_mfma_f32_16x16x32_bf16 v[64:67], a[228:231], v[156:159], v[64:67]
    ds_read_b128 v[148:151], v210 offset:12288
    v_mfma_f32_16x16x32_bf16 v[68:71], a[236:239], v[156:159], v[68:71]
    buffer_load_dwordx4 v208, s[40:43], s66 offen offset:3072 lds
    v_mfma_f32_16x16x32_bf16 v[68:71], a[232:235], v[152:155], v[68:71]
    v_mfma_f32_16x16x32_bf16 v[72:75], a[240:243], v[152:155], v[72:75]
    v_mfma_f32_16x16x32_bf16 v[72:75], a[244:247], v[156:159], v[72:75]
    s_add_u32 m0, s69, 67584
    v_mfma_f32_16x16x32_bf16 v[76:79], a[252:255], v[156:159], v[76:79]
    buffer_load_dwordx4 v205, s[44:47], s66 offen offset:0 lds
    v_mfma_f32_16x16x32_bf16 v[76:79], a[248:251], v[152:155], v[76:79]
    s_waitcnt lgkmcnt(3)
    v_mfma_f32_16x16x32_bf16 v[92:95], a[248:251], v[160:163], v[92:95]
    s_waitcnt lgkmcnt(2)
    ds_read_b128 v[152:155], v209 offset:14336
    v_mfma_f32_16x16x32_bf16 v[92:95], a[252:255], v[164:167], v[92:95]
    ds_read_b128 v[156:159], v210 offset:14336
    v_mfma_f32_16x16x32_bf16 v[88:91], a[244:247], v[164:167], v[88:91]
    buffer_load_dwordx4 v206, s[44:47], s66 offen offset:1024 lds
    v_mfma_f32_16x16x32_bf16 v[88:91], a[240:243], v[160:163], v[88:91]
    v_mfma_f32_16x16x32_bf16 v[84:87], a[232:235], v[160:163], v[84:87]
    v_mfma_f32_16x16x32_bf16 v[84:87], a[236:239], v[164:167], v[84:87]
    v_mfma_f32_16x16x32_bf16 v[80:83], a[228:231], v[164:167], v[80:83]
    buffer_load_dwordx4 v207, s[44:47], s66 offen offset:2048 lds
    v_mfma_f32_16x16x32_bf16 v[80:83], a[224:227], v[160:163], v[80:83]
    s_waitcnt lgkmcnt(3)
    v_mfma_f32_16x16x32_bf16 v[96:99], a[224:227], v[144:147], v[96:99]
    s_waitcnt lgkmcnt(2)
    ds_read_b128 v[160:163], v209 offset:16384
    v_mfma_f32_16x16x32_bf16 v[96:99], a[228:231], v[148:151], v[96:99]
    ds_read_b128 v[164:167], v210 offset:16384
    v_mfma_f32_16x16x32_bf16 v[100:103], a[236:239], v[148:151], v[100:103]
    buffer_load_dwordx4 v208, s[44:47], s66 offen offset:3072 lds
    v_mfma_f32_16x16x32_bf16 v[100:103], a[232:235], v[144:147], v[100:103]
    v_subrev_u32 v211, 102400, v211
    v_subrev_u32 v209, 102400, v209
    v_mfma_f32_16x16x32_bf16 v[104:107], a[240:243], v[144:147], v[104:107]
    v_subrev_u32 v212, 102400, v212
    v_subrev_u32 v210, 102400, v210
    v_mfma_f32_16x16x32_bf16 v[104:107], a[244:247], v[148:151], v[104:107]
    v_mfma_f32_16x16x32_bf16 v[108:111], a[252:255], v[148:151], v[108:111]
    v_mfma_f32_16x16x32_bf16 v[108:111], a[248:251], v[144:147], v[108:111]
    s_waitcnt vmcnt(17) lgkmcnt(0)
    s_barrier
    ds_read_b64_tr_b16 v[168:169], v211 offset:0
    v_mfma_f32_16x16x32_bf16 v[124:127], a[248:251], v[152:155], v[124:127]
    ds_read_b64_tr_b16 v[170:171], v211 offset:1024
    v_mfma_f32_16x16x32_bf16 v[124:127], a[252:255], v[156:159], v[124:127]
    ds_read_b128 v[144:147], v209 offset:0
    v_mfma_f32_16x16x32_bf16 v[120:123], a[244:247], v[156:159], v[120:123]
    ds_read_b64_tr_b16 v[172:173], v211 offset:8192
    buffer_load_dwordx4 a[28:31], v213, s[48:51], s78 offen offset:2048 sc1
    v_mfma_f32_16x16x32_bf16 v[120:123], a[240:243], v[152:155], v[120:123]
    ds_read_b64_tr_b16 v[174:175], v211 offset:9216
    v_mfma_f32_16x16x32_bf16 v[116:119], a[232:235], v[152:155], v[116:119]
    ds_read_b128 v[148:151], v210 offset:0
    v_mfma_f32_16x16x32_bf16 v[116:119], a[236:239], v[156:159], v[116:119]
    ds_read_b64_tr_b16 v[180:181], v211 offset:24576
    v_mfma_f32_16x16x32_bf16 v[112:115], a[228:231], v[156:159], v[112:115]
    ds_read_b64_tr_b16 v[182:183], v211 offset:25600
    buffer_load_dwordx4 a[32:35], v213, s[48:51], s78 offen offset:3072 sc1
    v_mfma_f32_16x16x32_bf16 v[112:115], a[224:227], v[152:155], v[112:115]
    ds_read_b64_tr_b16 v[176:177], v211 offset:16384
    v_mfma_f32_16x16x32_bf16 v[128:131], a[224:227], v[160:163], v[128:131]
    ds_read_b64_tr_b16 v[178:179], v211 offset:17408
    v_mfma_f32_16x16x32_bf16 v[128:131], a[228:231], v[164:167], v[128:131]
    s_sub_u32 s78, s78, 1024
    ds_read_b64_tr_b16 v[184:185], v212 offset:0
    v_mfma_f32_16x16x32_bf16 v[132:135], a[236:239], v[164:167], v[132:135]
    ds_read_b64_tr_b16 v[186:187], v212 offset:1024
    buffer_load_dwordx4 a[36:39], v214, s[48:51], s78 offen sc1
    v_mfma_f32_16x16x32_bf16 v[132:135], a[232:235], v[160:163], v[132:135]
    ds_read_b64_tr_b16 v[188:189], v212 offset:8192
    v_mfma_f32_16x16x32_bf16 v[136:139], a[240:243], v[160:163], v[136:139]
    s_add_u32 s78, s78, 6144
    ds_read_b64_tr_b16 v[190:191], v212 offset:9216
    v_mfma_f32_16x16x32_bf16 v[136:139], a[244:247], v[164:167], v[136:139]
    s_and_b32 s67, s83, 3
    s_xor_b32 s67, s67, 2
    ds_read_b64_tr_b16 v[196:197], v212 offset:24576
    v_mfma_f32_16x16x32_bf16 v[140:143], a[252:255], v[164:167], v[140:143]
    s_add_u32 s67, s67, 6
    ds_read_b64_tr_b16 v[198:199], v212 offset:25600
    buffer_load_dwordx4 a[40:43], v213, s[48:51], s78 offen offset:0 sc1
    v_mfma_f32_16x16x32_bf16 v[140:143], a[248:251], v[160:163], v[140:143]
    s_lshl_b32 s65, s67, 7
    s_waitcnt lgkmcnt(13)
    ds_read_b64_tr_b16 v[192:193], v212 offset:16384
    v_mfma_f32_16x16x32_bf16 v[0:3], v[168:171], v[144:147], v[0:3]
    s_mul_i32 s66, s67, 196608
    s_waitcnt lgkmcnt(11)
    ds_read_b64_tr_b16 v[194:195], v212 offset:17408
    v_mfma_f32_16x16x32_bf16 v[0:3], v[172:175], v[148:151], v[0:3]
    s_add_u32 m0, s68, 102400
    s_waitcnt lgkmcnt(10)
    ds_read_b128 v[152:155], v209 offset:2048
    v_mfma_f32_16x16x32_bf16 v[4:7], v[180:183], v[148:151], v[4:7]
    s_waitcnt lgkmcnt(9)
    ds_read_b128 v[156:159], v210 offset:2048
    buffer_load_dwordx4 v200, s[36:39], s65 offen offset:0 lds
    v_mfma_f32_16x16x32_bf16 v[4:7], v[176:179], v[144:147], v[4:7]
    s_waitcnt lgkmcnt(8)
    v_mfma_f32_16x16x32_bf16 v[8:11], v[184:187], v[144:147], v[8:11]
    s_waitcnt lgkmcnt(6)
    ds_read_b128 v[160:163], v209 offset:4096
    v_mfma_f32_16x16x32_bf16 v[8:11], v[188:191], v[148:151], v[8:11]
    s_waitcnt lgkmcnt(5)
    ds_read_b128 v[164:167], v210 offset:4096
    v_mfma_f32_16x16x32_bf16 v[12:15], v[196:199], v[148:151], v[12:15]
    s_waitcnt lgkmcnt(4)
    buffer_load_dwordx4 v201, s[36:39], s65 offen offset:1024 lds
    v_mfma_f32_16x16x32_bf16 v[12:15], v[192:195], v[144:147], v[12:15]
    s_waitcnt lgkmcnt(3)
    v_mfma_f32_16x16x32_bf16 v[28:31], v[192:195], v[152:155], v[28:31]
    s_waitcnt lgkmcnt(2)
    ds_read_b128 v[144:147], v209 offset:6144
    v_mfma_f32_16x16x32_bf16 v[28:31], v[196:199], v[156:159], v[28:31]
    ds_read_b128 v[148:151], v210 offset:6144
    v_mfma_f32_16x16x32_bf16 v[24:27], v[188:191], v[156:159], v[24:27]
    buffer_load_dwordx4 v202, s[36:39], s65 offen offset:2048 lds
    v_mfma_f32_16x16x32_bf16 v[24:27], v[184:187], v[152:155], v[24:27]
    v_mfma_f32_16x16x32_bf16 v[20:23], v[176:179], v[152:155], v[20:23]
    v_mfma_f32_16x16x32_bf16 v[20:23], v[180:183], v[156:159], v[20:23]
    v_mfma_f32_16x16x32_bf16 v[16:19], v[172:175], v[156:159], v[16:19]
    buffer_load_dwordx4 v203, s[36:39], s65 offen offset:3072 lds
    v_mfma_f32_16x16x32_bf16 v[16:19], v[168:171], v[152:155], v[16:19]
    s_waitcnt lgkmcnt(3)
    v_mfma_f32_16x16x32_bf16 v[32:35], v[168:171], v[160:163], v[32:35]
    s_waitcnt lgkmcnt(2)
    ds_read_b128 v[152:155], v209 offset:8192
    v_mfma_f32_16x16x32_bf16 v[32:35], v[172:175], v[164:167], v[32:35]
    ds_read_b128 v[156:159], v210 offset:8192
    v_mfma_f32_16x16x32_bf16 v[36:39], v[180:183], v[164:167], v[36:39]
    buffer_load_dwordx4 v204, s[36:39], s65 offen offset:3456 lds
    v_mfma_f32_16x16x32_bf16 v[36:39], v[176:179], v[160:163], v[36:39]
    v_mfma_f32_16x16x32_bf16 v[40:43], v[184:187], v[160:163], v[40:43]
    v_mfma_f32_16x16x32_bf16 v[40:43], v[188:191], v[164:167], v[40:43]
    s_add_u32 m0, s69, 102400
    v_mfma_f32_16x16x32_bf16 v[44:47], v[196:199], v[164:167], v[44:47]
    buffer_load_dwordx4 v205, s[40:43], s66 offen offset:0 lds
    v_mfma_f32_16x16x32_bf16 v[44:47], v[192:195], v[160:163], v[44:47]
    s_waitcnt lgkmcnt(3)
    v_mfma_f32_16x16x32_bf16 v[60:63], v[192:195], v[144:147], v[60:63]
    s_waitcnt lgkmcnt(2)
    ds_read_b128 v[160:163], v209 offset:10240
    v_mfma_f32_16x16x32_bf16 v[60:63], v[196:199], v[148:151], v[60:63]
    ds_read_b128 v[164:167], v210 offset:10240
    v_mfma_f32_16x16x32_bf16 v[56:59], v[188:191], v[148:151], v[56:59]
    buffer_load_dwordx4 v206, s[40:43], s66 offen offset:1024 lds
    v_mfma_f32_16x16x32_bf16 v[56:59], v[184:187], v[144:147], v[56:59]
    v_mfma_f32_16x16x32_bf16 v[52:55], v[176:179], v[144:147], v[52:55]
    v_mfma_f32_16x16x32_bf16 v[52:55], v[180:183], v[148:151], v[52:55]
    v_mfma_f32_16x16x32_bf16 v[48:51], v[172:175], v[148:151], v[48:51]
    buffer_load_dwordx4 v207, s[40:43], s66 offen offset:2048 lds
    v_mfma_f32_16x16x32_bf16 v[48:51], v[168:171], v[144:147], v[48:51]
    s_waitcnt lgkmcnt(3)
    v_mfma_f32_16x16x32_bf16 v[64:67], v[168:171], v[152:155], v[64:67]
    s_waitcnt lgkmcnt(2)
    ds_read_b128 v[144:147], v209 offset:12288
    v_mfma_f32_16x16x32_bf16 v[64:67], v[172:175], v[156:159], v[64:67]
    ds_read_b128 v[148:151], v210 offset:12288
    v_mfma_f32_16x16x32_bf16 v[68:71], v[180:183], v[156:159], v[68:71]
    buffer_load_dwordx4 v208, s[40:43], s66 offen offset:3072 lds
    v_mfma_f32_16x16x32_bf16 v[68:71], v[176:179], v[152:155], v[68:71]
    v_mfma_f32_16x16x32_bf16 v[72:75], v[184:187], v[152:155], v[72:75]
    v_mfma_f32_16x16x32_bf16 v[72:75], v[188:191], v[156:159], v[72:75]
    s_add_u32 m0, s69, 118784
    v_mfma_f32_16x16x32_bf16 v[76:79], v[196:199], v[156:159], v[76:79]
    buffer_load_dwordx4 v205, s[44:47], s66 offen offset:0 lds
    v_mfma_f32_16x16x32_bf16 v[76:79], v[192:195], v[152:155], v[76:79]
    s_waitcnt lgkmcnt(3)
    v_mfma_f32_16x16x32_bf16 v[92:95], v[192:195], v[160:163], v[92:95]
    s_waitcnt lgkmcnt(2)
    ds_read_b128 v[152:155], v209 offset:14336
    v_mfma_f32_16x16x32_bf16 v[92:95], v[196:199], v[164:167], v[92:95]
    ds_read_b128 v[156:159], v210 offset:14336
    v_mfma_f32_16x16x32_bf16 v[88:91], v[188:191], v[164:167], v[88:91]
    buffer_load_dwordx4 v206, s[44:47], s66 offen offset:1024 lds
    v_mfma_f32_16x16x32_bf16 v[88:91], v[184:187], v[160:163], v[88:91]
    v_mfma_f32_16x16x32_bf16 v[84:87], v[176:179], v[160:163], v[84:87]
    v_mfma_f32_16x16x32_bf16 v[84:87], v[180:183], v[164:167], v[84:87]
    v_mfma_f32_16x16x32_bf16 v[80:83], v[172:175], v[164:167], v[80:83]
    buffer_load_dwordx4 v207, s[44:47], s66 offen offset:2048 lds
    v_mfma_f32_16x16x32_bf16 v[80:83], v[168:171], v[160:163], v[80:83]
    s_waitcnt lgkmcnt(3)
    v_mfma_f32_16x16x32_bf16 v[96:99], v[168:171], v[144:147], v[96:99]
    s_waitcnt lgkmcnt(2)
    ds_read_b128 v[160:163], v209 offset:16384
    v_mfma_f32_16x16x32_bf16 v[96:99], v[172:175], v[148:151], v[96:99]
    ds_read_b128 v[164:167], v210 offset:16384
    v_mfma_f32_16x16x32_bf16 v[100:103], v[180:183], v[148:151], v[100:103]
    buffer_load_dwordx4 v208, s[44:47], s66 offen offset:3072 lds
    v_mfma_f32_16x16x32_bf16 v[100:103], v[176:179], v[144:147], v[100:103]
    v_add_u32 v211, 51200, v211
    v_add_u32 v209, 51200, v209
    v_mfma_f32_16x16x32_bf16 v[104:107], v[184:187], v[144:147], v[104:107]
    v_add_u32 v212, 51200, v212
    v_add_u32 v210, 51200, v210
    v_mfma_f32_16x16x32_bf16 v[104:107], v[188:191], v[148:151], v[104:107]
    v_mfma_f32_16x16x32_bf16 v[108:111], v[196:199], v[148:151], v[108:111]
    v_mfma_f32_16x16x32_bf16 v[108:111], v[192:195], v[144:147], v[108:111]
    s_waitcnt vmcnt(17) lgkmcnt(0)
    s_barrier
    ds_read_b64_tr_b16 a[224:225], v211 offset:0
    v_mfma_f32_16x16x32_bf16 v[124:127], v[192:195], v[152:155], v[124:127]
    ds_read_b64_tr_b16 a[226:227], v211 offset:1024
    v_mfma_f32_16x16x32_bf16 v[124:127], v[196:199], v[156:159], v[124:127]
    ds_read_b128 v[144:147], v209 offset:0
    v_mfma_f32_16x16x32_bf16 v[120:123], v[188:191], v[156:159], v[120:123]
    ds_read_b64_tr_b16 a[228:229], v211 offset:8192
    buffer_load_dwordx4 a[44:47], v213, s[48:51], s78 offen offset:1024 sc1
    v_mfma_f32_16x16x32_bf16 v[120:123], v[184:187], v[152:155], v[120:123]
    ds_read_b64_tr_b16 a[230:231], v211 offset:9216
    v_mfma_f32_16x16x32_bf16 v[116:119], v[176:179], v[152:155], v[116:119]
L_padG2:
    s_cbranch_execz L_retG
    ds_read_b128 v[148:151], v210 offset:0
    v_mfma_f32_16x16x32_bf16 v[116:119], v[180:183], v[156:159], v[116:119]
    ds_read_b64_tr_b16 a[236:237], v211 offset:24576
    v_mfma_f32_16x16x32_bf16 v[112:115], v[172:175], v[156:159], v[112:115]
    ds_read_b64_tr_b16 a[238:239], v211 offset:25600
    buffer_load_dwordx4 a[48:51], v213, s[48:51], s78 offen offset:2048 sc1
    v_mfma_f32_16x16x32_bf16 v[112:115], v[168:171], v[152:155], v[112:115]
    ds_read_b64_tr_b16 a[232:233], v211 offset:16384
    v_mfma_f32_16x16x32_bf16 v[128:131], v[168:171], v[160:163], v[128:131]
    ds_read_b64_tr_b16 a[234:235], v211 offset:17408
    v_mfma_f32_16x16x32_bf16 v[128:131], v[172:175], v[164:167], v[128:131]
    ds_read_b64_tr_b16 a[240:241], v212 offset:0
    v_mfma_f32_16x16x32_bf16 v[132:135], v[180:183], v[164:167], v[132:135]
    ds_read_b64_tr_b16 a[242:243], v212 offset:1024
    buffer_load_dwordx4 a[52:55], v213, s[48:51], s78 offen offset:3072 sc1
    v_mfma_f32_16x16x32_bf16 v[132:135], v[176:179], v[160:163], v[132:135]
    ds_read_b64_tr_b16 a[244:245], v212 offset:8192
    v_mfma_f32_16x16x32_bf16 v[136:139], v[184:187], v[160:163], v[136:139]
    s_sub_u32 s78, s78, 1024
    ds_read_b64_tr_b16 a[246:247], v212 offset:9216
    v_mfma_f32_16x16x32_bf16 v[136:139], v[188:191], v[164:167], v[136:139]
    s_and_b32 s67, s83, 3
    s_xor_b32 s67, s67, 3
    ds_read_b64_tr_b16 a[252:253], v212 offset:24576
    v_mfma_f32_16x16x32_bf16 v[140:143], v[196:199], v[164:167], v[140:143]
    s_add_u32 s67, s67, 6
    ds_read_b64_tr_b16 a[254:255], v212 offset:25600
    buffer_load_dwordx4 a[56:59], v214, s[48:51], s78 offen sc1
    v_mfma_f32_16x16x32_bf16 v[140:143], v[192:195], v[160:163], v[140:143]
    s_lshl_b32 s65, s67, 7
    s_waitcnt lgkmcnt(13)
    ds_read_b64_tr_b16 a[248:249], v212 offset:16384
    v_mfma_f32_16x16x32_bf16 v[0:3], a[224:227], v[144:147], v[0:3]
    s_mul_i32 s66, s67, 196608
    s_waitcnt lgkmcnt(11)
    ds_read_b64_tr_b16 a[250:251], v212 offset:17408
    v_mfma_f32_16x16x32_bf16 v[0:3], a[228:231], v[148:151], v[0:3]
    s_add_u32 m0, s68, 0
    s_waitcnt lgkmcnt(10)
    ds_read_b128 v[152:155], v209 offset:2048
    v_mfma_f32_16x16x32_bf16 v[4:7], a[236:239], v[148:151], v[4:7]
    s_waitcnt lgkmcnt(9)
    ds_read_b128 v[156:159], v210 offset:2048
    buffer_load_dwordx4 v200, s[36:39], s65 offen offset:0 lds
    v_mfma_f32_16x16x32_bf16 v[4:7], a[232:235], v[144:147], v[4:7]
    s_waitcnt lgkmcnt(8)
    v_mfma_f32_16x16x32_bf16 v[8:11], a[240:243], v[144:147], v[8:11]
    s_waitcnt lgkmcnt(6)
    ds_read_b128 v[160:163], v209 offset:4096
    v_mfma_f32_16x16x32_bf16 v[8:11], a[244:247], v[148:151], v[8:11]
    s_waitcnt lgkmcnt(5)
    ds_read_b128 v[164:167], v210 offset:4096
    v_mfma_f32_16x16x32_bf16 v[12:15], a[252:255], v[148:151], v[12:15]
    s_waitcnt lgkmcnt(4)
    buffer_load_dwordx4 v201, s[36:39], s65 offen offset:1024 lds
    v_mfma_f32_16x16x32_bf16 v[12:15], a[248:251], v[144:147], v[12:15]
    s_waitcnt lgkmcnt(3)
    v_mfma_f32_16x16x32_bf16 v[28:31], a[248:251], v[152:155], v[28:31]
    s_waitcnt lgkmcnt(2)
    ds_read_b128 v[144:147], v209 offset:6144
    v_mfma_f32_16x16x32_bf16 v[28:31], a[252:255], v[156:159], v[28:31]
    ds_read_b128 v[148:151], v210 offset:6144
    v_mfma_f32_16x16x32_bf16 v[24:27], a[244:247], v[156:159], v[24:27]
    buffer_load_dwordx4 v202, s[36:39], s65 offen offset:2048 lds
    v_mfma_f32_16x16x32_bf16 v[24:27], a[240:243], v[152:155], v[24:27]
    v_mfma_f32_16x16x32_bf16 v[20:23], a[232:235], v[152:155], v[20:23]
    v_mfma_f32_16x16x32_bf16 v[20:23], a[236:239], v[156:159], v[20:23]
    v_mfma_f32_16x16x32_bf16 v[16:19], a[228:231], v[156:159], v[16:19]
    buffer_load_dwordx4 v203, s[36:39], s65 offen offset:3072 lds
    v_mfma_f32_16x16x32_bf16 v[16:19], a[224:227], v[152:155], v[16:19]
    s_waitcnt lgkmcnt(3)
    v_mfma_f32_16x16x32_bf16 v[32:35], a[224:227], v[160:163], v[32:35]
    s_waitcnt lgkmcnt(2)
    ds_read_b128 v[152:155], v209 offset:8192
    v_mfma_f32_16x16x32_bf16 v[32:35], a[228:231], v[164:167], v[32:35]
    ds_read_b128 v[156:159], v210 offset:8192
    v_mfma_f32_16x16x32_bf16 v[36:39], a[236:239], v[164:167], v[36:39]
    buffer_load_dwordx4 v204, s[36:39], s65 offen offset:3456 lds
    v_mfma_f32_16x16x32_bf16 v[36:39], a[232:235], v[160:163], v[36:39]
    v_mfma_f32_16x16x32_bf16 v[40:43], a[240:243], v[160:163], v[40:43]
    v_mfma_f32_16x16x32_bf16 v[40:43], a[244:247], v[164:167], v[40:43]
    s_add_u32 m0, s69, 0
    v_mfma_f32_16x16x32_bf16 v[44:47], a[252:255], v[164:167], v[44:47]
    buffer_load_dwordx4 v205, s[40:43], s66 offen offset:0 lds
    v_mfma_f32_16x16x32_bf16 v[44:47], a[248:251], v[160:163], v[44:47]
    s_waitcnt lgkmcnt(3)
    v_mfma_f32_16x16x32_bf16 v[60:63], a[248:251], v[144:147], v[60:63]
    s_waitcnt lgkmcnt(2)
    ds_read_b128 v[160:163], v209 offset:10240
    v_mfma_f32_16x16x32_bf16 v[60:63], a[252:255], v[148:151], v[60:63]
    ds_read_b128 v[164:167], v210 offset:10240
    v_mfma_f32_16x16x32_bf16 v[56:59], a[244:247], v[148:151], v[56:59]
    buffer_load_dwordx4 v206, s[40:43], s66 offen offset:1024 lds
    v_mfma_f32_16x16x32_bf16 v[56:59], a[240:243], v[144:147], v[56:59]
    v_mfma_f32_16x16x32_bf16 v[52:55], a[232:235], v[144:147], v[52:55]
    v_mfma_f32_16x16x32_bf16 v[52:55], a[236:239], v[148:151], v[52:55]
    v_mfma_f32_16x16x32_bf16 v[48:51], a[228:231], v[148:151], v[48:51]
    buffer_load_dwordx4 v207, s[40:43], s66 offen offset:2048 lds
    v_mfma_f32_16x16x32_bf16 v[48:51], a[224:227], v[144:147], v[48:51]
    s_waitcnt lgkmcnt(3)
    v_mfma_f32_16x16x32_bf16 v[64:67], a[224:227], v[152:155], v[64:67]
    s_waitcnt lgkmcnt(2)
    ds_read_b128 v[144:147], v209 offset:12288
    v_mfma_f32_16x16x32_bf16 v[64:67], a[228:231], v[156:159], v[64:67]
    ds_read_b128 v[148:151], v210 offset:12288
    v_mfma_f32_16x16x32_bf16 v[68:71], a[236:239], v[156:159], v[68:71]
    buffer_load_dwordx4 v208, s[40:43], s66 offen offset:3072 lds
    v_mfma_f32_16x16x32_bf16 v[68:71], a[232:235], v[152:155], v[68:71]
    v_mfma_f32_16x16x32_bf16 v[72:75], a[240:243], v[152:155], v[72:75]
    v_mfma_f32_16x16x32_bf16 v[72:75], a[244:247], v[156:159], v[72:75]
    s_add_u32 m0, s69, 16384
    v_mfma_f32_16x16x32_bf16 v[76:79], a[252:255], v[156:159], v[76:79]
    buffer_load_dwordx4 v205, s[44:47], s66 offen offset:0 lds
    v_mfma_f32_16x16x32_bf16 v[76:79], a[248:251], v[152:155], v[76:79]
    s_waitcnt lgkmcnt(3)
    v_mfma_f32_16x16x32_bf16 v[92:95], a[248:251], v[160:163], v[92:95]
    s_waitcnt lgkmcnt(2)
    ds_read_b128 v[152:155], v209 offset:14336
    v_mfma_f32_16x16x32_bf16 v[92:95], a[252:255], v[164:167], v[92:95]
    ds_read_b128 v[156:159], v210 offset:14336
    v_mfma_f32_16x16x32_bf16 v[88:91], a[244:247], v[164:167], v[88:91]
    buffer_load_dwordx4 v206, s[44:47], s66 offen offset:1024 lds
    v_mfma_f32_16x16x32_bf16 v[88:91], a[240:243], v[160:163], v[88:91]
    v_mfma_f32_16x16x32_bf16 v[84:87], a[232:235], v[160:163], v[84:87]
    v_mfma_f32_16x16x32_bf16 v[84:87], a[236:239], v[164:167], v[84:87]
    v_mfma_f32_16x16x32_bf16 v[80:83], a[228:231], v[164:167], v[80:83]
    buffer_load_dwordx4 v207, s[44:47], s66 offen offset:2048 lds
    v_mfma_f32_16x16x32_bf16 v[80:83], a[224:227], v[160:163], v[80:83]
    s_waitcnt lgkmcnt(3)
    v_mfma_f32_16x16x32_bf16 v[96:99], a[224:227], v[144:147], v[96:99]
    s_waitcnt lgkmcnt(2)
    ds_read_b128 v[160:163], v209 offset:16384
    v_mfma_f32_16x16x32_bf16 v[96:99], a[228:231], v[148:151], v[96:99]
    ds_read_b128 v[164:167], v210 offset:16384
    v_mfma_f32_16x16x32_bf16 v[100:103], a[236:239], v[148:151], v[100:103]
    buffer_load_dwordx4 v208, s[44:47], s66 offen offset:3072 lds
    v_mfma_f32_16x16x32_bf16 v[100:103], a[232:235], v[144:147], v[100:103]
    v_add_u32 v211, 51200, v211
    v_add_u32 v209, 51200, v209
    v_mfma_f32_16x16x32_bf16 v[104:107], a[240:243], v[144:147], v[104:107]
    v_add_u32 v212, 51200, v212
    v_add_u32 v210, 51200, v210
    v_mfma_f32_16x16x32_bf16 v[104:107], a[244:247], v[148:151], v[104:107]
    v_mfma_f32_16x16x32_bf16 v[108:111], a[252:255], v[148:151], v[108:111]
    v_mfma_f32_16x16x32_bf16 v[108:111], a[248:251], v[144:147], v[108:111]
    s_waitcnt vmcnt(17) lgkmcnt(0)
    s_barrier
    ds_read_b64_tr_b16 v[168:169], v211 offset:0
    v_mfma_f32_16x16x32_bf16 v[124:127], a[248:251], v[152:155], v[124:127]
    ds_read_b64_tr_b16 v[170:171], v211 offset:1024
    v_mfma_f32_16x16x32_bf16 v[124:127], a[252:255], v[156:159], v[124:127]
    s_add_u32 s78, s78, 6144
    ds_read_b128 v[144:147], v209 offset:0
    v_mfma_f32_16x16x32_bf16 v[120:123], a[244:247], v[156:159], v[120:123]
    ds_read_b64_tr_b16 v[172:173], v211 offset:8192
    buffer_load_dwordx4 a[60:63], v213, s[48:51], s78 offen offset:0 sc1
    v_mfma_f32_16x16x32_bf16 v[120:123], a[240:243], v[152:155], v[120:123]
    ds_read_b64_tr_b16 v[174:175], v211 offset:9216
    v_mfma_f32_16x16x32_bf16 v[116:119], a[232:235], v[152:155], v[116:119]
    ds_read_b128 v[148:151], v210 offset:0
    v_mfma_f32_16x16x32_bf16 v[116:119], a[236:239], v[156:159], v[116:119]
    ds_read_b64_tr_b16 v[180:181], v211 offset:24576
    v_mfma_f32_16x16x32_bf16 v[112:115], a[228:231], v[156:159], v[112:115]
    ds_read_b64_tr_b16 v[182:183], v211 offset:25600
    buffer_load_dwordx4 a[64:67], v213, s[48:51], s78 offen offset:1024 sc1
    v_mfma_f32_16x16x32_bf16 v[112:115], a[224:227], v[152:155], v[112:115]
    ds_read_b64_tr_b16 v[176:177], v211 offset:16384
    v_mfma_f32_16x16x32_bf16 v[128:131], a[224:227], v[160:163], v[128:131]
    ds_read_b64_tr_b16 v[178:179], v211 offset:17408
    v_mfma_f32_16x16x32_bf16 v[128:131], a[228:231], v[164:167], v[128:131]
    ds_read_b64_tr_b16 v[184:185], v212 offset:0
    v_mfma_f32_16x16x32_bf16 v[132:135], a[236:239], v[164:167], v[132:135]
    ds_read_b64_tr_b16 v[186:187], v212 offset:1024
    buffer_load_dwordx4 a[68:71], v213, s[48:51], s78 offen offset:2048 sc1
    v_mfma_f32_16x16x32_bf16 v[132:135], a[232:235], v[160:163], v[132:135]
    ds_read_b64_tr_b16 v[188:189], v212 offset:8192
    v_mfma_f32_16x16x32_bf16 v[136:139], a[240:243], v[160:163], v[136:139]
    ds_read_b64_tr_b16 v[190:191], v212 offset:9216
    v_mfma_f32_16x16x32_bf16 v[136:139], a[244:247], v[164:167], v[136:139]
    ds_read_b64_tr_b16 v[196:197], v212 offset:24576
    v_mfma_f32_16x16x32_bf16 v[140:143], a[252:255], v[164:167], v[140:143]
    ds_read_b64_tr_b16 v[198:199], v212 offset:25600
    buffer_load_dwordx4 a[72:75], v213, s[48:51], s78 offen offset:3072 sc1
    v_mfma_f32_16x16x32_bf16 v[140:143], a[248:251], v[160:163], v[140:143]
    s_waitcnt lgkmcnt(13)
    ds_read_b64_tr_b16 v[192:193], v212 offset:16384
    v_mfma_f32_16x16x32_bf16 v[0:3], v[168:171], v[144:147], v[0:3]
    s_waitcnt lgkmcnt(11)
    ds_read_b64_tr_b16 v[194:195], v212 offset:17408
    v_mfma_f32_16x16x32_bf16 v[0:3], v[172:175], v[148:151], v[0:3]
    s_sub_u32 s78, s78, 1024
    s_waitcnt lgkmcnt(10)
    ds_read_b128 v[152:155], v209 offset:2048
    v_mfma_f32_16x16x32_bf16 v[4:7], v[180:183], v[148:151], v[4:7]
    s_waitcnt lgkmcnt(9)
    ds_read_b128 v[156:159], v210 offset:2048
    buffer_load_dwordx4 a[76:79], v214, s[48:51], s78 offen sc1
    v_mfma_f32_16x16x32_bf16 v[4:7], v[176:179], v[144:147], v[4:7]
    s_waitcnt lgkmcnt(8)
    v_mfma_f32_16x16x32_bf16 v[8:11], v[184:187], v[144:147], v[8:11]
    s_waitcnt lgkmcnt(6)
    ds_read_b128 v[160:163], v209 offset:4096
    v_mfma_f32_16x16x32_bf16 v[8:11], v[188:191], v[148:151], v[8:11]
    s_add_u32 s78, s78, 6144
    s_waitcnt lgkmcnt(5)
    ds_read_b128 v[164:167], v210 offset:4096
    v_mfma_f32_16x16x32_bf16 v[12:15], v[196:199], v[148:151], v[12:15]
    s_waitcnt lgkmcnt(4)
    buffer_load_dwordx4 a[80:83], v213, s[48:51], s78 offen offset:0 sc1
    v_mfma_f32_16x16x32_bf16 v[12:15], v[192:195], v[144:147], v[12:15]
    s_waitcnt lgkmcnt(3)
    v_mfma_f32_16x16x32_bf16 v[28:31], v[192:195], v[152:155], v[28:31]
    s_waitcnt lgkmcnt(2)
    ds_read_b128 v[144:147], v209 offset:6144
    v_mfma_f32_16x16x32_bf16 v[28:31], v[196:199], v[156:159], v[28:31]
    ds_read_b128 v[148:151], v210 offset:6144
    v_mfma_f32_16x16x32_bf16 v[24:27], v[188:191], v[156:159], v[24:27]
    buffer_load_dwordx4 a[84:87], v213, s[48:51], s78 offen offset:1024 sc1
    v_mfma_f32_16x16x32_bf16 v[24:27], v[184:187], v[152:155], v[24:27]
    s_and_b32 s74, s62, 1
    s_lshl_b32 s74, s74, 2
    s_mul_i32 s73, s62, 140
    v_mfma_f32_16x16x32_bf16 v[20:23], v[176:179], v[152:155], v[20:23]
    v_and_b32 v255, 15, v215
    v_mfma_f32_16x16x32_bf16 v[20:23], v[180:183], v[156:159], v[20:23]
    v_add_u32 v255, s74, v255
    v_mfma_f32_16x16x32_bf16 v[16:19], v[172:175], v[156:159], v[16:19]
    buffer_load_dwordx4 a[88:91], v213, s[48:51], s78 offen offset:2048 sc1
    v_mfma_f32_16x16x32_bf16 v[16:19], v[168:171], v[152:155], v[16:19]
    s_waitcnt lgkmcnt(3)
    v_add_u32 v252, 128, v255
    v_mfma_f32_16x16x32_bf16 v[32:35], v[168:171], v[160:163], v[32:35]
    s_waitcnt lgkmcnt(2)
    ds_read_b128 v[152:155], v209 offset:8192
    v_mfma_f32_16x16x32_bf16 v[32:35], v[172:175], v[164:167], v[32:35]
    ds_read_b128 v[156:159], v210 offset:8192
    v_mfma_f32_16x16x32_bf16 v[36:39], v[180:183], v[164:167], v[36:39]
    buffer_load_dwordx4 a[92:95], v213, s[48:51], s78 offen offset:3072 sc1
    v_mfma_f32_16x16x32_bf16 v[36:39], v[176:179], v[160:163], v[36:39]
    v_subrev_u32 v246, 12, v255
    v_mfma_f32_16x16x32_bf16 v[40:43], v[184:187], v[160:163], v[40:43]
    v_cmp_le_u32 vcc, 12, v255
    v_mfma_f32_16x16x32_bf16 v[40:43], v[188:191], v[164:167], v[40:43]
    s_sub_u32 s78, s78, 1024
    v_and_b32 v247, 0x300, v213
    v_mfma_f32_16x16x32_bf16 v[44:47], v[196:199], v[164:167], v[44:47]
    buffer_load_dwordx4 a[96:99], v214, s[48:51], s78 offen sc1
    v_mfma_f32_16x16x32_bf16 v[44:47], v[192:195], v[160:163], v[44:47]
    s_mov_b32 s74, 153600
    s_waitcnt lgkmcnt(3)
    v_mfma_f32_16x16x32_bf16 v[60:63], v[192:195], v[144:147], v[60:63]
    s_waitcnt lgkmcnt(2)
    ds_read_b128 v[160:163], v209 offset:10240
    v_mfma_f32_16x16x32_bf16 v[60:63], v[196:199], v[148:151], v[60:63]
    s_add_u32 s78, s78, 6144
    ds_read_b128 v[164:167], v210 offset:10240
    v_mfma_f32_16x16x32_bf16 v[56:59], v[188:191], v[148:151], v[56:59]
    buffer_load_dwordx4 a[100:103], v213, s[48:51], s78 offen offset:0 sc1
    v_mfma_f32_16x16x32_bf16 v[56:59], v[184:187], v[144:147], v[56:59]
    v_cndmask_b32 v252, v252, v246, vcc
    v_mfma_f32_16x16x32_bf16 v[52:55], v[176:179], v[144:147], v[52:55]
    v_add_u32 v246, s73, v255
    v_mfma_f32_16x16x32_bf16 v[52:55], v[180:183], v[148:151], v[52:55]
    v_and_b32 v244, 15, v246
    v_mfma_f32_16x16x32_bf16 v[48:51], v[172:175], v[148:151], v[48:51]
    buffer_load_dwordx4 a[104:107], v213, s[48:51], s78 offen offset:1024 sc1
    v_mfma_f32_16x16x32_bf16 v[48:51], v[168:171], v[144:147], v[48:51]
    s_waitcnt lgkmcnt(3)
    v_lshrrev_b32 v246, 4, v246
    v_mfma_f32_16x16x32_bf16 v[64:67], v[168:171], v[152:155], v[64:67]
    s_waitcnt lgkmcnt(2)
    ds_read_b128 v[144:147], v209 offset:12288
    v_mfma_f32_16x16x32_bf16 v[64:67], v[172:175], v[156:159], v[64:67]
    ds_read_b128 v[148:151], v210 offset:12288
    v_mfma_f32_16x16x32_bf16 v[68:71], v[180:183], v[156:159], v[68:71]
    buffer_load_dwordx4 a[108:111], v213, s[48:51], s78 offen offset:2048 sc1
    v_mfma_f32_16x16x32_bf16 v[68:71], v[176:179], v[152:155], v[68:71]
    v_lshl_add_u32 v244, v244, 4, v247
    v_mfma_f32_16x16x32_bf16 v[72:75], v[184:187], v[152:155], v[72:75]
    v_lshl_add_u32 v244, v246, 10, v244
    v_mfma_f32_16x16x32_bf16 v[72:75], v[188:191], v[156:159], v[72:75]
    v_lshl_add_u32 v255, v255, 4, s74
    v_mfma_f32_16x16x32_bf16 v[76:79], v[196:199], v[156:159], v[76:79]
    buffer_load_dwordx4 a[112:115], v213, s[48:51], s78 offen offset:3072 sc1
    v_mfma_f32_16x16x32_bf16 v[76:79], v[192:195], v[152:155], v[76:79]
    s_waitcnt lgkmcnt(3)
    v_add_u32 v246, s73, v252
    v_mfma_f32_16x16x32_bf16 v[92:95], v[192:195], v[160:163], v[92:95]
    s_waitcnt lgkmcnt(2)
    ds_read_b128 v[152:155], v209 offset:14336
    v_mfma_f32_16x16x32_bf16 v[92:95], v[196:199], v[164:167], v[92:95]
    s_sub_u32 s78, s78, 1024
    ds_read_b128 v[156:159], v210 offset:14336
    v_mfma_f32_16x16x32_bf16 v[88:91], v[188:191], v[164:167], v[88:91]
    buffer_load_dwordx4 a[116:119], v214, s[48:51], s78 offen sc1
    v_mfma_f32_16x16x32_bf16 v[88:91], v[184:187], v[160:163], v[88:91]
    v_and_b32 v245, 15, v246
    v_mfma_f32_16x16x32_bf16 v[84:87], v[176:179], v[160:163], v[84:87]
    v_lshrrev_b32 v246, 4, v246
    v_mfma_f32_16x16x32_bf16 v[84:87], v[180:183], v[164:167], v[84:87]
    s_add_u32 s78, s78, 6144
    v_lshl_add_u32 v245, v245, 4, v247
    v_mfma_f32_16x16x32_bf16 v[80:83], v[172:175], v[164:167], v[80:83]
    buffer_load_dwordx4 a[120:123], v213, s[48:51], s78 offen offset:0 sc1
    v_mfma_f32_16x16x32_bf16 v[80:83], v[168:171], v[160:163], v[80:83]
    s_waitcnt lgkmcnt(3)
    v_lshl_add_u32 v245, v246, 10, v245
    v_mfma_f32_16x16x32_bf16 v[96:99], v[168:171], v[144:147], v[96:99]
    s_waitcnt lgkmcnt(2)
    ds_read_b128 v[160:163], v209 offset:16384
    v_mfma_f32_16x16x32_bf16 v[96:99], v[172:175], v[148:151], v[96:99]
    ds_read_b128 v[164:167], v210 offset:16384
    v_mfma_f32_16x16x32_bf16 v[100:103], v[180:183], v[148:151], v[100:103]
    buffer_load_dwordx4 a[124:127], v213, s[48:51], s78 offen offset:1024 sc1
    v_mfma_f32_16x16x32_bf16 v[100:103], v[176:179], v[144:147], v[100:103]
    v_subrev_u32 v211, 102400, v211
    v_subrev_u32 v209, 102400, v209
    v_lshl_add_u32 v252, v252, 4, s74
    v_mfma_f32_16x16x32_bf16 v[104:107], v[184:187], v[144:147], v[104:107]
    v_subrev_u32 v212, 102400, v212
    v_subrev_u32 v210, 102400, v210
    v_mfma_f32_16x16x32_bf16 v[104:107], v[188:191], v[148:151], v[104:107]
    v_mfma_f32_16x16x32_bf16 v[108:111], v[196:199], v[148:151], v[108:111]
    buffer_load_dwordx4 a[128:131], v213, s[48:51], s78 offen offset:2048 sc1
    v_mfma_f32_16x16x32_bf16 v[108:111], v[192:195], v[144:147], v[108:111]
    s_waitcnt vmcnt(18) lgkmcnt(0)
    s_barrier
    ds_read_b64_tr_b16 a[224:225], v211 offset:0
    v_mfma_f32_16x16x32_bf16 v[124:127], v[192:195], v[152:155], v[124:127]
    ds_read_b64_tr_b16 a[226:227], v211 offset:1024
    v_mfma_f32_16x16x32_bf16 v[124:127], v[196:199], v[156:159], v[124:127]
    ds_read_b128 v[144:147], v209 offset:0
    v_mfma_f32_16x16x32_bf16 v[120:123], v[188:191], v[156:159], v[120:123]
    ds_read_b64_tr_b16 a[228:229], v211 offset:8192
    buffer_load_dwordx4 a[132:135], v213, s[48:51], s78 offen offset:3072 sc1
    v_mfma_f32_16x16x32_bf16 v[120:123], v[184:187], v[152:155], v[120:123]
    ds_read_b64_tr_b16 a[230:231], v211 offset:9216
    v_mfma_f32_16x16x32_bf16 v[116:119], v[176:179], v[152:155], v[116:119]
    ds_read_b128 v[148:151], v210 offset:0
    v_mfma_f32_16x16x32_bf16 v[116:119], v[180:183], v[156:159], v[116:119]
    s_sub_u32 s78, s78, 1024
    ds_read_b64_tr_b16 a[236:237], v211 offset:24576
    v_mfma_f32_16x16x32_bf16 v[112:115], v[172:175], v[156:159], v[112:115]
    ds_read_b64_tr_b16 a[238:239], v211 offset:25600
    buffer_load_dwordx4 a[136:139], v214, s[48:51], s78 offen sc1
    v_mfma_f32_16x16x32_bf16 v[112:115], v[168:171], v[152:155], v[112:115]
    ds_read_b64_tr_b16 a[232:233], v211 offset:16384
    v_mfma_f32_16x16x32_bf16 v[128:131], v[168:171], v[160:163], v[128:131]
    ds_read_b64_tr_b16 a[234:235], v211 offset:17408
    v_mfma_f32_16x16x32_bf16 v[128:131], v[172:175], v[164:167], v[128:131]
    s_add_u32 s78, s78, 6144
    ds_read_b64_tr_b16 a[240:241], v212 offset:0
    v_mfma_f32_16x16x32_bf16 v[132:135], v[180:183], v[164:167], v[132:135]
    ds_read_b64_tr_b16 a[242:243], v212 offset:1024
    buffer_load_dwordx4 a[140:143], v213, s[48:51], s78 offen offset:0 sc1
    v_mfma_f32_16x16x32_bf16 v[132:135], v[176:179], v[160:163], v[132:135]
    ds_read_b64_tr_b16 a[244:245], v212 offset:8192
    v_mfma_f32_16x16x32_bf16 v[136:139], v[184:187], v[160:163], v[136:139]
    ds_read_b64_tr_b16 a[246:247], v212 offset:9216
    v_mfma_f32_16x16x32_bf16 v[136:139], v[188:191], v[164:167], v[136:139]
    ds_read_b64_tr_b16 a[252:253], v212 offset:24576
    v_mfma_f32_16x16x32_bf16 v[140:143], v[196:199], v[164:167], v[140:143]
    ds_read_b64_tr_b16 a[254:255], v212 offset:25600
    v_mfma_f32_16x16x32_bf16 v[140:143], v[192:195], v[160:163], v[140:143]
    s_waitcnt lgkmcnt(13)
    ds_read_b64_tr_b16 a[248:249], v212 offset:16384
    v_mfma_f32_16x16x32_bf16 v[0:3], a[224:227], v[144:147], v[0:3]
    s_waitcnt lgkmcnt(11)
    ds_read_b64_tr_b16 a[250:251], v212 offset:17408
    v_mfma_f32_16x16x32_bf16 v[0:3], a[228:231], v[148:151], v[0:3]
    s_waitcnt lgkmcnt(10)
    ds_read_b128 v[152:155], v209 offset:2048
    v_mfma_f32_16x16x32_bf16 v[4:7], a[236:239], v[148:151], v[4:7]
    s_waitcnt lgkmcnt(9)
    ds_read_b128 v[156:159], v210 offset:2048
    buffer_load_dwordx4 a[144:147], v213, s[48:51], s78 offen offset:1024 sc1
    v_mfma_f32_16x16x32_bf16 v[4:7], a[232:235], v[144:147], v[4:7]
    s_waitcnt lgkmcnt(8)
    v_mfma_f32_16x16x32_bf16 v[8:11], a[240:243], v[144:147], v[8:11]
    s_waitcnt lgkmcnt(6)
    ds_read_b128 v[160:163], v209 offset:4096
    v_mfma_f32_16x16x32_bf16 v[8:11], a[244:247], v[148:151], v[8:11]
    s_waitcnt lgkmcnt(5)
    ds_read_b128 v[164:167], v210 offset:4096
    v_mfma_f32_16x16x32_bf16 v[12:15], a[252:255], v[148:151], v[12:15]
    s_waitcnt lgkmcnt(4)
    buffer_load_dwordx4 a[148:151], v213, s[48:51], s78 offen offset:2048 sc1
    v_mfma_f32_16x16x32_bf16 v[12:15], a[248:251], v[144:147], v[12:15]
    s_waitcnt lgkmcnt(3)
    ds_read_b64 v[216:217], v255 offset:0
    v_mfma_f32_16x16x32_bf16 v[28:31], a[248:251], v[152:155], v[28:31]
    s_waitcnt lgkmcnt(3)
    ds_read_b128 v[144:147], v209 offset:6144
    v_mfma_f32_16x16x32_bf16 v[28:31], a[252:255], v[156:159], v[28:31]
    ds_read_b128 v[148:151], v210 offset:6144
    v_mfma_f32_16x16x32_bf16 v[24:27], a[244:247], v[156:159], v[24:27]
    buffer_load_dwordx4 a[152:155], v213, s[48:51], s78 offen offset:3072 sc1
    v_mfma_f32_16x16x32_bf16 v[24:27], a[240:243], v[152:155], v[24:27]
    ds_read_b64 v[218:219], v255 offset:256
    v_mfma_f32_16x16x32_bf16 v[20:23], a[232:235], v[152:155], v[20:23]
    v_mfma_f32_16x16x32_bf16 v[20:23], a[236:239], v[156:159], v[20:23]
    s_sub_u32 s78, s78, 1024
    v_mfma_f32_16x16x32_bf16 v[16:19], a[228:231], v[156:159], v[16:19]
    buffer_load_dwordx4 a[156:159], v214, s[48:51], s78 offen sc1
    v_mfma_f32_16x16x32_bf16 v[16:19], a[224:227], v[152:155], v[16:19]
    s_waitcnt lgkmcnt(5)
    ds_read_b64 v[220:221], v255 offset:512
    v_mfma_f32_16x16x32_bf16 v[32:35], a[224:227], v[160:163], v[32:35]
    s_waitcnt lgkmcnt(5)
    ds_read_b128 v[152:155], v209 offset:8192
    v_mfma_f32_16x16x32_bf16 v[32:35], a[228:231], v[164:167], v[32:35]
    s_add_u32 s78, s78, 6144
    ds_read_b128 v[156:159], v210 offset:8192
    v_mfma_f32_16x16x32_bf16 v[36:39], a[236:239], v[164:167], v[36:39]
    buffer_load_dwordx4 a[160:163], v213, s[48:51], s78 offen offset:0 sc1
    v_mfma_f32_16x16x32_bf16 v[36:39], a[232:235], v[160:163], v[36:39]
    ds_read_b64 v[222:223], v255 offset:768
    v_mfma_f32_16x16x32_bf16 v[40:43], a[240:243], v[160:163], v[40:43]
    v_mfma_f32_16x16x32_bf16 v[40:43], a[244:247], v[164:167], v[40:43]
    v_mfma_f32_16x16x32_bf16 v[44:47], a[252:255], v[164:167], v[44:47]
    buffer_load_dwordx4 a[164:167], v213, s[48:51], s78 offen offset:1024 sc1
    v_mfma_f32_16x16x32_bf16 v[44:47], a[248:251], v[160:163], v[44:47]
    s_waitcnt lgkmcnt(6)
    v_mul_f32 v217, 1060205080, v217
    ds_read_b64 v[224:225], v255 offset:1024
    v_mfma_f32_16x16x32_bf16 v[60:63], a[248:251], v[144:147], v[60:63]
    s_waitcnt lgkmcnt(6)
    ds_read_b128 v[160:163], v209 offset:10240
    v_mfma_f32_16x16x32_bf16 v[60:63], a[252:255], v[148:151], v[60:63]
    ds_read_b128 v[164:167], v210 offset:10240
    v_mfma_f32_16x16x32_bf16 v[56:59], a[244:247], v[148:151], v[56:59]
    buffer_load_dwordx4 a[168:171], v213, s[48:51], s78 offen offset:2048 sc1
    v_mfma_f32_16x16x32_bf16 v[56:59], a[240:243], v[144:147], v[56:59]
    s_waitcnt lgkmcnt(7)
    v_mul_f32 v219, 1060205080, v219
    ds_read_b64 v[226:227], v255 offset:1280
    v_mfma_f32_16x16x32_bf16 v[52:55], a[232:235], v[144:147], v[52:55]
    v_rcp_f32 v234, -v217
    v_mfma_f32_16x16x32_bf16 v[52:55], a[236:239], v[148:151], v[52:55]
    v_mfma_f32_16x16x32_bf16 v[48:51], a[228:231], v[148:151], v[48:51]
    buffer_load_dwordx4 a[172:175], v213, s[48:51], s78 offen offset:3072 sc1
    v_mfma_f32_16x16x32_bf16 v[48:51], a[224:227], v[144:147], v[48:51]
    s_waitcnt lgkmcnt(6)
    v_mul_f32 v221, 1060205080, v221
    ds_read_b64 v[228:229], v255 offset:1536
    v_mfma_f32_16x16x32_bf16 v[64:67], a[224:227], v[152:155], v[64:67]
    s_waitcnt lgkmcnt(6)
    ds_read_b128 v[144:147], v209 offset:12288
    v_mfma_f32_16x16x32_bf16 v[64:67], a[228:231], v[156:159], v[64:67]
    s_sub_u32 s78, s78, 1024
    ds_read_b128 v[148:151], v210 offset:12288
    v_mfma_f32_16x16x32_bf16 v[68:71], a[236:239], v[156:159], v[68:71]
    buffer_load_dwordx4 a[176:179], v214, s[48:51], s78 offen sc1
    v_mfma_f32_16x16x32_bf16 v[68:71], a[232:235], v[152:155], v[68:71]
    s_waitcnt lgkmcnt(7)
    v_mul_f32 v223, 1060205080, v223
    ds_read_b64 v[230:231], v255 offset:1792
    v_mfma_f32_16x16x32_bf16 v[72:75], a[240:243], v[152:155], v[72:75]
    v_rcp_f32 v236, -v221
    v_mfma_f32_16x16x32_bf16 v[72:75], a[244:247], v[156:159], v[72:75]
    s_add_u32 s78, s78, 6144
    v_rcp_f32 v235, -v219
    v_mfma_f32_16x16x32_bf16 v[76:79], a[252:255], v[156:159], v[76:79]
    buffer_load_dwordx4 a[180:183], v213, s[48:51], s78 offen offset:0 sc1
    v_mfma_f32_16x16x32_bf16 v[76:79], a[248:251], v[152:155], v[76:79]
    s_waitcnt lgkmcnt(6)
    v_mul_f32 v225, 1060205080, v225
    ds_read_b64 v[232:233], v252 offset:0
    v_mfma_f32_16x16x32_bf16 v[92:95], a[248:251], v[160:163], v[92:95]
    s_waitcnt lgkmcnt(6)
    ds_read_b128 v[152:155], v209 offset:14336
    v_mfma_f32_16x16x32_bf16 v[92:95], a[252:255], v[164:167], v[92:95]
    ds_read_b128 v[156:159], v210 offset:14336
    v_mfma_f32_16x16x32_bf16 v[88:91], a[244:247], v[164:167], v[88:91]
    buffer_load_dwordx4 a[184:187], v213, s[48:51], s78 offen offset:1024 sc1
    v_mfma_f32_16x16x32_bf16 v[88:91], a[240:243], v[160:163], v[88:91]
    s_waitcnt lgkmcnt(7)
    v_mul_f32 v227, 1060205080, v227
    v_mfma_f32_16x16x32_bf16 v[84:87], a[232:235], v[160:163], v[84:87]
    v_rcp_f32 v238, -v225
    v_mfma_f32_16x16x32_bf16 v[84:87], a[236:239], v[164:167], v[84:87]
    v_rcp_f32 v237, -v223
    v_mfma_f32_16x16x32_bf16 v[80:83], a[228:231], v[164:167], v[80:83]
    buffer_load_dwordx4 a[188:191], v213, s[48:51], s78 offen offset:2048 sc1
    v_mfma_f32_16x16x32_bf16 v[80:83], a[224:227], v[160:163], v[80:83]
    s_waitcnt lgkmcnt(5)
    v_mul_f32 v229, 1060205080, v229
    v_mfma_f32_16x16x32_bf16 v[96:99], a[224:227], v[144:147], v[96:99]
    s_waitcnt lgkmcnt(4)
    ds_read_b128 v[160:163], v209 offset:16384
    v_mfma_f32_16x16x32_bf16 v[96:99], a[228:231], v[148:151], v[96:99]
    ds_read_b128 v[164:167], v210 offset:16384
    v_mfma_f32_16x16x32_bf16 v[100:103], a[236:239], v[148:151], v[100:103]
    buffer_load_dwordx4 a[192:195], v213, s[48:51], s78 offen offset:3072 sc1
    v_mfma_f32_16x16x32_bf16 v[100:103], a[232:235], v[144:147], v[100:103]
    s_waitcnt lgkmcnt(5)
    v_mul_f32 v231, 1060205080, v231
    v_mfma_f32_16x16x32_bf16 v[104:107], a[240:243], v[144:147], v[104:107]
    v_mfma_f32_16x16x32_bf16 v[104:107], a[244:247], v[148:151], v[104:107]
    s_sub_u32 s78, s78, 1024
    v_rcp_f32 v239, -v227
    v_mfma_f32_16x16x32_bf16 v[108:111], a[252:255], v[148:151], v[108:111]
    buffer_load_dwordx4 a[196:199], v214, s[48:51], s78 offen sc1
    v_mfma_f32_16x16x32_bf16 v[108:111], a[248:251], v[144:147], v[108:111]
    s_waitcnt lgkmcnt(0)
    s_barrier
    v_mul_f32 v233, 1060205080, v233
    v_mfma_f32_16x16x32_bf16 v[124:127], a[248:251], v[152:155], v[124:127]
    v_rcp_f32 v240, -v229
    v_mfma_f32_16x16x32_bf16 v[124:127], a[252:255], v[156:159], v[124:127]
    s_add_u32 s78, s78, 6144
    v_mfma_f32_16x16x32_bf16 v[120:123], a[244:247], v[156:159], v[120:123]
    buffer_load_dwordx4 a[200:203], v213, s[48:51], s78 offen offset:0 sc1
    v_mfma_f32_16x16x32_bf16 v[120:123], a[240:243], v[152:155], v[120:123]
    v_mfma_f32_16x16x32_bf16 v[116:119], a[232:235], v[152:155], v[116:119]
    v_rcp_f32 v241, -v231
    v_mfma_f32_16x16x32_bf16 v[116:119], a[236:239], v[156:159], v[116:119]
    v_mfma_f32_16x16x32_bf16 v[112:115], a[228:231], v[156:159], v[112:115]
    buffer_load_dwordx4 a[204:207], v213, s[48:51], s78 offen offset:1024 sc1
    v_mfma_f32_16x16x32_bf16 v[112:115], a[224:227], v[152:155], v[112:115]
    v_mfma_f32_16x16x32_bf16 v[128:131], a[224:227], v[160:163], v[128:131]
    v_rcp_f32 v242, -v233
    v_mfma_f32_16x16x32_bf16 v[128:131], a[228:231], v[164:167], v[128:131]
    v_mfma_f32_16x16x32_bf16 v[132:135], a[236:239], v[164:167], v[132:135]
    buffer_load_dwordx4 a[208:211], v213, s[48:51], s78 offen offset:2048 sc1
    v_mfma_f32_16x16x32_bf16 v[132:135], a[232:235], v[160:163], v[132:135]
    v_mfma_f32_16x16x32_bf16 v[136:139], a[240:243], v[160:163], v[136:139]
    v_mfma_f32_16x16x32_bf16 v[136:139], a[244:247], v[164:167], v[136:139]
    v_mfma_f32_16x16x32_bf16 v[140:143], a[252:255], v[164:167], v[140:143]
    v_mfma_f32_16x16x32_bf16 v[140:143], a[248:251], v[160:163], v[140:143]
    s_nop 0
    v_mov_b32_dpp v168, v128 row_newbcast:12 row_mask:0xf bank_mask:0xf
    v_mov_b32_dpp v169, v129 row_newbcast:12 row_mask:0xf bank_mask:0xf
    v_mov_b32_dpp v170, v130 row_newbcast:12 row_mask:0xf bank_mask:0xf
    v_mov_b32_dpp v171, v131 row_newbcast:12 row_mask:0xf bank_mask:0xf
    v_mov_b32_dpp v172, v132 row_newbcast:12 row_mask:0xf bank_mask:0xf
    v_mov_b32_dpp v173, v133 row_newbcast:12 row_mask:0xf bank_mask:0xf
    v_mov_b32_dpp v174, v134 row_newbcast:12 row_mask:0xf bank_mask:0xf
    v_mov_b32_dpp v175, v135 row_newbcast:12 row_mask:0xf bank_mask:0xf
    v_mov_b32_dpp v176, v136 row_newbcast:12 row_mask:0xf bank_mask:0xf
    v_mov_b32_dpp v177, v137 row_newbcast:12 row_mask:0xf bank_mask:0xf
    v_mov_b32_dpp v178, v138 row_newbcast:12 row_mask:0xf bank_mask:0xf
    v_mov_b32_dpp v179, v139 row_newbcast:12 row_mask:0xf bank_mask:0xf
    v_mov_b32_dpp v180, v140 row_newbcast:12 row_mask:0xf bank_mask:0xf
    v_mov_b32_dpp v181, v141 row_newbcast:12 row_mask:0xf bank_mask:0xf
    v_mov_b32_dpp v182, v142 row_newbcast:12 row_mask:0xf bank_mask:0xf
    v_mov_b32_dpp v183, v143 row_newbcast:12 row_mask:0xf bank_mask:0xf
    v_pk_fma_f32 v[0:1], v[168:169], v[216:217], v[0:1] op_sel_hi:[1,0,1] neg_lo:[0,1,0] neg_hi:[0,1,0]
    v_pk_fma_f32 v[2:3], v[170:171], v[216:217], v[2:3] op_sel_hi:[1,0,1] neg_lo:[0,1,0] neg_hi:[0,1,0]
    v_pk_fma_f32 v[8:9], v[176:177], v[216:217], v[8:9] op_sel_hi:[1,0,1] neg_lo:[0,1,0] neg_hi:[0,1,0]
    v_pk_fma_f32 v[10:11], v[178:179], v[216:217], v[10:11] op_sel_hi:[1,0,1] neg_lo:[0,1,0] neg_hi:[0,1,0]
    v_pk_mul_f32 v[0:1], v[0:1], v[234:235] op_sel:[0,0] op_sel_hi:[1,0]
    v_pk_mul_f32 v[2:3], v[2:3], v[234:235] op_sel:[0,0] op_sel_hi:[1,0]
    v_pk_mul_f32 v[8:9], v[8:9], v[234:235] op_sel:[0,0] op_sel_hi:[1,0]
    v_pk_mul_f32 v[10:11], v[10:11], v[234:235] op_sel:[0,0] op_sel_hi:[1,0]
    v_exp_f32 v0, v0
    v_exp_f32 v1, v1
L_padG3:
    s_cbranch_execz L_retG
    v_pk_fma_f32 v[4:5], v[172:173], v[216:217], v[4:5] op_sel_hi:[1,0,1] neg_lo:[0,1,0] neg_hi:[0,1,0]
    v_exp_f32 v2, v2
    v_exp_f32 v3, v3
    v_pk_fma_f32 v[6:7], v[174:175], v[216:217], v[6:7] op_sel_hi:[1,0,1] neg_lo:[0,1,0] neg_hi:[0,1,0]
    v_exp_f32 v8, v8
    v_exp_f32 v9, v9
    v_pk_fma_f32 v[12:13], v[180:181], v[216:217], v[12:13] op_sel_hi:[1,0,1] neg_lo:[0,1,0] neg_hi:[0,1,0]
    v_exp_f32 v10, v10
    v_exp_f32 v11, v11
    v_pk_fma_f32 v[14:15], v[182:183], v[216:217], v[14:15] op_sel_hi:[1,0,1] neg_lo:[0,1,0] neg_hi:[0,1,0]
    v_pk_fma_f32 v[0:1], v[0:1], v[216:217], v[216:217] op_sel:[0,1,1] op_sel_hi:[1,1,1]
    buffer_load_dwordx4 a[212:215], v213, s[48:51], s78 offen offset:3072 sc1
    v_pk_fma_f32 v[2:3], v[2:3], v[216:217], v[216:217] op_sel:[0,1,1] op_sel_hi:[1,1,1]
    v_pk_fma_f32 v[8:9], v[8:9], v[216:217], v[216:217] op_sel:[0,1,1] op_sel_hi:[1,1,1]
    v_pk_fma_f32 v[10:11], v[10:11], v[216:217], v[216:217] op_sel:[0,1,1] op_sel_hi:[1,1,1]
    v_rcp_f32 v0, v0
    v_rcp_f32 v1, v1
    v_rcp_f32 v2, v2
    v_rcp_f32 v3, v3
    v_rcp_f32 v8, v8
    v_rcp_f32 v9, v9
    v_rcp_f32 v10, v10
    v_rcp_f32 v11, v11
    v_pk_mul_f32 v[4:5], v[4:5], v[0:1]
    v_pk_mul_f32 v[6:7], v[6:7], v[2:3]
    v_pk_mul_f32 v[12:13], v[12:13], v[8:9]
    v_pk_mul_f32 v[14:15], v[14:15], v[10:11]
    v_cvt_pk_bf16_f32 v184, v4, v5
    v_cvt_pk_bf16_f32 v185, v6, v7
    v_cvt_pk_bf16_f32 v186, v12, v13
    v_cvt_pk_bf16_f32 v187, v14, v15
    buffer_store_dwordx4 v[184:187], v244, s[48:51], s94 offen offset:0 sc1
    v_pk_fma_f32 v[16:17], v[168:169], v[218:219], v[16:17] op_sel_hi:[1,0,1] neg_lo:[0,1,0] neg_hi:[0,1,0]
    v_pk_fma_f32 v[18:19], v[170:171], v[218:219], v[18:19] op_sel_hi:[1,0,1] neg_lo:[0,1,0] neg_hi:[0,1,0]
    v_pk_fma_f32 v[24:25], v[176:177], v[218:219], v[24:25] op_sel_hi:[1,0,1] neg_lo:[0,1,0] neg_hi:[0,1,0]
    v_pk_fma_f32 v[26:27], v[178:179], v[218:219], v[26:27] op_sel_hi:[1,0,1] neg_lo:[0,1,0] neg_hi:[0,1,0]
    v_pk_mul_f32 v[16:17], v[16:17], v[234:235] op_sel:[0,1] op_sel_hi:[1,1]
    v_pk_mul_f32 v[18:19], v[18:19], v[234:235] op_sel:[0,1] op_sel_hi:[1,1]
    v_pk_mul_f32 v[24:25], v[24:25], v[234:235] op_sel:[0,1] op_sel_hi:[1,1]
    v_pk_mul_f32 v[26:27], v[26:27], v[234:235] op_sel:[0,1] op_sel_hi:[1,1]
    v_exp_f32 v16, v16
    v_exp_f32 v17, v17
    v_pk_fma_f32 v[20:21], v[172:173], v[218:219], v[20:21] op_sel_hi:[1,0,1] neg_lo:[0,1,0] neg_hi:[0,1,0]
    v_exp_f32 v18, v18
    v_exp_f32 v19, v19
    v_pk_fma_f32 v[22:23], v[174:175], v[218:219], v[22:23] op_sel_hi:[1,0,1] neg_lo:[0,1,0] neg_hi:[0,1,0]
    v_exp_f32 v24, v24
    v_exp_f32 v25, v25
    v_pk_fma_f32 v[28:29], v[180:181], v[218:219], v[28:29] op_sel_hi:[1,0,1] neg_lo:[0,1,0] neg_hi:[0,1,0]
    v_exp_f32 v26, v26
    v_exp_f32 v27, v27
    v_pk_fma_f32 v[30:31], v[182:183], v[218:219], v[30:31] op_sel_hi:[1,0,1] neg_lo:[0,1,0] neg_hi:[0,1,0]
    v_pk_fma_f32 v[16:17], v[16:17], v[218:219], v[218:219] op_sel:[0,1,1] op_sel_hi:[1,1,1]
    s_sub_u32 s78, s78, 1024
    buffer_load_dwordx4 a[216:219], v214, s[48:51], s78 offen sc1
    v_pk_fma_f32 v[18:19], v[18:19], v[218:219], v[218:219] op_sel:[0,1,1] op_sel_hi:[1,1,1]
    v_pk_fma_f32 v[24:25], v[24:25], v[218:219], v[218:219] op_sel:[0,1,1] op_sel_hi:[1,1,1]
    v_pk_fma_f32 v[26:27], v[26:27], v[218:219], v[218:219] op_sel:[0,1,1] op_sel_hi:[1,1,1]
    v_rcp_f32 v16, v16
    v_rcp_f32 v17, v17
    v_rcp_f32 v18, v18
    v_rcp_f32 v19, v19
    v_rcp_f32 v24, v24
    v_rcp_f32 v25, v25
    v_rcp_f32 v26, v26
    v_rcp_f32 v27, v27
    v_pk_mul_f32 v[20:21], v[20:21], v[16:17]
    v_pk_mul_f32 v[22:23], v[22:23], v[18:19]
    v_pk_mul_f32 v[28:29], v[28:29], v[24:25]
    v_pk_mul_f32 v[30:31], v[30:31], v[26:27]
    v_cvt_pk_bf16_f32 v188, v20, v21
    v_cvt_pk_bf16_f32 v189, v22, v23
    v_cvt_pk_bf16_f32 v190, v28, v29
    v_cvt_pk_bf16_f32 v191, v30, v31
    buffer_store_dwordx4 v[188:191], v244, s[48:51], s94 offen offset:1024 sc1
    v_pk_fma_f32 v[32:33], v[168:169], v[220:221], v[32:33] op_sel_hi:[1,0,1] neg_lo:[0,1,0] neg_hi:[0,1,0]
    v_pk_fma_f32 v[34:35], v[170:171], v[220:221], v[34:35] op_sel_hi:[1,0,1] neg_lo:[0,1,0] neg_hi:[0,1,0]
    v_pk_fma_f32 v[40:41], v[176:177], v[220:221], v[40:41] op_sel_hi:[1,0,1] neg_lo:[0,1,0] neg_hi:[0,1,0]
    v_pk_fma_f32 v[42:43], v[178:179], v[220:221], v[42:43] op_sel_hi:[1,0,1] neg_lo:[0,1,0] neg_hi:[0,1,0]
    v_pk_mul_f32 v[32:33], v[32:33], v[236:237] op_sel:[0,0] op_sel_hi:[1,0]
    v_pk_mul_f32 v[34:35], v[34:35], v[236:237] op_sel:[0,0] op_sel_hi:[1,0]
    v_pk_mul_f32 v[40:41], v[40:41], v[236:237] op_sel:[0,0] op_sel_hi:[1,0]
    v_pk_mul_f32 v[42:43], v[42:43], v[236:237] op_sel:[0,0] op_sel_hi:[1,0]
    v_exp_f32 v32, v32
    v_exp_f32 v33, v33
    v_pk_fma_f32 v[36:37], v[172:173], v[220:221], v[36:37] op_sel_hi:[1,0,1] neg_lo:[0,1,0] neg_hi:[0,1,0]
    v_exp_f32 v34, v34
    v_exp_f32 v35, v35
    v_pk_fma_f32 v[38:39], v[174:175], v[220:221], v[38:39] op_sel_hi:[1,0,1] neg_lo:[0,1,0] neg_hi:[0,1,0]
    v_exp_f32 v40, v40
    v_exp_f32 v41, v41
    v_pk_fma_f32 v[44:45], v[180:181], v[220:221], v[44:45] op_sel_hi:[1,0,1] neg_lo:[0,1,0] neg_hi:[0,1,0]
    v_exp_f32 v42, v42
    v_exp_f32 v43, v43
    v_pk_fma_f32 v[46:47], v[182:183], v[220:221], v[46:47] op_sel_hi:[1,0,1] neg_lo:[0,1,0] neg_hi:[0,1,0]
    v_pk_fma_f32 v[32:33], v[32:33], v[220:221], v[220:221] op_sel:[0,1,1] op_sel_hi:[1,1,1]
    s_add_u32 s78, s78, 6144
    buffer_load_dwordx4 a[220:223], v213, s[48:51], s78 offen offset:0 sc1
    v_pk_fma_f32 v[34:35], v[34:35], v[220:221], v[220:221] op_sel:[0,1,1] op_sel_hi:[1,1,1]
    v_pk_fma_f32 v[40:41], v[40:41], v[220:221], v[220:221] op_sel:[0,1,1] op_sel_hi:[1,1,1]
    v_pk_fma_f32 v[42:43], v[42:43], v[220:221], v[220:221] op_sel:[0,1,1] op_sel_hi:[1,1,1]
    v_rcp_f32 v32, v32
    v_rcp_f32 v33, v33
    v_rcp_f32 v34, v34
    v_rcp_f32 v35, v35
    v_rcp_f32 v40, v40
    v_rcp_f32 v41, v41
    v_rcp_f32 v42, v42
    v_rcp_f32 v43, v43
    v_pk_mul_f32 v[36:37], v[36:37], v[32:33]
    v_pk_mul_f32 v[38:39], v[38:39], v[34:35]
    v_pk_mul_f32 v[44:45], v[44:45], v[40:41]
    v_pk_mul_f32 v[46:47], v[46:47], v[42:43]
    v_cvt_pk_bf16_f32 v184, v36, v37
    v_cvt_pk_bf16_f32 v185, v38, v39
    v_cvt_pk_bf16_f32 v186, v44, v45
    v_cvt_pk_bf16_f32 v187, v46, v47
    buffer_store_dwordx4 v[184:187], v244, s[48:51], s94 offen offset:2048 sc1
    v_pk_fma_f32 v[48:49], v[168:169], v[222:223], v[48:49] op_sel_hi:[1,0,1] neg_lo:[0,1,0] neg_hi:[0,1,0]
    v_pk_fma_f32 v[50:51], v[170:171], v[222:223], v[50:51] op_sel_hi:[1,0,1] neg_lo:[0,1,0] neg_hi:[0,1,0]
    v_pk_fma_f32 v[56:57], v[176:177], v[222:223], v[56:57] op_sel_hi:[1,0,1] neg_lo:[0,1,0] neg_hi:[0,1,0]
    v_pk_fma_f32 v[58:59], v[178:179], v[222:223], v[58:59] op_sel_hi:[1,0,1] neg_lo:[0,1,0] neg_hi:[0,1,0]
    v_pk_mul_f32 v[48:49], v[48:49], v[236:237] op_sel:[0,1] op_sel_hi:[1,1]
    v_pk_mul_f32 v[50:51], v[50:51], v[236:237] op_sel:[0,1] op_sel_hi:[1,1]
    v_pk_mul_f32 v[56:57], v[56:57], v[236:237] op_sel:[0,1] op_sel_hi:[1,1]
    v_pk_mul_f32 v[58:59], v[58:59], v[236:237] op_sel:[0,1] op_sel_hi:[1,1]
    v_exp_f32 v48, v48
    v_exp_f32 v49, v49
    v_pk_fma_f32 v[52:53], v[172:173], v[222:223], v[52:53] op_sel_hi:[1,0,1] neg_lo:[0,1,0] neg_hi:[0,1,0]
    v_exp_f32 v50, v50
    v_exp_f32 v51, v51
    v_pk_fma_f32 v[54:55], v[174:175], v[222:223], v[54:55] op_sel_hi:[1,0,1] neg_lo:[0,1,0] neg_hi:[0,1,0]
    v_exp_f32 v56, v56
    v_exp_f32 v57, v57
    v_pk_fma_f32 v[60:61], v[180:181], v[222:223], v[60:61] op_sel_hi:[1,0,1] neg_lo:[0,1,0] neg_hi:[0,1,0]
    v_exp_f32 v58, v58
    v_exp_f32 v59, v59
    v_pk_fma_f32 v[62:63], v[182:183], v[222:223], v[62:63] op_sel_hi:[1,0,1] neg_lo:[0,1,0] neg_hi:[0,1,0]
    v_pk_fma_f32 v[48:49], v[48:49], v[222:223], v[222:223] op_sel:[0,1,1] op_sel_hi:[1,1,1]
    buffer_load_dwordx4 a[224:227], v213, s[48:51], s78 offen offset:1024 sc1
    v_pk_fma_f32 v[50:51], v[50:51], v[222:223], v[222:223] op_sel:[0,1,1] op_sel_hi:[1,1,1]
    v_pk_fma_f32 v[56:57], v[56:57], v[222:223], v[222:223] op_sel:[0,1,1] op_sel_hi:[1,1,1]
    v_pk_fma_f32 v[58:59], v[58:59], v[222:223], v[222:223] op_sel:[0,1,1] op_sel_hi:[1,1,1]
    v_rcp_f32 v48, v48
    v_rcp_f32 v49, v49
    v_rcp_f32 v50, v50
    v_rcp_f32 v51, v51
    v_rcp_f32 v56, v56
    v_rcp_f32 v57, v57
    v_rcp_f32 v58, v58
    v_rcp_f32 v59, v59
    v_pk_mul_f32 v[52:53], v[52:53], v[48:49]
    v_pk_mul_f32 v[54:55], v[54:55], v[50:51]
    v_pk_mul_f32 v[60:61], v[60:61], v[56:57]
    v_pk_mul_f32 v[62:63], v[62:63], v[58:59]
    v_cvt_pk_bf16_f32 v188, v52, v53
    v_cvt_pk_bf16_f32 v189, v54, v55
    v_cvt_pk_bf16_f32 v190, v60, v61
    v_cvt_pk_bf16_f32 v191, v62, v63
    buffer_store_dwordx4 v[188:191], v244, s[48:51], s94 offen offset:3072 sc1
    v_pk_fma_f32 v[64:65], v[168:169], v[224:225], v[64:65] op_sel_hi:[1,0,1] neg_lo:[0,1,0] neg_hi:[0,1,0]
    v_pk_fma_f32 v[66:67], v[170:171], v[224:225], v[66:67] op_sel_hi:[1,0,1] neg_lo:[0,1,0] neg_hi:[0,1,0]
    v_pk_fma_f32 v[72:73], v[176:177], v[224:225], v[72:73] op_sel_hi:[1,0,1] neg_lo:[0,1,0] neg_hi:[0,1,0]
    v_pk_fma_f32 v[74:75], v[178:179], v[224:225], v[74:75] op_sel_hi:[1,0,1] neg_lo:[0,1,0] neg_hi:[0,1,0]
    v_pk_mul_f32 v[64:65], v[64:65], v[238:239] op_sel:[0,0] op_sel_hi:[1,0]
    v_pk_mul_f32 v[66:67], v[66:67], v[238:239] op_sel:[0,0] op_sel_hi:[1,0]
    v_pk_mul_f32 v[72:73], v[72:73], v[238:239] op_sel:[0,0] op_sel_hi:[1,0]
    v_pk_mul_f32 v[74:75], v[74:75], v[238:239] op_sel:[0,0] op_sel_hi:[1,0]
    v_exp_f32 v64, v64
    v_exp_f32 v65, v65
    v_pk_fma_f32 v[68:69], v[172:173], v[224:225], v[68:69] op_sel_hi:[1,0,1] neg_lo:[0,1,0] neg_hi:[0,1,0]
    v_exp_f32 v66, v66
    v_exp_f32 v67, v67
    v_pk_fma_f32 v[70:71], v[174:175], v[224:225], v[70:71] op_sel_hi:[1,0,1] neg_lo:[0,1,0] neg_hi:[0,1,0]
    v_exp_f32 v72, v72
    v_exp_f32 v73, v73
    v_pk_fma_f32 v[76:77], v[180:181], v[224:225], v[76:77] op_sel_hi:[1,0,1] neg_lo:[0,1,0] neg_hi:[0,1,0]
    v_exp_f32 v74, v74
    v_exp_f32 v75, v75
    v_pk_fma_f32 v[78:79], v[182:183], v[224:225], v[78:79] op_sel_hi:[1,0,1] neg_lo:[0,1,0] neg_hi:[0,1,0]
    v_pk_fma_f32 v[64:65], v[64:65], v[224:225], v[224:225] op_sel:[0,1,1] op_sel_hi:[1,1,1]
    buffer_load_dwordx4 a[228:231], v213, s[48:51], s78 offen offset:2048 sc1
    v_pk_fma_f32 v[66:67], v[66:67], v[224:225], v[224:225] op_sel:[0,1,1] op_sel_hi:[1,1,1]
    v_pk_fma_f32 v[72:73], v[72:73], v[224:225], v[224:225] op_sel:[0,1,1] op_sel_hi:[1,1,1]
    v_pk_fma_f32 v[74:75], v[74:75], v[224:225], v[224:225] op_sel:[0,1,1] op_sel_hi:[1,1,1]
    v_rcp_f32 v64, v64
    v_rcp_f32 v65, v65
    v_rcp_f32 v66, v66
    v_rcp_f32 v67, v67
    v_rcp_f32 v72, v72
    v_rcp_f32 v73, v73
    v_rcp_f32 v74, v74
    v_rcp_f32 v75, v75
    v_pk_mul_f32 v[68:69], v[68:69], v[64:65]
    v_pk_mul_f32 v[70:71], v[70:71], v[66:67]
    v_pk_mul_f32 v[76:77], v[76:77], v[72:73]
    v_pk_mul_f32 v[78:79], v[78:79], v[74:75]
    v_cvt_pk_bf16_f32 v184, v68, v69
    v_cvt_pk_bf16_f32 v185, v70, v71
    v_cvt_pk_bf16_f32 v186, v76, v77
    v_cvt_pk_bf16_f32 v187, v78, v79
    s_add_u32 s94, s94, 4096
    buffer_store_dwordx4 v[184:187], v244, s[48:51], s94 offen offset:0 sc1
    v_pk_fma_f32 v[80:81], v[168:169], v[226:227], v[80:81] op_sel_hi:[1,0,1] neg_lo:[0,1,0] neg_hi:[0,1,0]
    v_pk_fma_f32 v[82:83], v[170:171], v[226:227], v[82:83] op_sel_hi:[1,0,1] neg_lo:[0,1,0] neg_hi:[0,1,0]
    v_pk_fma_f32 v[88:89], v[176:177], v[226:227], v[88:89] op_sel_hi:[1,0,1] neg_lo:[0,1,0] neg_hi:[0,1,0]
    v_pk_fma_f32 v[90:91], v[178:179], v[226:227], v[90:91] op_sel_hi:[1,0,1] neg_lo:[0,1,0] neg_hi:[0,1,0]
    v_pk_mul_f32 v[80:81], v[80:81], v[238:239] op_sel:[0,1] op_sel_hi:[1,1]
    v_pk_mul_f32 v[82:83], v[82:83], v[238:239] op_sel:[0,1] op_sel_hi:[1,1]
    v_pk_mul_f32 v[88:89], v[88:89], v[238:239] op_sel:[0,1] op_sel_hi:[1,1]
    v_pk_mul_f32 v[90:91], v[90:91], v[238:239] op_sel:[0,1] op_sel_hi:[1,1]
    v_exp_f32 v80, v80
    v_exp_f32 v81, v81
    v_pk_fma_f32 v[84:85], v[172:173], v[226:227], v[84:85] op_sel_hi:[1,0,1] neg_lo:[0,1,0] neg_hi:[0,1,0]
    v_exp_f32 v82, v82
    v_exp_f32 v83, v83
    v_pk_fma_f32 v[86:87], v[174:175], v[226:227], v[86:87] op_sel_hi:[1,0,1] neg_lo:[0,1,0] neg_hi:[0,1,0]
    v_exp_f32 v88, v88
    v_exp_f32 v89, v89
    v_pk_fma_f32 v[92:93], v[180:181], v[226:227], v[92:93] op_sel_hi:[1,0,1] neg_lo:[0,1,0] neg_hi:[0,1,0]
    v_exp_f32 v90, v90
    v_exp_f32 v91, v91
    v_pk_fma_f32 v[94:95], v[182:183], v[226:227], v[94:95] op_sel_hi:[1,0,1] neg_lo:[0,1,0] neg_hi:[0,1,0]
    v_pk_fma_f32 v[80:81], v[80:81], v[226:227], v[226:227] op_sel:[0,1,1] op_sel_hi:[1,1,1]
    buffer_load_dwordx4 a[232:235], v213, s[48:51], s78 offen offset:3072 sc1
    v_pk_fma_f32 v[82:83], v[82:83], v[226:227], v[226:227] op_sel:[0,1,1] op_sel_hi:[1,1,1]
    v_pk_fma_f32 v[88:89], v[88:89], v[226:227], v[226:227] op_sel:[0,1,1] op_sel_hi:[1,1,1]
    v_pk_fma_f32 v[90:91], v[90:91], v[226:227], v[226:227] op_sel:[0,1,1] op_sel_hi:[1,1,1]
    v_rcp_f32 v80, v80
    v_rcp_f32 v81, v81
    v_rcp_f32 v82, v82
    v_rcp_f32 v83, v83
    v_rcp_f32 v88, v88
    v_rcp_f32 v89, v89
    v_rcp_f32 v90, v90
    v_rcp_f32 v91, v91
    v_pk_mul_f32 v[84:85], v[84:85], v[80:81]
    v_pk_mul_f32 v[86:87], v[86:87], v[82:83]
    v_pk_mul_f32 v[92:93], v[92:93], v[88:89]
    v_pk_mul_f32 v[94:95], v[94:95], v[90:91]
    v_cvt_pk_bf16_f32 v188, v84, v85
    v_cvt_pk_bf16_f32 v189, v86, v87
    v_cvt_pk_bf16_f32 v190, v92, v93
    v_cvt_pk_bf16_f32 v191, v94, v95
    buffer_store_dwordx4 v[188:191], v244, s[48:51], s94 offen offset:1024 sc1
    v_pk_fma_f32 v[96:97], v[168:169], v[228:229], v[96:97] op_sel_hi:[1,0,1] neg_lo:[0,1,0] neg_hi:[0,1,0]
    v_pk_fma_f32 v[98:99], v[170:171], v[228:229], v[98:99] op_sel_hi:[1,0,1] neg_lo:[0,1,0] neg_hi:[0,1,0]
    v_pk_fma_f32 v[104:105], v[176:177], v[228:229], v[104:105] op_sel_hi:[1,0,1] neg_lo:[0,1,0] neg_hi:[0,1,0]
    v_pk_fma_f32 v[106:107], v[178:179], v[228:229], v[106:107] op_sel_hi:[1,0,1] neg_lo:[0,1,0] neg_hi:[0,1,0]
    v_pk_mul_f32 v[96:97], v[96:97], v[240:241] op_sel:[0,0] op_sel_hi:[1,0]
    v_pk_mul_f32 v[98:99], v[98:99], v[240:241] op_sel:[0,0] op_sel_hi:[1,0]
    v_pk_mul_f32 v[104:105], v[104:105], v[240:241] op_sel:[0,0] op_sel_hi:[1,0]
    v_pk_mul_f32 v[106:107], v[106:107], v[240:241] op_sel:[0,0] op_sel_hi:[1,0]
    v_exp_f32 v96, v96
    v_exp_f32 v97, v97
    v_pk_fma_f32 v[100:101], v[172:173], v[228:229], v[100:101] op_sel_hi:[1,0,1] neg_lo:[0,1,0] neg_hi:[0,1,0]
    v_exp_f32 v98, v98
    v_exp_f32 v99, v99
    v_pk_fma_f32 v[102:103], v[174:175], v[228:229], v[102:103] op_sel_hi:[1,0,1] neg_lo:[0,1,0] neg_hi:[0,1,0]
    v_exp_f32 v104, v104
    v_exp_f32 v105, v105
    v_pk_fma_f32 v[108:109], v[180:181], v[228:229], v[108:109] op_sel_hi:[1,0,1] neg_lo:[0,1,0] neg_hi:[0,1,0]
    v_exp_f32 v106, v106
    v_exp_f32 v107, v107
    v_pk_fma_f32 v[110:111], v[182:183], v[228:229], v[110:111] op_sel_hi:[1,0,1] neg_lo:[0,1,0] neg_hi:[0,1,0]
    v_pk_fma_f32 v[96:97], v[96:97], v[228:229], v[228:229] op_sel:[0,1,1] op_sel_hi:[1,1,1]
    s_sub_u32 s78, s78, 1024
    buffer_load_dwordx4 a[236:239], v214, s[48:51], s78 offen sc1
    v_pk_fma_f32 v[98:99], v[98:99], v[228:229], v[228:229] op_sel:[0,1,1] op_sel_hi:[1,1,1]
    v_pk_fma_f32 v[104:105], v[104:105], v[228:229], v[228:229] op_sel:[0,1,1] op_sel_hi:[1,1,1]
    v_pk_fma_f32 v[106:107], v[106:107], v[228:229], v[228:229] op_sel:[0,1,1] op_sel_hi:[1,1,1]
    v_rcp_f32 v96, v96
    v_rcp_f32 v97, v97
    v_rcp_f32 v98, v98
    v_rcp_f32 v99, v99
    v_rcp_f32 v104, v104
    v_rcp_f32 v105, v105
    v_rcp_f32 v106, v106
    v_rcp_f32 v107, v107
    v_pk_mul_f32 v[100:101], v[100:101], v[96:97]
    v_pk_mul_f32 v[102:103], v[102:103], v[98:99]
    v_pk_mul_f32 v[108:109], v[108:109], v[104:105]
    v_pk_mul_f32 v[110:111], v[110:111], v[106:107]
    v_cvt_pk_bf16_f32 v184, v100, v101
    v_cvt_pk_bf16_f32 v185, v102, v103
    v_cvt_pk_bf16_f32 v186, v108, v109
    v_cvt_pk_bf16_f32 v187, v110, v111
    buffer_store_dwordx4 v[184:187], v244, s[48:51], s94 offen offset:2048 sc1
    v_pk_fma_f32 v[112:113], v[168:169], v[230:231], v[112:113] op_sel_hi:[1,0,1] neg_lo:[0,1,0] neg_hi:[0,1,0]
    v_pk_fma_f32 v[114:115], v[170:171], v[230:231], v[114:115] op_sel_hi:[1,0,1] neg_lo:[0,1,0] neg_hi:[0,1,0]
    v_pk_fma_f32 v[120:121], v[176:177], v[230:231], v[120:121] op_sel_hi:[1,0,1] neg_lo:[0,1,0] neg_hi:[0,1,0]
    v_pk_fma_f32 v[122:123], v[178:179], v[230:231], v[122:123] op_sel_hi:[1,0,1] neg_lo:[0,1,0] neg_hi:[0,1,0]
    v_pk_mul_f32 v[112:113], v[112:113], v[240:241] op_sel:[0,1] op_sel_hi:[1,1]
    v_pk_mul_f32 v[114:115], v[114:115], v[240:241] op_sel:[0,1] op_sel_hi:[1,1]
    v_pk_mul_f32 v[120:121], v[120:121], v[240:241] op_sel:[0,1] op_sel_hi:[1,1]
    v_pk_mul_f32 v[122:123], v[122:123], v[240:241] op_sel:[0,1] op_sel_hi:[1,1]
    v_exp_f32 v112, v112
    v_exp_f32 v113, v113
    v_pk_fma_f32 v[116:117], v[172:173], v[230:231], v[116:117] op_sel_hi:[1,0,1] neg_lo:[0,1,0] neg_hi:[0,1,0]
    v_exp_f32 v114, v114
    v_exp_f32 v115, v115
    v_pk_fma_f32 v[118:119], v[174:175], v[230:231], v[118:119] op_sel_hi:[1,0,1] neg_lo:[0,1,0] neg_hi:[0,1,0]
    v_exp_f32 v120, v120
    v_exp_f32 v121, v121
    v_pk_fma_f32 v[124:125], v[180:181], v[230:231], v[124:125] op_sel_hi:[1,0,1] neg_lo:[0,1,0] neg_hi:[0,1,0]
    v_exp_f32 v122, v122
    v_exp_f32 v123, v123
    v_pk_fma_f32 v[126:127], v[182:183], v[230:231], v[126:127] op_sel_hi:[1,0,1] neg_lo:[0,1,0] neg_hi:[0,1,0]
    v_pk_fma_f32 v[112:113], v[112:113], v[230:231], v[230:231] op_sel:[0,1,1] op_sel_hi:[1,1,1]
    s_add_u32 s98, s96, 0
    s_add_u32 m0, s81, 0
    s_nop 0
    buffer_load_dwordx4 v253, s[52:55], s98 offen offset:0 lds
    v_pk_fma_f32 v[114:115], v[114:115], v[230:231], v[230:231] op_sel:[0,1,1] op_sel_hi:[1,1,1]
    v_pk_fma_f32 v[120:121], v[120:121], v[230:231], v[230:231] op_sel:[0,1,1] op_sel_hi:[1,1,1]
    v_pk_fma_f32 v[122:123], v[122:123], v[230:231], v[230:231] op_sel:[0,1,1] op_sel_hi:[1,1,1]
    v_rcp_f32 v112, v112
    v_rcp_f32 v113, v113
    v_rcp_f32 v114, v114
    v_rcp_f32 v115, v115
    v_rcp_f32 v120, v120
    v_rcp_f32 v121, v121
    v_rcp_f32 v122, v122
    v_rcp_f32 v123, v123
    v_pk_mul_f32 v[116:117], v[116:117], v[112:113]
    v_pk_mul_f32 v[118:119], v[118:119], v[114:115]
    v_pk_mul_f32 v[124:125], v[124:125], v[120:121]
    v_pk_mul_f32 v[126:127], v[126:127], v[122:123]
    v_cvt_pk_bf16_f32 v188, v116, v117
    v_cvt_pk_bf16_f32 v189, v118, v119
    v_cvt_pk_bf16_f32 v190, v124, v125
    v_cvt_pk_bf16_f32 v191, v126, v127
    buffer_store_dwordx4 v[188:191], v244, s[48:51], s94 offen offset:3072 sc1
    v_pk_fma_f32 v[128:129], v[168:169], v[232:233], v[128:129] op_sel_hi:[1,0,1] neg_lo:[0,1,0] neg_hi:[0,1,0]
    v_pk_fma_f32 v[130:131], v[170:171], v[232:233], v[130:131] op_sel_hi:[1,0,1] neg_lo:[0,1,0] neg_hi:[0,1,0]
    v_pk_fma_f32 v[136:137], v[176:177], v[232:233], v[136:137] op_sel_hi:[1,0,1] neg_lo:[0,1,0] neg_hi:[0,1,0]
    v_pk_fma_f32 v[138:139], v[178:179], v[232:233], v[138:139] op_sel_hi:[1,0,1] neg_lo:[0,1,0] neg_hi:[0,1,0]
    v_pk_mul_f32 v[128:129], v[128:129], v[242:243] op_sel:[0,0] op_sel_hi:[1,0]
    v_pk_mul_f32 v[130:131], v[130:131], v[242:243] op_sel:[0,0] op_sel_hi:[1,0]
    v_pk_mul_f32 v[136:137], v[136:137], v[242:243] op_sel:[0,0] op_sel_hi:[1,0]
    v_pk_mul_f32 v[138:139], v[138:139], v[242:243] op_sel:[0,0] op_sel_hi:[1,0]
    v_exp_f32 v128, v128
    v_exp_f32 v129, v129
    v_pk_fma_f32 v[132:133], v[172:173], v[232:233], v[132:133] op_sel_hi:[1,0,1] neg_lo:[0,1,0] neg_hi:[0,1,0]
    v_exp_f32 v130, v130
    v_exp_f32 v131, v131
    v_pk_fma_f32 v[134:135], v[174:175], v[232:233], v[134:135] op_sel_hi:[1,0,1] neg_lo:[0,1,0] neg_hi:[0,1,0]
    v_exp_f32 v136, v136
    v_exp_f32 v137, v137
    v_pk_fma_f32 v[140:141], v[180:181], v[232:233], v[140:141] op_sel_hi:[1,0,1] neg_lo:[0,1,0] neg_hi:[0,1,0]
    v_exp_f32 v138, v138
    v_exp_f32 v139, v139
    v_pk_fma_f32 v[142:143], v[182:183], v[232:233], v[142:143] op_sel_hi:[1,0,1] neg_lo:[0,1,0] neg_hi:[0,1,0]
    v_pk_fma_f32 v[128:129], v[128:129], v[232:233], v[232:233] op_sel:[0,1,1] op_sel_hi:[1,1,1]
    buffer_load_dwordx4 v254, s[52:55], s98 offen offset:1024 lds
    v_pk_fma_f32 v[130:131], v[130:131], v[232:233], v[232:233] op_sel:[0,1,1] op_sel_hi:[1,1,1]
    v_pk_fma_f32 v[136:137], v[136:137], v[232:233], v[232:233] op_sel:[0,1,1] op_sel_hi:[1,1,1]
    v_pk_fma_f32 v[138:139], v[138:139], v[232:233], v[232:233] op_sel:[0,1,1] op_sel_hi:[1,1,1]
    v_rcp_f32 v128, v128
    v_rcp_f32 v129, v129
    v_rcp_f32 v130, v130
    v_rcp_f32 v131, v131
    v_rcp_f32 v136, v136
    v_rcp_f32 v137, v137
    v_rcp_f32 v138, v138
    v_rcp_f32 v139, v139
    v_pk_mul_f32 v[132:133], v[132:133], v[128:129]
    v_pk_mul_f32 v[134:135], v[134:135], v[130:131]
    v_pk_mul_f32 v[140:141], v[140:141], v[136:137]
    v_pk_mul_f32 v[142:143], v[142:143], v[138:139]
    v_cvt_pk_bf16_f32 v184, v132, v133
    v_cvt_pk_bf16_f32 v185, v134, v135
    v_cvt_pk_bf16_f32 v186, v140, v141
    v_cvt_pk_bf16_f32 v187, v142, v143
    s_sub_u32 s94, s94, 4096
    s_mov_b32 exec_lo, 0x0fff0fff
    s_mov_b32 exec_hi, 0x0fff0fff
    buffer_store_dwordx4 v[184:187], v245, s[48:51], s94 offen offset:0 sc1
    s_mov_b64 exec, -1
    v_mov_b32 v255, s82
    v_lshlrev_b32 v239, 2, v215
    s_waitcnt vmcnt(0)
    s_mov_b64 exec, 0xffff
    buffer_store_dword v255, v239, s[48:51], s95 offen sc1
    s_mov_b64 exec, -1
    s_add_u32 s98, s98, 20480
    s_add_u32 m0, s81, 2048
    s_nop 0
    buffer_load_dwordx4 v253, s[52:55], s98 offen offset:0 lds
    buffer_load_dwordx4 v254, s[52:55], s98 offen offset:1024 lds
    s_add_u32 s98, s98, 20480
    s_add_u32 m0, s81, 4096
    s_nop 0
    buffer_load_dwordx4 v253, s[52:55], s98 offen offset:0 lds
    buffer_load_dwordx4 v254, s[52:55], s98 offen offset:1024 lds
    s_add_u32 s98, s98, 20480
    s_add_u32 m0, s81, 6144
    s_nop 0
    buffer_load_dwordx4 v253, s[52:55], s98 offen offset:0 lds
    buffer_load_dwordx4 v254, s[52:55], s98 offen offset:1024 lds
    s_add_u32 s98, s98, s97
    s_add_u32 m0, s81, 8192
    s_nop 0
    buffer_load_dwordx4 v253, s[52:55], s98 offen offset:0 lds
    buffer_load_dwordx4 v254, s[52:55], s98 offen offset:1024 lds
    s_add_u32 s98, s96, 128
    s_add_u32 m0, s81, 40960
    s_nop 0
    buffer_load_dwordx4 v253, s[52:55], s98 offen offset:0 lds
    buffer_load_dwordx4 v254, s[52:55], s98 offen offset:1024 lds
    s_add_u32 s98, s98, 20480
    s_add_u32 m0, s81, 43008
    s_nop 0
    buffer_load_dwordx4 v253, s[52:55], s98 offen offset:0 lds
    buffer_load_dwordx4 v254, s[52:55], s98 offen offset:1024 lds
    s_add_u32 s98, s98, 20480
    s_add_u32 m0, s81, 45056
    s_nop 0
    buffer_load_dwordx4 v253, s[52:55], s98 offen offset:0 lds
    buffer_load_dwordx4 v254, s[52:55], s98 offen offset:1024 lds
    s_add_u32 s98, s98, 20480
    s_add_u32 m0, s81, 47104
    s_nop 0
    buffer_load_dwordx4 v253, s[52:55], s98 offen offset:0 lds
    buffer_load_dwordx4 v254, s[52:55], s98 offen offset:1024 lds
    s_add_u32 s98, s98, s97
    s_add_u32 m0, s81, 49152
    s_nop 0
    buffer_load_dwordx4 v253, s[52:55], s98 offen offset:0 lds
    buffer_load_dwordx4 v254, s[52:55], s98 offen offset:1024 lds
    s_add_u32 s98, s96, 256
    s_add_u32 m0, s81, 81920
    s_nop 0
    buffer_load_dwordx4 v253, s[52:55], s98 offen offset:0 lds
    buffer_load_dwordx4 v254, s[52:55], s98 offen offset:1024 lds
    s_add_u32 s98, s98, 20480
    s_add_u32 m0, s81, 83968
    s_nop 0
    buffer_load_dwordx4 v253, s[52:55], s98 offen offset:0 lds
    buffer_load_dwordx4 v254, s[52:55], s98 offen offset:1024 lds
    s_add_u32 s98, s98, 20480
    s_add_u32 m0, s81, 86016
    s_nop 0
    buffer_load_dwordx4 v253, s[52:55], s98 offen offset:0 lds
    buffer_load_dwordx4 v254, s[52:55], s98 offen offset:1024 lds
    s_add_u32 s98, s98, 20480
    s_add_u32 m0, s81, 88064
    s_nop 0
    buffer_load_dwordx4 v253, s[52:55], s98 offen offset:0 lds
    buffer_load_dwordx4 v254, s[52:55], s98 offen offset:1024 lds
    s_add_u32 s98, s98, s97
    s_add_u32 m0, s81, 90112
    s_nop 0
    buffer_load_dwordx4 v253, s[52:55], s98 offen offset:0 lds
    buffer_load_dwordx4 v254, s[52:55], s98 offen offset:1024 lds
    v_xor_b32 v241, 64, v249
    v_add_u32 v210, 81920, v249
    v_add_u32 v211, 81920, v241
    s_waitcnt vmcnt(20)
    ds_read_b128 v[144:147], v249 offset:0
    ds_read_b128 v[148:151], v249 offset:2048
    ds_read_b128 v[152:155], v249 offset:4096
    ds_read_b128 v[156:159], v249 offset:6144
    ds_read_b128 v[160:163], v249 offset:8192
    ds_read_b128 v[164:167], v241 offset:0
    ds_read_b128 v[168:171], v241 offset:2048
    ds_read_b128 v[172:175], v241 offset:4096
    ds_read_b128 v[176:179], v241 offset:6144
    ds_read_b128 v[180:183], v241 offset:8192
    s_add_u32 s98, s96, 384
    s_add_u32 m0, s81, 122880
    s_nop 0
    buffer_load_dwordx4 v253, s[52:55], s98 offen offset:0 lds
    buffer_load_dwordx4 v254, s[52:55], s98 offen offset:1024 lds
    s_add_u32 s98, s98, 20480
    s_add_u32 m0, s81, 124928
    s_nop 0
    buffer_load_dwordx4 v253, s[52:55], s98 offen offset:0 lds
    buffer_load_dwordx4 v254, s[52:55], s98 offen offset:1024 lds
    s_add_u32 s98, s98, 20480
    s_add_u32 m0, s81, 126976
    s_nop 0
    buffer_load_dwordx4 v253, s[52:55], s98 offen offset:0 lds
    buffer_load_dwordx4 v254, s[52:55], s98 offen offset:1024 lds
    s_add_u32 s98, s98, 20480
    s_add_u32 m0, s81, 129024
    s_nop 0
    buffer_load_dwordx4 v253, s[52:55], s98 offen offset:0 lds
    buffer_load_dwordx4 v254, s[52:55], s98 offen offset:1024 lds
    s_add_u32 s98, s98, s97
    s_add_u32 m0, s81, 131072
    s_nop 0
    buffer_load_dwordx4 v253, s[52:55], s98 offen offset:0 lds
    buffer_load_dwordx4 v254, s[52:55], s98 offen offset:1024 lds
    buffer_load_dword v252, v248, s[48:51], 0 offen sc1
    s_waitcnt lgkmcnt(0)
    s_add_u32 s98, s96, 512
    s_add_u32 m0, s81, 0
    s_nop 0
    buffer_load_dwordx4 v253, s[52:55], s98 offen offset:0 lds
    buffer_load_dwordx4 v254, s[52:55], s98 offen offset:1024 lds
    s_add_u32 s98, s98, 20480
    s_add_u32 m0, s81, 2048
    s_nop 0
    buffer_load_dwordx4 v253, s[52:55], s98 offen offset:0 lds
    buffer_load_dwordx4 v254, s[52:55], s98 offen offset:1024 lds
    s_add_u32 s98, s98, 20480
    s_add_u32 m0, s81, 4096
    s_nop 0
    buffer_load_dwordx4 v253, s[52:55], s98 offen offset:0 lds
    buffer_load_dwordx4 v254, s[52:55], s98 offen offset:1024 lds
    s_add_u32 s98, s98, 20480
    s_add_u32 m0, s81, 6144
    s_nop 0
    buffer_load_dwordx4 v253, s[52:55], s98 offen offset:0 lds
    buffer_load_dwordx4 v254, s[52:55], s98 offen offset:1024 lds
    s_mov_b32 s77, 143360
    s_mov_b32 s70, 0xffff0000
    s_lshl_b32 s73, s63, 12
    s_add_u32 s73, s73, 2351104
    s_mul_i32 s76, s60, 1720320
    s_add_u32 s76, s76, s73
    s_add_u32 s86, s60, 1
    s_and_b32 s86, s86, 3
    s_lshl_b32 s86, s86, 10
    s_waitcnt vmcnt(8)
    v_cmp_ne_u32 vcc, s82, v252
    s_nop 1
    s_cbranch_vccnz L_slow_7
L_ok_5:
    s_add_u32 s78, s86, s76
    buffer_load_dwordx4 v[0:3], v213, s[48:51], s78 offen sc1
    s_add_u32 s78, s78, s77
    buffer_load_dwordx4 v[4:7], v213, s[48:51], s78 offen sc1
    s_add_u32 s78, s78, s77
    buffer_load_dwordx4 v[8:11], v213, s[48:51], s78 offen sc1
    s_add_u32 s78, s78, s77
    buffer_load_dwordx4 v[12:15], v213, s[48:51], s78 offen sc1
    s_add_u32 s78, s78, s77
    buffer_load_dwordx4 v[16:19], v213, s[48:51], s78 offen sc1
    s_add_u32 s78, s78, s77
    buffer_load_dwordx4 v[20:23], v213, s[48:51], s78 offen sc1
    s_add_u32 s78, s78, s77
    buffer_load_dwordx4 v[24:27], v213, s[48:51], s78 offen sc1
    s_add_u32 s78, s78, s77
    buffer_load_dwordx4 v[28:31], v213, s[48:51], s78 offen sc1
    s_add_u32 s78, s78, s77
    buffer_load_dwordx4 v[32:35], v213, s[48:51], s78 offen sc1
    s_add_u32 s78, s78, s77
    buffer_load_dwordx4 v[36:39], v213, s[48:51], s78 offen sc1
    s_mul_i32 s90, s60, 286720
    s_sub_u32 s90, s76, s90
    s_add_u32 s90, s90, 6881280
    s_add_u32 s87, s60, 2
    s_and_b32 s87, s87, 3
    s_lshl_b32 s87, s87, 10
    s_add_u32 s88, s60, 3
    s_and_b32 s88, s88, 3
    s_lshl_b32 s88, s88, 10
    s_add_u32 s89, s60, 4
    s_and_b32 s89, s89, 3
    s_lshl_b32 s89, s89, 10
    v_and_b32 v236, 15, v215
    v_lshrrev_b32 v237, 4, v215
    v_lshl_add_u32 v238, v237, 2, v236
    v_and_b32 v238, 15, v238
    v_lshlrev_b32 v238, 4, v238
    v_lshl_add_u32 v238, v237, 8, v238
    v_add_u32 v204, s81, v238
    s_xor_b32 s73, s60, 2
    s_mul_i32 s73, s73, 10240
    v_add_u32 v205, s73, v238
    s_add_u32 s73, s60, 1
    s_and_b32 s73, s73, 3
    s_mul_i32 s73, s73, 10240
    s_sub_u32 s91, s81, s73
    s_sub_u32 s83, 40960, s91
    s_and_b32 s75, s64, 1
    v_lshrrev_b32 v236, 2, v215
    v_and_b32 v237, 3, v215
    v_lshl_add_u32 v238, v237, 2, v236
    v_and_b32 v238, 15, v238
    v_lshlrev_b32 v238, 4, v238
    v_lshl_add_u32 v238, v237, 8, v238
    s_xor_b32 s74, s75, 1
    s_lshl_b32 s74, s74, 7
    v_lshl_add_u32 v63, v237, 3, s74
    s_add_u32 s74, s73, 4096
    v_add_u32 v206, s74, v238
    v_lshrrev_b32 v239, 3, v215
    v_lshl_add_u32 v238, v237, 2, v239
    v_and_b32 v238, 15, v238
    v_lshlrev_b32 v238, 4, v238
    v_and_b32 v237, 7, v215
    v_lshl_add_u32 v238, v237, 8, v238
    s_lshl_b32 s74, s75, 5
    v_lshl_add_u32 v208, v237, 3, s74
    v_add_u32 v212, s73, v238
    v_xor_b32 v214, 128, v212
    v_lshlrev_b32 v62, 4, v239
    s_lshl_b32 s73, s63, 2
    s_add_u32 s73, s73, s60
    s_mul_i32 s74, s73, 57
    s_lshr_b32 s74, s74, 9
    s_mul_i32 s74, s74, 9
    s_sub_u32 s74, s73, s74
    s_mul_i32 s74, s74, 12
    s_cmp_lt_u32 s73, 126
    s_cselect_b32 s74, s74, 0
    s_cselect_b32 s71, 32, 0
    v_lshl_add_u32 v238, s73, 4, v236
    v_lshlrev_b32 v244, 4, v238
    s_lshl_b32 s73, s73, 4
    s_sub_u32 s73, s73, s74
    s_mul_i32 s73, s73, 1280
    s_mul_i32 s74, s64, 160
    s_add_u32 s73, s73, s74
    v_lshrrev_b32 v238, 4, v215
    v_mad_u32_u24 v238, v238, s71, v236
    v_mul_u32_u24 v238, 1280, v238
    v_add3_u32 v240, v238, v63, s73
    v_lshrrev_b32 v238, 5, v215
    v_mad_u32_u24 v238, v238, s71, v239
    v_mul_u32_u24 v238, 1280, v238
    v_add3_u32 v207, v238, v208, s73
    s_add_u32 s72, s71, 4
    s_mul_i32 s72, s72, 2560
    s_lshl_b32 s71, s72, 1
    v_min_u32 v238, 39, v215
    v_lshl_add_u32 v209, v238, 2, s74
    s_waitcnt vmcnt(9)
    v_mfma_f32_16x16x32_bf16 v[64:67], a[0:3], v[0:3], 0
    s_add_u32 s78, s78, s77
    s_waitcnt vmcnt(8)
    v_mfma_f32_16x16x32_bf16 v[64:67], a[20:23], v[4:7], v[64:67]
    buffer_load_dwordx4 v[40:43], v213, s[48:51], s78 offen sc1
    v_mfma_f32_16x16x32_bf16 v[68:71], a[24:27], v[4:7], 0
    ds_read_b128 v[184:187], v249 offset:40960
    v_mfma_f32_16x16x32_bf16 v[68:71], a[4:7], v[0:3], v[68:71]
    global_load_dword v209, v209, s[20:21]
    v_mfma_f32_16x16x32_bf16 v[72:75], a[8:11], v[0:3], 0
L_padG4:
    s_cbranch_execz L_retG
    ds_read_b128 v[188:191], v249 offset:43008
    v_mfma_f32_16x16x32_bf16 v[72:75], a[28:31], v[4:7], v[72:75]
    s_add_u32 s78, s78, s77
    ds_read_b128 v[192:195], v249 offset:45056
    v_mfma_f32_16x16x32_bf16 v[76:79], a[32:35], v[4:7], 0
    buffer_load_dwordx4 v[44:47], v213, s[48:51], s78 offen sc1
    v_mfma_f32_16x16x32_bf16 v[76:79], a[12:15], v[0:3], v[76:79]
    s_add_u32 s98, s98, s97
    s_add_u32 m0, s81, 8192
    ds_read_b128 v[196:199], v249 offset:47104
    v_mfma_f32_16x16x32_bf16 v[80:83], a[16:19], v[0:3], 0
    buffer_load_dwordx4 v253, s[52:55], s98 offen offset:0 lds
    v_mfma_f32_16x16x32_bf16 v[80:83], a[36:39], v[4:7], v[80:83]
    s_waitcnt vmcnt(11)
    ds_read_b128 v[200:203], v249 offset:49152
    v_mfma_f32_16x16x32_bf16 v[64:67], a[40:43], v[8:11], v[64:67]
    s_add_u32 s78, s87, s76
    s_waitcnt vmcnt(10)
    ds_read_b128 v[216:219], v241 offset:40960
    v_mfma_f32_16x16x32_bf16 v[64:67], a[60:63], v[12:15], v[64:67]
    buffer_load_dwordx4 v[0:3], v213, s[48:51], s78 offen sc1
    v_mfma_f32_16x16x32_bf16 v[68:71], a[64:67], v[12:15], v[68:71]
    ds_read_b128 v[220:223], v241 offset:43008
    v_mfma_f32_16x16x32_bf16 v[68:71], a[44:47], v[8:11], v[68:71]
    ds_read_b128 v[224:227], v241 offset:45056
    v_mfma_f32_16x16x32_bf16 v[72:75], a[48:51], v[8:11], v[72:75]
    ds_read_b128 v[228:231], v241 offset:47104
    v_mfma_f32_16x16x32_bf16 v[72:75], a[68:71], v[12:15], v[72:75]
    s_add_u32 s78, s78, s77
    ds_read_b128 v[232:235], v241 offset:49152
    v_mfma_f32_16x16x32_bf16 v[76:79], a[72:75], v[12:15], v[76:79]
    buffer_load_dwordx4 v[4:7], v213, s[48:51], s78 offen sc1
    v_mfma_f32_16x16x32_bf16 v[76:79], a[52:55], v[8:11], v[76:79]
    v_mfma_f32_16x16x32_bf16 v[80:83], a[56:59], v[8:11], v[80:83]
    v_mfma_f32_16x16x32_bf16 v[80:83], a[76:79], v[12:15], v[80:83]
    s_waitcnt vmcnt(11)
    v_mfma_f32_16x16x32_bf16 v[64:67], a[80:83], v[16:19], v[64:67]
    s_add_u32 s78, s78, s77
    s_waitcnt vmcnt(10)
    v_mfma_f32_16x16x32_bf16 v[64:67], a[100:103], v[20:23], v[64:67]
    buffer_load_dwordx4 v[8:11], v213, s[48:51], s78 offen sc1
    v_mfma_f32_16x16x32_bf16 v[68:71], a[104:107], v[20:23], v[68:71]
    v_mfma_f32_16x16x32_bf16 v[68:71], a[84:87], v[16:19], v[68:71]
    v_mfma_f32_16x16x32_bf16 v[72:75], a[88:91], v[16:19], v[72:75]
    v_mfma_f32_16x16x32_bf16 v[72:75], a[108:111], v[20:23], v[72:75]
    s_add_u32 s78, s78, s77
    v_mfma_f32_16x16x32_bf16 v[76:79], a[112:115], v[20:23], v[76:79]
    buffer_load_dwordx4 v[12:15], v213, s[48:51], s78 offen sc1
    v_mfma_f32_16x16x32_bf16 v[76:79], a[92:95], v[16:19], v[76:79]
    v_mfma_f32_16x16x32_bf16 v[80:83], a[96:99], v[16:19], v[80:83]
    v_mfma_f32_16x16x32_bf16 v[80:83], a[116:119], v[20:23], v[80:83]
    s_waitcnt vmcnt(11)
    v_mfma_f32_16x16x32_bf16 v[64:67], a[120:123], v[24:27], v[64:67]
    s_add_u32 s78, s78, s77
    s_waitcnt vmcnt(10)
    v_mfma_f32_16x16x32_bf16 v[64:67], a[140:143], v[28:31], v[64:67]
    buffer_load_dwordx4 v[16:19], v213, s[48:51], s78 offen sc1
    v_mfma_f32_16x16x32_bf16 v[68:71], a[144:147], v[28:31], v[68:71]
    v_mfma_f32_16x16x32_bf16 v[68:71], a[124:127], v[24:27], v[68:71]
    v_mfma_f32_16x16x32_bf16 v[72:75], a[128:131], v[24:27], v[72:75]
    v_mfma_f32_16x16x32_bf16 v[72:75], a[148:151], v[28:31], v[72:75]
    s_add_u32 s78, s78, s77
    v_mfma_f32_16x16x32_bf16 v[76:79], a[152:155], v[28:31], v[76:79]
    buffer_load_dwordx4 v[20:23], v213, s[48:51], s78 offen sc1
    v_mfma_f32_16x16x32_bf16 v[76:79], a[132:135], v[24:27], v[76:79]
    v_mfma_f32_16x16x32_bf16 v[80:83], a[136:139], v[24:27], v[80:83]
    v_mfma_f32_16x16x32_bf16 v[80:83], a[156:159], v[28:31], v[80:83]
    s_waitcnt vmcnt(11)
    v_mfma_f32_16x16x32_bf16 v[64:67], a[160:163], v[32:35], v[64:67]
    s_add_u32 s78, s78, s77
    s_waitcnt vmcnt(10)
    v_mfma_f32_16x16x32_bf16 v[64:67], a[180:183], v[36:39], v[64:67]
    buffer_load_dwordx4 v[24:27], v213, s[48:51], s78 offen sc1
    v_mfma_f32_16x16x32_bf16 v[68:71], a[184:187], v[36:39], v[68:71]
    v_mfma_f32_16x16x32_bf16 v[68:71], a[164:167], v[32:35], v[68:71]
    v_mfma_f32_16x16x32_bf16 v[72:75], a[168:171], v[32:35], v[72:75]
    v_mfma_f32_16x16x32_bf16 v[72:75], a[188:191], v[36:39], v[72:75]
    s_add_u32 s78, s78, s77
    v_mfma_f32_16x16x32_bf16 v[76:79], a[192:195], v[36:39], v[76:79]
    buffer_load_dwordx4 v[28:31], v213, s[48:51], s78 offen sc1
    v_mfma_f32_16x16x32_bf16 v[76:79], a[172:175], v[32:35], v[76:79]
    v_mfma_f32_16x16x32_bf16 v[80:83], a[176:179], v[32:35], v[80:83]
    buffer_load_dwordx4 v254, s[52:55], s98 offen offset:1024 lds
    v_mfma_f32_16x16x32_bf16 v[80:83], a[196:199], v[36:39], v[80:83]
    s_waitcnt vmcnt(12)
    v_mfma_f32_16x16x32_bf16 v[64:67], a[200:203], v[40:43], v[64:67]
    s_add_u32 s78, s78, s77
    s_waitcnt vmcnt(10)
    v_mfma_f32_16x16x32_bf16 v[64:67], a[220:223], v[44:47], v[64:67]
    buffer_load_dwordx4 v[32:35], v213, s[48:51], s78 offen sc1
    v_mfma_f32_16x16x32_bf16 v[68:71], a[224:227], v[44:47], v[68:71]
    v_mfma_f32_16x16x32_bf16 v[68:71], a[204:207], v[40:43], v[68:71]
    buffer_load_dwordx4 v[244:247], v244, s[48:51], 0 offen sc1
    v_mfma_f32_16x16x32_bf16 v[72:75], a[208:211], v[40:43], v[72:75]
    v_mfma_f32_16x16x32_bf16 v[72:75], a[228:231], v[44:47], v[72:75]
    s_add_u32 s78, s78, s77
    v_mfma_f32_16x16x32_bf16 v[76:79], a[232:235], v[44:47], v[76:79]
    buffer_load_dwordx4 v[36:39], v213, s[48:51], s78 offen sc1
    v_mfma_f32_16x16x32_bf16 v[76:79], a[212:215], v[40:43], v[76:79]
    v_mfma_f32_16x16x32_bf16 v[80:83], a[216:219], v[40:43], v[80:83]
    v_mfma_f32_16x16x32_bf16 v[80:83], a[236:239], v[44:47], v[80:83]
    s_waitcnt vmcnt(11)
    v_mfma_f32_16x16x32_bf16 v[84:87], a[0:3], v[0:3], 0
    s_add_u32 s78, s78, s77
    s_waitcnt vmcnt(10)
    v_mfma_f32_16x16x32_bf16 v[84:87], a[20:23], v[4:7], v[84:87]
    buffer_load_dwordx4 v[40:43], v213, s[48:51], s78 offen sc1
    v_mfma_f32_16x16x32_bf16 v[88:91], a[24:27], v[4:7], 0
    v_mfma_f32_16x16x32_bf16 v[88:91], a[4:7], v[0:3], v[88:91]
    ds_write_b64 v204, v[64:65] offset:40960
    v_mfma_f32_16x16x32_bf16 v[92:95], a[8:11], v[0:3], 0
    v_mfma_f32_16x16x32_bf16 v[92:95], a[28:31], v[4:7], v[92:95]
    s_add_u32 s78, s78, s77
    ds_write_b64 v204, v[66:67] offset:40968
    v_mfma_f32_16x16x32_bf16 v[96:99], a[32:35], v[4:7], 0
    buffer_load_dwordx4 v[44:47], v213, s[48:51], s78 offen sc1
    v_mfma_f32_16x16x32_bf16 v[96:99], a[12:15], v[0:3], v[96:99]
    v_mfma_f32_16x16x32_bf16 v[100:103], a[16:19], v[0:3], 0
    ds_write_b64 v204, v[68:69] offset:41984
    v_mfma_f32_16x16x32_bf16 v[100:103], a[36:39], v[4:7], v[100:103]
    s_add_u32 s78, s88, s76
    s_waitcnt vmcnt(11)
    v_mfma_f32_16x16x32_bf16 v[84:87], a[40:43], v[8:11], v[84:87]
    s_waitcnt vmcnt(10)
    ds_write_b64 v204, v[70:71] offset:41992
    v_mfma_f32_16x16x32_bf16 v[84:87], a[60:63], v[12:15], v[84:87]
    buffer_load_dwordx4 v[0:3], v213, s[48:51], s78 offen sc1
    v_mfma_f32_16x16x32_bf16 v[88:91], a[64:67], v[12:15], v[88:91]
    v_mfma_f32_16x16x32_bf16 v[88:91], a[44:47], v[8:11], v[88:91]
    ds_write_b64 v204, v[72:73] offset:43008
    v_mfma_f32_16x16x32_bf16 v[92:95], a[48:51], v[8:11], v[92:95]
    v_mfma_f32_16x16x32_bf16 v[92:95], a[68:71], v[12:15], v[92:95]
    s_add_u32 s78, s78, s77
    ds_write_b64 v204, v[74:75] offset:43016
    v_mfma_f32_16x16x32_bf16 v[96:99], a[72:75], v[12:15], v[96:99]
    buffer_load_dwordx4 v[4:7], v213, s[48:51], s78 offen sc1
    v_mfma_f32_16x16x32_bf16 v[96:99], a[52:55], v[8:11], v[96:99]
    v_mfma_f32_16x16x32_bf16 v[100:103], a[56:59], v[8:11], v[100:103]
    ds_write_b64 v204, v[76:77] offset:44032
    v_mfma_f32_16x16x32_bf16 v[100:103], a[76:79], v[12:15], v[100:103]
    s_add_u32 s78, s78, s77
    s_waitcnt vmcnt(11)
    v_mfma_f32_16x16x32_bf16 v[84:87], a[80:83], v[16:19], v[84:87]
    s_waitcnt vmcnt(10)
    ds_write_b64 v204, v[78:79] offset:44040
    v_mfma_f32_16x16x32_bf16 v[84:87], a[100:103], v[20:23], v[84:87]
    buffer_load_dwordx4 v[8:11], v213, s[48:51], s78 offen sc1
    v_mfma_f32_16x16x32_bf16 v[88:91], a[104:107], v[20:23], v[88:91]
    v_mfma_f32_16x16x32_bf16 v[88:91], a[84:87], v[16:19], v[88:91]
    ds_write_b64 v204, v[80:81] offset:45056
    v_mfma_f32_16x16x32_bf16 v[92:95], a[88:91], v[16:19], v[92:95]
    v_mfma_f32_16x16x32_bf16 v[92:95], a[108:111], v[20:23], v[92:95]
    s_add_u32 s78, s78, s77
    ds_write_b64 v204, v[82:83] offset:45064
    v_mfma_f32_16x16x32_bf16 v[96:99], a[112:115], v[20:23], v[96:99]
    buffer_load_dwordx4 v[12:15], v213, s[48:51], s78 offen sc1
    v_mfma_f32_16x16x32_bf16 v[96:99], a[92:95], v[16:19], v[96:99]
    v_mfma_f32_16x16x32_bf16 v[100:103], a[96:99], v[16:19], v[100:103]
    v_mfma_f32_16x16x32_bf16 v[100:103], a[116:119], v[20:23], v[100:103]
    s_waitcnt lgkmcnt(0)
    s_barrier
    s_waitcnt vmcnt(11)
    v_mfma_f32_16x16x32_bf16 v[84:87], a[120:123], v[24:27], v[84:87]
    s_add_u32 s78, s78, s77
    s_waitcnt vmcnt(10)
    ds_read_b128 v[64:67], v205 offset:40960
    v_mfma_f32_16x16x32_bf16 v[84:87], a[140:143], v[28:31], v[84:87]
    buffer_load_dwordx4 v[16:19], v213, s[48:51], s78 offen sc1
    v_mfma_f32_16x16x32_bf16 v[88:91], a[144:147], v[28:31], v[88:91]
    ds_read_b128 v[68:71], v205 offset:41984
    v_mfma_f32_16x16x32_bf16 v[88:91], a[124:127], v[24:27], v[88:91]
    ds_read_b128 v[72:75], v205 offset:43008
    v_mfma_f32_16x16x32_bf16 v[92:95], a[128:131], v[24:27], v[92:95]
    ds_read_b128 v[76:79], v205 offset:44032
    v_mfma_f32_16x16x32_bf16 v[92:95], a[148:151], v[28:31], v[92:95]
    s_add_u32 s78, s78, s77
    ds_read_b128 v[80:83], v205 offset:45056
    v_mfma_f32_16x16x32_bf16 v[96:99], a[152:155], v[28:31], v[96:99]
    buffer_load_dwordx4 v[20:23], v213, s[48:51], s78 offen sc1
    v_mfma_f32_16x16x32_bf16 v[96:99], a[132:135], v[24:27], v[96:99]
    ds_bpermute_b32 v126, v208, v209 offset:0
    v_mfma_f32_16x16x32_bf16 v[100:103], a[136:139], v[24:27], v[100:103]
    s_add_u32 s78, s78, s77
    ds_bpermute_b32 v127, v208, v209 offset:4
    v_mfma_f32_16x16x32_bf16 v[100:103], a[156:159], v[28:31], v[100:103]
    s_waitcnt vmcnt(10)
    ds_bpermute_b32 v130, v208, v209 offset:0
    v_mfma_f32_16x16x32_bf16 v[84:87], a[160:163], v[32:35], v[84:87]
    s_waitcnt vmcnt(8)
    ds_bpermute_b32 v131, v208, v209 offset:4
    v_mfma_f32_16x16x32_bf16 v[84:87], a[180:183], v[36:39], v[84:87]
    buffer_load_dwordx4 v[24:27], v213, s[48:51], s78 offen sc1
    v_mfma_f32_16x16x32_bf16 v[88:91], a[184:187], v[36:39], v[88:91]
    ds_bpermute_b32 v134, v208, v209 offset:64
    v_mfma_f32_16x16x32_bf16 v[88:91], a[164:167], v[32:35], v[88:91]
    ds_bpermute_b32 v135, v208, v209 offset:68
    v_mfma_f32_16x16x32_bf16 v[92:95], a[168:171], v[32:35], v[92:95]
    ds_bpermute_b32 v138, v208, v209 offset:64
    v_mfma_f32_16x16x32_bf16 v[92:95], a[188:191], v[36:39], v[92:95]
    s_add_u32 s78, s78, s77
    ds_bpermute_b32 v139, v208, v209 offset:68
    v_mfma_f32_16x16x32_bf16 v[96:99], a[192:195], v[36:39], v[96:99]
    buffer_load_dwordx4 v[28:31], v213, s[48:51], s78 offen sc1
    v_mfma_f32_16x16x32_bf16 v[96:99], a[172:175], v[32:35], v[96:99]
    ds_bpermute_b32 v142, v63, v209 offset:0
    v_mfma_f32_16x16x32_bf16 v[100:103], a[176:179], v[32:35], v[100:103]
    ds_bpermute_b32 v143, v63, v209 offset:4
    v_mfma_f32_16x16x32_bf16 v[100:103], a[196:199], v[36:39], v[100:103]
    s_waitcnt vmcnt(9)
    v_mfma_f32_16x16x32_bf16 v[84:87], a[200:203], v[40:43], v[84:87]
    s_add_u32 s78, s78, s77
    s_waitcnt vmcnt(8)
    v_mfma_f32_16x16x32_bf16 v[84:87], a[220:223], v[44:47], v[84:87]
    buffer_load_dwordx4 v[32:35], v213, s[48:51], s78 offen sc1
    v_mfma_f32_16x16x32_bf16 v[88:91], a[224:227], v[44:47], v[88:91]
    s_waitcnt lgkmcnt(9)
    v_lshlrev_b32 v124, 16, v126
    v_and_b32 v125, s70, v126
    v_mfma_f32_16x16x32_bf16 v[88:91], a[204:207], v[40:43], v[88:91]
    s_waitcnt lgkmcnt(8)
    v_lshlrev_b32 v126, 16, v127
    v_and_b32 v127, s70, v127
    v_mfma_f32_16x16x32_bf16 v[92:95], a[208:211], v[40:43], v[92:95]
    s_waitcnt lgkmcnt(7)
    v_lshlrev_b32 v128, 16, v130
    v_and_b32 v129, s70, v130
    v_mfma_f32_16x16x32_bf16 v[92:95], a[228:231], v[44:47], v[92:95]
    s_waitcnt lgkmcnt(6)
    v_lshlrev_b32 v130, 16, v131
    v_and_b32 v131, s70, v131
    v_mfma_f32_16x16x32_bf16 v[96:99], a[232:235], v[44:47], v[96:99]
    s_add_u32 s78, s78, s77
    buffer_load_dwordx4 v[36:39], v213, s[48:51], s78 offen sc1
    v_mfma_f32_16x16x32_bf16 v[96:99], a[212:215], v[40:43], v[96:99]
    s_waitcnt lgkmcnt(5)
    v_lshlrev_b32 v132, 16, v134
    v_and_b32 v133, s70, v134
    v_mfma_f32_16x16x32_bf16 v[100:103], a[216:219], v[40:43], v[100:103]
    s_waitcnt lgkmcnt(4)
    v_lshlrev_b32 v134, 16, v135
    v_and_b32 v135, s70, v135
    v_mfma_f32_16x16x32_bf16 v[100:103], a[236:239], v[44:47], v[100:103]
    s_waitcnt vmcnt(9) lgkmcnt(3)
    v_lshlrev_b32 v136, 16, v138
    v_and_b32 v137, s70, v138
    v_mfma_f32_16x16x32_bf16 v[64:67], a[0:3], v[0:3], v[64:67]
    s_waitcnt vmcnt(8) lgkmcnt(2)
    v_lshlrev_b32 v138, 16, v139
    v_and_b32 v139, s70, v139
    v_mfma_f32_16x16x32_bf16 v[64:67], a[20:23], v[4:7], v[64:67]
    s_add_u32 s78, s78, s77
    buffer_load_dwordx4 v[40:43], v213, s[48:51], s78 offen sc1
    v_mfma_f32_16x16x32_bf16 v[68:71], a[24:27], v[4:7], v[68:71]
    s_waitcnt lgkmcnt(1)
    v_lshlrev_b32 v140, 16, v142
    v_and_b32 v141, s70, v142
    v_mfma_f32_16x16x32_bf16 v[68:71], a[4:7], v[0:3], v[68:71]
    ds_write_b64 v204, v[84:85] offset:46080
    v_mfma_f32_16x16x32_bf16 v[72:75], a[8:11], v[0:3], v[72:75]
    s_waitcnt lgkmcnt(1)
    v_lshlrev_b32 v142, 16, v143
    v_and_b32 v143, s70, v143
    v_mfma_f32_16x16x32_bf16 v[72:75], a[28:31], v[4:7], v[72:75]
    s_add_u32 s78, s78, s77
    ds_write_b64 v204, v[86:87] offset:46088
    v_mfma_f32_16x16x32_bf16 v[76:79], a[32:35], v[4:7], v[76:79]
    buffer_load_dwordx4 v[44:47], v213, s[48:51], s78 offen sc1
    v_mfma_f32_16x16x32_bf16 v[76:79], a[12:15], v[0:3], v[76:79]
    v_mul_f32 v246, 1060205080, v246
    v_mfma_f32_16x16x32_bf16 v[80:83], a[16:19], v[0:3], v[80:83]
    ds_write_b64 v204, v[88:89] offset:47104
    v_mfma_f32_16x16x32_bf16 v[80:83], a[36:39], v[4:7], v[80:83]
    s_add_u32 s78, s89, s76
    s_waitcnt vmcnt(9)
    v_mul_f32 v245, v244, v246
    v_mfma_f32_16x16x32_bf16 v[64:67], a[40:43], v[8:11], v[64:67]
    s_waitcnt vmcnt(8)
    ds_write_b64 v204, v[90:91] offset:47112
    v_mfma_f32_16x16x32_bf16 v[64:67], a[60:63], v[12:15], v[64:67]
    buffer_load_dwordx4 v[0:3], v213, s[48:51], s78 offen sc1
    v_mfma_f32_16x16x32_bf16 v[68:71], a[64:67], v[12:15], v[68:71]
    v_mfma_f32_16x16x32_bf16 v[68:71], a[44:47], v[8:11], v[68:71]
    ds_write_b64 v204, v[92:93] offset:48128
    v_mfma_f32_16x16x32_bf16 v[72:75], a[48:51], v[8:11], v[72:75]
    v_mfma_f32_16x16x32_bf16 v[72:75], a[68:71], v[12:15], v[72:75]
    s_add_u32 s78, s78, s77
    ds_write_b64 v204, v[94:95] offset:48136
    v_mfma_f32_16x16x32_bf16 v[76:79], a[72:75], v[12:15], v[76:79]
    buffer_load_dwordx4 v[4:7], v213, s[48:51], s78 offen sc1
    v_mfma_f32_16x16x32_bf16 v[76:79], a[52:55], v[8:11], v[76:79]
    v_mfma_f32_16x16x32_bf16 v[80:83], a[56:59], v[8:11], v[80:83]
    ds_write_b64 v204, v[96:97] offset:49152
    v_mfma_f32_16x16x32_bf16 v[80:83], a[76:79], v[12:15], v[80:83]
    s_add_u32 s78, s78, s77
    s_waitcnt vmcnt(9)
    v_mfma_f32_16x16x32_bf16 v[64:67], a[80:83], v[16:19], v[64:67]
    s_waitcnt vmcnt(8)
    ds_write_b64 v204, v[98:99] offset:49160
    v_mfma_f32_16x16x32_bf16 v[64:67], a[100:103], v[20:23], v[64:67]
    buffer_load_dwordx4 v[8:11], v213, s[48:51], s78 offen sc1
    v_mfma_f32_16x16x32_bf16 v[68:71], a[104:107], v[20:23], v[68:71]
    v_mfma_f32_16x16x32_bf16 v[68:71], a[84:87], v[16:19], v[68:71]
    ds_write_b64 v204, v[100:101] offset:50176
    v_mfma_f32_16x16x32_bf16 v[72:75], a[88:91], v[16:19], v[72:75]
    v_mfma_f32_16x16x32_bf16 v[72:75], a[108:111], v[20:23], v[72:75]
    s_add_u32 s78, s78, s77
    ds_write_b64 v204, v[102:103] offset:50184
    v_mfma_f32_16x16x32_bf16 v[76:79], a[112:115], v[20:23], v[76:79]
    buffer_load_dwordx4 v[12:15], v213, s[48:51], s78 offen sc1
    v_mfma_f32_16x16x32_bf16 v[76:79], a[92:95], v[16:19], v[76:79]
    buffer_load_dword v252, v250, s[48:51], 0 offen sc1
    v_mfma_f32_16x16x32_bf16 v[80:83], a[96:99], v[16:19], v[80:83]
    v_mfma_f32_16x16x32_bf16 v[80:83], a[116:119], v[20:23], v[80:83]
    s_waitcnt lgkmcnt(0)
    s_barrier
    s_waitcnt vmcnt(10)
    v_mfma_f32_16x16x32_bf16 v[64:67], a[120:123], v[24:27], v[64:67]
    s_add_u32 s78, s78, s77
    s_waitcnt vmcnt(9)
    ds_read_b128 v[84:87], v205 offset:46080
    v_mfma_f32_16x16x32_bf16 v[64:67], a[140:143], v[28:31], v[64:67]
    buffer_load_dwordx4 v[16:19], v213, s[48:51], s78 offen sc1
    v_mfma_f32_16x16x32_bf16 v[68:71], a[144:147], v[28:31], v[68:71]
    ds_read_b128 v[88:91], v205 offset:47104
    v_mfma_f32_16x16x32_bf16 v[68:71], a[124:127], v[24:27], v[68:71]
    ds_read_b128 v[92:95], v205 offset:48128
    v_mfma_f32_16x16x32_bf16 v[72:75], a[128:131], v[24:27], v[72:75]
    ds_read_b128 v[96:99], v205 offset:49152
    v_mfma_f32_16x16x32_bf16 v[72:75], a[148:151], v[28:31], v[72:75]
    s_add_u32 s78, s78, s77
    ds_read_b128 v[100:103], v205 offset:50176
    v_mfma_f32_16x16x32_bf16 v[76:79], a[152:155], v[28:31], v[76:79]
    buffer_load_dwordx4 v[20:23], v213, s[48:51], s78 offen sc1
    v_mfma_f32_16x16x32_bf16 v[76:79], a[132:135], v[24:27], v[76:79]
    ds_bpermute_b32 v58, v62, v245 offset:0
    v_mfma_f32_16x16x32_bf16 v[80:83], a[136:139], v[24:27], v[80:83]
    s_add_u32 s78, s78, s77
    buffer_load_dwordx2 v[48:49], v207, s[36:39], 0 offen offset:0
    v_mfma_f32_16x16x32_bf16 v[80:83], a[156:159], v[28:31], v[80:83]
    s_waitcnt vmcnt(11)
    ds_bpermute_b32 v59, v62, v246 offset:0
    v_mfma_f32_16x16x32_bf16 v[64:67], a[160:163], v[32:35], v[64:67]
    s_waitcnt vmcnt(10)
    ds_bpermute_b32 v60, v62, v245 offset:128
    v_mfma_f32_16x16x32_bf16 v[64:67], a[180:183], v[36:39], v[64:67]
    buffer_load_dwordx4 v[24:27], v213, s[48:51], s78 offen sc1
    v_mfma_f32_16x16x32_bf16 v[68:71], a[184:187], v[36:39], v[68:71]
    ds_bpermute_b32 v61, v62, v246 offset:128
    v_mfma_f32_16x16x32_bf16 v[68:71], a[164:167], v[32:35], v[68:71]
    buffer_load_dwordx2 v[50:51], v207, s[36:39], s72 offen offset:0
    v_mfma_f32_16x16x32_bf16 v[72:75], a[168:171], v[32:35], v[72:75]
    v_mfma_f32_16x16x32_bf16 v[72:75], a[188:191], v[36:39], v[72:75]
    s_add_u32 s78, s78, s77
    v_mfma_f32_16x16x32_bf16 v[76:79], a[192:195], v[36:39], v[76:79]
    buffer_load_dwordx4 v[28:31], v213, s[48:51], s78 offen sc1
    v_mfma_f32_16x16x32_bf16 v[76:79], a[172:175], v[32:35], v[76:79]
    v_mfma_f32_16x16x32_bf16 v[80:83], a[176:179], v[32:35], v[80:83]
    buffer_load_dwordx2 v[52:53], v207, s[36:39], 0 offen offset:64
    v_mfma_f32_16x16x32_bf16 v[80:83], a[196:199], v[36:39], v[80:83]
    s_waitcnt vmcnt(13)
    v_mfma_f32_16x16x32_bf16 v[64:67], a[200:203], v[40:43], v[64:67]
    s_add_u32 s78, s78, s77
    s_waitcnt vmcnt(12)
    v_mfma_f32_16x16x32_bf16 v[64:67], a[220:223], v[44:47], v[64:67]
    buffer_load_dwordx4 v[32:35], v213, s[48:51], s78 offen sc1
    v_mfma_f32_16x16x32_bf16 v[68:71], a[224:227], v[44:47], v[68:71]
    v_mfma_f32_16x16x32_bf16 v[68:71], a[204:207], v[40:43], v[68:71]
    buffer_load_dwordx2 v[54:55], v207, s[36:39], s72 offen offset:64
    v_mfma_f32_16x16x32_bf16 v[72:75], a[208:211], v[40:43], v[72:75]
    v_mfma_f32_16x16x32_bf16 v[72:75], a[228:231], v[44:47], v[72:75]
    s_add_u32 s78, s78, s77
    v_mfma_f32_16x16x32_bf16 v[76:79], a[232:235], v[44:47], v[76:79]
    buffer_load_dwordx4 v[36:39], v213, s[48:51], s78 offen sc1
    v_mfma_f32_16x16x32_bf16 v[76:79], a[212:215], v[40:43], v[76:79]
    s_waitcnt lgkmcnt(4)
    v_mfma_f32_16x16x32_bf16 v[80:83], a[216:219], v[40:43], v[80:83]
    buffer_load_dwordx2 v[56:57], v240, s[36:39], 0 offen offset:0
    v_mfma_f32_16x16x32_bf16 v[80:83], a[236:239], v[44:47], v[80:83]
    s_waitcnt vmcnt(15)
    v_mfma_f32_16x16x32_bf16 v[84:87], a[0:3], v[0:3], v[84:87]
    s_add_u32 s78, s78, s77
    s_waitcnt vmcnt(14)
    v_mfma_f32_16x16x32_bf16 v[84:87], a[20:23], v[4:7], v[84:87]
    buffer_load_dwordx4 v[40:43], v213, s[48:51], s78 offen sc1
    v_mfma_f32_16x16x32_bf16 v[88:91], a[24:27], v[4:7], v[88:91]
    v_mfma_f32_16x16x32_bf16 v[88:91], a[4:7], v[0:3], v[88:91]
    ds_write_b128 v204, v[64:67] offset:40960
    v_mfma_f32_16x16x32_bf16 v[92:95], a[8:11], v[0:3], v[92:95]
    s_waitcnt vmcnt(12)
    v_cmp_ne_u32 vcc, s82, v252
    v_mfma_f32_16x16x32_bf16 v[92:95], a[28:31], v[4:7], v[92:95]
    s_add_u32 s78, s78, s77
    v_mfma_f32_16x16x32_bf16 v[96:99], a[32:35], v[4:7], v[96:99]
    buffer_load_dwordx4 v[44:47], v213, s[48:51], s78 offen sc1
    v_mfma_f32_16x16x32_bf16 v[96:99], a[12:15], v[0:3], v[96:99]
    s_cbranch_vccnz L_slow_11
L_ok_9:
    v_mfma_f32_16x16x32_bf16 v[100:103], a[16:19], v[0:3], v[100:103]
    ds_write_b128 v204, v[68:71] offset:41984
    v_mfma_f32_16x16x32_bf16 v[100:103], a[36:39], v[4:7], v[100:103]
    v_mfma_f32_16x16x32_bf16 v[84:87], a[40:43], v[8:11], v[84:87]
    s_add_u32 s78, s86, s90
    ds_read_b128 a[0:3], v210 offset:0
    v_mfma_f32_16x16x32_bf16 v[84:87], a[60:63], v[12:15], v[84:87]
    buffer_load_dwordx4 v[0:3], v213, s[48:51], s78 offen sc1
    v_mfma_f32_16x16x32_bf16 v[88:91], a[64:67], v[12:15], v[88:91]
    v_mfma_f32_16x16x32_bf16 v[88:91], a[44:47], v[8:11], v[88:91]
    ds_write_b128 v204, v[72:75] offset:43008
    v_mfma_f32_16x16x32_bf16 v[92:95], a[48:51], v[8:11], v[92:95]
    v_mfma_f32_16x16x32_bf16 v[92:95], a[68:71], v[12:15], v[92:95]
    s_add_u32 s78, s78, s77
    ds_read_b128 a[4:7], v210 offset:2048
    v_mfma_f32_16x16x32_bf16 v[96:99], a[72:75], v[12:15], v[96:99]
    buffer_load_dwordx4 v[4:7], v213, s[48:51], s78 offen sc1
    v_mfma_f32_16x16x32_bf16 v[96:99], a[52:55], v[8:11], v[96:99]
    v_mfma_f32_16x16x32_bf16 v[100:103], a[56:59], v[8:11], v[100:103]
    ds_write_b128 v204, v[76:79] offset:44032
    v_mfma_f32_16x16x32_bf16 v[100:103], a[76:79], v[12:15], v[100:103]
    s_waitcnt vmcnt(14)
    v_mfma_f32_16x16x32_bf16 v[84:87], a[80:83], v[16:19], v[84:87]
    s_add_u32 s78, s78, s77
    s_waitcnt vmcnt(13)
    ds_read_b128 a[8:11], v210 offset:4096
    v_mfma_f32_16x16x32_bf16 v[84:87], a[100:103], v[20:23], v[84:87]
    buffer_load_dwordx4 v[8:11], v213, s[48:51], s78 offen sc1
    v_mfma_f32_16x16x32_bf16 v[88:91], a[104:107], v[20:23], v[88:91]
    v_mfma_f32_16x16x32_bf16 v[88:91], a[84:87], v[16:19], v[88:91]
    ds_write_b128 v204, v[80:83] offset:45056
    v_mfma_f32_16x16x32_bf16 v[92:95], a[88:91], v[16:19], v[92:95]
    v_mfma_f32_16x16x32_bf16 v[92:95], a[108:111], v[20:23], v[92:95]
    s_add_u32 s78, s78, s77
    ds_read_b128 a[12:15], v210 offset:6144
    v_mfma_f32_16x16x32_bf16 v[96:99], a[112:115], v[20:23], v[96:99]
    buffer_load_dwordx4 v[12:15], v213, s[48:51], s78 offen sc1
    v_mfma_f32_16x16x32_bf16 v[96:99], a[92:95], v[16:19], v[96:99]
    s_add_u32 s78, s78, s77
    v_mfma_f32_16x16x32_bf16 v[100:103], a[96:99], v[16:19], v[100:103]
    s_waitcnt vmcnt(14)
    v_lshlrev_b32 v236, 16, v48
    v_and_b32 v237, s70, v48
    v_mfma_f32_16x16x32_bf16 v[100:103], a[116:119], v[20:23], v[100:103]
    s_waitcnt lgkmcnt(1)
    s_barrier
    s_waitcnt vmcnt(13)
    v_mfma_f32_16x16x32_bf16 v[84:87], a[120:123], v[24:27], v[84:87]
    s_waitcnt vmcnt(11)
    ds_read_b128 v[104:107], v212 offset:40960
    v_lshlrev_b32 v238, 16, v49
    v_mfma_f32_16x16x32_bf16 v[84:87], a[140:143], v[28:31], v[84:87]
    buffer_load_dwordx4 v[16:19], v213, s[48:51], s78 offen sc1
    v_mfma_f32_16x16x32_bf16 v[88:91], a[144:147], v[28:31], v[88:91]
    ds_read_b128 v[108:111], v214 offset:40960
    v_and_b32 v239, s70, v49
    v_mfma_f32_16x16x32_bf16 v[88:91], a[124:127], v[24:27], v[88:91]
    ds_read_b128 v[112:115], v212 offset:43008
    v_fma_f32 v236, v236, v59, -v58
    v_mfma_f32_16x16x32_bf16 v[92:95], a[128:131], v[24:27], v[92:95]
    ds_read_b128 v[116:119], v214 offset:43008
    v_fma_f32 v237, v237, v59, -v58
    v_mfma_f32_16x16x32_bf16 v[92:95], a[148:151], v[28:31], v[92:95]
    s_add_u32 s78, s78, s77
    ds_read_b128 v[120:123], v206 offset:40960
    v_fma_f32 v238, v238, v59, -v58
    v_mfma_f32_16x16x32_bf16 v[96:99], a[152:155], v[28:31], v[96:99]
    buffer_load_dwordx4 v[20:23], v213, s[48:51], s78 offen sc1
    v_mfma_f32_16x16x32_bf16 v[96:99], a[132:135], v[24:27], v[96:99]
    v_add_u32 v212, s91, v212
    v_add_u32 v214, s91, v214
    v_mfma_f32_16x16x32_bf16 v[100:103], a[136:139], v[24:27], v[100:103]
    s_add_u32 s78, s78, s77
    v_add_u32 v206, s91, v206
    v_fma_f32 v239, v239, v59, -v58
    v_mfma_f32_16x16x32_bf16 v[100:103], a[156:159], v[28:31], v[100:103]
    s_waitcnt vmcnt(11)
    ds_read_b128 a[16:19], v210 offset:8192
    v_mul_f32 v124, v124, v236
    v_mfma_f32_16x16x32_bf16 v[84:87], a[160:163], v[32:35], v[84:87]
    s_waitcnt vmcnt(9)
    ds_read_b128 a[20:23], v211 offset:0
    v_mul_f32 v125, v125, v237
    v_mfma_f32_16x16x32_bf16 v[84:87], a[180:183], v[36:39], v[84:87]
    buffer_load_dwordx4 v[24:27], v213, s[48:51], s78 offen sc1
    v_mfma_f32_16x16x32_bf16 v[88:91], a[184:187], v[36:39], v[88:91]
    ds_read_b128 a[24:27], v211 offset:2048
    v_mul_f32 v126, v126, v238
    v_mfma_f32_16x16x32_bf16 v[88:91], a[164:167], v[32:35], v[88:91]
    ds_read_b128 a[28:31], v211 offset:4096
    v_mul_f32 v127, v127, v239
    v_mfma_f32_16x16x32_bf16 v[92:95], a[168:171], v[32:35], v[92:95]
    ds_read_b128 a[32:35], v211 offset:6144
    v_lshlrev_b32 v236, 16, v50
    v_mfma_f32_16x16x32_bf16 v[92:95], a[188:191], v[36:39], v[92:95]
    s_add_u32 s78, s78, s77
    ds_read_b128 a[36:39], v211 offset:8192
    v_and_b32 v237, s70, v50
    v_mfma_f32_16x16x32_bf16 v[96:99], a[192:195], v[36:39], v[96:99]
    buffer_load_dwordx4 v[28:31], v213, s[48:51], s78 offen sc1
    v_mfma_f32_16x16x32_bf16 v[96:99], a[172:175], v[32:35], v[96:99]
    ds_read_b128 a[40:43], v210 offset:40960
    v_lshlrev_b32 v238, 16, v51
    v_mfma_f32_16x16x32_bf16 v[100:103], a[176:179], v[32:35], v[100:103]
    s_add_u32 s78, s78, s77
    ds_read_b128 a[44:47], v210 offset:43008
    v_and_b32 v239, s70, v51
    v_mfma_f32_16x16x32_bf16 v[100:103], a[196:199], v[36:39], v[100:103]
    s_waitcnt vmcnt(9)
    ds_read_b128 a[48:51], v210 offset:45056
    v_fma_f32 v236, v236, v61, -v60
    v_mfma_f32_16x16x32_bf16 v[84:87], a[200:203], v[40:43], v[84:87]
    s_waitcnt vmcnt(8)
    ds_read_b128 a[52:55], v210 offset:47104
    v_fma_f32 v237, v237, v61, -v60
    v_mfma_f32_16x16x32_bf16 v[84:87], a[220:223], v[44:47], v[84:87]
    buffer_load_dwordx4 v[32:35], v213, s[48:51], s78 offen sc1
    v_mfma_f32_16x16x32_bf16 v[88:91], a[224:227], v[44:47], v[88:91]
    ds_read_b128 a[56:59], v210 offset:49152
    v_fma_f32 v238, v238, v61, -v60
    v_mfma_f32_16x16x32_bf16 v[88:91], a[204:207], v[40:43], v[88:91]
    ds_read_b128 a[60:63], v211 offset:40960
    v_fma_f32 v239, v239, v61, -v60
    v_mfma_f32_16x16x32_bf16 v[92:95], a[208:211], v[40:43], v[92:95]
    ds_read_b128 a[64:67], v211 offset:43008
    v_mul_f32 v128, v128, v236
    v_mfma_f32_16x16x32_bf16 v[92:95], a[228:231], v[44:47], v[92:95]
    s_add_u32 s78, s78, s77
    ds_read_b128 a[68:71], v211 offset:45056
    v_mul_f32 v129, v129, v237
    v_mfma_f32_16x16x32_bf16 v[96:99], a[232:235], v[44:47], v[96:99]
    buffer_load_dwordx4 v[36:39], v213, s[48:51], s78 offen sc1
    v_mfma_f32_16x16x32_bf16 v[96:99], a[212:215], v[40:43], v[96:99]
    ds_read_b128 a[72:75], v211 offset:47104
    v_mul_f32 v130, v130, v238
    v_mfma_f32_16x16x32_bf16 v[100:103], a[216:219], v[40:43], v[100:103]
    ds_read_b128 a[76:79], v211 offset:49152
    v_mul_f32 v131, v131, v239
    v_mfma_f32_16x16x32_bf16 v[100:103], a[236:239], v[44:47], v[100:103]
    s_add_u32 s78, s87, s90
    s_waitcnt vmcnt(9)
    ds_read_b128 a[80:83], v249 offset:0
    v_mfma_f32_16x16x32_bf16 a[120:123], v[144:147], v[0:3], 0
    s_waitcnt vmcnt(8)
    ds_read_b128 a[84:87], v249 offset:2048
    v_lshlrev_b32 v236, 16, v52
    v_mfma_f32_16x16x32_bf16 a[120:123], v[164:167], v[4:7], a[120:123]
    buffer_load_dwordx4 v[40:43], v213, s[48:51], s78 offen sc1
    v_mfma_f32_16x16x32_bf16 a[124:127], v[168:171], v[4:7], 0
    ds_read_b128 a[88:91], v249 offset:4096
    v_and_b32 v237, s70, v52
    v_mfma_f32_16x16x32_bf16 a[124:127], v[148:151], v[0:3], a[124:127]
    ds_read_b128 a[92:95], v249 offset:6144
    v_lshlrev_b32 v238, 16, v53
    v_mfma_f32_16x16x32_bf16 a[128:131], v[152:155], v[0:3], 0
    ds_read_b128 a[96:99], v249 offset:8192
    v_and_b32 v239, s70, v53
    v_mfma_f32_16x16x32_bf16 a[128:131], v[172:175], v[4:7], a[128:131]
    s_add_u32 s78, s78, s77
    ds_read_b128 a[100:103], v241 offset:0
    v_fma_f32 v236, v236, v59, -v58
    v_mfma_f32_16x16x32_bf16 a[132:135], v[176:179], v[4:7], 0
    buffer_load_dwordx4 v[44:47], v213, s[48:51], s78 offen sc1
    v_mfma_f32_16x16x32_bf16 a[132:135], v[156:159], v[0:3], a[132:135]
    ds_read_b128 a[104:107], v241 offset:2048
    v_fma_f32 v237, v237, v59, -v58
    v_mfma_f32_16x16x32_bf16 a[136:139], v[160:163], v[0:3], 0
    s_add_u32 s78, s78, s77
    ds_read_b128 a[108:111], v241 offset:4096
    v_fma_f32 v238, v238, v59, -v58
    v_mfma_f32_16x16x32_bf16 a[136:139], v[180:183], v[4:7], a[136:139]
    s_waitcnt vmcnt(9)
    ds_read_b128 a[112:115], v241 offset:6144
    v_fma_f32 v239, v239, v59, -v58
    v_mfma_f32_16x16x32_bf16 a[120:123], v[184:187], v[8:11], a[120:123]
    s_waitcnt vmcnt(8)
    ds_read_b128 a[116:119], v241 offset:8192
    v_mul_f32 v132, v132, v236
    v_mfma_f32_16x16x32_bf16 a[120:123], v[216:219], v[12:15], a[120:123]
    buffer_load_dwordx4 v[0:3], v213, s[48:51], s78 offen sc1
    v_mfma_f32_16x16x32_bf16 a[124:127], v[220:223], v[12:15], a[124:127]
    v_mul_f32 v133, v133, v237
    v_mul_f32 v134, v134, v238
    v_mfma_f32_16x16x32_bf16 a[124:127], v[188:191], v[8:11], a[124:127]
    ds_write_b128 v204, v[84:87] offset:46080
    v_mfma_f32_16x16x32_bf16 a[128:131], v[192:195], v[8:11], a[128:131]
    v_add_u32 v205, 40960, v205
    v_mul_f32 v135, v135, v239
    v_mfma_f32_16x16x32_bf16 a[128:131], v[224:227], v[12:15], a[128:131]
    s_add_u32 s78, s78, s77
    v_lshlrev_b32 v236, 16, v54
    v_and_b32 v237, s70, v54
    v_mfma_f32_16x16x32_bf16 a[132:135], v[228:231], v[12:15], a[132:135]
    buffer_load_dwordx4 v[4:7], v213, s[48:51], s78 offen sc1
    v_mfma_f32_16x16x32_bf16 a[132:135], v[196:199], v[8:11], a[132:135]
    v_lshlrev_b32 v238, 16, v55
    v_and_b32 v239, s70, v55
    v_mfma_f32_16x16x32_bf16 a[136:139], v[200:203], v[8:11], a[136:139]
    s_add_u32 s78, s78, s77
    ds_write_b128 v204, v[88:91] offset:47104
    v_mfma_f32_16x16x32_bf16 a[136:139], v[232:235], v[12:15], a[136:139]
L_padG5:
    s_cbranch_execz L_retG
    s_waitcnt vmcnt(9)
    v_fma_f32 v236, v236, v61, -v60
    v_fma_f32 v237, v237, v61, -v60
    v_mfma_f32_16x16x32_bf16 a[120:123], a[0:3], v[16:19], a[120:123]
    s_waitcnt vmcnt(8) lgkmcnt(15)
    v_fma_f32 v238, v238, v61, -v60
    v_fma_f32 v239, v239, v61, -v60
    v_mfma_f32_16x16x32_bf16 a[120:123], a[20:23], v[20:23], a[120:123]
    s_waitcnt lgkmcnt(15)
    buffer_load_dwordx4 v[8:11], v213, s[48:51], s78 offen sc1
    v_mfma_f32_16x16x32_bf16 a[124:127], a[24:27], v[20:23], a[124:127]
    v_mul_f32 v136, v136, v236
    v_mul_f32 v137, v137, v237
    v_mfma_f32_16x16x32_bf16 a[124:127], a[4:7], v[16:19], a[124:127]
    s_add_u32 s78, s78, s77
    ds_write_b128 v204, v[92:95] offset:48128
    v_mfma_f32_16x16x32_bf16 a[128:131], a[8:11], v[16:19], a[128:131]
    s_waitcnt lgkmcnt(15)
    v_mul_f32 v138, v138, v238
    v_mul_f32 v139, v139, v239
    v_mfma_f32_16x16x32_bf16 a[128:131], a[28:31], v[20:23], a[128:131]
    s_waitcnt lgkmcnt(14)
    ds_read_b128 v[64:67], v212 offset:46080
    v_lshlrev_b32 v236, 16, v56
    v_mfma_f32_16x16x32_bf16 a[132:135], a[32:35], v[20:23], a[132:135]
    buffer_load_dwordx4 v[12:15], v213, s[48:51], s78 offen sc1
    v_mfma_f32_16x16x32_bf16 a[132:135], a[12:15], v[16:19], a[132:135]
    s_add_u32 s78, s78, s77
    ds_read_b128 v[68:71], v214 offset:46080
    v_and_b32 v237, s70, v56
    v_mfma_f32_16x16x32_bf16 a[136:139], a[16:19], v[16:19], a[136:139]
    s_waitcnt lgkmcnt(14)
    ds_write_b128 v204, v[96:99] offset:49152
    v_mfma_f32_16x16x32_bf16 a[136:139], a[36:39], v[20:23], a[136:139]
    s_waitcnt vmcnt(9) lgkmcnt(15)
    v_lshlrev_b32 v238, 16, v57
    v_and_b32 v239, s70, v57
    v_mfma_f32_16x16x32_bf16 a[120:123], a[40:43], v[24:27], a[120:123]
    s_waitcnt vmcnt(8) lgkmcnt(15)
    v_fma_f32 v236, v236, v246, -v245
    v_fma_f32 v237, v237, v246, -v245
    v_mfma_f32_16x16x32_bf16 a[120:123], a[60:63], v[28:31], a[120:123]
    s_waitcnt lgkmcnt(15)
    buffer_load_dwordx4 v[16:19], v213, s[48:51], s78 offen sc1
    v_mfma_f32_16x16x32_bf16 a[124:127], a[64:67], v[28:31], a[124:127]
    s_waitcnt lgkmcnt(2)
    v_add_f32 v104, v104, v64
    v_add_f32 v105, v105, v65
    v_mfma_f32_16x16x32_bf16 a[124:127], a[44:47], v[24:27], a[124:127]
    ds_write_b128 v204, v[100:103] offset:50176
    v_mfma_f32_16x16x32_bf16 a[128:131], a[48:51], v[24:27], a[128:131]
    s_add_u32 s78, s78, s77
    v_add_f32 v106, v106, v66
    v_add_f32 v107, v107, v67
    v_mfma_f32_16x16x32_bf16 a[128:131], a[68:71], v[28:31], a[128:131]
    s_waitcnt lgkmcnt(2)
    ds_read_b128 v[72:75], v212 offset:48128
    v_add_f32 v108, v108, v68
    v_mfma_f32_16x16x32_bf16 a[132:135], a[72:75], v[28:31], a[132:135]
    buffer_load_dwordx4 v[20:23], v213, s[48:51], s78 offen sc1
    v_mfma_f32_16x16x32_bf16 a[132:135], a[52:55], v[24:27], a[132:135]
    ds_read_b128 v[76:79], v214 offset:48128
    v_add_f32 v109, v109, v69
    v_mfma_f32_16x16x32_bf16 a[136:139], a[56:59], v[24:27], a[136:139]
    s_add_u32 s78, s78, s77
    v_add_f32 v110, v110, v70
    v_add_f32 v111, v111, v71
    v_mfma_f32_16x16x32_bf16 a[136:139], a[76:79], v[28:31], a[136:139]
    s_waitcnt vmcnt(9)
    ds_read_b128 v[80:83], v206 offset:46080
    v_fma_f32 v238, v238, v246, -v245
    v_mfma_f32_16x16x32_bf16 a[120:123], a[80:83], v[32:35], a[120:123]
    s_waitcnt vmcnt(8)
    v_add_u32 v204, 40960, v204
    v_add_u32 v212, s83, v212
    v_mfma_f32_16x16x32_bf16 a[120:123], a[100:103], v[36:39], a[120:123]
    buffer_load_dwordx4 v[24:27], v213, s[48:51], s78 offen sc1
    v_mfma_f32_16x16x32_bf16 a[124:127], a[104:107], v[36:39], a[124:127]
    v_add_u32 v214, s83, v214
    v_add_u32 v206, s83, v206
    v_mfma_f32_16x16x32_bf16 a[124:127], a[84:87], v[32:35], a[124:127]
    s_waitcnt lgkmcnt(2)
    v_add_f32 v112, v112, v72
    v_add_f32 v113, v113, v73
    v_mfma_f32_16x16x32_bf16 a[128:131], a[88:91], v[32:35], a[128:131]
    s_add_u32 s78, s78, s77
    v_add_f32 v114, v114, v74
    v_add_f32 v115, v115, v75
    v_mfma_f32_16x16x32_bf16 a[128:131], a[108:111], v[36:39], a[128:131]
    s_waitcnt lgkmcnt(1)
    v_add_f32 v116, v116, v76
    v_add_f32 v117, v117, v77
    v_mfma_f32_16x16x32_bf16 a[132:135], a[112:115], v[36:39], a[132:135]
    buffer_load_dwordx4 v[28:31], v213, s[48:51], s78 offen sc1
    v_mfma_f32_16x16x32_bf16 a[132:135], a[92:95], v[32:35], a[132:135]
    s_add_u32 s78, s88, s90
    v_add_f32 v118, v118, v78
    v_add_f32 v119, v119, v79
    v_mfma_f32_16x16x32_bf16 a[136:139], a[96:99], v[32:35], a[136:139]
    s_waitcnt lgkmcnt(0)
    v_add_f32 v120, v120, v80
    v_add_f32 v121, v121, v81
    v_mfma_f32_16x16x32_bf16 a[136:139], a[116:119], v[36:39], a[136:139]
    s_waitcnt vmcnt(9)
    v_add_f32 v122, v122, v82
    v_add_f32 v123, v123, v83
    v_mfma_f32_16x16x32_bf16 a[140:143], v[144:147], v[40:43], 0
    s_waitcnt vmcnt(8)
    v_exp_f32 v64, -v104
    v_mfma_f32_16x16x32_bf16 a[140:143], v[164:167], v[44:47], a[140:143]
    buffer_load_dwordx4 v[32:35], v213, s[48:51], s78 offen sc1
    v_mfma_f32_16x16x32_bf16 a[144:147], v[168:171], v[44:47], 0
    v_exp_f32 v65, -v105
    v_mfma_f32_16x16x32_bf16 a[144:147], v[148:151], v[40:43], a[144:147]
    ds_write_b128 v204, a[120:123] offset:40960
    v_mfma_f32_16x16x32_bf16 a[148:151], v[152:155], v[40:43], 0
    v_exp_f32 v66, -v106
    v_mfma_f32_16x16x32_bf16 a[148:151], v[172:175], v[44:47], a[148:151]
    s_add_u32 s78, s78, s77
    v_exp_f32 v67, -v107
    v_mfma_f32_16x16x32_bf16 a[152:155], v[176:179], v[44:47], 0
    buffer_load_dwordx4 v[36:39], v213, s[48:51], s78 offen sc1
    v_mfma_f32_16x16x32_bf16 a[152:155], v[156:159], v[40:43], a[152:155]
    v_exp_f32 v68, -v108
    v_mfma_f32_16x16x32_bf16 a[156:159], v[160:163], v[40:43], 0
    s_add_u32 s78, s78, s77
    ds_write_b128 v204, a[124:127] offset:41984
    v_mfma_f32_16x16x32_bf16 a[156:159], v[180:183], v[44:47], a[156:159]
    s_waitcnt vmcnt(9)
    v_exp_f32 v69, -v109
    v_mfma_f32_16x16x32_bf16 a[140:143], v[184:187], v[0:3], a[140:143]
    s_waitcnt vmcnt(8)
    v_exp_f32 v70, -v110
    v_mfma_f32_16x16x32_bf16 a[140:143], v[216:219], v[4:7], a[140:143]
    buffer_load_dwordx4 v[40:43], v213, s[48:51], s78 offen sc1
    v_mfma_f32_16x16x32_bf16 a[144:147], v[220:223], v[4:7], a[144:147]
    v_exp_f32 v71, -v111
    v_mfma_f32_16x16x32_bf16 a[144:147], v[188:191], v[0:3], a[144:147]
    ds_write_b128 v204, a[128:131] offset:43008
    v_mfma_f32_16x16x32_bf16 a[148:151], v[192:195], v[0:3], a[148:151]
    v_add_f32 v64, 1.0, v64
    v_add_f32 v65, 1.0, v65
    v_mfma_f32_16x16x32_bf16 a[148:151], v[224:227], v[4:7], a[148:151]
    s_add_u32 s78, s78, s77
    v_rcp_f32 v64, v64
    v_mfma_f32_16x16x32_bf16 a[152:155], v[228:231], v[4:7], a[152:155]
    buffer_load_dwordx4 v[44:47], v213, s[48:51], s78 offen sc1
    v_mfma_f32_16x16x32_bf16 a[152:155], v[196:199], v[0:3], a[152:155]
    v_rcp_f32 v65, v65
    v_mfma_f32_16x16x32_bf16 a[156:159], v[200:203], v[0:3], a[156:159]
    s_add_u32 s78, s78, s77
    ds_write_b128 v204, a[132:135] offset:44032
    v_mfma_f32_16x16x32_bf16 a[156:159], v[232:235], v[4:7], a[156:159]
    s_waitcnt vmcnt(9)
    v_mul_f32 v64, v104, v64
    v_mul_f32 v65, v105, v65
    v_mfma_f32_16x16x32_bf16 a[140:143], a[0:3], v[8:11], a[140:143]
    s_waitcnt vmcnt(8)
    v_exp_f32 v72, -v112
    v_mfma_f32_16x16x32_bf16 a[140:143], a[20:23], v[12:15], a[140:143]
    buffer_load_dwordx4 v[0:3], v213, s[48:51], s78 offen sc1
    v_mfma_f32_16x16x32_bf16 a[144:147], a[24:27], v[12:15], a[144:147]
    v_exp_f32 v73, -v113
    v_mfma_f32_16x16x32_bf16 a[144:147], a[4:7], v[8:11], a[144:147]
    ds_write_b128 v204, a[136:139] offset:45056
    v_mfma_f32_16x16x32_bf16 a[148:151], a[8:11], v[8:11], a[148:151]
    v_add_f32 v66, 1.0, v66
    v_add_f32 v67, 1.0, v67
    v_mfma_f32_16x16x32_bf16 a[148:151], a[28:31], v[12:15], a[148:151]
    s_add_u32 s78, s78, s77
    v_rcp_f32 v66, v66
    v_mfma_f32_16x16x32_bf16 a[152:155], a[32:35], v[12:15], a[152:155]
    buffer_load_dwordx4 v[4:7], v213, s[48:51], s78 offen sc1
    v_mfma_f32_16x16x32_bf16 a[152:155], a[12:15], v[8:11], a[152:155]
    v_rcp_f32 v67, v67
    v_mfma_f32_16x16x32_bf16 a[156:159], a[16:19], v[8:11], a[156:159]
    s_add_u32 s78, s78, s77
    v_mul_f32 v66, v106, v66
    v_mul_f32 v67, v107, v67
    v_mfma_f32_16x16x32_bf16 a[156:159], a[36:39], v[12:15], a[156:159]
    s_waitcnt lgkmcnt(0)
    s_barrier
    s_waitcnt vmcnt(9)
    v_mfma_f32_16x16x32_bf16 a[140:143], a[40:43], v[16:19], a[140:143]
    s_waitcnt vmcnt(8)
    ds_read_b128 a[120:123], v205 offset:40960
    v_add_f32 v68, 1.0, v68
    v_mfma_f32_16x16x32_bf16 a[140:143], a[60:63], v[20:23], a[140:143]
    buffer_load_dwordx4 v[8:11], v213, s[48:51], s78 offen sc1
    v_mfma_f32_16x16x32_bf16 a[144:147], a[64:67], v[20:23], a[144:147]
    ds_read_b128 a[124:127], v205 offset:41984
    v_add_f32 v69, 1.0, v69
    v_mfma_f32_16x16x32_bf16 a[144:147], a[44:47], v[16:19], a[144:147]
    ds_read_b128 a[128:131], v205 offset:43008
    v_add_f32 v70, 1.0, v70
    v_mfma_f32_16x16x32_bf16 a[148:151], a[48:51], v[16:19], a[148:151]
    ds_read_b128 a[132:135], v205 offset:44032
    v_add_f32 v71, 1.0, v71
    v_mfma_f32_16x16x32_bf16 a[148:151], a[68:71], v[20:23], a[148:151]
    s_add_u32 s78, s78, s77
    ds_read_b128 a[136:139], v205 offset:45056
    v_add_f32 v72, 1.0, v72
    v_mfma_f32_16x16x32_bf16 a[152:155], a[72:75], v[20:23], a[152:155]
    buffer_load_dwordx4 v[12:15], v213, s[48:51], s78 offen sc1
    v_mfma_f32_16x16x32_bf16 a[152:155], a[52:55], v[16:19], a[152:155]
    v_rcp_f32 v68, v68
    v_mfma_f32_16x16x32_bf16 a[156:159], a[56:59], v[16:19], a[156:159]
    s_add_u32 s78, s78, s77
    v_rcp_f32 v69, v69
    v_mfma_f32_16x16x32_bf16 a[156:159], a[76:79], v[20:23], a[156:159]
    s_waitcnt vmcnt(9)
    v_rcp_f32 v70, v70
    v_mfma_f32_16x16x32_bf16 a[140:143], a[80:83], v[24:27], a[140:143]
    s_waitcnt vmcnt(8)
    v_rcp_f32 v71, v71
    v_mfma_f32_16x16x32_bf16 a[140:143], a[100:103], v[28:31], a[140:143]
    buffer_load_dwordx4 v[16:19], v213, s[48:51], s78 offen sc1
    v_mfma_f32_16x16x32_bf16 a[144:147], a[104:107], v[28:31], a[144:147]
    v_rcp_f32 v72, v72
    v_mfma_f32_16x16x32_bf16 a[144:147], a[84:87], v[24:27], a[144:147]
    v_exp_f32 v74, -v114
    v_mfma_f32_16x16x32_bf16 a[148:151], a[88:91], v[24:27], a[148:151]
    v_exp_f32 v75, -v115
    v_mfma_f32_16x16x32_bf16 a[148:151], a[108:111], v[28:31], a[148:151]
    s_add_u32 s78, s78, s77
    v_mul_f32 v68, v108, v68
    v_mul_f32 v69, v109, v69
    v_mfma_f32_16x16x32_bf16 a[152:155], a[112:115], v[28:31], a[152:155]
    buffer_load_dwordx4 v[20:23], v213, s[48:51], s78 offen sc1
    v_mfma_f32_16x16x32_bf16 a[152:155], a[92:95], v[24:27], a[152:155]
    s_waitcnt lgkmcnt(0)
    v_exp_f32 v76, -v116
    v_mfma_f32_16x16x32_bf16 a[156:159], a[96:99], v[24:27], a[156:159]
    s_add_u32 s78, s89, s90
    v_exp_f32 v77, -v117
    v_mfma_f32_16x16x32_bf16 a[156:159], a[116:119], v[28:31], a[156:159]
    s_waitcnt vmcnt(9)
    v_mul_f32 v70, v110, v70
    v_mul_f32 v71, v111, v71
    v_mfma_f32_16x16x32_bf16 a[120:123], v[144:147], v[32:35], a[120:123]
    s_waitcnt vmcnt(8)
    v_exp_f32 v78, -v118
    v_mfma_f32_16x16x32_bf16 a[120:123], v[164:167], v[36:39], a[120:123]
    buffer_load_dwordx4 v[24:27], v213, s[48:51], s78 offen sc1
    v_mfma_f32_16x16x32_bf16 a[124:127], v[168:171], v[36:39], a[124:127]
    v_exp_f32 v79, -v119
    v_mfma_f32_16x16x32_bf16 a[124:127], v[148:151], v[32:35], a[124:127]
    ds_write_b128 v204, a[140:143] offset:46080
    v_mfma_f32_16x16x32_bf16 a[128:131], v[152:155], v[32:35], a[128:131]
    v_mul_f32 v72, v112, v72
    v_add_f32 v73, 1.0, v73
    v_mfma_f32_16x16x32_bf16 a[128:131], v[172:175], v[36:39], a[128:131]
    s_add_u32 s78, s78, s77
    v_rcp_f32 v73, v73
    v_mfma_f32_16x16x32_bf16 a[132:135], v[176:179], v[36:39], a[132:135]
    buffer_load_dwordx4 v[28:31], v213, s[48:51], s78 offen sc1
    v_mfma_f32_16x16x32_bf16 a[132:135], v[156:159], v[32:35], a[132:135]
    v_exp_f32 v80, -v120
    v_mfma_f32_16x16x32_bf16 a[136:139], v[160:163], v[32:35], a[136:139]
    s_add_u32 s78, s78, s77
    ds_write_b128 v204, a[144:147] offset:47104
    v_mfma_f32_16x16x32_bf16 a[136:139], v[180:183], v[36:39], a[136:139]
    s_waitcnt vmcnt(9)
    v_mul_f32 v73, v113, v73
    v_add_f32 v74, 1.0, v74
    v_mfma_f32_16x16x32_bf16 a[120:123], v[184:187], v[40:43], a[120:123]
    s_waitcnt vmcnt(8)
    v_rcp_f32 v74, v74
    v_mfma_f32_16x16x32_bf16 a[120:123], v[216:219], v[44:47], a[120:123]
    buffer_load_dwordx4 v[32:35], v213, s[48:51], s78 offen sc1
    v_mfma_f32_16x16x32_bf16 a[124:127], v[220:223], v[44:47], a[124:127]
    v_exp_f32 v81, -v121
    v_mfma_f32_16x16x32_bf16 a[124:127], v[188:191], v[40:43], a[124:127]
    ds_write_b128 v204, a[148:151] offset:48128
    v_mfma_f32_16x16x32_bf16 a[128:131], v[192:195], v[40:43], a[128:131]
    v_mul_f32 v74, v114, v74
    v_add_f32 v75, 1.0, v75
    v_mfma_f32_16x16x32_bf16 a[128:131], v[224:227], v[44:47], a[128:131]
    s_add_u32 s78, s78, s77
    v_rcp_f32 v75, v75
    v_mfma_f32_16x16x32_bf16 a[132:135], v[228:231], v[44:47], a[132:135]
    buffer_load_dwordx4 v[36:39], v213, s[48:51], s78 offen sc1
    v_mfma_f32_16x16x32_bf16 a[132:135], v[196:199], v[40:43], a[132:135]
    v_exp_f32 v82, -v122
    v_mfma_f32_16x16x32_bf16 a[136:139], v[200:203], v[40:43], a[136:139]
    s_add_u32 s78, s78, s77
    ds_write_b128 v204, a[152:155] offset:49152
    v_mfma_f32_16x16x32_bf16 a[136:139], v[232:235], v[44:47], a[136:139]
    s_waitcnt vmcnt(9)
    v_mul_f32 v75, v115, v75
    v_add_f32 v76, 1.0, v76
    v_mfma_f32_16x16x32_bf16 a[120:123], a[0:3], v[0:3], a[120:123]
    s_waitcnt vmcnt(8)
    v_rcp_f32 v76, v76
    v_mfma_f32_16x16x32_bf16 a[120:123], a[20:23], v[4:7], a[120:123]
    buffer_load_dwordx4 v[40:43], v213, s[48:51], s78 offen sc1
    v_mfma_f32_16x16x32_bf16 a[124:127], a[24:27], v[4:7], a[124:127]
    v_exp_f32 v83, -v123
    v_mfma_f32_16x16x32_bf16 a[124:127], a[4:7], v[0:3], a[124:127]
    ds_write_b128 v204, a[156:159] offset:50176
    v_mfma_f32_16x16x32_bf16 a[128:131], a[8:11], v[0:3], a[128:131]
    v_mul_f32 v76, v116, v76
    v_add_f32 v77, 1.0, v77
    v_mfma_f32_16x16x32_bf16 a[128:131], a[28:31], v[4:7], a[128:131]
    s_add_u32 s78, s78, s77
    v_rcp_f32 v77, v77
    v_mfma_f32_16x16x32_bf16 a[132:135], a[32:35], v[4:7], a[132:135]
    buffer_load_dwordx4 v[44:47], v213, s[48:51], s78 offen sc1
    v_mfma_f32_16x16x32_bf16 a[132:135], a[12:15], v[0:3], a[132:135]
    v_mul_f32 v77, v117, v77
    v_add_f32 v78, 1.0, v78
    v_mfma_f32_16x16x32_bf16 a[136:139], a[16:19], v[0:3], a[136:139]
    s_add_u32 s78, s78, s77
    v_rcp_f32 v78, v78
    v_mfma_f32_16x16x32_bf16 a[136:139], a[36:39], v[4:7], a[136:139]
    s_waitcnt lgkmcnt(0)
    s_barrier
    s_waitcnt vmcnt(9)
    v_mfma_f32_16x16x32_bf16 a[120:123], a[40:43], v[8:11], a[120:123]
    s_waitcnt vmcnt(8)
    ds_read_b128 a[140:143], v205 offset:46080
    v_mul_f32 v78, v118, v78
    v_mfma_f32_16x16x32_bf16 a[120:123], a[60:63], v[12:15], a[120:123]
    buffer_load_dwordx4 v[0:3], v213, s[48:51], s78 offen sc1
    v_mfma_f32_16x16x32_bf16 a[124:127], a[64:67], v[12:15], a[124:127]
    ds_read_b128 a[144:147], v205 offset:47104
    v_add_f32 v79, 1.0, v79
    v_mfma_f32_16x16x32_bf16 a[124:127], a[44:47], v[8:11], a[124:127]
    ds_read_b128 a[148:151], v205 offset:48128
    v_add_f32 v80, 1.0, v80
    v_mfma_f32_16x16x32_bf16 a[128:131], a[48:51], v[8:11], a[128:131]
    ds_read_b128 a[152:155], v205 offset:49152
    v_add_f32 v81, 1.0, v81
    v_mfma_f32_16x16x32_bf16 a[128:131], a[68:71], v[12:15], a[128:131]
    s_add_u32 s78, s78, s77
    ds_read_b128 a[156:159], v205 offset:50176
    v_add_f32 v82, 1.0, v82
    v_mfma_f32_16x16x32_bf16 a[132:135], a[72:75], v[12:15], a[132:135]
    buffer_load_dwordx4 v[4:7], v213, s[48:51], s78 offen sc1
    v_mfma_f32_16x16x32_bf16 a[132:135], a[52:55], v[8:11], a[132:135]
    v_rcp_f32 v79, v79
    v_mfma_f32_16x16x32_bf16 a[136:139], a[56:59], v[8:11], a[136:139]
    s_add_u32 s78, s78, s77
    v_rcp_f32 v80, v80
    v_mfma_f32_16x16x32_bf16 a[136:139], a[76:79], v[12:15], a[136:139]
    s_waitcnt vmcnt(9)
    v_rcp_f32 v81, v81
    v_mfma_f32_16x16x32_bf16 a[120:123], a[80:83], v[16:19], a[120:123]
    s_waitcnt vmcnt(8)
    v_rcp_f32 v82, v82
    v_mfma_f32_16x16x32_bf16 a[120:123], a[100:103], v[20:23], a[120:123]
    buffer_load_dwordx4 v[8:11], v213, s[48:51], s78 offen sc1
    v_mfma_f32_16x16x32_bf16 a[124:127], a[104:107], v[20:23], a[124:127]
    v_mul_f32 v79, v119, v79
    v_mul_f32 v80, v120, v80
    v_mfma_f32_16x16x32_bf16 a[124:127], a[84:87], v[16:19], a[124:127]
    v_mul_f32 v81, v121, v81
    v_mul_f32 v82, v122, v82
    v_mfma_f32_16x16x32_bf16 a[128:131], a[88:91], v[16:19], a[128:131]
    v_add_f32 v83, 1.0, v83
    v_fma_f32 v239, v239, v246, -v245
    v_mfma_f32_16x16x32_bf16 a[128:131], a[108:111], v[20:23], a[128:131]
    s_add_u32 s78, s78, s77
    v_rcp_f32 v83, v83
    v_mfma_f32_16x16x32_bf16 a[132:135], a[112:115], v[20:23], a[132:135]
    buffer_load_dwordx4 v[12:15], v213, s[48:51], s78 offen sc1
    v_mfma_f32_16x16x32_bf16 a[132:135], a[92:95], v[16:19], a[132:135]
    s_waitcnt lgkmcnt(0)
    v_mul_f32 v83, v123, v83
    v_mul_f32 v140, v140, v236
    v_mfma_f32_16x16x32_bf16 a[136:139], a[96:99], v[16:19], a[136:139]
    v_mul_f32 v141, v141, v237
    v_mul_f32 v142, v142, v238
    v_mfma_f32_16x16x32_bf16 a[136:139], a[116:119], v[20:23], a[136:139]
    s_waitcnt vmcnt(9)
    v_mul_f32 v143, v143, v239
    v_lshlrev_b32 v207, 1, v207
    v_mfma_f32_16x16x32_bf16 a[140:143], v[144:147], v[24:27], a[140:143]
    s_waitcnt vmcnt(8)
    v_lshlrev_b32 v240, 1, v240
    v_lshlrev_b32 v84, 16, v48
    v_mfma_f32_16x16x32_bf16 a[140:143], v[164:167], v[28:31], a[140:143]
    v_and_b32 v85, s70, v48
    v_lshlrev_b32 v86, 16, v49
    v_mfma_f32_16x16x32_bf16 a[144:147], v[168:171], v[28:31], a[144:147]
    ds_write_b128 v204, a[120:123] offset:40960
    v_mfma_f32_16x16x32_bf16 a[144:147], v[148:151], v[24:27], a[144:147]
    v_and_b32 v87, s70, v49
    v_lshlrev_b32 v88, 16, v50
    v_mfma_f32_16x16x32_bf16 a[148:151], v[152:155], v[24:27], a[148:151]
    v_and_b32 v89, s70, v50
    v_lshlrev_b32 v90, 16, v51
    v_mfma_f32_16x16x32_bf16 a[148:151], v[172:175], v[28:31], a[148:151]
    s_waitcnt vmcnt(7)
    ds_write_b128 v204, a[124:127] offset:41984
    v_mfma_f32_16x16x32_bf16 a[140:143], v[184:187], v[32:35], a[140:143]
    s_waitcnt vmcnt(6)
    v_and_b32 v91, s70, v51
    v_lshlrev_b32 v92, 16, v52
    v_mfma_f32_16x16x32_bf16 a[140:143], v[216:219], v[36:39], a[140:143]
    v_and_b32 v93, s70, v52
    v_lshlrev_b32 v94, 16, v53
    v_mfma_f32_16x16x32_bf16 a[144:147], v[220:223], v[36:39], a[144:147]
    ds_write_b128 v204, a[128:131] offset:43008
    v_mfma_f32_16x16x32_bf16 a[144:147], v[188:191], v[32:35], a[144:147]
    v_and_b32 v95, s70, v53
    v_lshlrev_b32 v96, 16, v54
    v_mfma_f32_16x16x32_bf16 a[148:151], v[192:195], v[32:35], a[148:151]
    v_and_b32 v97, s70, v54
    v_lshlrev_b32 v98, 16, v55
    v_mfma_f32_16x16x32_bf16 a[148:151], v[224:227], v[36:39], a[148:151]
    s_waitcnt vmcnt(5)
    ds_write_b128 v204, a[132:135] offset:44032
    v_mfma_f32_16x16x32_bf16 a[140:143], a[0:3], v[40:43], a[140:143]
    s_waitcnt vmcnt(4)
    v_and_b32 v99, s70, v55
    v_lshlrev_b32 v100, 16, v56
    v_mfma_f32_16x16x32_bf16 a[140:143], a[20:23], v[44:47], a[140:143]
    v_and_b32 v101, s70, v56
    v_lshlrev_b32 v102, 16, v57
    v_and_b32 v103, s70, v57
    v_mfma_f32_16x16x32_bf16 a[144:147], a[24:27], v[44:47], a[144:147]
    ds_write_b128 v204, a[136:139] offset:45056
    v_mfma_f32_16x16x32_bf16 a[144:147], a[4:7], v[40:43], a[144:147]
    v_fmac_f32 v84, v124, v64
    v_fmac_f32 v85, v125, v65
    v_mfma_f32_16x16x32_bf16 a[148:151], a[8:11], v[40:43], a[148:151]
    v_fmac_f32 v86, v126, v66
    v_fmac_f32 v87, v127, v67
    v_mfma_f32_16x16x32_bf16 a[148:151], a[28:31], v[44:47], a[148:151]
    s_waitcnt vmcnt(3)
    v_fmac_f32 v88, v128, v68
    v_fmac_f32 v89, v129, v69
    v_mfma_f32_16x16x32_bf16 a[140:143], a[40:43], v[0:3], a[140:143]
    s_waitcnt vmcnt(2)
    v_fmac_f32 v90, v130, v70
    v_fmac_f32 v91, v131, v71
    v_mfma_f32_16x16x32_bf16 a[140:143], a[60:63], v[4:7], a[140:143]
    s_waitcnt lgkmcnt(0)
    s_barrier
    v_mfma_f32_16x16x32_bf16 a[144:147], a[64:67], v[4:7], a[144:147]
    ds_read_b128 v[104:107], v212 offset:40960
    v_fmac_f32 v92, v132, v72
    v_mfma_f32_16x16x32_bf16 a[144:147], a[44:47], v[0:3], a[144:147]
    ds_read_b128 v[108:111], v214 offset:40960
    v_fmac_f32 v93, v133, v73
    v_mfma_f32_16x16x32_bf16 a[148:151], a[48:51], v[0:3], a[148:151]
    ds_read_b128 v[112:115], v212 offset:43008
    v_fmac_f32 v94, v134, v74
    v_mfma_f32_16x16x32_bf16 a[148:151], a[68:71], v[4:7], a[148:151]
    s_waitcnt vmcnt(1)
    ds_read_b128 v[116:119], v214 offset:43008
    v_fmac_f32 v95, v135, v75
    v_mfma_f32_16x16x32_bf16 a[140:143], a[80:83], v[8:11], a[140:143]
    s_waitcnt vmcnt(0)
    ds_read_b128 v[120:123], v206 offset:40960
    v_fmac_f32 v96, v136, v76
    v_mfma_f32_16x16x32_bf16 a[140:143], a[100:103], v[12:15], a[140:143]
    v_fmac_f32 v97, v137, v77
    v_fmac_f32 v98, v138, v78
    v_mfma_f32_16x16x32_bf16 a[144:147], a[104:107], v[12:15], a[144:147]
    v_add_u32 v212, s91, v212
    v_add_u32 v214, s91, v214
    v_mfma_f32_16x16x32_bf16 a[144:147], a[84:87], v[8:11], a[144:147]
    v_add_u32 v206, s91, v206
    v_fmac_f32 v99, v139, v79
    v_mfma_f32_16x16x32_bf16 a[148:151], a[88:91], v[8:11], a[148:151]
    v_fmac_f32 v100, v140, v80
    v_fmac_f32 v101, v141, v81
    v_mfma_f32_16x16x32_bf16 a[148:151], a[108:111], v[12:15], a[148:151]
    v_fmac_f32 v102, v142, v82
    v_fmac_f32 v103, v143, v83
    v_mfma_f32_16x16x32_bf16 a[152:155], a[112:115], v[12:15], a[152:155]
    s_waitcnt lgkmcnt(4)
    v_fmac_f32 v84, v104, v64
    v_fmac_f32 v85, v105, v65
    v_mfma_f32_16x16x32_bf16 a[152:155], a[92:95], v[8:11], a[152:155]
    ds_write_b128 v204, a[140:143] offset:46080
    v_mfma_f32_16x16x32_bf16 a[152:155], a[72:75], v[4:7], a[152:155]
    v_fmac_f32 v86, v106, v66
    v_fmac_f32 v87, v107, v67
    v_mfma_f32_16x16x32_bf16 a[152:155], a[52:55], v[0:3], a[152:155]
    ds_write_b128 v204, a[144:147] offset:47104
    v_mfma_f32_16x16x32_bf16 a[152:155], a[32:35], v[44:47], a[152:155]
    s_waitcnt lgkmcnt(5)
    v_fmac_f32 v88, v108, v68
    v_fmac_f32 v89, v109, v69
    v_mfma_f32_16x16x32_bf16 a[152:155], a[12:15], v[40:43], a[152:155]
    ds_read_b128 v[124:127], v212 offset:46080
    v_fmac_f32 v90, v110, v70
    v_mfma_f32_16x16x32_bf16 a[152:155], v[228:231], v[36:39], a[152:155]
    ds_read_b128 v[128:131], v214 offset:46080
    v_fmac_f32 v91, v111, v71
    v_mfma_f32_16x16x32_bf16 a[152:155], v[196:199], v[32:35], a[152:155]
    v_mfma_f32_16x16x32_bf16 a[152:155], v[176:179], v[28:31], a[152:155]
    ds_write_b128 v204, a[148:151] offset:48128
    v_mfma_f32_16x16x32_bf16 a[152:155], v[156:159], v[24:27], a[152:155]
    v_mfma_f32_16x16x32_bf16 a[156:159], v[160:163], v[24:27], a[156:159]
    v_mfma_f32_16x16x32_bf16 a[156:159], v[180:183], v[28:31], a[156:159]
    s_waitcnt lgkmcnt(2)
    v_fmac_f32 v84, v124, v64
    v_fmac_f32 v85, v125, v65
    v_mfma_f32_16x16x32_bf16 a[156:159], v[200:203], v[32:35], a[156:159]
    v_fmac_f32 v86, v126, v66
    v_fmac_f32 v87, v127, v67
    v_mfma_f32_16x16x32_bf16 a[156:159], v[232:235], v[36:39], a[156:159]
    s_waitcnt lgkmcnt(1)
    v_fmac_f32 v88, v128, v68
    v_fmac_f32 v89, v129, v69
    v_mfma_f32_16x16x32_bf16 a[156:159], a[16:19], v[40:43], a[156:159]
    v_fmac_f32 v90, v130, v70
    v_fmac_f32 v91, v131, v71
    v_mfma_f32_16x16x32_bf16 a[156:159], a[36:39], v[44:47], a[156:159]
    ds_write_b128 v204, a[152:155] offset:49152
    v_mfma_f32_16x16x32_bf16 a[156:159], a[56:59], v[0:3], a[156:159]
    buffer_store_dwordx4 v[84:87], v207, s[56:59], 0 offen offset:0 sc0 sc1
    v_mfma_f32_16x16x32_bf16 a[156:159], a[76:79], v[4:7], a[156:159]
    ds_read_b128 v[132:135], v212 offset:48128
    v_mfma_f32_16x16x32_bf16 a[156:159], a[96:99], v[8:11], a[156:159]
    ds_read_b128 v[136:139], v214 offset:48128
    v_mfma_f32_16x16x32_bf16 a[156:159], a[116:119], v[12:15], a[156:159]
    buffer_store_dwordx4 v[88:91], v207, s[56:59], s71 offen offset:0 sc0 sc1
    v_pk_fma_f32 v[92:93], v[112:113], v[72:73], v[92:93]
    v_pk_fma_f32 v[94:95], v[114:115], v[74:75], v[94:95]
    v_pk_fma_f32 v[96:97], v[116:117], v[76:77], v[96:97]
    v_pk_fma_f32 v[98:99], v[118:119], v[78:79], v[98:99]
    v_pk_fma_f32 v[100:101], v[120:121], v[80:81], v[100:101]
    v_pk_fma_f32 v[102:103], v[122:123], v[82:83], v[102:103]
    s_nop 0
    ds_write_b128 v204, a[156:159] offset:50176
    ds_read_b128 v[140:143], v206 offset:46080
    s_waitcnt lgkmcnt(3)
    v_pk_fma_f32 v[92:93], v[132:133], v[72:73], v[92:93]
    v_pk_fma_f32 v[94:95], v[134:135], v[74:75], v[94:95]
    buffer_store_dwordx4 v[92:95], v207, s[56:59], 0 offen offset:128 sc0 sc1
    s_waitcnt lgkmcnt(2)
    v_pk_fma_f32 v[96:97], v[136:137], v[76:77], v[96:97]
    v_pk_fma_f32 v[98:99], v[138:139], v[78:79], v[98:99]
    buffer_store_dwordx4 v[96:99], v207, s[56:59], s71 offen offset:128 sc0 sc1
    s_waitcnt lgkmcnt(0)
    v_pk_fma_f32 v[100:101], v[140:141], v[80:81], v[100:101]
    v_pk_fma_f32 v[102:103], v[142:143], v[82:83], v[102:103]
    buffer_store_dwordx4 v[100:103], v240, s[56:59], 0 offen offset:0 sc0 sc1
    s_endpgm
L_slow_3:
    s_mov_b32 s80, 0x80000
L_spin_2:
    s_sleep 2
    buffer_load_dword v252, v213, s[48:51], s73 offen sc1
    s_waitcnt vmcnt(0)
    v_cmp_ne_u32 vcc, s82, v252
    s_sub_u32 s80, s80, 1
    s_cmp_eq_u32 s80, 0
    s_cbranch_scc1 L_done_4
    s_nop 1
    s_cbranch_vccnz L_spin_2
L_done_4:
    s_mov_b64 exec, -1
    s_branch L_ok_1
L_slow_7:
    s_mov_b32 s80, 0x80000
L_spin_6:
    s_sleep 2
    buffer_load_dword v252, v248, s[48:51], 0 offen sc1
    s_waitcnt vmcnt(0)
    v_cmp_ne_u32 vcc, s82, v252
    s_sub_u32 s80, s80, 1
    s_cmp_eq_u32 s80, 0
    s_cbranch_scc1 L_done_8
    s_nop 1
    s_cbranch_vccnz L_spin_6
L_done_8:
    s_mov_b64 exec, -1
    s_branch L_ok_5
L_slow_11:
    s_mov_b32 s80, 0x80000
L_spin_10:
    s_sleep 2
    buffer_load_dword v252, v250, s[48:51], 0 offen sc1
    s_waitcnt vmcnt(0)
    v_cmp_ne_u32 vcc, s82, v252
    s_sub_u32 s80, s80, 1
    s_cmp_eq_u32 s80, 0
    s_cbranch_scc1 L_done_12
    s_nop 1
    s_cbranch_vccnz L_spin_10
L_done_12:
    s_mov_b64 exec, -1
    s_branch L_ok_9
.p2align 12
L_mainS:
L_padS0:
    s_cbranch_execz L_padS4
    s_waitcnt vmcnt(10)
    s_barrier
    ds_read_b128 v[168:171], v211 offset:0
    ds_read_b128 v[144:147], v209 offset:0
    ds_read_b128 v[172:175], v212 offset:0
    ds_read_b128 v[148:151], v210 offset:0
    ds_read_b128 v[180:183], v212 offset:4096
    ds_read_b128 v[176:179], v211 offset:4096
    ds_read_b128 v[184:187], v211 offset:2048
    ds_read_b128 v[188:191], v212 offset:2048
    ds_read_b128 v[196:199], v212 offset:6144
    ds_read_b128 v[192:195], v211 offset:6144
    ds_read_b128 v[152:155], v209 offset:2048
    ds_read_b128 v[156:159], v210 offset:2048
    s_waitcnt lgkmcnt(10)
    v_mfma_f32_16x16x32_bf16 v[0:3], v[144:147], v[168:171], 0
    s_waitcnt lgkmcnt(8)
    ds_read_b128 v[160:163], v209 offset:4096
    buffer_load_dwordx4 v206, s[40:43], s66 offen offset:1024 lds
    v_mfma_f32_16x16x32_bf16 v[0:3], v[148:151], v[172:175], v[0:3]
    s_waitcnt lgkmcnt(8)
    ds_read_b128 v[164:167], v210 offset:4096
    v_mfma_f32_16x16x32_bf16 v[4:7], v[148:151], v[180:183], 0
    s_waitcnt lgkmcnt(8)
    buffer_load_dwordx4 v207, s[40:43], s66 offen offset:2048 lds
    v_mfma_f32_16x16x32_bf16 v[4:7], v[144:147], v[176:179], v[4:7]
    s_waitcnt lgkmcnt(7)
    v_mfma_f32_16x16x32_bf16 v[8:11], v[144:147], v[184:187], 0
    s_waitcnt lgkmcnt(6)
    v_mfma_f32_16x16x32_bf16 v[8:11], v[148:151], v[188:191], v[8:11]
    s_waitcnt lgkmcnt(5)
    v_mfma_f32_16x16x32_bf16 v[12:15], v[148:151], v[196:199], 0
    s_waitcnt lgkmcnt(4)
    buffer_load_dwordx4 v208, s[40:43], s66 offen offset:3072 lds
    v_mfma_f32_16x16x32_bf16 v[12:15], v[144:147], v[192:195], v[12:15]
    s_waitcnt lgkmcnt(3)
    v_mfma_f32_16x16x32_bf16 v[28:31], v[152:155], v[192:195], 0
    s_waitcnt lgkmcnt(2)
    ds_read_b128 v[144:147], v209 offset:6144
    v_mfma_f32_16x16x32_bf16 v[28:31], v[156:159], v[196:199], v[28:31]
    s_add_u32 m0, s69, 55296
    ds_read_b128 v[148:151], v210 offset:6144
    v_mfma_f32_16x16x32_bf16 v[24:27], v[156:159], v[188:191], 0
    buffer_load_dwordx4 v205, s[44:47], s66 offen offset:0 lds
    v_mfma_f32_16x16x32_bf16 v[24:27], v[152:155], v[184:187], v[24:27]
    v_mfma_f32_16x16x32_bf16 v[20:23], v[152:155], v[176:179], 0
    v_mfma_f32_16x16x32_bf16 v[20:23], v[156:159], v[180:183], v[20:23]
    v_mfma_f32_16x16x32_bf16 v[16:19], v[156:159], v[172:175], 0
    buffer_load_dwordx4 v206, s[44:47], s66 offen offset:1024 lds
    v_mfma_f32_16x16x32_bf16 v[16:19], v[152:155], v[168:171], v[16:19]
    s_waitcnt lgkmcnt(3)
    v_mfma_f32_16x16x32_bf16 v[32:35], v[160:163], v[168:171], 0
    s_waitcnt lgkmcnt(2)
    ds_read_b128 v[152:155], v209 offset:8192
    v_mfma_f32_16x16x32_bf16 v[32:35], v[164:167], v[172:175], v[32:35]
    ds_read_b128 v[156:159], v210 offset:8192
    v_mfma_f32_16x16x32_bf16 v[36:39], v[164:167], v[180:183], 0
    buffer_load_dwordx4 v207, s[44:47], s66 offen offset:2048 lds
    v_mfma_f32_16x16x32_bf16 v[36:39], v[160:163], v[176:179], v[36:39]
    v_mfma_f32_16x16x32_bf16 v[40:43], v[160:163], v[184:187], 0
    v_mfma_f32_16x16x32_bf16 v[40:43], v[164:167], v[188:191], v[40:43]
    v_mfma_f32_16x16x32_bf16 v[44:47], v[164:167], v[196:199], 0
    buffer_load_dwordx4 v208, s[44:47], s66 offen offset:3072 lds
    v_mfma_f32_16x16x32_bf16 v[44:47], v[160:163], v[192:195], v[44:47]
    s_and_b32 s67, s83, 3
    s_add_u32 s67, s67, 2
    s_waitcnt lgkmcnt(3)
    v_mfma_f32_16x16x32_bf16 v[60:63], v[144:147], v[192:195], 0
    s_lshl_b32 s65, s67, 7
    s_waitcnt lgkmcnt(2)
    ds_read_b128 v[160:163], v209 offset:10240
    v_mfma_f32_16x16x32_bf16 v[60:63], v[148:151], v[196:199], v[60:63]
    s_mul_i32 s66, s67, 128
    s_add_u32 m0, s68, 102400
    ds_read_b128 v[164:167], v210 offset:10240
    v_mfma_f32_16x16x32_bf16 v[56:59], v[148:151], v[188:191], 0
    buffer_load_dwordx4 v200, s[36:39], s65 offen offset:0 lds
    v_mfma_f32_16x16x32_bf16 v[56:59], v[144:147], v[184:187], v[56:59]
    v_mfma_f32_16x16x32_bf16 v[52:55], v[144:147], v[176:179], 0
    v_mfma_f32_16x16x32_bf16 v[52:55], v[148:151], v[180:183], v[52:55]
    v_mfma_f32_16x16x32_bf16 v[48:51], v[148:151], v[172:175], 0
    buffer_load_dwordx4 v201, s[36:39], s65 offen offset:1024 lds
    v_mfma_f32_16x16x32_bf16 v[48:51], v[144:147], v[168:171], v[48:51]
    s_waitcnt lgkmcnt(3)
    v_mfma_f32_16x16x32_bf16 v[64:67], v[152:155], v[168:171], 0
    s_waitcnt lgkmcnt(2)
    ds_read_b128 v[144:147], v209 offset:12288
    v_mfma_f32_16x16x32_bf16 v[64:67], v[156:159], v[172:175], v[64:67]
    ds_read_b128 v[148:151], v210 offset:12288
    v_mfma_f32_16x16x32_bf16 v[68:71], v[156:159], v[180:183], 0
    buffer_load_dwordx4 v202, s[36:39], s65 offen offset:2048 lds
    v_mfma_f32_16x16x32_bf16 v[68:71], v[152:155], v[176:179], v[68:71]
    v_mfma_f32_16x16x32_bf16 v[72:75], v[152:155], v[184:187], 0
    buffer_load_dwordx4 v203, s[36:39], s65 offen offset:3072 lds
    v_mfma_f32_16x16x32_bf16 v[72:75], v[156:159], v[188:191], v[72:75]
    v_mfma_f32_16x16x32_bf16 v[76:79], v[156:159], v[196:199], 0
    buffer_load_dwordx4 v204, s[36:39], s65 offen offset:3584 lds
    v_mfma_f32_16x16x32_bf16 v[76:79], v[152:155], v[192:195], v[76:79]
    s_waitcnt lgkmcnt(3)
    v_mfma_f32_16x16x32_bf16 v[92:95], v[160:163], v[192:195], 0
    s_waitcnt lgkmcnt(2)
    ds_read_b128 v[152:155], v209 offset:14336
    v_mfma_f32_16x16x32_bf16 v[92:95], v[164:167], v[196:199], v[92:95]
    s_add_u32 m0, s69, 102400
    ds_read_b128 v[156:159], v210 offset:14336
    v_mfma_f32_16x16x32_bf16 v[88:91], v[164:167], v[188:191], 0
    buffer_load_dwordx4 v205, s[40:43], s66 offen offset:0 lds
    v_mfma_f32_16x16x32_bf16 v[88:91], v[160:163], v[184:187], v[88:91]
    v_mfma_f32_16x16x32_bf16 v[84:87], v[160:163], v[176:179], 0
    v_mfma_f32_16x16x32_bf16 v[84:87], v[164:167], v[180:183], v[84:87]
    v_mov_b32 v240, s82
    v_and_b32 v241, 0, v215
    v_mfma_f32_16x16x32_bf16 v[80:83], v[164:167], v[172:175], 0
    buffer_load_dwordx4 v206, s[40:43], s66 offen offset:1024 lds
    v_mfma_f32_16x16x32_bf16 v[80:83], v[160:163], v[168:171], v[80:83]
    s_waitcnt lgkmcnt(3)
    v_mfma_f32_16x16x32_bf16 v[96:99], v[144:147], v[168:171], 0
    s_waitcnt lgkmcnt(2)
    ds_read_b128 v[160:163], v209 offset:16384
    v_mfma_f32_16x16x32_bf16 v[96:99], v[148:151], v[172:175], v[96:99]
    ds_read_b128 v[164:167], v210 offset:16384
    v_mfma_f32_16x16x32_bf16 v[100:103], v[148:151], v[180:183], 0
    buffer_load_dwordx4 v207, s[40:43], s66 offen offset:2048 lds
    v_mfma_f32_16x16x32_bf16 v[100:103], v[144:147], v[176:179], v[100:103]
    v_add_u32 v211, 51200, v211
    v_add_u32 v209, 51200, v209
    v_mfma_f32_16x16x32_bf16 v[104:107], v[144:147], v[184:187], 0
    v_add_u32 v212, 51200, v212
    v_add_u32 v210, 51200, v210
    v_mfma_f32_16x16x32_bf16 v[104:107], v[148:151], v[188:191], v[104:107]
    v_mfma_f32_16x16x32_bf16 v[108:111], v[148:151], v[196:199], 0
    buffer_load_dwordx4 v208, s[40:43], s66 offen offset:3072 lds
    v_mfma_f32_16x16x32_bf16 v[108:111], v[144:147], v[192:195], v[108:111]
    s_waitcnt vmcnt(9) lgkmcnt(0)
    s_barrier
    ds_read_b128 a[224:227], v211 offset:0
    v_mfma_f32_16x16x32_bf16 v[124:127], v[152:155], v[192:195], 0
    s_add_u32 m0, s69, 106496
    s_lshl_b32 s74, s2, 4
    ds_read_b128 v[144:147], v209 offset:0
    v_mfma_f32_16x16x32_bf16 v[124:127], v[156:159], v[196:199], v[124:127]
    s_add_u32 s74, s74, 43008
    s_cmp_eq_u32 s60, 0
    ds_read_b128 a[228:231], v212 offset:0
    v_mfma_f32_16x16x32_bf16 v[120:123], v[156:159], v[188:191], 0
    s_cselect_b32 s74, s74, 2146435072
    buffer_load_dwordx4 v205, s[44:47], s66 offen offset:0 lds
    v_mfma_f32_16x16x32_bf16 v[120:123], v[152:155], v[184:187], v[120:123]
    ds_read_b128 v[148:151], v210 offset:0
    buffer_store_dword v240, v241, s[48:51], s74 offen sc1
    v_mfma_f32_16x16x32_bf16 v[116:119], v[152:155], v[176:179], 0
    ds_read_b128 a[236:239], v212 offset:4096
    v_mfma_f32_16x16x32_bf16 v[116:119], v[156:159], v[180:183], v[116:119]
    ds_read_b128 a[232:235], v211 offset:4096
    v_mfma_f32_16x16x32_bf16 v[112:115], v[156:159], v[172:175], 0
    buffer_load_dwordx4 v206, s[44:47], s66 offen offset:1024 lds
    v_mfma_f32_16x16x32_bf16 v[112:115], v[152:155], v[168:171], v[112:115]
    ds_read_b128 a[240:243], v211 offset:2048
    v_mfma_f32_16x16x32_bf16 v[128:131], v[160:163], v[168:171], 0
    ds_read_b128 a[244:247], v212 offset:2048
    v_mfma_f32_16x16x32_bf16 v[128:131], v[164:167], v[172:175], v[128:131]
    ds_read_b128 a[252:255], v212 offset:6144
    v_mfma_f32_16x16x32_bf16 v[132:135], v[164:167], v[180:183], 0
    buffer_load_dwordx4 v207, s[44:47], s66 offen offset:2048 lds
    v_mfma_f32_16x16x32_bf16 v[132:135], v[160:163], v[176:179], v[132:135]
    ds_read_b128 a[248:251], v211 offset:6144
    v_mfma_f32_16x16x32_bf16 v[136:139], v[160:163], v[184:187], 0
    ds_read_b128 v[152:155], v209 offset:2048
    v_mfma_f32_16x16x32_bf16 v[136:139], v[164:167], v[188:191], v[136:139]
    s_and_b32 s67, s83, 3
    ds_read_b128 v[156:159], v210 offset:2048
    v_mfma_f32_16x16x32_bf16 v[140:143], v[164:167], v[196:199], 0
    s_xor_b32 s67, s67, 1
    buffer_load_dwordx4 v208, s[44:47], s66 offen offset:3072 lds
    v_mfma_f32_16x16x32_bf16 v[140:143], v[160:163], v[192:195], v[140:143]
    s_add_u32 s67, s67, 2
    s_lshl_b32 s65, s67, 7
    s_waitcnt lgkmcnt(10)
    v_mfma_f32_16x16x32_bf16 v[0:3], v[144:147], a[224:227], v[0:3]
    s_mul_i32 s66, s67, 128
    s_waitcnt lgkmcnt(8)
    ds_read_b128 v[160:163], v209 offset:4096
    v_mfma_f32_16x16x32_bf16 v[0:3], v[148:151], a[228:231], v[0:3]
    s_add_u32 m0, s68, 0
    s_waitcnt lgkmcnt(8)
    ds_read_b128 v[164:167], v210 offset:4096
    v_mfma_f32_16x16x32_bf16 v[4:7], v[148:151], a[236:239], v[4:7]
    s_waitcnt lgkmcnt(8)
    buffer_load_dwordx4 v200, s[36:39], s65 offen offset:0 lds
    v_mfma_f32_16x16x32_bf16 v[4:7], v[144:147], a[232:235], v[4:7]
    s_waitcnt lgkmcnt(7)
    v_mfma_f32_16x16x32_bf16 v[8:11], v[144:147], a[240:243], v[8:11]
    s_waitcnt lgkmcnt(6)
    v_mfma_f32_16x16x32_bf16 v[8:11], v[148:151], a[244:247], v[8:11]
    s_waitcnt lgkmcnt(5)
    v_mfma_f32_16x16x32_bf16 v[12:15], v[148:151], a[252:255], v[12:15]
    s_waitcnt lgkmcnt(4)
    buffer_load_dwordx4 v201, s[36:39], s65 offen offset:1024 lds
    v_mfma_f32_16x16x32_bf16 v[12:15], v[144:147], a[248:251], v[12:15]
    s_waitcnt lgkmcnt(3)
    v_mfma_f32_16x16x32_bf16 v[28:31], v[152:155], a[248:251], v[28:31]
    s_waitcnt lgkmcnt(2)
    ds_read_b128 v[144:147], v209 offset:6144
    v_mfma_f32_16x16x32_bf16 v[28:31], v[156:159], a[252:255], v[28:31]
    ds_read_b128 v[148:151], v210 offset:6144
    v_mfma_f32_16x16x32_bf16 v[24:27], v[156:159], a[244:247], v[24:27]
    buffer_load_dwordx4 v202, s[36:39], s65 offen offset:2048 lds
    v_mfma_f32_16x16x32_bf16 v[24:27], v[152:155], a[240:243], v[24:27]
    v_mfma_f32_16x16x32_bf16 v[20:23], v[152:155], a[232:235], v[20:23]
    v_mfma_f32_16x16x32_bf16 v[20:23], v[156:159], a[236:239], v[20:23]
    v_mfma_f32_16x16x32_bf16 v[16:19], v[156:159], a[228:231], v[16:19]
    buffer_load_dwordx4 v203, s[36:39], s65 offen offset:3072 lds
    v_mfma_f32_16x16x32_bf16 v[16:19], v[152:155], a[224:227], v[16:19]
    s_waitcnt lgkmcnt(3)
    v_mfma_f32_16x16x32_bf16 v[32:35], v[160:163], a[224:227], v[32:35]
    s_waitcnt lgkmcnt(2)
    ds_read_b128 v[152:155], v209 offset:8192
    v_mfma_f32_16x16x32_bf16 v[32:35], v[164:167], a[228:231], v[32:35]
    ds_read_b128 v[156:159], v210 offset:8192
    v_mfma_f32_16x16x32_bf16 v[36:39], v[164:167], a[236:239], v[36:39]
    buffer_load_dwordx4 v204, s[36:39], s65 offen offset:3584 lds
    v_mfma_f32_16x16x32_bf16 v[36:39], v[160:163], a[232:235], v[36:39]
    v_mfma_f32_16x16x32_bf16 v[40:43], v[160:163], a[240:243], v[40:43]
    v_mfma_f32_16x16x32_bf16 v[40:43], v[164:167], a[244:247], v[40:43]
    s_add_u32 m0, s69, 0
    v_mfma_f32_16x16x32_bf16 v[44:47], v[164:167], a[252:255], v[44:47]
    buffer_load_dwordx4 v205, s[40:43], s66 offen offset:0 lds
    v_mfma_f32_16x16x32_bf16 v[44:47], v[160:163], a[248:251], v[44:47]
    s_waitcnt lgkmcnt(3)
    v_mfma_f32_16x16x32_bf16 v[60:63], v[144:147], a[248:251], v[60:63]
    s_waitcnt lgkmcnt(2)
    ds_read_b128 v[160:163], v209 offset:10240
    v_mfma_f32_16x16x32_bf16 v[60:63], v[148:151], a[252:255], v[60:63]
    ds_read_b128 v[164:167], v210 offset:10240
    v_mfma_f32_16x16x32_bf16 v[56:59], v[148:151], a[244:247], v[56:59]
    buffer_load_dwordx4 v206, s[40:43], s66 offen offset:1024 lds
    v_mfma_f32_16x16x32_bf16 v[56:59], v[144:147], a[240:243], v[56:59]
    v_mfma_f32_16x16x32_bf16 v[52:55], v[144:147], a[232:235], v[52:55]
    v_mfma_f32_16x16x32_bf16 v[52:55], v[148:151], a[236:239], v[52:55]
    v_mfma_f32_16x16x32_bf16 v[48:51], v[148:151], a[228:231], v[48:51]
    buffer_load_dwordx4 v207, s[40:43], s66 offen offset:2048 lds
    v_mfma_f32_16x16x32_bf16 v[48:51], v[144:147], a[224:227], v[48:51]
    s_waitcnt lgkmcnt(3)
    v_mfma_f32_16x16x32_bf16 v[64:67], v[152:155], a[224:227], v[64:67]
    s_waitcnt lgkmcnt(2)
    ds_read_b128 v[144:147], v209 offset:12288
    v_mfma_f32_16x16x32_bf16 v[64:67], v[156:159], a[228:231], v[64:67]
    ds_read_b128 v[148:151], v210 offset:12288
    v_mfma_f32_16x16x32_bf16 v[68:71], v[156:159], a[236:239], v[68:71]
    buffer_load_dwordx4 v208, s[40:43], s66 offen offset:3072 lds
    v_mfma_f32_16x16x32_bf16 v[68:71], v[152:155], a[232:235], v[68:71]
    v_mfma_f32_16x16x32_bf16 v[72:75], v[152:155], a[240:243], v[72:75]
    v_mfma_f32_16x16x32_bf16 v[72:75], v[156:159], a[244:247], v[72:75]
    s_add_u32 m0, s69, 4096
    v_mfma_f32_16x16x32_bf16 v[76:79], v[156:159], a[252:255], v[76:79]
    buffer_load_dwordx4 v205, s[44:47], s66 offen offset:0 lds
    v_mfma_f32_16x16x32_bf16 v[76:79], v[152:155], a[248:251], v[76:79]
    s_waitcnt lgkmcnt(3)
    v_mfma_f32_16x16x32_bf16 v[92:95], v[160:163], a[248:251], v[92:95]
    s_waitcnt lgkmcnt(2)
    ds_read_b128 v[152:155], v209 offset:14336
    v_mfma_f32_16x16x32_bf16 v[92:95], v[164:167], a[252:255], v[92:95]
    ds_read_b128 v[156:159], v210 offset:14336
    v_mfma_f32_16x16x32_bf16 v[88:91], v[164:167], a[244:247], v[88:91]
    buffer_load_dwordx4 v206, s[44:47], s66 offen offset:1024 lds
    v_mfma_f32_16x16x32_bf16 v[88:91], v[160:163], a[240:243], v[88:91]
    v_mfma_f32_16x16x32_bf16 v[84:87], v[160:163], a[232:235], v[84:87]
    v_mfma_f32_16x16x32_bf16 v[84:87], v[164:167], a[236:239], v[84:87]
    v_mfma_f32_16x16x32_bf16 v[80:83], v[164:167], a[228:231], v[80:83]
    buffer_load_dwordx4 v207, s[44:47], s66 offen offset:2048 lds
    v_mfma_f32_16x16x32_bf16 v[80:83], v[160:163], a[224:227], v[80:83]
    s_waitcnt lgkmcnt(3)
    v_mfma_f32_16x16x32_bf16 v[96:99], v[144:147], a[224:227], v[96:99]
    s_waitcnt lgkmcnt(2)
    ds_read_b128 v[160:163], v209 offset:16384
    v_mfma_f32_16x16x32_bf16 v[96:99], v[148:151], a[228:231], v[96:99]
    ds_read_b128 v[164:167], v210 offset:16384
    v_mfma_f32_16x16x32_bf16 v[100:103], v[148:151], a[236:239], v[100:103]
    buffer_load_dwordx4 v208, s[44:47], s66 offen offset:3072 lds
    v_mfma_f32_16x16x32_bf16 v[100:103], v[144:147], a[232:235], v[100:103]
    v_add_u32 v211, 51200, v211
    v_add_u32 v209, 51200, v209
    v_mfma_f32_16x16x32_bf16 v[104:107], v[144:147], a[240:243], v[104:107]
    v_add_u32 v212, 51200, v212
    v_add_u32 v210, 51200, v210
    v_mfma_f32_16x16x32_bf16 v[104:107], v[148:151], a[244:247], v[104:107]
    v_mfma_f32_16x16x32_bf16 v[108:111], v[148:151], a[252:255], v[108:111]
    v_mfma_f32_16x16x32_bf16 v[108:111], v[144:147], a[248:251], v[108:111]
    s_waitcnt vmcnt(13) lgkmcnt(0)
    s_barrier
    ds_read_b128 v[168:171], v211 offset:0
    v_mfma_f32_16x16x32_bf16 v[124:127], v[152:155], a[248:251], v[124:127]
    ds_read_b128 v[144:147], v209 offset:0
    v_mfma_f32_16x16x32_bf16 v[124:127], v[156:159], a[252:255], v[124:127]
    ds_read_b128 v[172:175], v212 offset:0
    v_mfma_f32_16x16x32_bf16 v[120:123], v[156:159], a[244:247], v[120:123]
    v_mfma_f32_16x16x32_bf16 v[120:123], v[152:155], a[240:243], v[120:123]
    ds_read_b128 v[148:151], v210 offset:0
    v_mfma_f32_16x16x32_bf16 v[116:119], v[152:155], a[232:235], v[116:119]
    ds_read_b128 v[180:183], v212 offset:4096
    v_mfma_f32_16x16x32_bf16 v[116:119], v[156:159], a[236:239], v[116:119]
    ds_read_b128 v[176:179], v211 offset:4096
    v_mfma_f32_16x16x32_bf16 v[112:115], v[156:159], a[228:231], v[112:115]
    v_mfma_f32_16x16x32_bf16 v[112:115], v[152:155], a[224:227], v[112:115]
    ds_read_b128 v[184:187], v211 offset:2048
    v_mfma_f32_16x16x32_bf16 v[128:131], v[160:163], a[224:227], v[128:131]
    ds_read_b128 v[188:191], v212 offset:2048
    v_mfma_f32_16x16x32_bf16 v[128:131], v[164:167], a[228:231], v[128:131]
    ds_read_b128 v[196:199], v212 offset:6144
    v_mfma_f32_16x16x32_bf16 v[132:135], v[164:167], a[236:239], v[132:135]
    v_mfma_f32_16x16x32_bf16 v[132:135], v[160:163], a[232:235], v[132:135]
    ds_read_b128 v[192:195], v211 offset:6144
    v_mfma_f32_16x16x32_bf16 v[136:139], v[160:163], a[240:243], v[136:139]
    ds_read_b128 v[152:155], v209 offset:2048
    v_mfma_f32_16x16x32_bf16 v[136:139], v[164:167], a[244:247], v[136:139]
    ds_read_b128 v[156:159], v210 offset:2048
    v_mfma_f32_16x16x32_bf16 v[140:143], v[164:167], a[252:255], v[140:143]
    s_and_b32 s67, s83, 3
    s_xor_b32 s67, s67, 2
    v_mfma_f32_16x16x32_bf16 v[140:143], v[160:163], a[248:251], v[140:143]
    s_add_u32 s67, s67, 2
    s_lshl_b32 s65, s67, 7
    s_waitcnt lgkmcnt(10)
    v_mfma_f32_16x16x32_bf16 v[0:3], v[144:147], v[168:171], v[0:3]
    s_mul_i32 s66, s67, 128
    s_waitcnt lgkmcnt(8)
    ds_read_b128 v[160:163], v209 offset:4096
    v_mfma_f32_16x16x32_bf16 v[0:3], v[148:151], v[172:175], v[0:3]
    s_add_u32 m0, s68, 51200
    s_waitcnt lgkmcnt(8)
    ds_read_b128 v[164:167], v210 offset:4096
    v_mfma_f32_16x16x32_bf16 v[4:7], v[148:151], v[180:183], v[4:7]
    s_waitcnt lgkmcnt(8)
    buffer_load_dwordx4 v200, s[36:39], s65 offen offset:0 lds
    v_mfma_f32_16x16x32_bf16 v[4:7], v[144:147], v[176:179], v[4:7]
    s_waitcnt lgkmcnt(7)
    v_mfma_f32_16x16x32_bf16 v[8:11], v[144:147], v[184:187], v[8:11]
    s_waitcnt lgkmcnt(6)
    v_mfma_f32_16x16x32_bf16 v[8:11], v[148:151], v[188:191], v[8:11]
    s_waitcnt lgkmcnt(5)
    v_mfma_f32_16x16x32_bf16 v[12:15], v[148:151], v[196:199], v[12:15]
    s_waitcnt lgkmcnt(4)
    buffer_load_dwordx4 v201, s[36:39], s65 offen offset:1024 lds
    v_mfma_f32_16x16x32_bf16 v[12:15], v[144:147], v[192:195], v[12:15]
    s_waitcnt lgkmcnt(3)
    v_mfma_f32_16x16x32_bf16 v[28:31], v[152:155], v[192:195], v[28:31]
    s_waitcnt lgkmcnt(2)
    ds_read_b128 v[144:147], v209 offset:6144
    v_mfma_f32_16x16x32_bf16 v[28:31], v[156:159], v[196:199], v[28:31]
    ds_read_b128 v[148:151], v210 offset:6144
    v_mfma_f32_16x16x32_bf16 v[24:27], v[156:159], v[188:191], v[24:27]
    buffer_load_dwordx4 v202, s[36:39], s65 offen offset:2048 lds
    v_mfma_f32_16x16x32_bf16 v[24:27], v[152:155], v[184:187], v[24:27]
    v_mfma_f32_16x16x32_bf16 v[20:23], v[152:155], v[176:179], v[20:23]
    v_mfma_f32_16x16x32_bf16 v[20:23], v[156:159], v[180:183], v[20:23]
    v_mfma_f32_16x16x32_bf16 v[16:19], v[156:159], v[172:175], v[16:19]
    buffer_load_dwordx4 v203, s[36:39], s65 offen offset:3072 lds
    v_mfma_f32_16x16x32_bf16 v[16:19], v[152:155], v[168:171], v[16:19]
    s_waitcnt lgkmcnt(3)
    v_mfma_f32_16x16x32_bf16 v[32:35], v[160:163], v[168:171], v[32:35]
    s_waitcnt lgkmcnt(2)
    ds_read_b128 v[152:155], v209 offset:8192
    v_mfma_f32_16x16x32_bf16 v[32:35], v[164:167], v[172:175], v[32:35]
    ds_read_b128 v[156:159], v210 offset:8192
    v_mfma_f32_16x16x32_bf16 v[36:39], v[164:167], v[180:183], v[36:39]
    buffer_load_dwordx4 v204, s[36:39], s65 offen offset:3584 lds
    v_mfma_f32_16x16x32_bf16 v[36:39], v[160:163], v[176:179], v[36:39]
    v_mfma_f32_16x16x32_bf16 v[40:43], v[160:163], v[184:187], v[40:43]
    v_mfma_f32_16x16x32_bf16 v[40:43], v[164:167], v[188:191], v[40:43]
    s_add_u32 m0, s69, 51200
    v_mfma_f32_16x16x32_bf16 v[44:47], v[164:167], v[196:199], v[44:47]
    buffer_load_dwordx4 v205, s[40:43], s66 offen offset:0 lds
    v_mfma_f32_16x16x32_bf16 v[44:47], v[160:163], v[192:195], v[44:47]
    s_waitcnt lgkmcnt(3)
    v_mfma_f32_16x16x32_bf16 v[60:63], v[144:147], v[192:195], v[60:63]
    s_waitcnt lgkmcnt(2)
    ds_read_b128 v[160:163], v209 offset:10240
    v_mfma_f32_16x16x32_bf16 v[60:63], v[148:151], v[196:199], v[60:63]
    ds_read_b128 v[164:167], v210 offset:10240
    v_mfma_f32_16x16x32_bf16 v[56:59], v[148:151], v[188:191], v[56:59]
    buffer_load_dwordx4 v206, s[40:43], s66 offen offset:1024 lds
    v_mfma_f32_16x16x32_bf16 v[56:59], v[144:147], v[184:187], v[56:59]
    v_mfma_f32_16x16x32_bf16 v[52:55], v[144:147], v[176:179], v[52:55]
    v_mfma_f32_16x16x32_bf16 v[52:55], v[148:151], v[180:183], v[52:55]
    v_mfma_f32_16x16x32_bf16 v[48:51], v[148:151], v[172:175], v[48:51]
    buffer_load_dwordx4 v207, s[40:43], s66 offen offset:2048 lds
    v_mfma_f32_16x16x32_bf16 v[48:51], v[144:147], v[168:171], v[48:51]
    s_waitcnt lgkmcnt(3)
    v_mfma_f32_16x16x32_bf16 v[64:67], v[152:155], v[168:171], v[64:67]
    s_waitcnt lgkmcnt(2)
    ds_read_b128 v[144:147], v209 offset:12288
    v_mfma_f32_16x16x32_bf16 v[64:67], v[156:159], v[172:175], v[64:67]
    ds_read_b128 v[148:151], v210 offset:12288
    v_mfma_f32_16x16x32_bf16 v[68:71], v[156:159], v[180:183], v[68:71]
    buffer_load_dwordx4 v208, s[40:43], s66 offen offset:3072 lds
    v_mfma_f32_16x16x32_bf16 v[68:71], v[152:155], v[176:179], v[68:71]
    v_mfma_f32_16x16x32_bf16 v[72:75], v[152:155], v[184:187], v[72:75]
    v_mfma_f32_16x16x32_bf16 v[72:75], v[156:159], v[188:191], v[72:75]
    s_add_u32 m0, s69, 55296
    v_mfma_f32_16x16x32_bf16 v[76:79], v[156:159], v[196:199], v[76:79]
    buffer_load_dwordx4 v205, s[44:47], s66 offen offset:0 lds
    v_mfma_f32_16x16x32_bf16 v[76:79], v[152:155], v[192:195], v[76:79]
    s_waitcnt lgkmcnt(3)
    v_mfma_f32_16x16x32_bf16 v[92:95], v[160:163], v[192:195], v[92:95]
    s_waitcnt lgkmcnt(2)
    ds_read_b128 v[152:155], v209 offset:14336
    v_mfma_f32_16x16x32_bf16 v[92:95], v[164:167], v[196:199], v[92:95]
    ds_read_b128 v[156:159], v210 offset:14336
    v_mfma_f32_16x16x32_bf16 v[88:91], v[164:167], v[188:191], v[88:91]
    buffer_load_dwordx4 v206, s[44:47], s66 offen offset:1024 lds
    v_mfma_f32_16x16x32_bf16 v[88:91], v[160:163], v[184:187], v[88:91]
    v_mfma_f32_16x16x32_bf16 v[84:87], v[160:163], v[176:179], v[84:87]
    v_mfma_f32_16x16x32_bf16 v[84:87], v[164:167], v[180:183], v[84:87]
    v_mfma_f32_16x16x32_bf16 v[80:83], v[164:167], v[172:175], v[80:83]
    buffer_load_dwordx4 v207, s[44:47], s66 offen offset:2048 lds
    v_mfma_f32_16x16x32_bf16 v[80:83], v[160:163], v[168:171], v[80:83]
    s_waitcnt lgkmcnt(3)
    v_mfma_f32_16x16x32_bf16 v[96:99], v[144:147], v[168:171], v[96:99]
    s_waitcnt lgkmcnt(2)
    ds_read_b128 v[160:163], v209 offset:16384
    v_mfma_f32_16x16x32_bf16 v[96:99], v[148:151], v[172:175], v[96:99]
    ds_read_b128 v[164:167], v210 offset:16384
    v_mfma_f32_16x16x32_bf16 v[100:103], v[148:151], v[180:183], v[100:103]
    buffer_load_dwordx4 v208, s[44:47], s66 offen offset:3072 lds
    v_mfma_f32_16x16x32_bf16 v[100:103], v[144:147], v[176:179], v[100:103]
    v_subrev_u32 v211, 102400, v211
    v_subrev_u32 v209, 102400, v209
    v_mfma_f32_16x16x32_bf16 v[104:107], v[144:147], v[184:187], v[104:107]
    v_subrev_u32 v212, 102400, v212
    v_subrev_u32 v210, 102400, v210
    v_mfma_f32_16x16x32_bf16 v[104:107], v[148:151], v[188:191], v[104:107]
    v_mfma_f32_16x16x32_bf16 v[108:111], v[148:151], v[196:199], v[108:111]
    v_mfma_f32_16x16x32_bf16 v[108:111], v[144:147], v[192:195], v[108:111]
    s_waitcnt vmcnt(13) lgkmcnt(0)
    s_barrier
    ds_read_b128 a[224:227], v211 offset:0
    v_mfma_f32_16x16x32_bf16 v[124:127], v[152:155], v[192:195], v[124:127]
    ds_read_b128 v[144:147], v209 offset:0
    v_mfma_f32_16x16x32_bf16 v[124:127], v[156:159], v[196:199], v[124:127]
    ds_read_b128 a[228:231], v212 offset:0
    v_mfma_f32_16x16x32_bf16 v[120:123], v[156:159], v[188:191], v[120:123]
    v_mfma_f32_16x16x32_bf16 v[120:123], v[152:155], v[184:187], v[120:123]
    ds_read_b128 v[148:151], v210 offset:0
    v_mfma_f32_16x16x32_bf16 v[116:119], v[152:155], v[176:179], v[116:119]
    ds_read_b128 a[236:239], v212 offset:4096
    v_mfma_f32_16x16x32_bf16 v[116:119], v[156:159], v[180:183], v[116:119]
    ds_read_b128 a[232:235], v211 offset:4096
    v_mfma_f32_16x16x32_bf16 v[112:115], v[156:159], v[172:175], v[112:115]
    v_mfma_f32_16x16x32_bf16 v[112:115], v[152:155], v[168:171], v[112:115]
    ds_read_b128 a[240:243], v211 offset:2048
    v_mfma_f32_16x16x32_bf16 v[128:131], v[160:163], v[168:171], v[128:131]
    ds_read_b128 a[244:247], v212 offset:2048
    v_mfma_f32_16x16x32_bf16 v[128:131], v[164:167], v[172:175], v[128:131]
    ds_read_b128 a[252:255], v212 offset:6144
    v_mfma_f32_16x16x32_bf16 v[132:135], v[164:167], v[180:183], v[132:135]
    v_mfma_f32_16x16x32_bf16 v[132:135], v[160:163], v[176:179], v[132:135]
    ds_read_b128 a[248:251], v211 offset:6144
    v_mfma_f32_16x16x32_bf16 v[136:139], v[160:163], v[184:187], v[136:139]
    ds_read_b128 v[152:155], v209 offset:2048
    v_mfma_f32_16x16x32_bf16 v[136:139], v[164:167], v[188:191], v[136:139]
    ds_read_b128 v[156:159], v210 offset:2048
    v_mfma_f32_16x16x32_bf16 v[140:143], v[164:167], v[196:199], v[140:143]
    s_and_b32 s67, s83, 3
    s_xor_b32 s67, s67, 3
    v_mfma_f32_16x16x32_bf16 v[140:143], v[160:163], v[192:195], v[140:143]
    s_add_u32 s67, s67, 2
    s_lshl_b32 s65, s67, 7
    s_waitcnt lgkmcnt(10)
    v_mfma_f32_16x16x32_bf16 v[0:3], v[144:147], a[224:227], v[0:3]
    s_mul_i32 s66, s67, 128
    s_waitcnt lgkmcnt(8)
    ds_read_b128 v[160:163], v209 offset:4096
    v_mfma_f32_16x16x32_bf16 v[0:3], v[148:151], a[228:231], v[0:3]
    s_add_u32 m0, s68, 102400
    s_waitcnt lgkmcnt(8)
    ds_read_b128 v[164:167], v210 offset:4096
    v_mfma_f32_16x16x32_bf16 v[4:7], v[148:151], a[236:239], v[4:7]
    s_waitcnt lgkmcnt(8)
    buffer_load_dwordx4 v200, s[36:39], s65 offen offset:0 lds
    v_mfma_f32_16x16x32_bf16 v[4:7], v[144:147], a[232:235], v[4:7]
    s_waitcnt lgkmcnt(7)
    v_mfma_f32_16x16x32_bf16 v[8:11], v[144:147], a[240:243], v[8:11]
    s_waitcnt lgkmcnt(6)
    v_mfma_f32_16x16x32_bf16 v[8:11], v[148:151], a[244:247], v[8:11]
    s_waitcnt lgkmcnt(5)
    v_mfma_f32_16x16x32_bf16 v[12:15], v[148:151], a[252:255], v[12:15]
    s_waitcnt lgkmcnt(4)
    buffer_load_dwordx4 v201, s[36:39], s65 offen offset:1024 lds
    v_mfma_f32_16x16x32_bf16 v[12:15], v[144:147], a[248:251], v[12:15]
    s_waitcnt lgkmcnt(3)
    v_mfma_f32_16x16x32_bf16 v[28:31], v[152:155], a[248:251], v[28:31]
    s_waitcnt lgkmcnt(2)
    ds_read_b128 v[144:147], v209 offset:6144
    v_mfma_f32_16x16x32_bf16 v[28:31], v[156:159], a[252:255], v[28:31]
    ds_read_b128 v[148:151], v210 offset:6144
    v_mfma_f32_16x16x32_bf16 v[24:27], v[156:159], a[244:247], v[24:27]
    buffer_load_dwordx4 v202, s[36:39], s65 offen offset:2048 lds
    v_mfma_f32_16x16x32_bf16 v[24:27], v[152:155], a[240:243], v[24:27]
    v_mfma_f32_16x16x32_bf16 v[20:23], v[152:155], a[232:235], v[20:23]
    v_mfma_f32_16x16x32_bf16 v[20:23], v[156:159], a[236:239], v[20:23]
    v_mfma_f32_16x16x32_bf16 v[16:19], v[156:159], a[228:231], v[16:19]
    buffer_load_dwordx4 v203, s[36:39], s65 offen offset:3072 lds
    v_mfma_f32_16x16x32_bf16 v[16:19], v[152:155], a[224:227], v[16:19]
    s_waitcnt lgkmcnt(3)
    v_mfma_f32_16x16x32_bf16 v[32:35], v[160:163], a[224:227], v[32:35]
    s_waitcnt lgkmcnt(2)
    ds_read_b128 v[152:155], v209 offset:8192
    v_mfma_f32_16x16x32_bf16 v[32:35], v[164:167], a[228:231], v[32:35]
    ds_read_b128 v[156:159], v210 offset:8192
    v_mfma_f32_16x16x32_bf16 v[36:39], v[164:167], a[236:239], v[36:39]
    buffer_load_dwordx4 v204, s[36:39], s65 offen offset:3584 lds
    v_mfma_f32_16x16x32_bf16 v[36:39], v[160:163], a[232:235], v[36:39]
    v_mfma_f32_16x16x32_bf16 v[40:43], v[160:163], a[240:243], v[40:43]
    v_mfma_f32_16x16x32_bf16 v[40:43], v[164:167], a[244:247], v[40:43]
    s_lshl_b32 s73, s60, 10
    s_add_u32 s73, s73, 43008
    v_mfma_f32_16x16x32_bf16 v[44:47], v[164:167], a[252:255], v[44:47]
    buffer_load_dword v252, v213, s[48:51], s73 offen sc1
    v_mfma_f32_16x16x32_bf16 v[44:47], v[160:163], a[248:251], v[44:47]
    s_waitcnt lgkmcnt(3)
    v_mfma_f32_16x16x32_bf16 v[60:63], v[144:147], a[248:251], v[60:63]
    s_waitcnt lgkmcnt(2)
    ds_read_b128 v[160:163], v209 offset:10240
    v_mfma_f32_16x16x32_bf16 v[60:63], v[148:151], a[252:255], v[60:63]
    s_add_u32 m0, s69, 102400
    ds_read_b128 v[164:167], v210 offset:10240
    v_mfma_f32_16x16x32_bf16 v[56:59], v[148:151], a[244:247], v[56:59]
    buffer_load_dwordx4 v205, s[40:43], s66 offen offset:0 lds
    v_mfma_f32_16x16x32_bf16 v[56:59], v[144:147], a[240:243], v[56:59]
    v_mfma_f32_16x16x32_bf16 v[52:55], v[144:147], a[232:235], v[52:55]
    s_mul_i32 s98, s62, 1152
    s_mul_i32 s99, s60, 288
    v_mfma_f32_16x16x32_bf16 v[52:55], v[148:151], a[236:239], v[52:55]
    s_add_u32 s98, s98, s99
    s_add_u32 s98, s98, 47360
    v_mfma_f32_16x16x32_bf16 v[48:51], v[148:151], a[228:231], v[48:51]
    buffer_load_dwordx4 v206, s[40:43], s66 offen offset:1024 lds
    v_mfma_f32_16x16x32_bf16 v[48:51], v[144:147], a[224:227], v[48:51]
    s_waitcnt lgkmcnt(3)
    v_mfma_f32_16x16x32_bf16 v[64:67], v[152:155], a[224:227], v[64:67]
    s_waitcnt lgkmcnt(2)
    ds_read_b128 v[144:147], v209 offset:12288
    v_mfma_f32_16x16x32_bf16 v[64:67], v[156:159], a[228:231], v[64:67]
    ds_read_b128 v[148:151], v210 offset:12288
    v_mfma_f32_16x16x32_bf16 v[68:71], v[156:159], a[236:239], v[68:71]
    buffer_load_dwordx4 v207, s[40:43], s66 offen offset:2048 lds
    v_mfma_f32_16x16x32_bf16 v[68:71], v[152:155], a[232:235], v[68:71]
    v_mfma_f32_16x16x32_bf16 v[72:75], v[152:155], a[240:243], v[72:75]
    v_mfma_f32_16x16x32_bf16 v[72:75], v[156:159], a[244:247], v[72:75]
    s_mov_b32 s75, 47104
    s_or_b32 s74, s60, s2
    s_cselect_b32 s74, 2146435072, s75
    v_mfma_f32_16x16x32_bf16 v[76:79], v[156:159], a[252:255], v[76:79]
    buffer_load_dwordx4 v208, s[40:43], s66 offen offset:3072 lds
    v_mfma_f32_16x16x32_bf16 v[76:79], v[152:155], a[248:251], v[76:79]
    s_waitcnt lgkmcnt(3)
    v_mfma_f32_16x16x32_bf16 v[92:95], v[160:163], a[248:251], v[92:95]
    s_waitcnt lgkmcnt(2)
    ds_read_b128 v[152:155], v209 offset:14336
    v_mfma_f32_16x16x32_bf16 v[92:95], v[164:167], a[252:255], v[92:95]
    s_add_u32 m0, s69, 106496
    ds_read_b128 v[156:159], v210 offset:14336
    v_mfma_f32_16x16x32_bf16 v[88:91], v[164:167], a[244:247], v[88:91]
    buffer_load_dwordx4 v205, s[44:47], s66 offen offset:0 lds
    v_mfma_f32_16x16x32_bf16 v[88:91], v[160:163], a[240:243], v[88:91]
    v_mfma_f32_16x16x32_bf16 v[84:87], v[160:163], a[232:235], v[84:87]
    v_and_b32 v255, 0xff, v213
L_padS1:
    s_cbranch_execz L_padS5
    v_mfma_f32_16x16x32_bf16 v[84:87], v[164:167], a[236:239], v[84:87]
    v_mov_b32 v240, s82
    v_and_b32 v241, 0, v215
    v_mfma_f32_16x16x32_bf16 v[80:83], v[164:167], a[228:231], v[80:83]
    buffer_load_dwordx4 v206, s[44:47], s66 offen offset:1024 lds
    v_mfma_f32_16x16x32_bf16 v[80:83], v[160:163], a[224:227], v[80:83]
    s_waitcnt lgkmcnt(3)
    v_mfma_f32_16x16x32_bf16 v[96:99], v[144:147], a[224:227], v[96:99]
    s_waitcnt lgkmcnt(2)
    ds_read_b128 v[160:163], v209 offset:16384
    v_mfma_f32_16x16x32_bf16 v[96:99], v[148:151], a[228:231], v[96:99]
    ds_read_b128 v[164:167], v210 offset:16384
    v_mfma_f32_16x16x32_bf16 v[100:103], v[148:151], a[236:239], v[100:103]
    buffer_load_dwordx4 v207, s[44:47], s66 offen offset:2048 lds
    v_mfma_f32_16x16x32_bf16 v[100:103], v[144:147], a[232:235], v[100:103]
    v_add_u32 v211, 51200, v211
    v_add_u32 v209, 51200, v209
    v_mfma_f32_16x16x32_bf16 v[104:107], v[144:147], a[240:243], v[104:107]
    v_add_u32 v212, 51200, v212
    v_add_u32 v210, 51200, v210
    v_mfma_f32_16x16x32_bf16 v[104:107], v[148:151], a[244:247], v[104:107]
    s_waitcnt vmcnt(7)
    v_cmp_ne_u32 vcc, s82, v252
    v_mfma_f32_16x16x32_bf16 v[108:111], v[148:151], a[252:255], v[108:111]
    buffer_load_dwordx4 v208, s[44:47], s66 offen offset:3072 lds
    v_mfma_f32_16x16x32_bf16 v[108:111], v[144:147], a[248:251], v[108:111]
    s_cbranch_vccnz L_slow_15
L_ok_13:
    s_waitcnt lgkmcnt(0)
    s_barrier
    ds_read_b128 v[168:171], v211 offset:0
    v_mfma_f32_16x16x32_bf16 v[124:127], v[152:155], a[248:251], v[124:127]
    ds_read_b128 v[144:147], v209 offset:0
    buffer_store_dword v240, v241, s[48:51], s74 offen sc1
    v_mfma_f32_16x16x32_bf16 v[124:127], v[156:159], a[252:255], v[124:127]
    s_add_u32 m0, s99, 153600
    ds_read_b128 v[172:175], v212 offset:0
    v_mfma_f32_16x16x32_bf16 v[120:123], v[156:159], a[244:247], v[120:123]
    buffer_load_dwordx4 v213, s[48:51], s98 offen sc1 lds
    v_mfma_f32_16x16x32_bf16 v[120:123], v[152:155], a[240:243], v[120:123]
    ds_read_b128 v[148:151], v210 offset:0
    v_mfma_f32_16x16x32_bf16 v[116:119], v[152:155], a[232:235], v[116:119]
    s_lshl_b32 s73, s3, 8
    ds_read_b128 v[180:183], v212 offset:4096
    v_mfma_f32_16x16x32_bf16 v[116:119], v[156:159], a[236:239], v[116:119]
    s_add_u32 s73, s73, 37888
    s_mul_i32 s76, s64, 52
    ds_read_b128 v[176:179], v211 offset:4096
    v_mfma_f32_16x16x32_bf16 v[112:115], v[156:159], a[228:231], v[112:115]
    s_mul_i32 s75, s60, 12
    buffer_load_dwordx4 v[244:247], v255, s[48:51], s73 offen sc1
    v_mfma_f32_16x16x32_bf16 v[112:115], v[152:155], a[224:227], v[112:115]
    s_add_u32 s76, s76, s75
    s_mul_i32 s76, s76, 5
    ds_read_b128 v[184:187], v211 offset:2048
    v_mfma_f32_16x16x32_bf16 v[128:131], v[160:163], a[224:227], v[128:131]
    s_and_b32 s75, s64, 1
    s_add_u32 s76, s76, s75
    ds_read_b128 v[188:191], v212 offset:2048
    v_mfma_f32_16x16x32_bf16 v[128:131], v[164:167], a[228:231], v[128:131]
    s_lshl_b32 s76, s76, 10
    s_add_u32 s78, s76, 221184
    ds_read_b128 v[196:199], v212 offset:6144
    v_mfma_f32_16x16x32_bf16 v[132:135], v[164:167], a[236:239], v[132:135]
    buffer_load_dwordx4 a[0:3], v213, s[48:51], s78 offen offset:0 sc1
    v_mfma_f32_16x16x32_bf16 v[132:135], v[160:163], a[232:235], v[132:135]
    ds_read_b128 v[192:195], v211 offset:6144
    v_mfma_f32_16x16x32_bf16 v[136:139], v[160:163], a[240:243], v[136:139]
    ds_read_b128 v[152:155], v209 offset:2048
    v_mfma_f32_16x16x32_bf16 v[136:139], v[164:167], a[244:247], v[136:139]
    ds_read_b128 v[156:159], v210 offset:2048
    v_mfma_f32_16x16x32_bf16 v[140:143], v[164:167], a[252:255], v[140:143]
    s_and_b32 s67, s83, 3
    buffer_load_dwordx4 a[4:7], v213, s[48:51], s78 offen offset:1024 sc1
    v_mfma_f32_16x16x32_bf16 v[140:143], v[160:163], a[248:251], v[140:143]
    s_add_u32 s67, s67, 6
    s_lshl_b32 s65, s67, 7
    s_waitcnt lgkmcnt(10)
    v_mfma_f32_16x16x32_bf16 v[0:3], v[144:147], v[168:171], v[0:3]
    s_mul_i32 s66, s67, 128
    s_waitcnt lgkmcnt(8)
    ds_read_b128 v[160:163], v209 offset:4096
    v_mfma_f32_16x16x32_bf16 v[0:3], v[148:151], v[172:175], v[0:3]
    s_add_u32 m0, s68, 0
    s_waitcnt lgkmcnt(8)
    ds_read_b128 v[164:167], v210 offset:4096
    v_mfma_f32_16x16x32_bf16 v[4:7], v[148:151], v[180:183], v[4:7]
    s_waitcnt lgkmcnt(8)
    buffer_load_dwordx4 v200, s[36:39], s65 offen offset:0 lds
    v_mfma_f32_16x16x32_bf16 v[4:7], v[144:147], v[176:179], v[4:7]
    s_waitcnt lgkmcnt(7)
    v_mfma_f32_16x16x32_bf16 v[8:11], v[144:147], v[184:187], v[8:11]
    s_waitcnt lgkmcnt(6)
    v_mfma_f32_16x16x32_bf16 v[8:11], v[148:151], v[188:191], v[8:11]
    s_waitcnt lgkmcnt(5)
    v_mfma_f32_16x16x32_bf16 v[12:15], v[148:151], v[196:199], v[12:15]
    s_waitcnt lgkmcnt(4)
    buffer_load_dwordx4 v201, s[36:39], s65 offen offset:1024 lds
    v_mfma_f32_16x16x32_bf16 v[12:15], v[144:147], v[192:195], v[12:15]
    s_waitcnt lgkmcnt(3)
    v_mfma_f32_16x16x32_bf16 v[28:31], v[152:155], v[192:195], v[28:31]
    s_waitcnt lgkmcnt(2)
    ds_read_b128 v[144:147], v209 offset:6144
    v_mfma_f32_16x16x32_bf16 v[28:31], v[156:159], v[196:199], v[28:31]
    ds_read_b128 v[148:151], v210 offset:6144
    v_mfma_f32_16x16x32_bf16 v[24:27], v[156:159], v[188:191], v[24:27]
    buffer_load_dwordx4 v202, s[36:39], s65 offen offset:2048 lds
    v_mfma_f32_16x16x32_bf16 v[24:27], v[152:155], v[184:187], v[24:27]
    v_mfma_f32_16x16x32_bf16 v[20:23], v[152:155], v[176:179], v[20:23]
    v_mfma_f32_16x16x32_bf16 v[20:23], v[156:159], v[180:183], v[20:23]
    v_mfma_f32_16x16x32_bf16 v[16:19], v[156:159], v[172:175], v[16:19]
    buffer_load_dwordx4 v203, s[36:39], s65 offen offset:3072 lds
    v_mfma_f32_16x16x32_bf16 v[16:19], v[152:155], v[168:171], v[16:19]
    s_waitcnt lgkmcnt(3)
    v_mfma_f32_16x16x32_bf16 v[32:35], v[160:163], v[168:171], v[32:35]
    s_waitcnt lgkmcnt(2)
    ds_read_b128 v[152:155], v209 offset:8192
    v_mfma_f32_16x16x32_bf16 v[32:35], v[164:167], v[172:175], v[32:35]
    ds_read_b128 v[156:159], v210 offset:8192
    v_mfma_f32_16x16x32_bf16 v[36:39], v[164:167], v[180:183], v[36:39]
    buffer_load_dwordx4 v204, s[36:39], s65 offen offset:3584 lds
    v_mfma_f32_16x16x32_bf16 v[36:39], v[160:163], v[176:179], v[36:39]
    v_mfma_f32_16x16x32_bf16 v[40:43], v[160:163], v[184:187], v[40:43]
    v_mfma_f32_16x16x32_bf16 v[40:43], v[164:167], v[188:191], v[40:43]
    s_add_u32 m0, s69, 0
    v_mfma_f32_16x16x32_bf16 v[44:47], v[164:167], v[196:199], v[44:47]
    buffer_load_dwordx4 v205, s[40:43], s66 offen offset:0 lds
    v_mfma_f32_16x16x32_bf16 v[44:47], v[160:163], v[192:195], v[44:47]
    s_waitcnt lgkmcnt(3)
    v_mfma_f32_16x16x32_bf16 v[60:63], v[144:147], v[192:195], v[60:63]
    s_waitcnt lgkmcnt(2)
    ds_read_b128 v[160:163], v209 offset:10240
    v_mfma_f32_16x16x32_bf16 v[60:63], v[148:151], v[196:199], v[60:63]
    ds_read_b128 v[164:167], v210 offset:10240
    v_mfma_f32_16x16x32_bf16 v[56:59], v[148:151], v[188:191], v[56:59]
    buffer_load_dwordx4 v206, s[40:43], s66 offen offset:1024 lds
    v_mfma_f32_16x16x32_bf16 v[56:59], v[144:147], v[184:187], v[56:59]
    v_mfma_f32_16x16x32_bf16 v[52:55], v[144:147], v[176:179], v[52:55]
    v_mfma_f32_16x16x32_bf16 v[52:55], v[148:151], v[180:183], v[52:55]
    v_mfma_f32_16x16x32_bf16 v[48:51], v[148:151], v[172:175], v[48:51]
    buffer_load_dwordx4 v207, s[40:43], s66 offen offset:2048 lds
    v_mfma_f32_16x16x32_bf16 v[48:51], v[144:147], v[168:171], v[48:51]
    s_waitcnt lgkmcnt(3)
    v_mfma_f32_16x16x32_bf16 v[64:67], v[152:155], v[168:171], v[64:67]
    s_waitcnt lgkmcnt(2)
    ds_read_b128 v[144:147], v209 offset:12288
    v_mfma_f32_16x16x32_bf16 v[64:67], v[156:159], v[172:175], v[64:67]
    ds_read_b128 v[148:151], v210 offset:12288
    v_mfma_f32_16x16x32_bf16 v[68:71], v[156:159], v[180:183], v[68:71]
    buffer_load_dwordx4 v208, s[40:43], s66 offen offset:3072 lds
    v_mfma_f32_16x16x32_bf16 v[68:71], v[152:155], v[176:179], v[68:71]
    v_mfma_f32_16x16x32_bf16 v[72:75], v[152:155], v[184:187], v[72:75]
    v_mfma_f32_16x16x32_bf16 v[72:75], v[156:159], v[188:191], v[72:75]
    s_add_u32 m0, s69, 4096
    v_mfma_f32_16x16x32_bf16 v[76:79], v[156:159], v[196:199], v[76:79]
    buffer_load_dwordx4 v205, s[44:47], s66 offen offset:0 lds
    v_mfma_f32_16x16x32_bf16 v[76:79], v[152:155], v[192:195], v[76:79]
    s_waitcnt lgkmcnt(3)
    v_mfma_f32_16x16x32_bf16 v[92:95], v[160:163], v[192:195], v[92:95]
    s_waitcnt lgkmcnt(2)
    ds_read_b128 v[152:155], v209 offset:14336
    v_mfma_f32_16x16x32_bf16 v[92:95], v[164:167], v[196:199], v[92:95]
    ds_read_b128 v[156:159], v210 offset:14336
    v_mfma_f32_16x16x32_bf16 v[88:91], v[164:167], v[188:191], v[88:91]
    buffer_load_dwordx4 v206, s[44:47], s66 offen offset:1024 lds
    v_mfma_f32_16x16x32_bf16 v[88:91], v[160:163], v[184:187], v[88:91]
    v_mfma_f32_16x16x32_bf16 v[84:87], v[160:163], v[176:179], v[84:87]
    v_mfma_f32_16x16x32_bf16 v[84:87], v[164:167], v[180:183], v[84:87]
    v_mfma_f32_16x16x32_bf16 v[80:83], v[164:167], v[172:175], v[80:83]
    buffer_load_dwordx4 v207, s[44:47], s66 offen offset:2048 lds
    v_mfma_f32_16x16x32_bf16 v[80:83], v[160:163], v[168:171], v[80:83]
    s_waitcnt lgkmcnt(3)
    v_mfma_f32_16x16x32_bf16 v[96:99], v[144:147], v[168:171], v[96:99]
    s_waitcnt lgkmcnt(2)
    ds_read_b128 v[160:163], v209 offset:16384
    v_mfma_f32_16x16x32_bf16 v[96:99], v[148:151], v[172:175], v[96:99]
    ds_read_b128 v[164:167], v210 offset:16384
    v_mfma_f32_16x16x32_bf16 v[100:103], v[148:151], v[180:183], v[100:103]
    buffer_load_dwordx4 v208, s[44:47], s66 offen offset:3072 lds
    v_mfma_f32_16x16x32_bf16 v[100:103], v[144:147], v[176:179], v[100:103]
    v_add_u32 v211, 51200, v211
    v_add_u32 v209, 51200, v209
    v_mfma_f32_16x16x32_bf16 v[104:107], v[144:147], v[184:187], v[104:107]
    v_add_u32 v212, 51200, v212
    v_add_u32 v210, 51200, v210
    v_mfma_f32_16x16x32_bf16 v[104:107], v[148:151], v[188:191], v[104:107]
    v_mfma_f32_16x16x32_bf16 v[108:111], v[148:151], v[196:199], v[108:111]
    v_mfma_f32_16x16x32_bf16 v[108:111], v[144:147], v[192:195], v[108:111]
    s_waitcnt vmcnt(18) lgkmcnt(0)
    s_barrier
    ds_read_b128 a[224:227], v211 offset:0
    v_mfma_f32_16x16x32_bf16 v[124:127], v[152:155], v[192:195], v[124:127]
    ds_read_b128 v[144:147], v209 offset:0
    v_mfma_f32_16x16x32_bf16 v[124:127], v[156:159], v[196:199], v[124:127]
    ds_read_b128 a[228:231], v212 offset:0
    v_mfma_f32_16x16x32_bf16 v[120:123], v[156:159], v[188:191], v[120:123]
    buffer_load_dwordx4 a[8:11], v213, s[48:51], s78 offen offset:2048 sc1
    v_mfma_f32_16x16x32_bf16 v[120:123], v[152:155], v[184:187], v[120:123]
    ds_read_b128 v[148:151], v210 offset:0
    v_mfma_f32_16x16x32_bf16 v[116:119], v[152:155], v[176:179], v[116:119]
    ds_read_b128 a[236:239], v212 offset:4096
    v_mfma_f32_16x16x32_bf16 v[116:119], v[156:159], v[180:183], v[116:119]
    ds_read_b128 a[232:235], v211 offset:4096
    v_mfma_f32_16x16x32_bf16 v[112:115], v[156:159], v[172:175], v[112:115]
    buffer_load_dwordx4 a[12:15], v213, s[48:51], s78 offen offset:3072 sc1
    v_mfma_f32_16x16x32_bf16 v[112:115], v[152:155], v[168:171], v[112:115]
    ds_read_b128 a[240:243], v211 offset:2048
    v_mfma_f32_16x16x32_bf16 v[128:131], v[160:163], v[168:171], v[128:131]
    ds_read_b128 a[244:247], v212 offset:2048
    v_mfma_f32_16x16x32_bf16 v[128:131], v[164:167], v[172:175], v[128:131]
    s_sub_u32 s78, s78, 1024
    ds_read_b128 a[252:255], v212 offset:6144
    v_mfma_f32_16x16x32_bf16 v[132:135], v[164:167], v[180:183], v[132:135]
    buffer_load_dwordx4 a[16:19], v214, s[48:51], s78 offen sc1
    v_mfma_f32_16x16x32_bf16 v[132:135], v[160:163], v[176:179], v[132:135]
    ds_read_b128 a[248:251], v211 offset:6144
    v_mfma_f32_16x16x32_bf16 v[136:139], v[160:163], v[184:187], v[136:139]
    ds_read_b128 v[152:155], v209 offset:2048
    v_mfma_f32_16x16x32_bf16 v[136:139], v[164:167], v[188:191], v[136:139]
    s_add_u32 s78, s78, 6144
    s_and_b32 s67, s83, 3
    ds_read_b128 v[156:159], v210 offset:2048
    v_mfma_f32_16x16x32_bf16 v[140:143], v[164:167], v[196:199], v[140:143]
    s_xor_b32 s67, s67, 1
    buffer_load_dwordx4 a[20:23], v213, s[48:51], s78 offen offset:0 sc1
    v_mfma_f32_16x16x32_bf16 v[140:143], v[160:163], v[192:195], v[140:143]
    s_add_u32 s67, s67, 6
    s_lshl_b32 s65, s67, 7
    s_waitcnt lgkmcnt(10)
    v_mfma_f32_16x16x32_bf16 v[0:3], v[144:147], a[224:227], v[0:3]
    s_mul_i32 s66, s67, 128
    s_waitcnt lgkmcnt(8)
    ds_read_b128 v[160:163], v209 offset:4096
    v_mfma_f32_16x16x32_bf16 v[0:3], v[148:151], a[228:231], v[0:3]
    s_add_u32 m0, s68, 51200
    s_waitcnt lgkmcnt(8)
    ds_read_b128 v[164:167], v210 offset:4096
    v_mfma_f32_16x16x32_bf16 v[4:7], v[148:151], a[236:239], v[4:7]
    s_waitcnt lgkmcnt(8)
    buffer_load_dwordx4 v200, s[36:39], s65 offen offset:0 lds
    v_mfma_f32_16x16x32_bf16 v[4:7], v[144:147], a[232:235], v[4:7]
    s_waitcnt lgkmcnt(7)
    v_mfma_f32_16x16x32_bf16 v[8:11], v[144:147], a[240:243], v[8:11]
    s_waitcnt lgkmcnt(6)
    v_mfma_f32_16x16x32_bf16 v[8:11], v[148:151], a[244:247], v[8:11]
    s_waitcnt lgkmcnt(5)
    v_mfma_f32_16x16x32_bf16 v[12:15], v[148:151], a[252:255], v[12:15]
    s_waitcnt lgkmcnt(4)
    buffer_load_dwordx4 v201, s[36:39], s65 offen offset:1024 lds
    v_mfma_f32_16x16x32_bf16 v[12:15], v[144:147], a[248:251], v[12:15]
    s_waitcnt lgkmcnt(3)
    v_mfma_f32_16x16x32_bf16 v[28:31], v[152:155], a[248:251], v[28:31]
    s_waitcnt lgkmcnt(2)
    ds_read_b128 v[144:147], v209 offset:6144
    v_mfma_f32_16x16x32_bf16 v[28:31], v[156:159], a[252:255], v[28:31]
    ds_read_b128 v[148:151], v210 offset:6144
    v_mfma_f32_16x16x32_bf16 v[24:27], v[156:159], a[244:247], v[24:27]
    buffer_load_dwordx4 v202, s[36:39], s65 offen offset:2048 lds
    v_mfma_f32_16x16x32_bf16 v[24:27], v[152:155], a[240:243], v[24:27]
    v_mfma_f32_16x16x32_bf16 v[20:23], v[152:155], a[232:235], v[20:23]
    v_mfma_f32_16x16x32_bf16 v[20:23], v[156:159], a[236:239], v[20:23]
    v_mfma_f32_16x16x32_bf16 v[16:19], v[156:159], a[228:231], v[16:19]
    buffer_load_dwordx4 v203, s[36:39], s65 offen offset:3072 lds
    v_mfma_f32_16x16x32_bf16 v[16:19], v[152:155], a[224:227], v[16:19]
    s_waitcnt lgkmcnt(3)
    v_mfma_f32_16x16x32_bf16 v[32:35], v[160:163], a[224:227], v[32:35]
    s_waitcnt lgkmcnt(2)
    ds_read_b128 v[152:155], v209 offset:8192
    v_mfma_f32_16x16x32_bf16 v[32:35], v[164:167], a[228:231], v[32:35]
    ds_read_b128 v[156:159], v210 offset:8192
    v_mfma_f32_16x16x32_bf16 v[36:39], v[164:167], a[236:239], v[36:39]
    buffer_load_dwordx4 v204, s[36:39], s65 offen offset:3584 lds
    v_mfma_f32_16x16x32_bf16 v[36:39], v[160:163], a[232:235], v[36:39]
    v_mfma_f32_16x16x32_bf16 v[40:43], v[160:163], a[240:243], v[40:43]
    v_mfma_f32_16x16x32_bf16 v[40:43], v[164:167], a[244:247], v[40:43]
    s_add_u32 m0, s69, 51200
    v_mfma_f32_16x16x32_bf16 v[44:47], v[164:167], a[252:255], v[44:47]
    buffer_load_dwordx4 v205, s[40:43], s66 offen offset:0 lds
    v_mfma_f32_16x16x32_bf16 v[44:47], v[160:163], a[248:251], v[44:47]
    s_waitcnt lgkmcnt(3)
    v_mfma_f32_16x16x32_bf16 v[60:63], v[144:147], a[248:251], v[60:63]
    s_waitcnt lgkmcnt(2)
    ds_read_b128 v[160:163], v209 offset:10240
    v_mfma_f32_16x16x32_bf16 v[60:63], v[148:151], a[252:255], v[60:63]
    ds_read_b128 v[164:167], v210 offset:10240
    v_mfma_f32_16x16x32_bf16 v[56:59], v[148:151], a[244:247], v[56:59]
    buffer_load_dwordx4 v206, s[40:43], s66 offen offset:1024 lds
    v_mfma_f32_16x16x32_bf16 v[56:59], v[144:147], a[240:243], v[56:59]
    v_mfma_f32_16x16x32_bf16 v[52:55], v[144:147], a[232:235], v[52:55]
    v_mfma_f32_16x16x32_bf16 v[52:55], v[148:151], a[236:239], v[52:55]
    v_mfma_f32_16x16x32_bf16 v[48:51], v[148:151], a[228:231], v[48:51]
    buffer_load_dwordx4 v207, s[40:43], s66 offen offset:2048 lds
    v_mfma_f32_16x16x32_bf16 v[48:51], v[144:147], a[224:227], v[48:51]
    s_waitcnt lgkmcnt(3)
    v_mfma_f32_16x16x32_bf16 v[64:67], v[152:155], a[224:227], v[64:67]
    s_waitcnt lgkmcnt(2)
    ds_read_b128 v[144:147], v209 offset:12288
    v_mfma_f32_16x16x32_bf16 v[64:67], v[156:159], a[228:231], v[64:67]
    ds_read_b128 v[148:151], v210 offset:12288
    v_mfma_f32_16x16x32_bf16 v[68:71], v[156:159], a[236:239], v[68:71]
    buffer_load_dwordx4 v208, s[40:43], s66 offen offset:3072 lds
    v_mfma_f32_16x16x32_bf16 v[68:71], v[152:155], a[232:235], v[68:71]
    v_mfma_f32_16x16x32_bf16 v[72:75], v[152:155], a[240:243], v[72:75]
    v_mfma_f32_16x16x32_bf16 v[72:75], v[156:159], a[244:247], v[72:75]
    s_add_u32 m0, s69, 55296
    v_mfma_f32_16x16x32_bf16 v[76:79], v[156:159], a[252:255], v[76:79]
    buffer_load_dwordx4 v205, s[44:47], s66 offen offset:0 lds
    v_mfma_f32_16x16x32_bf16 v[76:79], v[152:155], a[248:251], v[76:79]
    s_waitcnt lgkmcnt(3)
    v_mfma_f32_16x16x32_bf16 v[92:95], v[160:163], a[248:251], v[92:95]
    s_waitcnt lgkmcnt(2)
    ds_read_b128 v[152:155], v209 offset:14336
    v_mfma_f32_16x16x32_bf16 v[92:95], v[164:167], a[252:255], v[92:95]
    ds_read_b128 v[156:159], v210 offset:14336
    v_mfma_f32_16x16x32_bf16 v[88:91], v[164:167], a[244:247], v[88:91]
    buffer_load_dwordx4 v206, s[44:47], s66 offen offset:1024 lds
    v_mfma_f32_16x16x32_bf16 v[88:91], v[160:163], a[240:243], v[88:91]
    v_mfma_f32_16x16x32_bf16 v[84:87], v[160:163], a[232:235], v[84:87]
    v_mfma_f32_16x16x32_bf16 v[84:87], v[164:167], a[236:239], v[84:87]
    v_mfma_f32_16x16x32_bf16 v[80:83], v[164:167], a[228:231], v[80:83]
    buffer_load_dwordx4 v207, s[44:47], s66 offen offset:2048 lds
    v_mfma_f32_16x16x32_bf16 v[80:83], v[160:163], a[224:227], v[80:83]
    s_waitcnt lgkmcnt(3)
    v_mfma_f32_16x16x32_bf16 v[96:99], v[144:147], a[224:227], v[96:99]
    s_waitcnt lgkmcnt(2)
    ds_read_b128 v[160:163], v209 offset:16384
    v_mfma_f32_16x16x32_bf16 v[96:99], v[148:151], a[228:231], v[96:99]
    ds_read_b128 v[164:167], v210 offset:16384
    v_mfma_f32_16x16x32_bf16 v[100:103], v[148:151], a[236:239], v[100:103]
    buffer_load_dwordx4 v208, s[44:47], s66 offen offset:3072 lds
    v_mfma_f32_16x16x32_bf16 v[100:103], v[144:147], a[232:235], v[100:103]
    v_subrev_u32 v211, 102400, v211
    v_subrev_u32 v209, 102400, v209
    v_mfma_f32_16x16x32_bf16 v[104:107], v[144:147], a[240:243], v[104:107]
    v_subrev_u32 v212, 102400, v212
    v_subrev_u32 v210, 102400, v210
    v_mfma_f32_16x16x32_bf16 v[104:107], v[148:151], a[244:247], v[104:107]
    v_mfma_f32_16x16x32_bf16 v[108:111], v[148:151], a[252:255], v[108:111]
    v_mfma_f32_16x16x32_bf16 v[108:111], v[144:147], a[248:251], v[108:111]
    s_waitcnt vmcnt(17) lgkmcnt(0)
    s_barrier
    ds_read_b128 v[168:171], v211 offset:0
    v_mfma_f32_16x16x32_bf16 v[124:127], v[152:155], a[248:251], v[124:127]
    ds_read_b128 v[144:147], v209 offset:0
    v_mfma_f32_16x16x32_bf16 v[124:127], v[156:159], a[252:255], v[124:127]
    ds_read_b128 v[172:175], v212 offset:0
    v_mfma_f32_16x16x32_bf16 v[120:123], v[156:159], a[244:247], v[120:123]
    buffer_load_dwordx4 a[24:27], v213, s[48:51], s78 offen offset:1024 sc1
    v_mfma_f32_16x16x32_bf16 v[120:123], v[152:155], a[240:243], v[120:123]
    ds_read_b128 v[148:151], v210 offset:0
    v_mfma_f32_16x16x32_bf16 v[116:119], v[152:155], a[232:235], v[116:119]
    ds_read_b128 v[180:183], v212 offset:4096
    v_mfma_f32_16x16x32_bf16 v[116:119], v[156:159], a[236:239], v[116:119]
    ds_read_b128 v[176:179], v211 offset:4096
    v_mfma_f32_16x16x32_bf16 v[112:115], v[156:159], a[228:231], v[112:115]
    buffer_load_dwordx4 a[28:31], v213, s[48:51], s78 offen offset:2048 sc1
    v_mfma_f32_16x16x32_bf16 v[112:115], v[152:155], a[224:227], v[112:115]
    ds_read_b128 v[184:187], v211 offset:2048
    v_mfma_f32_16x16x32_bf16 v[128:131], v[160:163], a[224:227], v[128:131]
    ds_read_b128 v[188:191], v212 offset:2048
    v_mfma_f32_16x16x32_bf16 v[128:131], v[164:167], a[228:231], v[128:131]
    ds_read_b128 v[196:199], v212 offset:6144
    v_mfma_f32_16x16x32_bf16 v[132:135], v[164:167], a[236:239], v[132:135]
    buffer_load_dwordx4 a[32:35], v213, s[48:51], s78 offen offset:3072 sc1
    v_mfma_f32_16x16x32_bf16 v[132:135], v[160:163], a[232:235], v[132:135]
    ds_read_b128 v[192:195], v211 offset:6144
    v_mfma_f32_16x16x32_bf16 v[136:139], v[160:163], a[240:243], v[136:139]
    ds_read_b128 v[152:155], v209 offset:2048
    v_mfma_f32_16x16x32_bf16 v[136:139], v[164:167], a[244:247], v[136:139]
    s_sub_u32 s78, s78, 1024
    s_and_b32 s67, s83, 3
    ds_read_b128 v[156:159], v210 offset:2048
    v_mfma_f32_16x16x32_bf16 v[140:143], v[164:167], a[252:255], v[140:143]
    s_xor_b32 s67, s67, 2
    buffer_load_dwordx4 a[36:39], v214, s[48:51], s78 offen sc1
    v_mfma_f32_16x16x32_bf16 v[140:143], v[160:163], a[248:251], v[140:143]
    s_add_u32 s67, s67, 6
    s_lshl_b32 s65, s67, 7
    s_waitcnt lgkmcnt(10)
    v_mfma_f32_16x16x32_bf16 v[0:3], v[144:147], v[168:171], v[0:3]
    s_mul_i32 s66, s67, 128
    s_waitcnt lgkmcnt(8)
    ds_read_b128 v[160:163], v209 offset:4096
    v_mfma_f32_16x16x32_bf16 v[0:3], v[148:151], v[172:175], v[0:3]
    s_add_u32 m0, s68, 102400
    s_waitcnt lgkmcnt(8)
    ds_read_b128 v[164:167], v210 offset:4096
    v_mfma_f32_16x16x32_bf16 v[4:7], v[148:151], v[180:183], v[4:7]
    s_waitcnt lgkmcnt(8)
    buffer_load_dwordx4 v200, s[36:39], s65 offen offset:0 lds
    v_mfma_f32_16x16x32_bf16 v[4:7], v[144:147], v[176:179], v[4:7]
    s_waitcnt lgkmcnt(7)
    v_mfma_f32_16x16x32_bf16 v[8:11], v[144:147], v[184:187], v[8:11]
    s_waitcnt lgkmcnt(6)
    v_mfma_f32_16x16x32_bf16 v[8:11], v[148:151], v[188:191], v[8:11]
    s_waitcnt lgkmcnt(5)
    v_mfma_f32_16x16x32_bf16 v[12:15], v[148:151], v[196:199], v[12:15]
    s_waitcnt lgkmcnt(4)
    buffer_load_dwordx4 v201, s[36:39], s65 offen offset:1024 lds
    v_mfma_f32_16x16x32_bf16 v[12:15], v[144:147], v[192:195], v[12:15]
    s_waitcnt lgkmcnt(3)
    v_mfma_f32_16x16x32_bf16 v[28:31], v[152:155], v[192:195], v[28:31]
    s_waitcnt lgkmcnt(2)
    ds_read_b128 v[144:147], v209 offset:6144
    v_mfma_f32_16x16x32_bf16 v[28:31], v[156:159], v[196:199], v[28:31]
    ds_read_b128 v[148:151], v210 offset:6144
    v_mfma_f32_16x16x32_bf16 v[24:27], v[156:159], v[188:191], v[24:27]
    buffer_load_dwordx4 v202, s[36:39], s65 offen offset:2048 lds
    v_mfma_f32_16x16x32_bf16 v[24:27], v[152:155], v[184:187], v[24:27]
    v_mfma_f32_16x16x32_bf16 v[20:23], v[152:155], v[176:179], v[20:23]
    v_mfma_f32_16x16x32_bf16 v[20:23], v[156:159], v[180:183], v[20:23]
    v_mfma_f32_16x16x32_bf16 v[16:19], v[156:159], v[172:175], v[16:19]
    buffer_load_dwordx4 v203, s[36:39], s65 offen offset:3072 lds
    v_mfma_f32_16x16x32_bf16 v[16:19], v[152:155], v[168:171], v[16:19]
    s_waitcnt lgkmcnt(3)
    v_mfma_f32_16x16x32_bf16 v[32:35], v[160:163], v[168:171], v[32:35]
    s_waitcnt lgkmcnt(2)
    ds_read_b128 v[152:155], v209 offset:8192
    v_mfma_f32_16x16x32_bf16 v[32:35], v[164:167], v[172:175], v[32:35]
    ds_read_b128 v[156:159], v210 offset:8192
    v_mfma_f32_16x16x32_bf16 v[36:39], v[164:167], v[180:183], v[36:39]
    buffer_load_dwordx4 v204, s[36:39], s65 offen offset:3584 lds
    v_mfma_f32_16x16x32_bf16 v[36:39], v[160:163], v[176:179], v[36:39]
    v_mfma_f32_16x16x32_bf16 v[40:43], v[160:163], v[184:187], v[40:43]
    v_mfma_f32_16x16x32_bf16 v[40:43], v[164:167], v[188:191], v[40:43]
    s_add_u32 m0, s69, 102400
    v_mfma_f32_16x16x32_bf16 v[44:47], v[164:167], v[196:199], v[44:47]
    buffer_load_dwordx4 v205, s[40:43], s66 offen offset:0 lds
    v_mfma_f32_16x16x32_bf16 v[44:47], v[160:163], v[192:195], v[44:47]
    s_waitcnt lgkmcnt(3)
    v_mfma_f32_16x16x32_bf16 v[60:63], v[144:147], v[192:195], v[60:63]
    s_waitcnt lgkmcnt(2)
    ds_read_b128 v[160:163], v209 offset:10240
    v_mfma_f32_16x16x32_bf16 v[60:63], v[148:151], v[196:199], v[60:63]
    ds_read_b128 v[164:167], v210 offset:10240
    v_mfma_f32_16x16x32_bf16 v[56:59], v[148:151], v[188:191], v[56:59]
    buffer_load_dwordx4 v206, s[40:43], s66 offen offset:1024 lds
    v_mfma_f32_16x16x32_bf16 v[56:59], v[144:147], v[184:187], v[56:59]
    v_mfma_f32_16x16x32_bf16 v[52:55], v[144:147], v[176:179], v[52:55]
    v_mfma_f32_16x16x32_bf16 v[52:55], v[148:151], v[180:183], v[52:55]
    v_mfma_f32_16x16x32_bf16 v[48:51], v[148:151], v[172:175], v[48:51]
    buffer_load_dwordx4 v207, s[40:43], s66 offen offset:2048 lds
    v_mfma_f32_16x16x32_bf16 v[48:51], v[144:147], v[168:171], v[48:51]
    s_waitcnt lgkmcnt(3)
    v_mfma_f32_16x16x32_bf16 v[64:67], v[152:155], v[168:171], v[64:67]
    s_waitcnt lgkmcnt(2)
    ds_read_b128 v[144:147], v209 offset:12288
    v_mfma_f32_16x16x32_bf16 v[64:67], v[156:159], v[172:175], v[64:67]
    ds_read_b128 v[148:151], v210 offset:12288
    v_mfma_f32_16x16x32_bf16 v[68:71], v[156:159], v[180:183], v[68:71]
    buffer_load_dwordx4 v208, s[40:43], s66 offen offset:3072 lds
    v_mfma_f32_16x16x32_bf16 v[68:71], v[152:155], v[176:179], v[68:71]
    v_mfma_f32_16x16x32_bf16 v[72:75], v[152:155], v[184:187], v[72:75]
    v_mfma_f32_16x16x32_bf16 v[72:75], v[156:159], v[188:191], v[72:75]
    s_add_u32 m0, s69, 106496
    v_mfma_f32_16x16x32_bf16 v[76:79], v[156:159], v[196:199], v[76:79]
    buffer_load_dwordx4 v205, s[44:47], s66 offen offset:0 lds
    v_mfma_f32_16x16x32_bf16 v[76:79], v[152:155], v[192:195], v[76:79]
    s_waitcnt lgkmcnt(3)
    v_mfma_f32_16x16x32_bf16 v[92:95], v[160:163], v[192:195], v[92:95]
    s_waitcnt lgkmcnt(2)
    ds_read_b128 v[152:155], v209 offset:14336
    v_mfma_f32_16x16x32_bf16 v[92:95], v[164:167], v[196:199], v[92:95]
    ds_read_b128 v[156:159], v210 offset:14336
    v_mfma_f32_16x16x32_bf16 v[88:91], v[164:167], v[188:191], v[88:91]
    buffer_load_dwordx4 v206, s[44:47], s66 offen offset:1024 lds
    v_mfma_f32_16x16x32_bf16 v[88:91], v[160:163], v[184:187], v[88:91]
    v_mfma_f32_16x16x32_bf16 v[84:87], v[160:163], v[176:179], v[84:87]
    v_mfma_f32_16x16x32_bf16 v[84:87], v[164:167], v[180:183], v[84:87]
    v_mfma_f32_16x16x32_bf16 v[80:83], v[164:167], v[172:175], v[80:83]
    buffer_load_dwordx4 v207, s[44:47], s66 offen offset:2048 lds
    v_mfma_f32_16x16x32_bf16 v[80:83], v[160:163], v[168:171], v[80:83]
    s_waitcnt lgkmcnt(3)
    v_mfma_f32_16x16x32_bf16 v[96:99], v[144:147], v[168:171], v[96:99]
    s_waitcnt lgkmcnt(2)
    ds_read_b128 v[160:163], v209 offset:16384
    v_mfma_f32_16x16x32_bf16 v[96:99], v[148:151], v[172:175], v[96:99]
    ds_read_b128 v[164:167], v210 offset:16384
    v_mfma_f32_16x16x32_bf16 v[100:103], v[148:151], v[180:183], v[100:103]
    buffer_load_dwordx4 v208, s[44:47], s66 offen offset:3072 lds
    v_mfma_f32_16x16x32_bf16 v[100:103], v[144:147], v[176:179], v[100:103]
    v_add_u32 v211, 51200, v211
    v_add_u32 v209, 51200, v209
    v_mfma_f32_16x16x32_bf16 v[104:107], v[144:147], v[184:187], v[104:107]
    v_add_u32 v212, 51200, v212
    v_add_u32 v210, 51200, v210
    v_mfma_f32_16x16x32_bf16 v[104:107], v[148:151], v[188:191], v[104:107]
    v_mfma_f32_16x16x32_bf16 v[108:111], v[148:151], v[196:199], v[108:111]
    v_mfma_f32_16x16x32_bf16 v[108:111], v[144:147], v[192:195], v[108:111]
    s_waitcnt vmcnt(17) lgkmcnt(0)
    s_barrier
    ds_read_b128 a[224:227], v211 offset:0
    v_mfma_f32_16x16x32_bf16 v[124:127], v[152:155], v[192:195], v[124:127]
    ds_read_b128 v[144:147], v209 offset:0
    v_mfma_f32_16x16x32_bf16 v[124:127], v[156:159], v[196:199], v[124:127]
    s_add_u32 s78, s78, 6144
    ds_read_b128 a[228:231], v212 offset:0
    v_mfma_f32_16x16x32_bf16 v[120:123], v[156:159], v[188:191], v[120:123]
    buffer_load_dwordx4 a[40:43], v213, s[48:51], s78 offen offset:0 sc1
    v_mfma_f32_16x16x32_bf16 v[120:123], v[152:155], v[184:187], v[120:123]
    ds_read_b128 v[148:151], v210 offset:0
    v_mfma_f32_16x16x32_bf16 v[116:119], v[152:155], v[176:179], v[116:119]
    ds_read_b128 a[236:239], v212 offset:4096
    v_mfma_f32_16x16x32_bf16 v[116:119], v[156:159], v[180:183], v[116:119]
    ds_read_b128 a[232:235], v211 offset:4096
    v_mfma_f32_16x16x32_bf16 v[112:115], v[156:159], v[172:175], v[112:115]
    buffer_load_dwordx4 a[44:47], v213, s[48:51], s78 offen offset:1024 sc1
    v_mfma_f32_16x16x32_bf16 v[112:115], v[152:155], v[168:171], v[112:115]
    ds_read_b128 a[240:243], v211 offset:2048
    v_mfma_f32_16x16x32_bf16 v[128:131], v[160:163], v[168:171], v[128:131]
    ds_read_b128 a[244:247], v212 offset:2048
    v_mfma_f32_16x16x32_bf16 v[128:131], v[164:167], v[172:175], v[128:131]
    ds_read_b128 a[252:255], v212 offset:6144
    v_mfma_f32_16x16x32_bf16 v[132:135], v[164:167], v[180:183], v[132:135]
    buffer_load_dwordx4 a[48:51], v213, s[48:51], s78 offen offset:2048 sc1
    v_mfma_f32_16x16x32_bf16 v[132:135], v[160:163], v[176:179], v[132:135]
    ds_read_b128 a[248:251], v211 offset:6144
    v_mfma_f32_16x16x32_bf16 v[136:139], v[160:163], v[184:187], v[136:139]
    ds_read_b128 v[152:155], v209 offset:2048
    v_mfma_f32_16x16x32_bf16 v[136:139], v[164:167], v[188:191], v[136:139]
    s_and_b32 s67, s83, 3
    ds_read_b128 v[156:159], v210 offset:2048
    v_mfma_f32_16x16x32_bf16 v[140:143], v[164:167], v[196:199], v[140:143]
    s_xor_b32 s67, s67, 3
    buffer_load_dwordx4 a[52:55], v213, s[48:51], s78 offen offset:3072 sc1
    v_mfma_f32_16x16x32_bf16 v[140:143], v[160:163], v[192:195], v[140:143]
    s_add_u32 s67, s67, 6
    s_lshl_b32 s65, s67, 7
    s_waitcnt lgkmcnt(10)
    v_mfma_f32_16x16x32_bf16 v[0:3], v[144:147], a[224:227], v[0:3]
    s_mul_i32 s66, s67, 128
    s_waitcnt lgkmcnt(8)
    ds_read_b128 v[160:163], v209 offset:4096
    v_mfma_f32_16x16x32_bf16 v[0:3], v[148:151], a[228:231], v[0:3]
    s_add_u32 m0, s68, 0
    s_waitcnt lgkmcnt(8)
    ds_read_b128 v[164:167], v210 offset:4096
    v_mfma_f32_16x16x32_bf16 v[4:7], v[148:151], a[236:239], v[4:7]
    s_waitcnt lgkmcnt(8)
    buffer_load_dwordx4 v200, s[36:39], s65 offen offset:0 lds
    v_mfma_f32_16x16x32_bf16 v[4:7], v[144:147], a[232:235], v[4:7]
    s_waitcnt lgkmcnt(7)
    v_mfma_f32_16x16x32_bf16 v[8:11], v[144:147], a[240:243], v[8:11]
    s_waitcnt lgkmcnt(6)
    v_mfma_f32_16x16x32_bf16 v[8:11], v[148:151], a[244:247], v[8:11]
    s_waitcnt lgkmcnt(5)
    v_mfma_f32_16x16x32_bf16 v[12:15], v[148:151], a[252:255], v[12:15]
    s_waitcnt lgkmcnt(4)
    buffer_load_dwordx4 v201, s[36:39], s65 offen offset:1024 lds
    v_mfma_f32_16x16x32_bf16 v[12:15], v[144:147], a[248:251], v[12:15]
    s_waitcnt lgkmcnt(3)
    v_mfma_f32_16x16x32_bf16 v[28:31], v[152:155], a[248:251], v[28:31]
    s_waitcnt lgkmcnt(2)
    ds_read_b128 v[144:147], v209 offset:6144
    v_mfma_f32_16x16x32_bf16 v[28:31], v[156:159], a[252:255], v[28:31]
    ds_read_b128 v[148:151], v210 offset:6144
    v_mfma_f32_16x16x32_bf16 v[24:27], v[156:159], a[244:247], v[24:27]
    buffer_load_dwordx4 v202, s[36:39], s65 offen offset:2048 lds
    v_mfma_f32_16x16x32_bf16 v[24:27], v[152:155], a[240:243], v[24:27]
    v_mfma_f32_16x16x32_bf16 v[20:23], v[152:155], a[232:235], v[20:23]
    v_mfma_f32_16x16x32_bf16 v[20:23], v[156:159], a[236:239], v[20:23]
    v_mfma_f32_16x16x32_bf16 v[16:19], v[156:159], a[228:231], v[16:19]
    buffer_load_dwordx4 v203, s[36:39], s65 offen offset:3072 lds
    v_mfma_f32_16x16x32_bf16 v[16:19], v[152:155], a[224:227], v[16:19]
    s_waitcnt lgkmcnt(3)
    v_mfma_f32_16x16x32_bf16 v[32:35], v[160:163], a[224:227], v[32:35]
    s_waitcnt lgkmcnt(2)
    ds_read_b128 v[152:155], v209 offset:8192
    v_mfma_f32_16x16x32_bf16 v[32:35], v[164:167], a[228:231], v[32:35]
L_padS2:
    s_cbranch_execz L_padS6
    ds_read_b128 v[156:159], v210 offset:8192
    v_mfma_f32_16x16x32_bf16 v[36:39], v[164:167], a[236:239], v[36:39]
    buffer_load_dwordx4 v204, s[36:39], s65 offen offset:3584 lds
    v_mfma_f32_16x16x32_bf16 v[36:39], v[160:163], a[232:235], v[36:39]
    v_mfma_f32_16x16x32_bf16 v[40:43], v[160:163], a[240:243], v[40:43]
    v_mfma_f32_16x16x32_bf16 v[40:43], v[164:167], a[244:247], v[40:43]
    s_add_u32 m0, s69, 0
    v_mfma_f32_16x16x32_bf16 v[44:47], v[164:167], a[252:255], v[44:47]
    buffer_load_dwordx4 v205, s[40:43], s66 offen offset:0 lds
    v_mfma_f32_16x16x32_bf16 v[44:47], v[160:163], a[248:251], v[44:47]
    s_waitcnt lgkmcnt(3)
    v_mfma_f32_16x16x32_bf16 v[60:63], v[144:147], a[248:251], v[60:63]
    s_waitcnt lgkmcnt(2)
    ds_read_b128 v[160:163], v209 offset:10240
    v_mfma_f32_16x16x32_bf16 v[60:63], v[148:151], a[252:255], v[60:63]
    ds_read_b128 v[164:167], v210 offset:10240
    v_mfma_f32_16x16x32_bf16 v[56:59], v[148:151], a[244:247], v[56:59]
    buffer_load_dwordx4 v206, s[40:43], s66 offen offset:1024 lds
    v_mfma_f32_16x16x32_bf16 v[56:59], v[144:147], a[240:243], v[56:59]
    v_mfma_f32_16x16x32_bf16 v[52:55], v[144:147], a[232:235], v[52:55]
    v_mfma_f32_16x16x32_bf16 v[52:55], v[148:151], a[236:239], v[52:55]
    v_mfma_f32_16x16x32_bf16 v[48:51], v[148:151], a[228:231], v[48:51]
    buffer_load_dwordx4 v207, s[40:43], s66 offen offset:2048 lds
    v_mfma_f32_16x16x32_bf16 v[48:51], v[144:147], a[224:227], v[48:51]
    s_waitcnt lgkmcnt(3)
    v_mfma_f32_16x16x32_bf16 v[64:67], v[152:155], a[224:227], v[64:67]
    s_waitcnt lgkmcnt(2)
    ds_read_b128 v[144:147], v209 offset:12288
    v_mfma_f32_16x16x32_bf16 v[64:67], v[156:159], a[228:231], v[64:67]
    ds_read_b128 v[148:151], v210 offset:12288
    v_mfma_f32_16x16x32_bf16 v[68:71], v[156:159], a[236:239], v[68:71]
    buffer_load_dwordx4 v208, s[40:43], s66 offen offset:3072 lds
    v_mfma_f32_16x16x32_bf16 v[68:71], v[152:155], a[232:235], v[68:71]
    v_mfma_f32_16x16x32_bf16 v[72:75], v[152:155], a[240:243], v[72:75]
    v_mfma_f32_16x16x32_bf16 v[72:75], v[156:159], a[244:247], v[72:75]
    s_add_u32 m0, s69, 4096
    v_mfma_f32_16x16x32_bf16 v[76:79], v[156:159], a[252:255], v[76:79]
    buffer_load_dwordx4 v205, s[44:47], s66 offen offset:0 lds
    v_mfma_f32_16x16x32_bf16 v[76:79], v[152:155], a[248:251], v[76:79]
    s_waitcnt lgkmcnt(3)
    v_mfma_f32_16x16x32_bf16 v[92:95], v[160:163], a[248:251], v[92:95]
    s_waitcnt lgkmcnt(2)
    ds_read_b128 v[152:155], v209 offset:14336
    v_mfma_f32_16x16x32_bf16 v[92:95], v[164:167], a[252:255], v[92:95]
    ds_read_b128 v[156:159], v210 offset:14336
    v_mfma_f32_16x16x32_bf16 v[88:91], v[164:167], a[244:247], v[88:91]
    buffer_load_dwordx4 v206, s[44:47], s66 offen offset:1024 lds
    v_mfma_f32_16x16x32_bf16 v[88:91], v[160:163], a[240:243], v[88:91]
    v_mfma_f32_16x16x32_bf16 v[84:87], v[160:163], a[232:235], v[84:87]
    v_mfma_f32_16x16x32_bf16 v[84:87], v[164:167], a[236:239], v[84:87]
    v_mfma_f32_16x16x32_bf16 v[80:83], v[164:167], a[228:231], v[80:83]
    buffer_load_dwordx4 v207, s[44:47], s66 offen offset:2048 lds
    v_mfma_f32_16x16x32_bf16 v[80:83], v[160:163], a[224:227], v[80:83]
    s_waitcnt lgkmcnt(3)
    v_mfma_f32_16x16x32_bf16 v[96:99], v[144:147], a[224:227], v[96:99]
    s_waitcnt lgkmcnt(2)
    ds_read_b128 v[160:163], v209 offset:16384
    v_mfma_f32_16x16x32_bf16 v[96:99], v[148:151], a[228:231], v[96:99]
    ds_read_b128 v[164:167], v210 offset:16384
    v_mfma_f32_16x16x32_bf16 v[100:103], v[148:151], a[236:239], v[100:103]
    buffer_load_dwordx4 v208, s[44:47], s66 offen offset:3072 lds
    v_mfma_f32_16x16x32_bf16 v[100:103], v[144:147], a[232:235], v[100:103]
    v_add_u32 v211, 51200, v211
    v_add_u32 v209, 51200, v209
    v_mfma_f32_16x16x32_bf16 v[104:107], v[144:147], a[240:243], v[104:107]
    v_add_u32 v212, 51200, v212
    v_add_u32 v210, 51200, v210
    v_mfma_f32_16x16x32_bf16 v[104:107], v[148:151], a[244:247], v[104:107]
    v_mfma_f32_16x16x32_bf16 v[108:111], v[148:151], a[252:255], v[108:111]
    v_mfma_f32_16x16x32_bf16 v[108:111], v[144:147], a[248:251], v[108:111]
    s_waitcnt vmcnt(17) lgkmcnt(0)
    s_barrier
    ds_read_b128 v[168:171], v211 offset:0
    v_mfma_f32_16x16x32_bf16 v[124:127], v[152:155], a[248:251], v[124:127]
    ds_read_b128 v[144:147], v209 offset:0
    v_mfma_f32_16x16x32_bf16 v[124:127], v[156:159], a[252:255], v[124:127]
    s_sub_u32 s78, s78, 1024
    ds_read_b128 v[172:175], v212 offset:0
    v_mfma_f32_16x16x32_bf16 v[120:123], v[156:159], a[244:247], v[120:123]
    buffer_load_dwordx4 a[56:59], v214, s[48:51], s78 offen sc1
    v_mfma_f32_16x16x32_bf16 v[120:123], v[152:155], a[240:243], v[120:123]
    ds_read_b128 v[148:151], v210 offset:0
    v_mfma_f32_16x16x32_bf16 v[116:119], v[152:155], a[232:235], v[116:119]
    ds_read_b128 v[180:183], v212 offset:4096
    v_mfma_f32_16x16x32_bf16 v[116:119], v[156:159], a[236:239], v[116:119]
    s_add_u32 s78, s78, 6144
    ds_read_b128 v[176:179], v211 offset:4096
    v_mfma_f32_16x16x32_bf16 v[112:115], v[156:159], a[228:231], v[112:115]
    buffer_load_dwordx4 a[60:63], v213, s[48:51], s78 offen offset:0 sc1
    v_mfma_f32_16x16x32_bf16 v[112:115], v[152:155], a[224:227], v[112:115]
    ds_read_b128 v[184:187], v211 offset:2048
    v_mfma_f32_16x16x32_bf16 v[128:131], v[160:163], a[224:227], v[128:131]
    ds_read_b128 v[188:191], v212 offset:2048
    v_mfma_f32_16x16x32_bf16 v[128:131], v[164:167], a[228:231], v[128:131]
    ds_read_b128 v[196:199], v212 offset:6144
    v_mfma_f32_16x16x32_bf16 v[132:135], v[164:167], a[236:239], v[132:135]
    buffer_load_dwordx4 a[64:67], v213, s[48:51], s78 offen offset:1024 sc1
    v_mfma_f32_16x16x32_bf16 v[132:135], v[160:163], a[232:235], v[132:135]
    ds_read_b128 v[192:195], v211 offset:6144
    v_mfma_f32_16x16x32_bf16 v[136:139], v[160:163], a[240:243], v[136:139]
    ds_read_b128 v[152:155], v209 offset:2048
    v_mfma_f32_16x16x32_bf16 v[136:139], v[164:167], a[244:247], v[136:139]
    ds_read_b128 v[156:159], v210 offset:2048
    v_mfma_f32_16x16x32_bf16 v[140:143], v[164:167], a[252:255], v[140:143]
    buffer_load_dwordx4 a[68:71], v213, s[48:51], s78 offen offset:2048 sc1
    v_mfma_f32_16x16x32_bf16 v[140:143], v[160:163], a[248:251], v[140:143]
    s_waitcnt lgkmcnt(10)
    v_mfma_f32_16x16x32_bf16 v[0:3], v[144:147], v[168:171], v[0:3]
    s_waitcnt lgkmcnt(8)
    ds_read_b128 v[160:163], v209 offset:4096
    v_mfma_f32_16x16x32_bf16 v[0:3], v[148:151], v[172:175], v[0:3]
    s_waitcnt lgkmcnt(8)
    ds_read_b128 v[164:167], v210 offset:4096
    v_mfma_f32_16x16x32_bf16 v[4:7], v[148:151], v[180:183], v[4:7]
    s_waitcnt lgkmcnt(8)
    buffer_load_dwordx4 a[72:75], v213, s[48:51], s78 offen offset:3072 sc1
    v_mfma_f32_16x16x32_bf16 v[4:7], v[144:147], v[176:179], v[4:7]
    s_waitcnt lgkmcnt(7)
    v_mfma_f32_16x16x32_bf16 v[8:11], v[144:147], v[184:187], v[8:11]
    s_waitcnt lgkmcnt(6)
    v_mfma_f32_16x16x32_bf16 v[8:11], v[148:151], v[188:191], v[8:11]
    s_sub_u32 s78, s78, 1024
    s_waitcnt lgkmcnt(5)
    v_mfma_f32_16x16x32_bf16 v[12:15], v[148:151], v[196:199], v[12:15]
    s_waitcnt lgkmcnt(4)
    buffer_load_dwordx4 a[76:79], v214, s[48:51], s78 offen sc1
    v_mfma_f32_16x16x32_bf16 v[12:15], v[144:147], v[192:195], v[12:15]
    s_waitcnt lgkmcnt(3)
    v_mfma_f32_16x16x32_bf16 v[28:31], v[152:155], v[192:195], v[28:31]
    s_waitcnt lgkmcnt(2)
    ds_read_b128 v[144:147], v209 offset:6144
    v_mfma_f32_16x16x32_bf16 v[28:31], v[156:159], v[196:199], v[28:31]
    s_add_u32 s78, s78, 6144
    ds_read_b128 v[148:151], v210 offset:6144
    v_mfma_f32_16x16x32_bf16 v[24:27], v[156:159], v[188:191], v[24:27]
    buffer_load_dwordx4 a[80:83], v213, s[48:51], s78 offen offset:0 sc1
    v_mfma_f32_16x16x32_bf16 v[24:27], v[152:155], v[184:187], v[24:27]
    v_mfma_f32_16x16x32_bf16 v[20:23], v[152:155], v[176:179], v[20:23]
    v_mfma_f32_16x16x32_bf16 v[20:23], v[156:159], v[180:183], v[20:23]
    v_mfma_f32_16x16x32_bf16 v[16:19], v[156:159], v[172:175], v[16:19]
    buffer_load_dwordx4 a[84:87], v213, s[48:51], s78 offen offset:1024 sc1
    v_mfma_f32_16x16x32_bf16 v[16:19], v[152:155], v[168:171], v[16:19]
    s_waitcnt lgkmcnt(3)
    v_mfma_f32_16x16x32_bf16 v[32:35], v[160:163], v[168:171], v[32:35]
    s_waitcnt lgkmcnt(2)
    ds_read_b128 v[152:155], v209 offset:8192
    v_mfma_f32_16x16x32_bf16 v[32:35], v[164:167], v[172:175], v[32:35]
    ds_read_b128 v[156:159], v210 offset:8192
    v_mfma_f32_16x16x32_bf16 v[36:39], v[164:167], v[180:183], v[36:39]
    buffer_load_dwordx4 a[88:91], v213, s[48:51], s78 offen offset:2048 sc1
    v_mfma_f32_16x16x32_bf16 v[36:39], v[160:163], v[176:179], v[36:39]
    v_mfma_f32_16x16x32_bf16 v[40:43], v[160:163], v[184:187], v[40:43]
    v_mfma_f32_16x16x32_bf16 v[40:43], v[164:167], v[188:191], v[40:43]
    v_mfma_f32_16x16x32_bf16 v[44:47], v[164:167], v[196:199], v[44:47]
    buffer_load_dwordx4 a[92:95], v213, s[48:51], s78 offen offset:3072 sc1
    v_mfma_f32_16x16x32_bf16 v[44:47], v[160:163], v[192:195], v[44:47]
    s_waitcnt lgkmcnt(3)
    v_mfma_f32_16x16x32_bf16 v[60:63], v[144:147], v[192:195], v[60:63]
    s_waitcnt lgkmcnt(2)
    ds_read_b128 v[160:163], v209 offset:10240
    v_mfma_f32_16x16x32_bf16 v[60:63], v[148:151], v[196:199], v[60:63]
    s_sub_u32 s78, s78, 1024
    ds_read_b128 v[164:167], v210 offset:10240
    v_mfma_f32_16x16x32_bf16 v[56:59], v[148:151], v[188:191], v[56:59]
    buffer_load_dwordx4 a[96:99], v214, s[48:51], s78 offen sc1
    v_mfma_f32_16x16x32_bf16 v[56:59], v[144:147], v[184:187], v[56:59]
    v_mfma_f32_16x16x32_bf16 v[52:55], v[144:147], v[176:179], v[52:55]
    v_mfma_f32_16x16x32_bf16 v[52:55], v[148:151], v[180:183], v[52:55]
    s_add_u32 s78, s78, 6144
    v_mfma_f32_16x16x32_bf16 v[48:51], v[148:151], v[172:175], v[48:51]
    buffer_load_dwordx4 a[100:103], v213, s[48:51], s78 offen offset:0 sc1
    v_mfma_f32_16x16x32_bf16 v[48:51], v[144:147], v[168:171], v[48:51]
    s_waitcnt lgkmcnt(3)
    v_mfma_f32_16x16x32_bf16 v[64:67], v[152:155], v[168:171], v[64:67]
    s_waitcnt lgkmcnt(2)
    ds_read_b128 v[144:147], v209 offset:12288
    v_mfma_f32_16x16x32_bf16 v[64:67], v[156:159], v[172:175], v[64:67]
    ds_read_b128 v[148:151], v210 offset:12288
    v_mfma_f32_16x16x32_bf16 v[68:71], v[156:159], v[180:183], v[68:71]
    buffer_load_dwordx4 a[104:107], v213, s[48:51], s78 offen offset:1024 sc1
    v_mfma_f32_16x16x32_bf16 v[68:71], v[152:155], v[176:179], v[68:71]
    v_mfma_f32_16x16x32_bf16 v[72:75], v[152:155], v[184:187], v[72:75]
    v_mfma_f32_16x16x32_bf16 v[72:75], v[156:159], v[188:191], v[72:75]
    v_mfma_f32_16x16x32_bf16 v[76:79], v[156:159], v[196:199], v[76:79]
    buffer_load_dwordx4 a[108:111], v213, s[48:51], s78 offen offset:2048 sc1
    v_mfma_f32_16x16x32_bf16 v[76:79], v[152:155], v[192:195], v[76:79]
    s_waitcnt lgkmcnt(3)
    v_mfma_f32_16x16x32_bf16 v[92:95], v[160:163], v[192:195], v[92:95]
    s_waitcnt lgkmcnt(2)
    ds_read_b128 v[152:155], v209 offset:14336
    v_mfma_f32_16x16x32_bf16 v[92:95], v[164:167], v[196:199], v[92:95]
    ds_read_b128 v[156:159], v210 offset:14336
    v_mfma_f32_16x16x32_bf16 v[88:91], v[164:167], v[188:191], v[88:91]
    buffer_load_dwordx4 a[112:115], v213, s[48:51], s78 offen offset:3072 sc1
    v_mfma_f32_16x16x32_bf16 v[88:91], v[160:163], v[184:187], v[88:91]
    v_mfma_f32_16x16x32_bf16 v[84:87], v[160:163], v[176:179], v[84:87]
    v_mfma_f32_16x16x32_bf16 v[84:87], v[164:167], v[180:183], v[84:87]
    s_sub_u32 s78, s78, 1024
    v_mfma_f32_16x16x32_bf16 v[80:83], v[164:167], v[172:175], v[80:83]
    buffer_load_dwordx4 a[116:119], v214, s[48:51], s78 offen sc1
    v_mfma_f32_16x16x32_bf16 v[80:83], v[160:163], v[168:171], v[80:83]
    s_waitcnt lgkmcnt(3)
    v_mfma_f32_16x16x32_bf16 v[96:99], v[144:147], v[168:171], v[96:99]
    s_waitcnt lgkmcnt(2)
    ds_read_b128 v[160:163], v209 offset:16384
    v_mfma_f32_16x16x32_bf16 v[96:99], v[148:151], v[172:175], v[96:99]
    s_add_u32 s78, s78, 6144
    ds_read_b128 v[164:167], v210 offset:16384
    v_mfma_f32_16x16x32_bf16 v[100:103], v[148:151], v[180:183], v[100:103]
    buffer_load_dwordx4 a[120:123], v213, s[48:51], s78 offen offset:0 sc1
    v_mfma_f32_16x16x32_bf16 v[100:103], v[144:147], v[176:179], v[100:103]
    v_subrev_u32 v211, 102400, v211
    v_subrev_u32 v209, 102400, v209
    v_mfma_f32_16x16x32_bf16 v[104:107], v[144:147], v[184:187], v[104:107]
    v_subrev_u32 v212, 102400, v212
    v_subrev_u32 v210, 102400, v210
    v_mfma_f32_16x16x32_bf16 v[104:107], v[148:151], v[188:191], v[104:107]
    v_mfma_f32_16x16x32_bf16 v[108:111], v[148:151], v[196:199], v[108:111]
    buffer_load_dwordx4 a[124:127], v213, s[48:51], s78 offen offset:1024 sc1
    v_mfma_f32_16x16x32_bf16 v[108:111], v[144:147], v[192:195], v[108:111]
    s_waitcnt vmcnt(18) lgkmcnt(0)
    s_barrier
    ds_read_b128 a[224:227], v211 offset:0
    v_mfma_f32_16x16x32_bf16 v[124:127], v[152:155], v[192:195], v[124:127]
    ds_read_b128 v[144:147], v209 offset:0
    v_mfma_f32_16x16x32_bf16 v[124:127], v[156:159], v[196:199], v[124:127]
    ds_read_b128 a[228:231], v212 offset:0
    v_mfma_f32_16x16x32_bf16 v[120:123], v[156:159], v[188:191], v[120:123]
    buffer_load_dwordx4 a[128:131], v213, s[48:51], s78 offen offset:2048 sc1
    v_mfma_f32_16x16x32_bf16 v[120:123], v[152:155], v[184:187], v[120:123]
    ds_read_b128 v[148:151], v210 offset:0
    v_mfma_f32_16x16x32_bf16 v[116:119], v[152:155], v[176:179], v[116:119]
    ds_read_b128 a[236:239], v212 offset:4096
    v_mfma_f32_16x16x32_bf16 v[116:119], v[156:159], v[180:183], v[116:119]
    ds_read_b128 a[232:235], v211 offset:4096
    v_mfma_f32_16x16x32_bf16 v[112:115], v[156:159], v[172:175], v[112:115]
    buffer_load_dwordx4 a[132:135], v213, s[48:51], s78 offen offset:3072 sc1
    v_mfma_f32_16x16x32_bf16 v[112:115], v[152:155], v[168:171], v[112:115]
    ds_read_b128 a[240:243], v211 offset:2048
    v_mfma_f32_16x16x32_bf16 v[128:131], v[160:163], v[168:171], v[128:131]
    ds_read_b128 a[244:247], v212 offset:2048
    v_mfma_f32_16x16x32_bf16 v[128:131], v[164:167], v[172:175], v[128:131]
    s_sub_u32 s78, s78, 1024
    ds_read_b128 a[252:255], v212 offset:6144
    v_mfma_f32_16x16x32_bf16 v[132:135], v[164:167], v[180:183], v[132:135]
    buffer_load_dwordx4 a[136:139], v214, s[48:51], s78 offen sc1
    v_mfma_f32_16x16x32_bf16 v[132:135], v[160:163], v[176:179], v[132:135]
    ds_read_b128 a[248:251], v211 offset:6144
    v_mfma_f32_16x16x32_bf16 v[136:139], v[160:163], v[184:187], v[136:139]
    ds_read_b128 v[152:155], v209 offset:2048
    v_mfma_f32_16x16x32_bf16 v[136:139], v[164:167], v[188:191], v[136:139]
    ds_read_b128 v[156:159], v210 offset:2048
    v_mfma_f32_16x16x32_bf16 v[140:143], v[164:167], v[196:199], v[140:143]
    v_mfma_f32_16x16x32_bf16 v[140:143], v[160:163], v[192:195], v[140:143]
    s_waitcnt lgkmcnt(10)
    v_mfma_f32_16x16x32_bf16 v[0:3], v[144:147], a[224:227], v[0:3]
    s_waitcnt lgkmcnt(8)
    ds_read_b128 v[160:163], v209 offset:4096
    v_mfma_f32_16x16x32_bf16 v[0:3], v[148:151], a[228:231], v[0:3]
    s_add_u32 s78, s78, 6144
    s_waitcnt lgkmcnt(8)
    ds_read_b128 v[164:167], v210 offset:4096
    v_mfma_f32_16x16x32_bf16 v[4:7], v[148:151], a[236:239], v[4:7]
    s_waitcnt lgkmcnt(8)
    buffer_load_dwordx4 a[140:143], v213, s[48:51], s78 offen offset:0 sc1
    v_mfma_f32_16x16x32_bf16 v[4:7], v[144:147], a[232:235], v[4:7]
    s_waitcnt lgkmcnt(7)
    v_mfma_f32_16x16x32_bf16 v[8:11], v[144:147], a[240:243], v[8:11]
    s_waitcnt lgkmcnt(6)
    v_mfma_f32_16x16x32_bf16 v[8:11], v[148:151], a[244:247], v[8:11]
    s_waitcnt lgkmcnt(5)
    v_mfma_f32_16x16x32_bf16 v[12:15], v[148:151], a[252:255], v[12:15]
    s_waitcnt lgkmcnt(4)
    buffer_load_dwordx4 a[144:147], v213, s[48:51], s78 offen offset:1024 sc1
    v_mfma_f32_16x16x32_bf16 v[12:15], v[144:147], a[248:251], v[12:15]
    s_waitcnt lgkmcnt(3)
    v_mfma_f32_16x16x32_bf16 v[28:31], v[152:155], a[248:251], v[28:31]
    s_waitcnt lgkmcnt(2)
    ds_read_b128 v[144:147], v209 offset:6144
    v_mfma_f32_16x16x32_bf16 v[28:31], v[156:159], a[252:255], v[28:31]
    ds_read_b128 v[148:151], v210 offset:6144
    v_mfma_f32_16x16x32_bf16 v[24:27], v[156:159], a[244:247], v[24:27]
    buffer_load_dwordx4 a[148:151], v213, s[48:51], s78 offen offset:2048 sc1
    v_mfma_f32_16x16x32_bf16 v[24:27], v[152:155], a[240:243], v[24:27]
    v_mfma_f32_16x16x32_bf16 v[20:23], v[152:155], a[232:235], v[20:23]
    v_mfma_f32_16x16x32_bf16 v[20:23], v[156:159], a[236:239], v[20:23]
    v_mfma_f32_16x16x32_bf16 v[16:19], v[156:159], a[228:231], v[16:19]
    buffer_load_dwordx4 a[152:155], v213, s[48:51], s78 offen offset:3072 sc1
    v_mfma_f32_16x16x32_bf16 v[16:19], v[152:155], a[224:227], v[16:19]
    s_waitcnt lgkmcnt(3)
    v_mfma_f32_16x16x32_bf16 v[32:35], v[160:163], a[224:227], v[32:35]
    s_waitcnt lgkmcnt(2)
    ds_read_b128 v[152:155], v209 offset:8192
    v_mfma_f32_16x16x32_bf16 v[32:35], v[164:167], a[228:231], v[32:35]
    s_sub_u32 s78, s78, 1024
    ds_read_b128 v[156:159], v210 offset:8192
    v_mfma_f32_16x16x32_bf16 v[36:39], v[164:167], a[236:239], v[36:39]
    buffer_load_dwordx4 a[156:159], v214, s[48:51], s78 offen sc1
    v_mfma_f32_16x16x32_bf16 v[36:39], v[160:163], a[232:235], v[36:39]
    v_mfma_f32_16x16x32_bf16 v[40:43], v[160:163], a[240:243], v[40:43]
    v_mfma_f32_16x16x32_bf16 v[40:43], v[164:167], a[244:247], v[40:43]
    s_add_u32 s78, s78, 6144
    v_mfma_f32_16x16x32_bf16 v[44:47], v[164:167], a[252:255], v[44:47]
    buffer_load_dwordx4 a[160:163], v213, s[48:51], s78 offen offset:0 sc1
    v_mfma_f32_16x16x32_bf16 v[44:47], v[160:163], a[248:251], v[44:47]
    s_waitcnt lgkmcnt(3)
    v_mfma_f32_16x16x32_bf16 v[60:63], v[144:147], a[248:251], v[60:63]
    s_waitcnt lgkmcnt(2)
    ds_read_b128 v[160:163], v209 offset:10240
    v_mfma_f32_16x16x32_bf16 v[60:63], v[148:151], a[252:255], v[60:63]
    ds_read_b128 v[164:167], v210 offset:10240
    v_mfma_f32_16x16x32_bf16 v[56:59], v[148:151], a[244:247], v[56:59]
    buffer_load_dwordx4 a[164:167], v213, s[48:51], s78 offen offset:1024 sc1
    v_mfma_f32_16x16x32_bf16 v[56:59], v[144:147], a[240:243], v[56:59]
    v_mfma_f32_16x16x32_bf16 v[52:55], v[144:147], a[232:235], v[52:55]
    v_mfma_f32_16x16x32_bf16 v[52:55], v[148:151], a[236:239], v[52:55]
    v_mfma_f32_16x16x32_bf16 v[48:51], v[148:151], a[228:231], v[48:51]
    buffer_load_dwordx4 a[168:171], v213, s[48:51], s78 offen offset:2048 sc1
    v_mfma_f32_16x16x32_bf16 v[48:51], v[144:147], a[224:227], v[48:51]
    s_waitcnt lgkmcnt(3)
    v_mfma_f32_16x16x32_bf16 v[64:67], v[152:155], a[224:227], v[64:67]
    s_waitcnt lgkmcnt(2)
    ds_read_b128 v[144:147], v209 offset:12288
    v_mfma_f32_16x16x32_bf16 v[64:67], v[156:159], a[228:231], v[64:67]
    ds_read_b128 v[148:151], v210 offset:12288
    v_mfma_f32_16x16x32_bf16 v[68:71], v[156:159], a[236:239], v[68:71]
    buffer_load_dwordx4 a[172:175], v213, s[48:51], s78 offen offset:3072 sc1
    v_mfma_f32_16x16x32_bf16 v[68:71], v[152:155], a[232:235], v[68:71]
    v_mfma_f32_16x16x32_bf16 v[72:75], v[152:155], a[240:243], v[72:75]
    v_mfma_f32_16x16x32_bf16 v[72:75], v[156:159], a[244:247], v[72:75]
    s_sub_u32 s78, s78, 1024
    v_mfma_f32_16x16x32_bf16 v[76:79], v[156:159], a[252:255], v[76:79]
    buffer_load_dwordx4 a[176:179], v214, s[48:51], s78 offen sc1
    v_mfma_f32_16x16x32_bf16 v[76:79], v[152:155], a[248:251], v[76:79]
    s_waitcnt lgkmcnt(3)
    v_mfma_f32_16x16x32_bf16 v[92:95], v[160:163], a[248:251], v[92:95]
    s_waitcnt lgkmcnt(2)
    ds_read_b128 v[152:155], v209 offset:14336
    v_mfma_f32_16x16x32_bf16 v[92:95], v[164:167], a[252:255], v[92:95]
    s_add_u32 s78, s78, 6144
    ds_read_b128 v[156:159], v210 offset:14336
    v_lshrrev_b32 v255, 4, v215
    v_mul_u32_u24 v255, 288, v255
    v_mfma_f32_16x16x32_bf16 v[88:91], v[164:167], a[244:247], v[88:91]
    buffer_load_dwordx4 a[180:183], v213, s[48:51], s78 offen offset:0 sc1
    v_mfma_f32_16x16x32_bf16 v[88:91], v[160:163], a[240:243], v[88:91]
    v_mfma_f32_16x16x32_bf16 v[84:87], v[160:163], a[232:235], v[84:87]
    v_mfma_f32_16x16x32_bf16 v[84:87], v[164:167], a[236:239], v[84:87]
    v_add_u32 v255, 153600, v255
    v_mfma_f32_16x16x32_bf16 v[80:83], v[164:167], a[228:231], v[80:83]
    buffer_load_dwordx4 a[184:187], v213, s[48:51], s78 offen offset:1024 sc1
    v_mfma_f32_16x16x32_bf16 v[80:83], v[160:163], a[224:227], v[80:83]
    s_waitcnt lgkmcnt(3)
    v_mfma_f32_16x16x32_bf16 v[96:99], v[144:147], a[224:227], v[96:99]
    s_waitcnt lgkmcnt(2)
    ds_read_b128 v[160:163], v209 offset:16384
    v_mfma_f32_16x16x32_bf16 v[96:99], v[148:151], a[228:231], v[96:99]
    ds_read_b128 v[164:167], v210 offset:16384
    v_mfma_f32_16x16x32_bf16 v[100:103], v[148:151], a[236:239], v[100:103]
    buffer_load_dwordx4 a[188:191], v213, s[48:51], s78 offen offset:2048 sc1
    v_mfma_f32_16x16x32_bf16 v[100:103], v[144:147], a[232:235], v[100:103]
    v_mfma_f32_16x16x32_bf16 v[104:107], v[144:147], a[240:243], v[104:107]
    v_mfma_f32_16x16x32_bf16 v[104:107], v[148:151], a[244:247], v[104:107]
    v_mfma_f32_16x16x32_bf16 v[108:111], v[148:151], a[252:255], v[108:111]
    buffer_load_dwordx4 a[192:195], v213, s[48:51], s78 offen offset:3072 sc1
    v_mfma_f32_16x16x32_bf16 v[108:111], v[144:147], a[248:251], v[108:111]
    s_waitcnt lgkmcnt(0)
    s_barrier
    v_mfma_f32_16x16x32_bf16 v[124:127], v[152:155], a[248:251], v[124:127]
    ds_read_b128 v[176:179], v255 offset:0
    v_mfma_f32_16x16x32_bf16 v[124:127], v[156:159], a[252:255], v[124:127]
    s_sub_u32 s78, s78, 1024
    ds_read_b128 v[180:183], v255 offset:144
    v_mfma_f32_16x16x32_bf16 v[120:123], v[156:159], a[244:247], v[120:123]
    buffer_load_dwordx4 a[196:199], v214, s[48:51], s78 offen sc1
    v_mfma_f32_16x16x32_bf16 v[120:123], v[152:155], a[240:243], v[120:123]
    v_mfma_f32_16x16x32_bf16 v[116:119], v[152:155], a[232:235], v[116:119]
    ds_read_b128 v[236:239], v255 offset:16
    v_mfma_f32_16x16x32_bf16 v[116:119], v[156:159], a[236:239], v[116:119]
    s_add_u32 s78, s78, 6144
    ds_read_b128 v[240:243], v255 offset:160
    v_mfma_f32_16x16x32_bf16 v[112:115], v[156:159], a[228:231], v[112:115]
    buffer_load_dwordx4 a[200:203], v213, s[48:51], s78 offen offset:0 sc1
    v_mfma_f32_16x16x32_bf16 v[112:115], v[152:155], a[224:227], v[112:115]
    v_mfma_f32_16x16x32_bf16 v[128:131], v[160:163], a[224:227], v[128:131]
    v_mfma_f32_16x16x32_bf16 v[128:131], v[164:167], a[228:231], v[128:131]
    v_mfma_f32_16x16x32_bf16 v[132:135], v[164:167], a[236:239], v[132:135]
    buffer_load_dwordx4 a[204:207], v213, s[48:51], s78 offen offset:1024 sc1
    v_mfma_f32_16x16x32_bf16 v[132:135], v[160:163], a[232:235], v[132:135]
    v_mfma_f32_16x16x32_bf16 v[136:139], v[160:163], a[240:243], v[136:139]
    v_mfma_f32_16x16x32_bf16 v[136:139], v[164:167], a[244:247], v[136:139]
    v_mfma_f32_16x16x32_bf16 v[140:143], v[164:167], a[252:255], v[140:143]
    v_mfma_f32_16x16x32_bf16 v[140:143], v[160:163], a[248:251], v[140:143]
    s_waitcnt lgkmcnt(3)
    v_pk_mul_f32 v[0:1], v[0:1], v[176:177]
    v_pk_mul_f32 v[4:5], v[4:5], v[176:177]
    v_pk_mul_f32 v[8:9], v[8:9], v[176:177]
    v_pk_mul_f32 v[12:13], v[12:13], v[176:177]
    s_waitcnt lgkmcnt(2)
    v_pk_fma_f32 v[0:1], v[180:181], v[244:245], v[0:1] op_sel:[0,0,0] op_sel_hi:[1,0,1] neg_lo:[0,1,0] neg_hi:[0,1,0]
    buffer_load_dwordx4 a[208:211], v213, s[48:51], s78 offen offset:2048 sc1
    v_pk_fma_f32 v[4:5], v[180:181], v[246:247], v[4:5] op_sel:[0,0,0] op_sel_hi:[1,0,1] neg_lo:[0,1,0] neg_hi:[0,1,0]
    v_pk_fma_f32 v[8:9], v[180:181], v[244:245], v[8:9] op_sel:[0,1,0] op_sel_hi:[1,1,1] neg_lo:[0,1,0] neg_hi:[0,1,0]
    v_pk_fma_f32 v[12:13], v[180:181], v[246:247], v[12:13] op_sel:[0,1,0] op_sel_hi:[1,1,1] neg_lo:[0,1,0] neg_hi:[0,1,0]
    v_pk_mul_f32 v[2:3], v[2:3], v[178:179]
    v_pk_mul_f32 v[6:7], v[6:7], v[178:179]
    v_pk_mul_f32 v[10:11], v[10:11], v[178:179]
    v_pk_mul_f32 v[14:15], v[14:15], v[178:179]
    v_pk_fma_f32 v[2:3], v[182:183], v[244:245], v[2:3] op_sel:[0,0,0] op_sel_hi:[1,0,1] neg_lo:[0,1,0] neg_hi:[0,1,0]
    v_pk_fma_f32 v[6:7], v[182:183], v[246:247], v[6:7] op_sel:[0,0,0] op_sel_hi:[1,0,1] neg_lo:[0,1,0] neg_hi:[0,1,0]
    v_pk_fma_f32 v[10:11], v[182:183], v[244:245], v[10:11] op_sel:[0,1,0] op_sel_hi:[1,1,1] neg_lo:[0,1,0] neg_hi:[0,1,0]
    v_pk_fma_f32 v[14:15], v[182:183], v[246:247], v[14:15] op_sel:[0,1,0] op_sel_hi:[1,1,1] neg_lo:[0,1,0] neg_hi:[0,1,0]
    ds_read_b128 v[144:147], v255 offset:32
    ds_read_b128 v[148:151], v255 offset:176
    v_pk_fma_f32 v[168:169], v[216:217], v[0:1], v[2:3] op_sel:[0,0,0] op_sel_hi:[0,1,1]
    v_pk_fma_f32 v[170:171], v[216:217], v[4:5], v[6:7] op_sel:[0,0,0] op_sel_hi:[0,1,1]
    v_pk_fma_f32 v[168:169], v[218:219], v[4:5], v[168:169] op_sel:[0,0,0] op_sel_hi:[0,1,1] neg_lo:[1,0,0] neg_hi:[1,0,0]
    buffer_load_dwordx4 a[212:215], v213, s[48:51], s78 offen offset:3072 sc1
    v_pk_fma_f32 v[170:171], v[218:219], v[0:1], v[170:171] op_sel:[0,0,0] op_sel_hi:[0,1,1]
    v_pk_fma_f32 v[172:173], v[216:217], v[8:9], v[10:11] op_sel:[1,0,0] op_sel_hi:[1,1,1]
    v_pk_fma_f32 v[174:175], v[216:217], v[12:13], v[14:15] op_sel:[1,0,0] op_sel_hi:[1,1,1]
    v_pk_fma_f32 v[172:173], v[218:219], v[12:13], v[172:173] op_sel:[1,0,0] op_sel_hi:[1,1,1] neg_lo:[1,0,0] neg_hi:[1,0,0]
    v_pk_fma_f32 v[174:175], v[218:219], v[8:9], v[174:175] op_sel:[1,0,0] op_sel_hi:[1,1,1]
    s_waitcnt lgkmcnt(3)
    v_pk_mul_f32 v[16:17], v[16:17], v[236:237]
    v_pk_mul_f32 v[20:21], v[20:21], v[236:237]
    v_pk_mul_f32 v[24:25], v[24:25], v[236:237]
    v_pk_mul_f32 v[28:29], v[28:29], v[236:237]
    s_waitcnt lgkmcnt(2)
    v_pk_fma_f32 v[16:17], v[240:241], v[244:245], v[16:17] op_sel:[0,0,0] op_sel_hi:[1,0,1] neg_lo:[0,1,0] neg_hi:[0,1,0]
    s_sub_u32 s78, s78, 1024
    buffer_load_dwordx4 a[216:219], v214, s[48:51], s78 offen sc1
    v_pk_fma_f32 v[20:21], v[240:241], v[246:247], v[20:21] op_sel:[0,0,0] op_sel_hi:[1,0,1] neg_lo:[0,1,0] neg_hi:[0,1,0]
    v_pk_fma_f32 v[24:25], v[240:241], v[244:245], v[24:25] op_sel:[0,1,0] op_sel_hi:[1,1,1] neg_lo:[0,1,0] neg_hi:[0,1,0]
    v_pk_fma_f32 v[28:29], v[240:241], v[246:247], v[28:29] op_sel:[0,1,0] op_sel_hi:[1,1,1] neg_lo:[0,1,0] neg_hi:[0,1,0]
    v_pk_mul_f32 v[18:19], v[18:19], v[238:239]
    v_pk_mul_f32 v[22:23], v[22:23], v[238:239]
    v_pk_mul_f32 v[26:27], v[26:27], v[238:239]
    v_pk_mul_f32 v[30:31], v[30:31], v[238:239]
    v_pk_fma_f32 v[18:19], v[242:243], v[244:245], v[18:19] op_sel:[0,0,0] op_sel_hi:[1,0,1] neg_lo:[0,1,0] neg_hi:[0,1,0]
    v_pk_fma_f32 v[22:23], v[242:243], v[246:247], v[22:23] op_sel:[0,0,0] op_sel_hi:[1,0,1] neg_lo:[0,1,0] neg_hi:[0,1,0]
    v_pk_fma_f32 v[26:27], v[242:243], v[244:245], v[26:27] op_sel:[0,1,0] op_sel_hi:[1,1,1] neg_lo:[0,1,0] neg_hi:[0,1,0]
    v_pk_fma_f32 v[30:31], v[242:243], v[246:247], v[30:31] op_sel:[0,1,0] op_sel_hi:[1,1,1] neg_lo:[0,1,0] neg_hi:[0,1,0]
    ds_read_b128 v[152:155], v255 offset:48
    ds_read_b128 v[156:159], v255 offset:192
    v_pk_fma_f32 v[160:161], v[216:217], v[168:169], v[16:17] op_sel:[0,0,0] op_sel_hi:[0,1,1]
    v_pk_fma_f32 v[162:163], v[216:217], v[170:171], v[20:21] op_sel:[0,0,0] op_sel_hi:[0,1,1]
    v_pk_fma_f32 v[160:161], v[218:219], v[170:171], v[160:161] op_sel:[0,0,0] op_sel_hi:[0,1,1] neg_lo:[1,0,0] neg_hi:[1,0,0]
    s_add_u32 s78, s78, 6144
    buffer_load_dwordx4 a[220:223], v213, s[48:51], s78 offen offset:0 sc1
    v_pk_fma_f32 v[162:163], v[218:219], v[168:169], v[162:163] op_sel:[0,0,0] op_sel_hi:[0,1,1]
    v_pk_fma_f32 v[164:165], v[216:217], v[172:173], v[24:25] op_sel:[1,0,0] op_sel_hi:[1,1,1]
    v_pk_fma_f32 v[166:167], v[216:217], v[174:175], v[28:29] op_sel:[1,0,0] op_sel_hi:[1,1,1]
    v_pk_fma_f32 v[164:165], v[218:219], v[174:175], v[164:165] op_sel:[1,0,0] op_sel_hi:[1,1,1] neg_lo:[1,0,0] neg_hi:[1,0,0]
    v_pk_fma_f32 v[166:167], v[218:219], v[172:173], v[166:167] op_sel:[1,0,0] op_sel_hi:[1,1,1]
    v_pk_fma_f32 v[168:169], v[216:217], v[160:161], v[18:19] op_sel:[0,0,0] op_sel_hi:[0,1,1]
    v_pk_fma_f32 v[170:171], v[216:217], v[162:163], v[22:23] op_sel:[0,0,0] op_sel_hi:[0,1,1]
    v_pk_fma_f32 v[168:169], v[218:219], v[162:163], v[168:169] op_sel:[0,0,0] op_sel_hi:[0,1,1] neg_lo:[1,0,0] neg_hi:[1,0,0]
    v_pk_fma_f32 v[170:171], v[218:219], v[160:161], v[170:171] op_sel:[0,0,0] op_sel_hi:[0,1,1]
    v_pk_fma_f32 v[172:173], v[216:217], v[164:165], v[26:27] op_sel:[1,0,0] op_sel_hi:[1,1,1]
    v_pk_fma_f32 v[174:175], v[216:217], v[166:167], v[30:31] op_sel:[1,0,0] op_sel_hi:[1,1,1]
    v_pk_fma_f32 v[172:173], v[218:219], v[166:167], v[172:173] op_sel:[1,0,0] op_sel_hi:[1,1,1] neg_lo:[1,0,0] neg_hi:[1,0,0]
    v_pk_fma_f32 v[174:175], v[218:219], v[164:165], v[174:175] op_sel:[1,0,0] op_sel_hi:[1,1,1]
    s_waitcnt lgkmcnt(3)
    v_pk_mul_f32 v[32:33], v[32:33], v[144:145]
    v_pk_mul_f32 v[36:37], v[36:37], v[144:145]
    v_pk_mul_f32 v[40:41], v[40:41], v[144:145]
    v_pk_mul_f32 v[44:45], v[44:45], v[144:145]
    s_waitcnt lgkmcnt(2)
    v_pk_fma_f32 v[32:33], v[148:149], v[244:245], v[32:33] op_sel:[0,0,0] op_sel_hi:[1,0,1] neg_lo:[0,1,0] neg_hi:[0,1,0]
    buffer_load_dwordx4 a[224:227], v213, s[48:51], s78 offen offset:1024 sc1
    v_pk_fma_f32 v[36:37], v[148:149], v[246:247], v[36:37] op_sel:[0,0,0] op_sel_hi:[1,0,1] neg_lo:[0,1,0] neg_hi:[0,1,0]
    v_pk_fma_f32 v[40:41], v[148:149], v[244:245], v[40:41] op_sel:[0,1,0] op_sel_hi:[1,1,1] neg_lo:[0,1,0] neg_hi:[0,1,0]
    v_pk_fma_f32 v[44:45], v[148:149], v[246:247], v[44:45] op_sel:[0,1,0] op_sel_hi:[1,1,1] neg_lo:[0,1,0] neg_hi:[0,1,0]
    v_pk_mul_f32 v[34:35], v[34:35], v[146:147]
    v_pk_mul_f32 v[38:39], v[38:39], v[146:147]
    v_pk_mul_f32 v[42:43], v[42:43], v[146:147]
    v_pk_mul_f32 v[46:47], v[46:47], v[146:147]
    v_pk_fma_f32 v[34:35], v[150:151], v[244:245], v[34:35] op_sel:[0,0,0] op_sel_hi:[1,0,1] neg_lo:[0,1,0] neg_hi:[0,1,0]
    v_pk_fma_f32 v[38:39], v[150:151], v[246:247], v[38:39] op_sel:[0,0,0] op_sel_hi:[1,0,1] neg_lo:[0,1,0] neg_hi:[0,1,0]
    v_pk_fma_f32 v[42:43], v[150:151], v[244:245], v[42:43] op_sel:[0,1,0] op_sel_hi:[1,1,1] neg_lo:[0,1,0] neg_hi:[0,1,0]
    v_pk_fma_f32 v[46:47], v[150:151], v[246:247], v[46:47] op_sel:[0,1,0] op_sel_hi:[1,1,1] neg_lo:[0,1,0] neg_hi:[0,1,0]
    ds_read_b128 v[144:147], v255 offset:64
    ds_read_b128 v[148:151], v255 offset:208
    v_pk_fma_f32 v[160:161], v[216:217], v[168:169], v[32:33] op_sel:[0,0,0] op_sel_hi:[0,1,1]
    v_pk_fma_f32 v[162:163], v[216:217], v[170:171], v[36:37] op_sel:[0,0,0] op_sel_hi:[0,1,1]
    v_pk_fma_f32 v[160:161], v[218:219], v[170:171], v[160:161] op_sel:[0,0,0] op_sel_hi:[0,1,1] neg_lo:[1,0,0] neg_hi:[1,0,0]
    buffer_load_dwordx4 a[228:231], v213, s[48:51], s78 offen offset:2048 sc1
    v_pk_fma_f32 v[162:163], v[218:219], v[168:169], v[162:163] op_sel:[0,0,0] op_sel_hi:[0,1,1]
    v_pk_fma_f32 v[164:165], v[216:217], v[172:173], v[40:41] op_sel:[1,0,0] op_sel_hi:[1,1,1]
    v_pk_fma_f32 v[166:167], v[216:217], v[174:175], v[44:45] op_sel:[1,0,0] op_sel_hi:[1,1,1]
    v_pk_fma_f32 v[164:165], v[218:219], v[174:175], v[164:165] op_sel:[1,0,0] op_sel_hi:[1,1,1] neg_lo:[1,0,0] neg_hi:[1,0,0]
    v_pk_fma_f32 v[166:167], v[218:219], v[172:173], v[166:167] op_sel:[1,0,0] op_sel_hi:[1,1,1]
    v_pk_fma_f32 v[168:169], v[216:217], v[160:161], v[34:35] op_sel:[0,0,0] op_sel_hi:[0,1,1]
    v_pk_fma_f32 v[170:171], v[216:217], v[162:163], v[38:39] op_sel:[0,0,0] op_sel_hi:[0,1,1]
    v_pk_fma_f32 v[168:169], v[218:219], v[162:163], v[168:169] op_sel:[0,0,0] op_sel_hi:[0,1,1] neg_lo:[1,0,0] neg_hi:[1,0,0]
    v_pk_fma_f32 v[170:171], v[218:219], v[160:161], v[170:171] op_sel:[0,0,0] op_sel_hi:[0,1,1]
    v_pk_fma_f32 v[172:173], v[216:217], v[164:165], v[42:43] op_sel:[1,0,0] op_sel_hi:[1,1,1]
    v_pk_fma_f32 v[174:175], v[216:217], v[166:167], v[46:47] op_sel:[1,0,0] op_sel_hi:[1,1,1]
    v_pk_fma_f32 v[172:173], v[218:219], v[166:167], v[172:173] op_sel:[1,0,0] op_sel_hi:[1,1,1] neg_lo:[1,0,0] neg_hi:[1,0,0]
    v_pk_fma_f32 v[174:175], v[218:219], v[164:165], v[174:175] op_sel:[1,0,0] op_sel_hi:[1,1,1]
    s_waitcnt lgkmcnt(3)
    v_pk_mul_f32 v[48:49], v[48:49], v[152:153]
    v_pk_mul_f32 v[52:53], v[52:53], v[152:153]
    v_pk_mul_f32 v[56:57], v[56:57], v[152:153]
    v_pk_mul_f32 v[60:61], v[60:61], v[152:153]
    s_waitcnt lgkmcnt(2)
    v_pk_fma_f32 v[48:49], v[156:157], v[244:245], v[48:49] op_sel:[0,0,0] op_sel_hi:[1,0,1] neg_lo:[0,1,0] neg_hi:[0,1,0]
    buffer_load_dwordx4 a[232:235], v213, s[48:51], s78 offen offset:3072 sc1
    v_pk_fma_f32 v[52:53], v[156:157], v[246:247], v[52:53] op_sel:[0,0,0] op_sel_hi:[1,0,1] neg_lo:[0,1,0] neg_hi:[0,1,0]
    v_pk_fma_f32 v[56:57], v[156:157], v[244:245], v[56:57] op_sel:[0,1,0] op_sel_hi:[1,1,1] neg_lo:[0,1,0] neg_hi:[0,1,0]
    v_pk_fma_f32 v[60:61], v[156:157], v[246:247], v[60:61] op_sel:[0,1,0] op_sel_hi:[1,1,1] neg_lo:[0,1,0] neg_hi:[0,1,0]
    v_pk_mul_f32 v[50:51], v[50:51], v[154:155]
    v_pk_mul_f32 v[54:55], v[54:55], v[154:155]
    v_pk_mul_f32 v[58:59], v[58:59], v[154:155]
    v_pk_mul_f32 v[62:63], v[62:63], v[154:155]
    v_pk_fma_f32 v[50:51], v[158:159], v[244:245], v[50:51] op_sel:[0,0,0] op_sel_hi:[1,0,1] neg_lo:[0,1,0] neg_hi:[0,1,0]
    v_pk_fma_f32 v[54:55], v[158:159], v[246:247], v[54:55] op_sel:[0,0,0] op_sel_hi:[1,0,1] neg_lo:[0,1,0] neg_hi:[0,1,0]
    v_pk_fma_f32 v[58:59], v[158:159], v[244:245], v[58:59] op_sel:[0,1,0] op_sel_hi:[1,1,1] neg_lo:[0,1,0] neg_hi:[0,1,0]
    v_pk_fma_f32 v[62:63], v[158:159], v[246:247], v[62:63] op_sel:[0,1,0] op_sel_hi:[1,1,1] neg_lo:[0,1,0] neg_hi:[0,1,0]
    ds_read_b128 v[152:155], v255 offset:80
    ds_read_b128 v[156:159], v255 offset:224
    v_pk_fma_f32 v[160:161], v[216:217], v[168:169], v[48:49] op_sel:[0,0,0] op_sel_hi:[0,1,1]
    v_pk_fma_f32 v[162:163], v[216:217], v[170:171], v[52:53] op_sel:[0,0,0] op_sel_hi:[0,1,1]
    v_pk_fma_f32 v[160:161], v[218:219], v[170:171], v[160:161] op_sel:[0,0,0] op_sel_hi:[0,1,1] neg_lo:[1,0,0] neg_hi:[1,0,0]
    s_sub_u32 s78, s78, 1024
    buffer_load_dwordx4 a[236:239], v214, s[48:51], s78 offen sc1
    v_pk_fma_f32 v[162:163], v[218:219], v[168:169], v[162:163] op_sel:[0,0,0] op_sel_hi:[0,1,1]
    v_pk_fma_f32 v[164:165], v[216:217], v[172:173], v[56:57] op_sel:[1,0,0] op_sel_hi:[1,1,1]
    v_pk_fma_f32 v[166:167], v[216:217], v[174:175], v[60:61] op_sel:[1,0,0] op_sel_hi:[1,1,1]
    v_pk_fma_f32 v[164:165], v[218:219], v[174:175], v[164:165] op_sel:[1,0,0] op_sel_hi:[1,1,1] neg_lo:[1,0,0] neg_hi:[1,0,0]
    v_pk_fma_f32 v[166:167], v[218:219], v[172:173], v[166:167] op_sel:[1,0,0] op_sel_hi:[1,1,1]
    v_pk_fma_f32 v[168:169], v[216:217], v[160:161], v[50:51] op_sel:[0,0,0] op_sel_hi:[0,1,1]
    v_pk_fma_f32 v[170:171], v[216:217], v[162:163], v[54:55] op_sel:[0,0,0] op_sel_hi:[0,1,1]
    v_pk_fma_f32 v[168:169], v[218:219], v[162:163], v[168:169] op_sel:[0,0,0] op_sel_hi:[0,1,1] neg_lo:[1,0,0] neg_hi:[1,0,0]
    v_pk_fma_f32 v[170:171], v[218:219], v[160:161], v[170:171] op_sel:[0,0,0] op_sel_hi:[0,1,1]
    v_pk_fma_f32 v[172:173], v[216:217], v[164:165], v[58:59] op_sel:[1,0,0] op_sel_hi:[1,1,1]
    v_pk_fma_f32 v[174:175], v[216:217], v[166:167], v[62:63] op_sel:[1,0,0] op_sel_hi:[1,1,1]
    v_pk_fma_f32 v[172:173], v[218:219], v[166:167], v[172:173] op_sel:[1,0,0] op_sel_hi:[1,1,1] neg_lo:[1,0,0] neg_hi:[1,0,0]
    v_pk_fma_f32 v[174:175], v[218:219], v[164:165], v[174:175] op_sel:[1,0,0] op_sel_hi:[1,1,1]
    s_waitcnt lgkmcnt(3)
    v_pk_mul_f32 v[64:65], v[64:65], v[144:145]
    v_pk_mul_f32 v[68:69], v[68:69], v[144:145]
    v_pk_mul_f32 v[72:73], v[72:73], v[144:145]
L_padS3:
    s_cbranch_execz L_retS
    v_pk_mul_f32 v[76:77], v[76:77], v[144:145]
    s_waitcnt lgkmcnt(2)
    v_pk_fma_f32 v[64:65], v[148:149], v[244:245], v[64:65] op_sel:[0,0,0] op_sel_hi:[1,0,1] neg_lo:[0,1,0] neg_hi:[0,1,0]
    s_add_u32 s98, s96, 0
    s_add_u32 m0, s81, 0
    s_nop 0
    buffer_load_dwordx4 v253, s[52:55], s98 offen offset:0 lds
    v_pk_fma_f32 v[68:69], v[148:149], v[246:247], v[68:69] op_sel:[0,0,0] op_sel_hi:[1,0,1] neg_lo:[0,1,0] neg_hi:[0,1,0]
    v_pk_fma_f32 v[72:73], v[148:149], v[244:245], v[72:73] op_sel:[0,1,0] op_sel_hi:[1,1,1] neg_lo:[0,1,0] neg_hi:[0,1,0]
    v_pk_fma_f32 v[76:77], v[148:149], v[246:247], v[76:77] op_sel:[0,1,0] op_sel_hi:[1,1,1] neg_lo:[0,1,0] neg_hi:[0,1,0]
    v_pk_mul_f32 v[66:67], v[66:67], v[146:147]
    v_pk_mul_f32 v[70:71], v[70:71], v[146:147]
    v_pk_mul_f32 v[74:75], v[74:75], v[146:147]
    v_pk_mul_f32 v[78:79], v[78:79], v[146:147]
    v_pk_fma_f32 v[66:67], v[150:151], v[244:245], v[66:67] op_sel:[0,0,0] op_sel_hi:[1,0,1] neg_lo:[0,1,0] neg_hi:[0,1,0]
    v_pk_fma_f32 v[70:71], v[150:151], v[246:247], v[70:71] op_sel:[0,0,0] op_sel_hi:[1,0,1] neg_lo:[0,1,0] neg_hi:[0,1,0]
    v_pk_fma_f32 v[74:75], v[150:151], v[244:245], v[74:75] op_sel:[0,1,0] op_sel_hi:[1,1,1] neg_lo:[0,1,0] neg_hi:[0,1,0]
    v_pk_fma_f32 v[78:79], v[150:151], v[246:247], v[78:79] op_sel:[0,1,0] op_sel_hi:[1,1,1] neg_lo:[0,1,0] neg_hi:[0,1,0]
    ds_read_b128 v[144:147], v255 offset:96
    ds_read_b128 v[148:151], v255 offset:240
    v_pk_fma_f32 v[160:161], v[216:217], v[168:169], v[64:65] op_sel:[0,0,0] op_sel_hi:[0,1,1]
    v_pk_fma_f32 v[162:163], v[216:217], v[170:171], v[68:69] op_sel:[0,0,0] op_sel_hi:[0,1,1]
    v_pk_fma_f32 v[160:161], v[218:219], v[170:171], v[160:161] op_sel:[0,0,0] op_sel_hi:[0,1,1] neg_lo:[1,0,0] neg_hi:[1,0,0]
    buffer_load_dwordx4 v254, s[52:55], s98 offen offset:1024 lds
    v_pk_fma_f32 v[162:163], v[218:219], v[168:169], v[162:163] op_sel:[0,0,0] op_sel_hi:[0,1,1]
    v_pk_fma_f32 v[164:165], v[216:217], v[172:173], v[72:73] op_sel:[1,0,0] op_sel_hi:[1,1,1]
    v_pk_fma_f32 v[166:167], v[216:217], v[174:175], v[76:77] op_sel:[1,0,0] op_sel_hi:[1,1,1]
    v_pk_fma_f32 v[164:165], v[218:219], v[174:175], v[164:165] op_sel:[1,0,0] op_sel_hi:[1,1,1] neg_lo:[1,0,0] neg_hi:[1,0,0]
    v_pk_fma_f32 v[166:167], v[218:219], v[172:173], v[166:167] op_sel:[1,0,0] op_sel_hi:[1,1,1]
    v_pk_fma_f32 v[168:169], v[216:217], v[160:161], v[66:67] op_sel:[0,0,0] op_sel_hi:[0,1,1]
    v_pk_fma_f32 v[170:171], v[216:217], v[162:163], v[70:71] op_sel:[0,0,0] op_sel_hi:[0,1,1]
    v_pk_fma_f32 v[168:169], v[218:219], v[162:163], v[168:169] op_sel:[0,0,0] op_sel_hi:[0,1,1] neg_lo:[1,0,0] neg_hi:[1,0,0]
    v_pk_fma_f32 v[170:171], v[218:219], v[160:161], v[170:171] op_sel:[0,0,0] op_sel_hi:[0,1,1]
    v_pk_fma_f32 v[172:173], v[216:217], v[164:165], v[74:75] op_sel:[1,0,0] op_sel_hi:[1,1,1]
    v_pk_fma_f32 v[174:175], v[216:217], v[166:167], v[78:79] op_sel:[1,0,0] op_sel_hi:[1,1,1]
    v_pk_fma_f32 v[172:173], v[218:219], v[166:167], v[172:173] op_sel:[1,0,0] op_sel_hi:[1,1,1] neg_lo:[1,0,0] neg_hi:[1,0,0]
    v_pk_fma_f32 v[174:175], v[218:219], v[164:165], v[174:175] op_sel:[1,0,0] op_sel_hi:[1,1,1]
    s_waitcnt lgkmcnt(3)
    v_pk_mul_f32 v[80:81], v[80:81], v[152:153]
    v_pk_mul_f32 v[84:85], v[84:85], v[152:153]
    v_pk_mul_f32 v[88:89], v[88:89], v[152:153]
    v_pk_mul_f32 v[92:93], v[92:93], v[152:153]
    s_waitcnt lgkmcnt(2)
    v_pk_fma_f32 v[80:81], v[156:157], v[244:245], v[80:81] op_sel:[0,0,0] op_sel_hi:[1,0,1] neg_lo:[0,1,0] neg_hi:[0,1,0]
    s_add_u32 s98, s98, 20480
    s_add_u32 m0, s81, 2048
    s_nop 0
    buffer_load_dwordx4 v253, s[52:55], s98 offen offset:0 lds
    v_pk_fma_f32 v[84:85], v[156:157], v[246:247], v[84:85] op_sel:[0,0,0] op_sel_hi:[1,0,1] neg_lo:[0,1,0] neg_hi:[0,1,0]
    v_pk_fma_f32 v[88:89], v[156:157], v[244:245], v[88:89] op_sel:[0,1,0] op_sel_hi:[1,1,1] neg_lo:[0,1,0] neg_hi:[0,1,0]
    v_pk_fma_f32 v[92:93], v[156:157], v[246:247], v[92:93] op_sel:[0,1,0] op_sel_hi:[1,1,1] neg_lo:[0,1,0] neg_hi:[0,1,0]
    v_pk_mul_f32 v[82:83], v[82:83], v[154:155]
    v_pk_mul_f32 v[86:87], v[86:87], v[154:155]
    v_pk_mul_f32 v[90:91], v[90:91], v[154:155]
    v_pk_mul_f32 v[94:95], v[94:95], v[154:155]
    v_pk_fma_f32 v[82:83], v[158:159], v[244:245], v[82:83] op_sel:[0,0,0] op_sel_hi:[1,0,1] neg_lo:[0,1,0] neg_hi:[0,1,0]
    v_pk_fma_f32 v[86:87], v[158:159], v[246:247], v[86:87] op_sel:[0,0,0] op_sel_hi:[1,0,1] neg_lo:[0,1,0] neg_hi:[0,1,0]
    v_pk_fma_f32 v[90:91], v[158:159], v[244:245], v[90:91] op_sel:[0,1,0] op_sel_hi:[1,1,1] neg_lo:[0,1,0] neg_hi:[0,1,0]
    v_pk_fma_f32 v[94:95], v[158:159], v[246:247], v[94:95] op_sel:[0,1,0] op_sel_hi:[1,1,1] neg_lo:[0,1,0] neg_hi:[0,1,0]
    ds_read_b128 v[152:155], v255 offset:112
    ds_read_b128 v[156:159], v255 offset:256
    v_pk_fma_f32 v[160:161], v[216:217], v[168:169], v[80:81] op_sel:[0,0,0] op_sel_hi:[0,1,1]
    v_pk_fma_f32 v[162:163], v[216:217], v[170:171], v[84:85] op_sel:[0,0,0] op_sel_hi:[0,1,1]
    v_pk_fma_f32 v[160:161], v[218:219], v[170:171], v[160:161] op_sel:[0,0,0] op_sel_hi:[0,1,1] neg_lo:[1,0,0] neg_hi:[1,0,0]
    buffer_load_dwordx4 v254, s[52:55], s98 offen offset:1024 lds
    v_pk_fma_f32 v[162:163], v[218:219], v[168:169], v[162:163] op_sel:[0,0,0] op_sel_hi:[0,1,1]
    v_pk_fma_f32 v[164:165], v[216:217], v[172:173], v[88:89] op_sel:[1,0,0] op_sel_hi:[1,1,1]
    v_pk_fma_f32 v[166:167], v[216:217], v[174:175], v[92:93] op_sel:[1,0,0] op_sel_hi:[1,1,1]
    v_pk_fma_f32 v[164:165], v[218:219], v[174:175], v[164:165] op_sel:[1,0,0] op_sel_hi:[1,1,1] neg_lo:[1,0,0] neg_hi:[1,0,0]
    v_pk_fma_f32 v[166:167], v[218:219], v[172:173], v[166:167] op_sel:[1,0,0] op_sel_hi:[1,1,1]
    v_pk_fma_f32 v[168:169], v[216:217], v[160:161], v[82:83] op_sel:[0,0,0] op_sel_hi:[0,1,1]
    v_pk_fma_f32 v[170:171], v[216:217], v[162:163], v[86:87] op_sel:[0,0,0] op_sel_hi:[0,1,1]
    v_pk_fma_f32 v[168:169], v[218:219], v[162:163], v[168:169] op_sel:[0,0,0] op_sel_hi:[0,1,1] neg_lo:[1,0,0] neg_hi:[1,0,0]
    v_pk_fma_f32 v[170:171], v[218:219], v[160:161], v[170:171] op_sel:[0,0,0] op_sel_hi:[0,1,1]
    v_pk_fma_f32 v[172:173], v[216:217], v[164:165], v[90:91] op_sel:[1,0,0] op_sel_hi:[1,1,1]
    v_pk_fma_f32 v[174:175], v[216:217], v[166:167], v[94:95] op_sel:[1,0,0] op_sel_hi:[1,1,1]
    v_pk_fma_f32 v[172:173], v[218:219], v[166:167], v[172:173] op_sel:[1,0,0] op_sel_hi:[1,1,1] neg_lo:[1,0,0] neg_hi:[1,0,0]
    v_pk_fma_f32 v[174:175], v[218:219], v[164:165], v[174:175] op_sel:[1,0,0] op_sel_hi:[1,1,1]
    s_waitcnt lgkmcnt(3)
    v_pk_mul_f32 v[96:97], v[96:97], v[144:145]
    v_pk_mul_f32 v[100:101], v[100:101], v[144:145]
    v_pk_mul_f32 v[104:105], v[104:105], v[144:145]
    v_pk_mul_f32 v[108:109], v[108:109], v[144:145]
    s_waitcnt lgkmcnt(2)
    v_pk_fma_f32 v[96:97], v[148:149], v[244:245], v[96:97] op_sel:[0,0,0] op_sel_hi:[1,0,1] neg_lo:[0,1,0] neg_hi:[0,1,0]
    s_add_u32 s98, s98, 20480
    s_add_u32 m0, s81, 4096
    s_nop 0
    buffer_load_dwordx4 v253, s[52:55], s98 offen offset:0 lds
    v_pk_fma_f32 v[100:101], v[148:149], v[246:247], v[100:101] op_sel:[0,0,0] op_sel_hi:[1,0,1] neg_lo:[0,1,0] neg_hi:[0,1,0]
    v_pk_fma_f32 v[104:105], v[148:149], v[244:245], v[104:105] op_sel:[0,1,0] op_sel_hi:[1,1,1] neg_lo:[0,1,0] neg_hi:[0,1,0]
    v_pk_fma_f32 v[108:109], v[148:149], v[246:247], v[108:109] op_sel:[0,1,0] op_sel_hi:[1,1,1] neg_lo:[0,1,0] neg_hi:[0,1,0]
    v_pk_mul_f32 v[98:99], v[98:99], v[146:147]
    v_pk_mul_f32 v[102:103], v[102:103], v[146:147]
    v_pk_mul_f32 v[106:107], v[106:107], v[146:147]
    v_pk_mul_f32 v[110:111], v[110:111], v[146:147]
    v_pk_fma_f32 v[98:99], v[150:151], v[244:245], v[98:99] op_sel:[0,0,0] op_sel_hi:[1,0,1] neg_lo:[0,1,0] neg_hi:[0,1,0]
    v_pk_fma_f32 v[102:103], v[150:151], v[246:247], v[102:103] op_sel:[0,0,0] op_sel_hi:[1,0,1] neg_lo:[0,1,0] neg_hi:[0,1,0]
    v_pk_fma_f32 v[106:107], v[150:151], v[244:245], v[106:107] op_sel:[0,1,0] op_sel_hi:[1,1,1] neg_lo:[0,1,0] neg_hi:[0,1,0]
    v_pk_fma_f32 v[110:111], v[150:151], v[246:247], v[110:111] op_sel:[0,1,0] op_sel_hi:[1,1,1] neg_lo:[0,1,0] neg_hi:[0,1,0]
    ds_read_b128 v[144:147], v255 offset:128
    ds_read_b128 v[148:151], v255 offset:272
    v_pk_fma_f32 v[160:161], v[216:217], v[168:169], v[96:97] op_sel:[0,0,0] op_sel_hi:[0,1,1]
    v_pk_fma_f32 v[162:163], v[216:217], v[170:171], v[100:101] op_sel:[0,0,0] op_sel_hi:[0,1,1]
    v_pk_fma_f32 v[160:161], v[218:219], v[170:171], v[160:161] op_sel:[0,0,0] op_sel_hi:[0,1,1] neg_lo:[1,0,0] neg_hi:[1,0,0]
    buffer_load_dwordx4 v254, s[52:55], s98 offen offset:1024 lds
    v_pk_fma_f32 v[162:163], v[218:219], v[168:169], v[162:163] op_sel:[0,0,0] op_sel_hi:[0,1,1]
    v_pk_fma_f32 v[164:165], v[216:217], v[172:173], v[104:105] op_sel:[1,0,0] op_sel_hi:[1,1,1]
    v_pk_fma_f32 v[166:167], v[216:217], v[174:175], v[108:109] op_sel:[1,0,0] op_sel_hi:[1,1,1]
    v_pk_fma_f32 v[164:165], v[218:219], v[174:175], v[164:165] op_sel:[1,0,0] op_sel_hi:[1,1,1] neg_lo:[1,0,0] neg_hi:[1,0,0]
    v_pk_fma_f32 v[166:167], v[218:219], v[172:173], v[166:167] op_sel:[1,0,0] op_sel_hi:[1,1,1]
    v_pk_fma_f32 v[168:169], v[216:217], v[160:161], v[98:99] op_sel:[0,0,0] op_sel_hi:[0,1,1]
    v_pk_fma_f32 v[170:171], v[216:217], v[162:163], v[102:103] op_sel:[0,0,0] op_sel_hi:[0,1,1]
    v_pk_fma_f32 v[168:169], v[218:219], v[162:163], v[168:169] op_sel:[0,0,0] op_sel_hi:[0,1,1] neg_lo:[1,0,0] neg_hi:[1,0,0]
    v_pk_fma_f32 v[170:171], v[218:219], v[160:161], v[170:171] op_sel:[0,0,0] op_sel_hi:[0,1,1]
    v_pk_fma_f32 v[172:173], v[216:217], v[164:165], v[106:107] op_sel:[1,0,0] op_sel_hi:[1,1,1]
    v_pk_fma_f32 v[174:175], v[216:217], v[166:167], v[110:111] op_sel:[1,0,0] op_sel_hi:[1,1,1]
    v_pk_fma_f32 v[172:173], v[218:219], v[166:167], v[172:173] op_sel:[1,0,0] op_sel_hi:[1,1,1] neg_lo:[1,0,0] neg_hi:[1,0,0]
    v_pk_fma_f32 v[174:175], v[218:219], v[164:165], v[174:175] op_sel:[1,0,0] op_sel_hi:[1,1,1]
    s_waitcnt lgkmcnt(3)
    v_pk_mul_f32 v[112:113], v[112:113], v[152:153]
    v_pk_mul_f32 v[116:117], v[116:117], v[152:153]
    v_pk_mul_f32 v[120:121], v[120:121], v[152:153]
    v_pk_mul_f32 v[124:125], v[124:125], v[152:153]
    s_waitcnt lgkmcnt(2)
    v_pk_fma_f32 v[112:113], v[156:157], v[244:245], v[112:113] op_sel:[0,0,0] op_sel_hi:[1,0,1] neg_lo:[0,1,0] neg_hi:[0,1,0]
    s_add_u32 s98, s98, 20480
    s_add_u32 m0, s81, 6144
    s_nop 0
    buffer_load_dwordx4 v253, s[52:55], s98 offen offset:0 lds
    v_pk_fma_f32 v[116:117], v[156:157], v[246:247], v[116:117] op_sel:[0,0,0] op_sel_hi:[1,0,1] neg_lo:[0,1,0] neg_hi:[0,1,0]
    v_pk_fma_f32 v[120:121], v[156:157], v[244:245], v[120:121] op_sel:[0,1,0] op_sel_hi:[1,1,1] neg_lo:[0,1,0] neg_hi:[0,1,0]
    v_pk_fma_f32 v[124:125], v[156:157], v[246:247], v[124:125] op_sel:[0,1,0] op_sel_hi:[1,1,1] neg_lo:[0,1,0] neg_hi:[0,1,0]
    v_pk_mul_f32 v[114:115], v[114:115], v[154:155]
    v_pk_mul_f32 v[118:119], v[118:119], v[154:155]
    v_pk_mul_f32 v[122:123], v[122:123], v[154:155]
    v_pk_mul_f32 v[126:127], v[126:127], v[154:155]
    v_pk_fma_f32 v[114:115], v[158:159], v[244:245], v[114:115] op_sel:[0,0,0] op_sel_hi:[1,0,1] neg_lo:[0,1,0] neg_hi:[0,1,0]
    v_pk_fma_f32 v[118:119], v[158:159], v[246:247], v[118:119] op_sel:[0,0,0] op_sel_hi:[1,0,1] neg_lo:[0,1,0] neg_hi:[0,1,0]
    v_pk_fma_f32 v[122:123], v[158:159], v[244:245], v[122:123] op_sel:[0,1,0] op_sel_hi:[1,1,1] neg_lo:[0,1,0] neg_hi:[0,1,0]
    v_pk_fma_f32 v[126:127], v[158:159], v[246:247], v[126:127] op_sel:[0,1,0] op_sel_hi:[1,1,1] neg_lo:[0,1,0] neg_hi:[0,1,0]
    v_pk_fma_f32 v[160:161], v[216:217], v[168:169], v[112:113] op_sel:[0,0,0] op_sel_hi:[0,1,1]
    v_pk_fma_f32 v[162:163], v[216:217], v[170:171], v[116:117] op_sel:[0,0,0] op_sel_hi:[0,1,1]
    v_pk_fma_f32 v[160:161], v[218:219], v[170:171], v[160:161] op_sel:[0,0,0] op_sel_hi:[0,1,1] neg_lo:[1,0,0] neg_hi:[1,0,0]
    v_pk_fma_f32 v[162:163], v[218:219], v[168:169], v[162:163] op_sel:[0,0,0] op_sel_hi:[0,1,1]
    v_pk_fma_f32 v[164:165], v[216:217], v[172:173], v[120:121] op_sel:[1,0,0] op_sel_hi:[1,1,1]
    buffer_load_dwordx4 v254, s[52:55], s98 offen offset:1024 lds
    v_pk_fma_f32 v[166:167], v[216:217], v[174:175], v[124:125] op_sel:[1,0,0] op_sel_hi:[1,1,1]
    v_pk_fma_f32 v[164:165], v[218:219], v[174:175], v[164:165] op_sel:[1,0,0] op_sel_hi:[1,1,1] neg_lo:[1,0,0] neg_hi:[1,0,0]
    v_pk_fma_f32 v[166:167], v[218:219], v[172:173], v[166:167] op_sel:[1,0,0] op_sel_hi:[1,1,1]
    v_pk_fma_f32 v[168:169], v[216:217], v[160:161], v[114:115] op_sel:[0,0,0] op_sel_hi:[0,1,1]
    v_pk_fma_f32 v[170:171], v[216:217], v[162:163], v[118:119] op_sel:[0,0,0] op_sel_hi:[0,1,1]
    v_pk_fma_f32 v[168:169], v[218:219], v[162:163], v[168:169] op_sel:[0,0,0] op_sel_hi:[0,1,1] neg_lo:[1,0,0] neg_hi:[1,0,0]
    v_pk_fma_f32 v[170:171], v[218:219], v[160:161], v[170:171] op_sel:[0,0,0] op_sel_hi:[0,1,1]
    v_pk_fma_f32 v[172:173], v[216:217], v[164:165], v[122:123] op_sel:[1,0,0] op_sel_hi:[1,1,1]
    v_pk_fma_f32 v[174:175], v[216:217], v[166:167], v[126:127] op_sel:[1,0,0] op_sel_hi:[1,1,1]
    v_pk_fma_f32 v[172:173], v[218:219], v[166:167], v[172:173] op_sel:[1,0,0] op_sel_hi:[1,1,1] neg_lo:[1,0,0] neg_hi:[1,0,0]
    v_pk_fma_f32 v[174:175], v[218:219], v[164:165], v[174:175] op_sel:[1,0,0] op_sel_hi:[1,1,1]
    s_waitcnt lgkmcnt(1)
    v_pk_mul_f32 v[128:129], v[128:129], v[144:145]
    v_pk_mul_f32 v[132:133], v[132:133], v[144:145]
    v_pk_mul_f32 v[136:137], v[136:137], v[144:145]
    v_pk_mul_f32 v[140:141], v[140:141], v[144:145]
    s_waitcnt lgkmcnt(0)
    v_pk_fma_f32 v[128:129], v[148:149], v[244:245], v[128:129] op_sel:[0,0,0] op_sel_hi:[1,0,1] neg_lo:[0,1,0] neg_hi:[0,1,0]
    s_add_u32 s98, s98, s97
    s_add_u32 m0, s81, 8192
    s_nop 0
    buffer_load_dwordx4 v253, s[52:55], s98 offen offset:0 lds
    v_pk_fma_f32 v[132:133], v[148:149], v[246:247], v[132:133] op_sel:[0,0,0] op_sel_hi:[1,0,1] neg_lo:[0,1,0] neg_hi:[0,1,0]
    v_pk_fma_f32 v[136:137], v[148:149], v[244:245], v[136:137] op_sel:[0,1,0] op_sel_hi:[1,1,1] neg_lo:[0,1,0] neg_hi:[0,1,0]
    v_pk_fma_f32 v[140:141], v[148:149], v[246:247], v[140:141] op_sel:[0,1,0] op_sel_hi:[1,1,1] neg_lo:[0,1,0] neg_hi:[0,1,0]
    v_pk_mul_f32 v[130:131], v[130:131], v[146:147]
    v_pk_mul_f32 v[134:135], v[134:135], v[146:147]
    v_pk_mul_f32 v[138:139], v[138:139], v[146:147]
    v_pk_mul_f32 v[142:143], v[142:143], v[146:147]
    v_pk_fma_f32 v[130:131], v[150:151], v[244:245], v[130:131] op_sel:[0,0,0] op_sel_hi:[1,0,1] neg_lo:[0,1,0] neg_hi:[0,1,0]
    v_pk_fma_f32 v[134:135], v[150:151], v[246:247], v[134:135] op_sel:[0,0,0] op_sel_hi:[1,0,1] neg_lo:[0,1,0] neg_hi:[0,1,0]
    v_pk_fma_f32 v[138:139], v[150:151], v[244:245], v[138:139] op_sel:[0,1,0] op_sel_hi:[1,1,1] neg_lo:[0,1,0] neg_hi:[0,1,0]
    v_pk_fma_f32 v[142:143], v[150:151], v[246:247], v[142:143] op_sel:[0,1,0] op_sel_hi:[1,1,1] neg_lo:[0,1,0] neg_hi:[0,1,0]
    v_pk_fma_f32 v[160:161], v[216:217], v[168:169], v[128:129] op_sel:[0,0,0] op_sel_hi:[0,1,1]
    v_pk_fma_f32 v[162:163], v[216:217], v[170:171], v[132:133] op_sel:[0,0,0] op_sel_hi:[0,1,1]
    v_pk_fma_f32 v[160:161], v[218:219], v[170:171], v[160:161] op_sel:[0,0,0] op_sel_hi:[0,1,1] neg_lo:[1,0,0] neg_hi:[1,0,0]
    v_pk_fma_f32 v[162:163], v[218:219], v[168:169], v[162:163] op_sel:[0,0,0] op_sel_hi:[0,1,1]
    v_pk_fma_f32 v[164:165], v[216:217], v[172:173], v[136:137] op_sel:[1,0,0] op_sel_hi:[1,1,1]
    buffer_load_dwordx4 v254, s[52:55], s98 offen offset:1024 lds
    v_pk_fma_f32 v[166:167], v[216:217], v[174:175], v[140:141] op_sel:[1,0,0] op_sel_hi:[1,1,1]
    v_pk_fma_f32 v[164:165], v[218:219], v[174:175], v[164:165] op_sel:[1,0,0] op_sel_hi:[1,1,1] neg_lo:[1,0,0] neg_hi:[1,0,0]
    v_pk_fma_f32 v[166:167], v[218:219], v[172:173], v[166:167] op_sel:[1,0,0] op_sel_hi:[1,1,1]
    v_pk_fma_f32 v[168:169], v[216:217], v[160:161], v[130:131] op_sel:[0,0,0] op_sel_hi:[0,1,1]
    v_pk_fma_f32 v[170:171], v[216:217], v[162:163], v[134:135] op_sel:[0,0,0] op_sel_hi:[0,1,1]
    v_pk_fma_f32 v[168:169], v[218:219], v[162:163], v[168:169] op_sel:[0,0,0] op_sel_hi:[0,1,1] neg_lo:[1,0,0] neg_hi:[1,0,0]
    v_pk_fma_f32 v[170:171], v[218:219], v[160:161], v[170:171] op_sel:[0,0,0] op_sel_hi:[0,1,1]
    v_pk_fma_f32 v[172:173], v[216:217], v[164:165], v[138:139] op_sel:[1,0,0] op_sel_hi:[1,1,1]
    v_pk_fma_f32 v[174:175], v[216:217], v[166:167], v[142:143] op_sel:[1,0,0] op_sel_hi:[1,1,1]
    v_pk_fma_f32 v[172:173], v[218:219], v[166:167], v[172:173] op_sel:[1,0,0] op_sel_hi:[1,1,1] neg_lo:[1,0,0] neg_hi:[1,0,0]
    v_pk_fma_f32 v[174:175], v[218:219], v[164:165], v[174:175] op_sel:[1,0,0] op_sel_hi:[1,1,1]
    v_swap_b32 v169, v172
    v_swap_b32 v171, v174
    v_pk_fma_f32 v[172:173], v[224:225], v[168:169], v[172:173]
    v_pk_fma_f32 v[174:175], v[224:225], v[170:171], v[174:175]
    v_pk_fma_f32 v[172:173], v[226:227], v[170:171], v[172:173] neg_lo:[1,0,0] neg_hi:[1,0,0]
    v_pk_fma_f32 v[174:175], v[226:227], v[168:169], v[174:175]
    v_pk_mul_f32 v[160:161], v[232:233], v[172:173]
    v_pk_mul_f32 v[162:163], v[232:233], v[174:175]
    v_pk_fma_f32 v[160:161], v[234:235], v[174:175], v[160:161] neg_lo:[1,0,0] neg_hi:[1,0,0]
    v_pk_fma_f32 v[162:163], v[234:235], v[172:173], v[162:163]
    s_nop 1
    v_permlane32_swap_b32 v160, v162
    v_permlane32_swap_b32 v161, v163
    v_and_b32 v176, 15, v215
    v_lshrrev_b32 v177, 4, v215
    v_pk_add_f32 v[160:161], v[160:161], v[162:163]
    v_lshlrev_b32 v176, 4, v176
    v_lshl_add_u32 v178, v177, 2, v176
    v_permlane16_swap_b32 v160, v161
    v_add_f32 v160, v160, v161
    buffer_store_dword v160, v178, s[48:51], s79 offen sc1
    s_barrier
    v_mov_b32 v198, 2146435072
    v_lshl_add_u32 v199, v177, 8, v176
    s_sub_u32 s79, s79, 4096
    s_movk_i32 s70, 1024
    s_sub_u32 s74, 16, s62
    v_cmp_gt_i32 vcc, s74, v177
    s_nop 1
    v_cndmask_b32 v194, v199, v198, vcc
    s_add_u32 s98, s96, 128
    s_add_u32 m0, s81, 40960
    s_nop 0
    buffer_load_dwordx4 v253, s[52:55], s98 offen offset:0 lds
    s_sub_u32 s74, 12, s62
    v_cmp_gt_i32 vcc, s74, v177
    s_nop 1
    v_cndmask_b32 v195, v199, v198, vcc
    s_sub_u32 s74, 8, s62
    v_cmp_gt_i32 vcc, s74, v177
    s_nop 1
    v_cndmask_b32 v196, v199, v198, vcc
    s_sub_u32 s74, 4, s62
    v_cmp_gt_i32 vcc, s74, v177
    s_nop 1
    v_cndmask_b32 v197, v199, v198, vcc
    v_mov_b32 v144, v172
    v_mov_b32 v148, v172
    v_mov_b32 v145, v173
    v_mov_b32 v149, v173
    v_mov_b32 v146, v174
    buffer_load_dwordx4 v254, s[52:55], s98 offen offset:1024 lds
    v_mov_b32 v150, v174
    v_mov_b32 v147, v175
    v_mov_b32 v151, v175
    v_permlane16_swap_b32 v144, v148
    v_permlane16_swap_b32 v145, v149
    v_permlane16_swap_b32 v146, v150
    v_permlane16_swap_b32 v147, v151
    v_mov_b32 v152, v144
    s_add_u32 s98, s98, 20480
    s_add_u32 m0, s81, 43008
    s_nop 0
    buffer_load_dwordx4 v253, s[52:55], s98 offen offset:0 lds
    v_mov_b32 v156, v148
    v_mov_b32 v153, v145
    v_mov_b32 v157, v149
    v_mov_b32 v154, v146
    v_mov_b32 v158, v150
    v_mov_b32 v155, v147
    v_mov_b32 v159, v151
    v_permlane32_swap_b32 v144, v152
    buffer_load_dwordx4 v254, s[52:55], s98 offen offset:1024 lds
    v_permlane32_swap_b32 v148, v156
    v_permlane32_swap_b32 v145, v153
    v_permlane32_swap_b32 v149, v157
    v_permlane32_swap_b32 v146, v154
    v_permlane32_swap_b32 v150, v158
    v_permlane32_swap_b32 v147, v155
    v_permlane32_swap_b32 v151, v159
    v_pk_fma_f32 v[148:149], v[228:229], v[144:145], v[148:149]
    s_add_u32 s98, s98, 20480
    s_add_u32 m0, s81, 45056
    s_nop 0
    buffer_load_dwordx4 v253, s[52:55], s98 offen offset:0 lds
    v_pk_fma_f32 v[150:151], v[228:229], v[146:147], v[150:151]
    v_pk_fma_f32 v[148:149], v[230:231], v[146:147], v[148:149] neg_lo:[1,0,0] neg_hi:[1,0,0]
    v_pk_fma_f32 v[150:151], v[230:231], v[144:145], v[150:151]
    v_pk_fma_f32 v[152:153], v[228:229], v[148:149], v[152:153]
    v_pk_fma_f32 v[154:155], v[228:229], v[150:151], v[154:155]
    v_pk_fma_f32 v[152:153], v[230:231], v[150:151], v[152:153] neg_lo:[1,0,0] neg_hi:[1,0,0]
    v_pk_fma_f32 v[154:155], v[230:231], v[148:149], v[154:155]
    v_mov_b32 v156, 0
    buffer_load_dwordx4 v254, s[52:55], s98 offen offset:1024 lds
    v_mov_b32 v157, 0
    v_mov_b32 v158, 0
    v_mov_b32 v159, 0
    v_cndmask_b32 v156, v156, v144, s[86:87]
    v_cndmask_b32 v157, v157, v145, s[86:87]
    v_cndmask_b32 v158, v158, v146, s[86:87]
    v_cndmask_b32 v159, v159, v147, s[86:87]
    v_cndmask_b32 v156, v156, v148, s[88:89]
    s_add_u32 s98, s98, 20480
    s_add_u32 m0, s81, 47104
    s_nop 0
    buffer_load_dwordx4 v253, s[52:55], s98 offen offset:0 lds
    v_cndmask_b32 v157, v157, v149, s[88:89]
    v_cndmask_b32 v158, v158, v150, s[88:89]
    v_cndmask_b32 v159, v159, v151, s[88:89]
    v_cndmask_b32 v156, v156, v152, s[90:91]
    v_cndmask_b32 v157, v157, v153, s[90:91]
    v_cndmask_b32 v158, v158, v154, s[90:91]
    v_cndmask_b32 v159, v159, v155, s[90:91]
    v_pk_mul_f32 v[180:181], v[220:221], v[156:157]
    buffer_load_dwordx4 v254, s[52:55], s98 offen offset:1024 lds
    v_pk_mul_f32 v[182:183], v[220:221], v[158:159]
    v_pk_fma_f32 v[180:181], v[222:223], v[158:159], v[180:181] neg_lo:[1,0,0] neg_hi:[1,0,0]
    v_pk_fma_f32 v[182:183], v[222:223], v[156:157], v[182:183]
    v_pk_mul_f32 v[184:185], v[220:221], v[168:169]
    v_pk_mul_f32 v[186:187], v[220:221], v[170:171]
    v_pk_fma_f32 v[184:185], v[222:223], v[170:171], v[184:185] neg_lo:[1,0,0] neg_hi:[1,0,0]
    v_pk_fma_f32 v[186:187], v[222:223], v[168:169], v[186:187]
    v_pk_mul_f32 v[144:145], v[228:229], v[228:229]
    s_add_u32 s98, s98, s97
    s_add_u32 m0, s81, 49152
    s_nop 0
    buffer_load_dwordx4 v253, s[52:55], s98 offen offset:0 lds
    v_pk_mul_f32 v[146:147], v[228:229], v[230:231]
    v_pk_fma_f32 v[144:145], v[230:231], v[230:231], v[144:145] neg_lo:[1,0,0] neg_hi:[1,0,0]
    v_pk_fma_f32 v[146:147], v[230:231], v[228:229], v[146:147]
    v_pk_mul_f32 v[148:149], v[144:145], v[228:229]
    v_pk_mul_f32 v[150:151], v[144:145], v[230:231]
    v_pk_fma_f32 v[148:149], v[146:147], v[230:231], v[148:149] neg_lo:[1,0,0] neg_hi:[1,0,0]
    v_pk_fma_f32 v[150:151], v[146:147], v[228:229], v[150:151]
    v_pk_mul_f32 v[152:153], v[144:145], v[144:145]
    buffer_load_dwordx4 v254, s[52:55], s98 offen offset:1024 lds
    v_pk_mul_f32 v[154:155], v[144:145], v[146:147]
    v_pk_fma_f32 v[152:153], v[146:147], v[146:147], v[152:153] neg_lo:[1,0,0] neg_hi:[1,0,0]
    v_pk_fma_f32 v[154:155], v[146:147], v[144:145], v[154:155]
    v_pk_mul_f32 v[156:157], v[152:153], v[152:153]
    v_pk_mul_f32 v[158:159], v[152:153], v[154:155]
    v_pk_fma_f32 v[156:157], v[154:155], v[154:155], v[156:157] neg_lo:[1,0,0] neg_hi:[1,0,0]
    v_pk_fma_f32 v[158:159], v[154:155], v[152:153], v[158:159]
    v_pk_mul_f32 v[160:161], v[156:157], v[152:153]
    s_add_u32 s98, s96, 256
    s_add_u32 m0, s81, 81920
    s_nop 0
    buffer_load_dwordx4 v253, s[52:55], s98 offen offset:0 lds
    v_pk_mul_f32 v[162:163], v[156:157], v[154:155]
    v_pk_fma_f32 v[160:161], v[158:159], v[154:155], v[160:161] neg_lo:[1,0,0] neg_hi:[1,0,0]
    v_pk_fma_f32 v[162:163], v[158:159], v[152:153], v[162:163]
    v_pk_mul_f32 v[188:189], v[156:157], v[156:157]
    v_pk_mul_f32 v[190:191], v[156:157], v[158:159]
    v_pk_fma_f32 v[188:189], v[158:159], v[158:159], v[188:189] neg_lo:[1,0,0] neg_hi:[1,0,0]
    v_pk_fma_f32 v[190:191], v[158:159], v[156:157], v[190:191]
    v_mov_b32 v164, 1.0
    buffer_load_dwordx4 v254, s[52:55], s98 offen offset:1024 lds
    v_mov_b32 v165, 1.0
    v_mov_b32 v166, 0
    v_mov_b32 v167, 0
    v_cndmask_b32 v240, v160, v156, s[86:87]
    v_cndmask_b32 v241, v161, v157, s[86:87]
    v_cndmask_b32 v242, v162, v158, s[86:87]
    v_cndmask_b32 v243, v163, v159, s[86:87]
    v_cndmask_b32 v240, v240, v152, s[88:89]
    s_add_u32 s98, s98, 20480
    s_add_u32 m0, s81, 83968
    s_nop 0
    buffer_load_dwordx4 v253, s[52:55], s98 offen offset:0 lds
    v_cndmask_b32 v241, v241, v153, s[88:89]
    v_cndmask_b32 v242, v242, v154, s[88:89]
    v_cndmask_b32 v243, v243, v155, s[88:89]
    v_cndmask_b32 v240, v240, v164, s[90:91]
    v_cndmask_b32 v241, v241, v165, s[90:91]
    v_cndmask_b32 v242, v242, v166, s[90:91]
    v_cndmask_b32 v243, v243, v167, s[90:91]
    v_cndmask_b32 v164, v164, v228, s[86:87]
    buffer_load_dwordx4 v254, s[52:55], s98 offen offset:1024 lds
    v_cndmask_b32 v165, v165, v229, s[86:87]
    v_cndmask_b32 v166, v166, v230, s[86:87]
    v_cndmask_b32 v167, v167, v231, s[86:87]
    v_cndmask_b32 v164, v164, v144, s[88:89]
    v_cndmask_b32 v165, v165, v145, s[88:89]
    v_cndmask_b32 v166, v166, v146, s[88:89]
    v_cndmask_b32 v167, v167, v147, s[88:89]
    v_cndmask_b32 v164, v164, v148, s[90:91]
    v_cndmask_b32 v165, v165, v149, s[90:91]
    v_cndmask_b32 v166, v166, v150, s[90:91]
    v_cndmask_b32 v167, v167, v151, s[90:91]
    v_pk_mul_f32 v[236:237], v[220:221], v[164:165]
    v_pk_mul_f32 v[238:239], v[220:221], v[166:167]
    v_pk_fma_f32 v[236:237], v[222:223], v[166:167], v[236:237] neg_lo:[1,0,0] neg_hi:[1,0,0]
    v_pk_fma_f32 v[238:239], v[222:223], v[164:165], v[238:239]
    v_bfe_u32 v164, v215, 2, 2
    v_and_b32 v166, 3, v215
    v_mov_b32 v169, 2146435072
    s_mul_i32 s73, s62, 9216
    s_cmp_eq_u32 s62, 14
    s_cselect_b32 s74, 0, 4
    v_cmp_lt_u32 vcc, s74, v164
    v_add_u32 v165, s73, v213
    s_nop 0
    v_cndmask_b32 v200, v165, v169, vcc
    s_cmp_eq_u32 s62, 14
    s_cselect_b32 s73, 64, s70
    v_add_u32 v201, s73, v200
    s_cmp_eq_u32 s62, 14
    s_cselect_b32 s73, 64, s70
    v_add_u32 v202, s73, v201
    s_cmp_eq_u32 s62, 14
    s_cselect_b32 s73, 64, s70
    v_add_u32 v203, s73, v202
    s_cmp_eq_u32 s62, 14
    s_cselect_b32 s73, 832, s70
    v_add_u32 v204, s73, v203
    s_cmp_eq_u32 s62, 14
    s_cselect_b32 s73, 64, s70
    v_add_u32 v205, s73, v204
    s_cmp_eq_u32 s62, 14
    s_cselect_b32 s73, 64, s70
    v_add_u32 v206, s73, v205
    s_cmp_eq_u32 s62, 14
    s_cselect_b32 s73, 64, s70
    v_add_u32 v207, s73, v206
    s_cmp_eq_u32 s62, 14
    s_cselect_b32 s73, 832, s70
    v_add_u32 v208, s73, v207
    v_and_b32 v168, 1, v215
    v_lshlrev_b32 v168, 4, v168
    v_mov_b32 v169, 0x3f80
    v_lshlrev_b32 v168, v168, v169
    v_cmp_eq_u32 vcc, v164, v177
    s_nop 1
    v_cndmask_b32 v168, 0, v168, vcc
    v_cmp_gt_u32 vcc, 2, v166
    s_nop 1
    v_cndmask_b32 v192, 0, v168, vcc
    v_sub_u32 v193, v168, v192
    buffer_load_dwordx4 v[144:147], v194, s[48:51], s79 offen offset:0 sc1
    buffer_load_dwordx4 v[148:151], v195, s[48:51], s79 offen offset:1024 sc1
    buffer_load_dwordx4 v[152:155], v196, s[48:51], s79 offen offset:2048 sc1
    buffer_load_dwordx4 v[156:159], v197, s[48:51], s79 offen offset:3072 sc1
    v_pk_mul_f32 v[160:161], v[220:221], v[0:1] op_sel:[0,0] op_sel_hi:[0,1]
    v_pk_mul_f32 v[162:163], v[222:223], v[0:1] op_sel:[0,0] op_sel_hi:[0,1]
    v_pk_fma_f32 v[0:1], v[222:223], v[4:5], v[160:161] op_sel:[0,0,0] op_sel_hi:[0,1,1] neg_lo:[1,0,0] neg_hi:[1,0,0]
    v_pk_fma_f32 v[4:5], v[220:221], v[4:5], v[162:163] op_sel:[0,0,0] op_sel_hi:[0,1,1]
    v_pk_mul_f32 v[164:165], v[220:221], v[8:9] op_sel:[1,0] op_sel_hi:[1,1]
    v_pk_mul_f32 v[166:167], v[222:223], v[8:9] op_sel:[1,0] op_sel_hi:[1,1]
    v_pk_fma_f32 v[8:9], v[222:223], v[12:13], v[164:165] op_sel:[1,0,0] op_sel_hi:[1,1,1] neg_lo:[1,0,0] neg_hi:[1,0,0]
    s_add_u32 s98, s98, 20480
    s_add_u32 m0, s81, 86016
    s_nop 0
    buffer_load_dwordx4 v253, s[52:55], s98 offen offset:0 lds
    v_pk_fma_f32 v[12:13], v[220:221], v[12:13], v[166:167] op_sel:[1,0,0] op_sel_hi:[1,1,1]
    v_pk_mul_f32 v[160:161], v[220:221], v[2:3] op_sel:[0,0] op_sel_hi:[0,1]
    v_pk_mul_f32 v[162:163], v[222:223], v[2:3] op_sel:[0,0] op_sel_hi:[0,1]
    v_pk_fma_f32 v[2:3], v[222:223], v[6:7], v[160:161] op_sel:[0,0,0] op_sel_hi:[0,1,1] neg_lo:[1,0,0] neg_hi:[1,0,0]
    v_pk_fma_f32 v[6:7], v[220:221], v[6:7], v[162:163] op_sel:[0,0,0] op_sel_hi:[0,1,1]
    v_pk_mul_f32 v[164:165], v[220:221], v[10:11] op_sel:[1,0] op_sel_hi:[1,1]
    v_pk_mul_f32 v[166:167], v[222:223], v[10:11] op_sel:[1,0] op_sel_hi:[1,1]
    v_pk_fma_f32 v[10:11], v[222:223], v[14:15], v[164:165] op_sel:[1,0,0] op_sel_hi:[1,1,1] neg_lo:[1,0,0] neg_hi:[1,0,0]
    v_pk_fma_f32 v[14:15], v[220:221], v[14:15], v[166:167] op_sel:[1,0,0] op_sel_hi:[1,1,1]
    v_pk_mul_f32 v[160:161], v[220:221], v[16:17] op_sel:[0,0] op_sel_hi:[0,1]
    v_pk_mul_f32 v[162:163], v[222:223], v[16:17] op_sel:[0,0] op_sel_hi:[0,1]
    buffer_load_dwordx4 v254, s[52:55], s98 offen offset:1024 lds
    v_pk_fma_f32 v[16:17], v[222:223], v[20:21], v[160:161] op_sel:[0,0,0] op_sel_hi:[0,1,1] neg_lo:[1,0,0] neg_hi:[1,0,0]
    v_pk_fma_f32 v[20:21], v[220:221], v[20:21], v[162:163] op_sel:[0,0,0] op_sel_hi:[0,1,1]
    v_pk_mul_f32 v[164:165], v[220:221], v[24:25] op_sel:[1,0] op_sel_hi:[1,1]
    v_pk_mul_f32 v[166:167], v[222:223], v[24:25] op_sel:[1,0] op_sel_hi:[1,1]
    v_pk_fma_f32 v[24:25], v[222:223], v[28:29], v[164:165] op_sel:[1,0,0] op_sel_hi:[1,1,1] neg_lo:[1,0,0] neg_hi:[1,0,0]
    v_pk_fma_f32 v[28:29], v[220:221], v[28:29], v[166:167] op_sel:[1,0,0] op_sel_hi:[1,1,1]
    v_pk_mul_f32 v[160:161], v[220:221], v[18:19] op_sel:[0,0] op_sel_hi:[0,1]
    v_pk_mul_f32 v[162:163], v[222:223], v[18:19] op_sel:[0,0] op_sel_hi:[0,1]
    v_pk_fma_f32 v[18:19], v[222:223], v[22:23], v[160:161] op_sel:[0,0,0] op_sel_hi:[0,1,1] neg_lo:[1,0,0] neg_hi:[1,0,0]
    v_pk_fma_f32 v[22:23], v[220:221], v[22:23], v[162:163] op_sel:[0,0,0] op_sel_hi:[0,1,1]
    v_pk_mul_f32 v[164:165], v[220:221], v[26:27] op_sel:[1,0] op_sel_hi:[1,1]
    s_add_u32 s98, s98, 20480
    s_add_u32 m0, s81, 88064
    s_nop 0
    buffer_load_dwordx4 v253, s[52:55], s98 offen offset:0 lds
    v_pk_mul_f32 v[166:167], v[222:223], v[26:27] op_sel:[1,0] op_sel_hi:[1,1]
    v_pk_fma_f32 v[26:27], v[222:223], v[30:31], v[164:165] op_sel:[1,0,0] op_sel_hi:[1,1,1] neg_lo:[1,0,0] neg_hi:[1,0,0]
    v_pk_fma_f32 v[30:31], v[220:221], v[30:31], v[166:167] op_sel:[1,0,0] op_sel_hi:[1,1,1]
    v_pk_mul_f32 v[160:161], v[220:221], v[32:33] op_sel:[0,0] op_sel_hi:[0,1]
    v_pk_mul_f32 v[162:163], v[222:223], v[32:33] op_sel:[0,0] op_sel_hi:[0,1]
    v_pk_fma_f32 v[32:33], v[222:223], v[36:37], v[160:161] op_sel:[0,0,0] op_sel_hi:[0,1,1] neg_lo:[1,0,0] neg_hi:[1,0,0]
    v_pk_fma_f32 v[36:37], v[220:221], v[36:37], v[162:163] op_sel:[0,0,0] op_sel_hi:[0,1,1]
    v_pk_mul_f32 v[164:165], v[220:221], v[40:41] op_sel:[1,0] op_sel_hi:[1,1]
    v_pk_mul_f32 v[166:167], v[222:223], v[40:41] op_sel:[1,0] op_sel_hi:[1,1]
    v_pk_fma_f32 v[40:41], v[222:223], v[44:45], v[164:165] op_sel:[1,0,0] op_sel_hi:[1,1,1] neg_lo:[1,0,0] neg_hi:[1,0,0]
    v_pk_fma_f32 v[44:45], v[220:221], v[44:45], v[166:167] op_sel:[1,0,0] op_sel_hi:[1,1,1]
    buffer_load_dwordx4 v254, s[52:55], s98 offen offset:1024 lds
    v_pk_mul_f32 v[160:161], v[220:221], v[34:35] op_sel:[0,0] op_sel_hi:[0,1]
    v_pk_mul_f32 v[162:163], v[222:223], v[34:35] op_sel:[0,0] op_sel_hi:[0,1]
    v_pk_fma_f32 v[34:35], v[222:223], v[38:39], v[160:161] op_sel:[0,0,0] op_sel_hi:[0,1,1] neg_lo:[1,0,0] neg_hi:[1,0,0]
    v_pk_fma_f32 v[38:39], v[220:221], v[38:39], v[162:163] op_sel:[0,0,0] op_sel_hi:[0,1,1]
    v_pk_mul_f32 v[164:165], v[220:221], v[42:43] op_sel:[1,0] op_sel_hi:[1,1]
    v_pk_mul_f32 v[166:167], v[222:223], v[42:43] op_sel:[1,0] op_sel_hi:[1,1]
    v_pk_fma_f32 v[42:43], v[222:223], v[46:47], v[164:165] op_sel:[1,0,0] op_sel_hi:[1,1,1] neg_lo:[1,0,0] neg_hi:[1,0,0]
    v_pk_fma_f32 v[46:47], v[220:221], v[46:47], v[166:167] op_sel:[1,0,0] op_sel_hi:[1,1,1]
    v_pk_mul_f32 v[160:161], v[220:221], v[48:49] op_sel:[0,0] op_sel_hi:[0,1]
    v_pk_mul_f32 v[162:163], v[222:223], v[48:49] op_sel:[0,0] op_sel_hi:[0,1]
    v_pk_fma_f32 v[48:49], v[222:223], v[52:53], v[160:161] op_sel:[0,0,0] op_sel_hi:[0,1,1] neg_lo:[1,0,0] neg_hi:[1,0,0]
    s_add_u32 s98, s98, s97
    s_add_u32 m0, s81, 90112
    s_nop 0
    buffer_load_dwordx4 v253, s[52:55], s98 offen offset:0 lds
    v_pk_fma_f32 v[52:53], v[220:221], v[52:53], v[162:163] op_sel:[0,0,0] op_sel_hi:[0,1,1]
    v_pk_mul_f32 v[164:165], v[220:221], v[56:57] op_sel:[1,0] op_sel_hi:[1,1]
    v_pk_mul_f32 v[166:167], v[222:223], v[56:57] op_sel:[1,0] op_sel_hi:[1,1]
    v_pk_fma_f32 v[56:57], v[222:223], v[60:61], v[164:165] op_sel:[1,0,0] op_sel_hi:[1,1,1] neg_lo:[1,0,0] neg_hi:[1,0,0]
    v_pk_fma_f32 v[60:61], v[220:221], v[60:61], v[166:167] op_sel:[1,0,0] op_sel_hi:[1,1,1]
    v_pk_mul_f32 v[160:161], v[220:221], v[50:51] op_sel:[0,0] op_sel_hi:[0,1]
    v_pk_mul_f32 v[162:163], v[222:223], v[50:51] op_sel:[0,0] op_sel_hi:[0,1]
    v_pk_fma_f32 v[50:51], v[222:223], v[54:55], v[160:161] op_sel:[0,0,0] op_sel_hi:[0,1,1] neg_lo:[1,0,0] neg_hi:[1,0,0]
    v_pk_fma_f32 v[54:55], v[220:221], v[54:55], v[162:163] op_sel:[0,0,0] op_sel_hi:[0,1,1]
    v_pk_mul_f32 v[164:165], v[220:221], v[58:59] op_sel:[1,0] op_sel_hi:[1,1]
    v_pk_mul_f32 v[166:167], v[222:223], v[58:59] op_sel:[1,0] op_sel_hi:[1,1]
    buffer_load_dwordx4 v254, s[52:55], s98 offen offset:1024 lds
    v_pk_fma_f32 v[58:59], v[222:223], v[62:63], v[164:165] op_sel:[1,0,0] op_sel_hi:[1,1,1] neg_lo:[1,0,0] neg_hi:[1,0,0]
    v_pk_fma_f32 v[62:63], v[220:221], v[62:63], v[166:167] op_sel:[1,0,0] op_sel_hi:[1,1,1]
    v_pk_mul_f32 v[160:161], v[220:221], v[64:65] op_sel:[0,0] op_sel_hi:[0,1]
    v_pk_mul_f32 v[162:163], v[222:223], v[64:65] op_sel:[0,0] op_sel_hi:[0,1]
    v_pk_fma_f32 v[64:65], v[222:223], v[68:69], v[160:161] op_sel:[0,0,0] op_sel_hi:[0,1,1] neg_lo:[1,0,0] neg_hi:[1,0,0]
    v_pk_fma_f32 v[68:69], v[220:221], v[68:69], v[162:163] op_sel:[0,0,0] op_sel_hi:[0,1,1]
    v_pk_mul_f32 v[164:165], v[220:221], v[72:73] op_sel:[1,0] op_sel_hi:[1,1]
    v_pk_mul_f32 v[166:167], v[222:223], v[72:73] op_sel:[1,0] op_sel_hi:[1,1]
    v_pk_fma_f32 v[72:73], v[222:223], v[76:77], v[164:165] op_sel:[1,0,0] op_sel_hi:[1,1,1] neg_lo:[1,0,0] neg_hi:[1,0,0]
    v_pk_fma_f32 v[76:77], v[220:221], v[76:77], v[166:167] op_sel:[1,0,0] op_sel_hi:[1,1,1]
    v_pk_mul_f32 v[160:161], v[220:221], v[66:67] op_sel:[0,0] op_sel_hi:[0,1]
    v_pk_mul_f32 v[162:163], v[222:223], v[66:67] op_sel:[0,0] op_sel_hi:[0,1]
    s_add_u32 s98, s96, 384
    s_add_u32 m0, s81, 122880
    s_nop 0
    buffer_load_dwordx4 v253, s[52:55], s98 offen offset:0 lds
    v_pk_fma_f32 v[66:67], v[222:223], v[70:71], v[160:161] op_sel:[0,0,0] op_sel_hi:[0,1,1] neg_lo:[1,0,0] neg_hi:[1,0,0]
    v_pk_fma_f32 v[70:71], v[220:221], v[70:71], v[162:163] op_sel:[0,0,0] op_sel_hi:[0,1,1]
    v_pk_mul_f32 v[164:165], v[220:221], v[74:75] op_sel:[1,0] op_sel_hi:[1,1]
    v_pk_mul_f32 v[166:167], v[222:223], v[74:75] op_sel:[1,0] op_sel_hi:[1,1]
    v_pk_fma_f32 v[74:75], v[222:223], v[78:79], v[164:165] op_sel:[1,0,0] op_sel_hi:[1,1,1] neg_lo:[1,0,0] neg_hi:[1,0,0]
    v_pk_fma_f32 v[78:79], v[220:221], v[78:79], v[166:167] op_sel:[1,0,0] op_sel_hi:[1,1,1]
    v_pk_mul_f32 v[160:161], v[220:221], v[80:81] op_sel:[0,0] op_sel_hi:[0,1]
    v_pk_mul_f32 v[162:163], v[222:223], v[80:81] op_sel:[0,0] op_sel_hi:[0,1]
    v_pk_fma_f32 v[80:81], v[222:223], v[84:85], v[160:161] op_sel:[0,0,0] op_sel_hi:[0,1,1] neg_lo:[1,0,0] neg_hi:[1,0,0]
    v_pk_fma_f32 v[84:85], v[220:221], v[84:85], v[162:163] op_sel:[0,0,0] op_sel_hi:[0,1,1]
    v_pk_mul_f32 v[164:165], v[220:221], v[88:89] op_sel:[1,0] op_sel_hi:[1,1]
    buffer_load_dwordx4 v254, s[52:55], s98 offen offset:1024 lds
    v_pk_mul_f32 v[166:167], v[222:223], v[88:89] op_sel:[1,0] op_sel_hi:[1,1]
    v_pk_fma_f32 v[88:89], v[222:223], v[92:93], v[164:165] op_sel:[1,0,0] op_sel_hi:[1,1,1] neg_lo:[1,0,0] neg_hi:[1,0,0]
    v_pk_fma_f32 v[92:93], v[220:221], v[92:93], v[166:167] op_sel:[1,0,0] op_sel_hi:[1,1,1]
    v_pk_mul_f32 v[160:161], v[220:221], v[82:83] op_sel:[0,0] op_sel_hi:[0,1]
    v_pk_mul_f32 v[162:163], v[222:223], v[82:83] op_sel:[0,0] op_sel_hi:[0,1]
    v_pk_fma_f32 v[82:83], v[222:223], v[86:87], v[160:161] op_sel:[0,0,0] op_sel_hi:[0,1,1] neg_lo:[1,0,0] neg_hi:[1,0,0]
    v_pk_fma_f32 v[86:87], v[220:221], v[86:87], v[162:163] op_sel:[0,0,0] op_sel_hi:[0,1,1]
    v_pk_mul_f32 v[164:165], v[220:221], v[90:91] op_sel:[1,0] op_sel_hi:[1,1]
    v_pk_mul_f32 v[166:167], v[222:223], v[90:91] op_sel:[1,0] op_sel_hi:[1,1]
    v_pk_fma_f32 v[90:91], v[222:223], v[94:95], v[164:165] op_sel:[1,0,0] op_sel_hi:[1,1,1] neg_lo:[1,0,0] neg_hi:[1,0,0]
    v_pk_fma_f32 v[94:95], v[220:221], v[94:95], v[166:167] op_sel:[1,0,0] op_sel_hi:[1,1,1]
    s_add_u32 s98, s98, 20480
    s_add_u32 m0, s81, 124928
    s_nop 0
    buffer_load_dwordx4 v253, s[52:55], s98 offen offset:0 lds
    v_pk_mul_f32 v[160:161], v[220:221], v[96:97] op_sel:[0,0] op_sel_hi:[0,1]
    v_pk_mul_f32 v[162:163], v[222:223], v[96:97] op_sel:[0,0] op_sel_hi:[0,1]
    v_pk_fma_f32 v[96:97], v[222:223], v[100:101], v[160:161] op_sel:[0,0,0] op_sel_hi:[0,1,1] neg_lo:[1,0,0] neg_hi:[1,0,0]
    v_pk_fma_f32 v[100:101], v[220:221], v[100:101], v[162:163] op_sel:[0,0,0] op_sel_hi:[0,1,1]
    v_pk_mul_f32 v[164:165], v[220:221], v[104:105] op_sel:[1,0] op_sel_hi:[1,1]
    v_pk_mul_f32 v[166:167], v[222:223], v[104:105] op_sel:[1,0] op_sel_hi:[1,1]
    v_pk_fma_f32 v[104:105], v[222:223], v[108:109], v[164:165] op_sel:[1,0,0] op_sel_hi:[1,1,1] neg_lo:[1,0,0] neg_hi:[1,0,0]
    v_pk_fma_f32 v[108:109], v[220:221], v[108:109], v[166:167] op_sel:[1,0,0] op_sel_hi:[1,1,1]
    v_pk_mul_f32 v[160:161], v[220:221], v[98:99] op_sel:[0,0] op_sel_hi:[0,1]
    v_pk_mul_f32 v[162:163], v[222:223], v[98:99] op_sel:[0,0] op_sel_hi:[0,1]
    v_pk_fma_f32 v[98:99], v[222:223], v[102:103], v[160:161] op_sel:[0,0,0] op_sel_hi:[0,1,1] neg_lo:[1,0,0] neg_hi:[1,0,0]
    buffer_load_dwordx4 v254, s[52:55], s98 offen offset:1024 lds
    v_pk_fma_f32 v[102:103], v[220:221], v[102:103], v[162:163] op_sel:[0,0,0] op_sel_hi:[0,1,1]
    v_pk_mul_f32 v[164:165], v[220:221], v[106:107] op_sel:[1,0] op_sel_hi:[1,1]
    v_pk_mul_f32 v[166:167], v[222:223], v[106:107] op_sel:[1,0] op_sel_hi:[1,1]
    v_pk_fma_f32 v[106:107], v[222:223], v[110:111], v[164:165] op_sel:[1,0,0] op_sel_hi:[1,1,1] neg_lo:[1,0,0] neg_hi:[1,0,0]
    v_pk_fma_f32 v[110:111], v[220:221], v[110:111], v[166:167] op_sel:[1,0,0] op_sel_hi:[1,1,1]
    v_pk_mul_f32 v[160:161], v[220:221], v[112:113] op_sel:[0,0] op_sel_hi:[0,1]
    v_pk_mul_f32 v[162:163], v[222:223], v[112:113] op_sel:[0,0] op_sel_hi:[0,1]
L_padS4:
    s_cbranch_execz L_retS
    v_pk_fma_f32 v[112:113], v[222:223], v[116:117], v[160:161] op_sel:[0,0,0] op_sel_hi:[0,1,1] neg_lo:[1,0,0] neg_hi:[1,0,0]
    v_pk_fma_f32 v[116:117], v[220:221], v[116:117], v[162:163] op_sel:[0,0,0] op_sel_hi:[0,1,1]
    v_pk_mul_f32 v[164:165], v[220:221], v[120:121] op_sel:[1,0] op_sel_hi:[1,1]
    v_pk_mul_f32 v[166:167], v[222:223], v[120:121] op_sel:[1,0] op_sel_hi:[1,1]
    s_add_u32 s98, s98, 20480
    s_add_u32 m0, s81, 126976
    s_nop 0
    buffer_load_dwordx4 v253, s[52:55], s98 offen offset:0 lds
    v_pk_fma_f32 v[120:121], v[222:223], v[124:125], v[164:165] op_sel:[1,0,0] op_sel_hi:[1,1,1] neg_lo:[1,0,0] neg_hi:[1,0,0]
    v_pk_fma_f32 v[124:125], v[220:221], v[124:125], v[166:167] op_sel:[1,0,0] op_sel_hi:[1,1,1]
    v_pk_mul_f32 v[160:161], v[220:221], v[114:115] op_sel:[0,0] op_sel_hi:[0,1]
    v_pk_mul_f32 v[162:163], v[222:223], v[114:115] op_sel:[0,0] op_sel_hi:[0,1]
    v_pk_fma_f32 v[114:115], v[222:223], v[118:119], v[160:161] op_sel:[0,0,0] op_sel_hi:[0,1,1] neg_lo:[1,0,0] neg_hi:[1,0,0]
    v_pk_fma_f32 v[118:119], v[220:221], v[118:119], v[162:163] op_sel:[0,0,0] op_sel_hi:[0,1,1]
    v_pk_mul_f32 v[164:165], v[220:221], v[122:123] op_sel:[1,0] op_sel_hi:[1,1]
    v_pk_mul_f32 v[166:167], v[222:223], v[122:123] op_sel:[1,0] op_sel_hi:[1,1]
    v_pk_fma_f32 v[122:123], v[222:223], v[126:127], v[164:165] op_sel:[1,0,0] op_sel_hi:[1,1,1] neg_lo:[1,0,0] neg_hi:[1,0,0]
    v_pk_fma_f32 v[126:127], v[220:221], v[126:127], v[166:167] op_sel:[1,0,0] op_sel_hi:[1,1,1]
    v_pk_mul_f32 v[160:161], v[220:221], v[128:129] op_sel:[0,0] op_sel_hi:[0,1]
    buffer_load_dwordx4 v254, s[52:55], s98 offen offset:1024 lds
    v_pk_mul_f32 v[162:163], v[222:223], v[128:129] op_sel:[0,0] op_sel_hi:[0,1]
    v_pk_fma_f32 v[128:129], v[222:223], v[132:133], v[160:161] op_sel:[0,0,0] op_sel_hi:[0,1,1] neg_lo:[1,0,0] neg_hi:[1,0,0]
    v_pk_fma_f32 v[132:133], v[220:221], v[132:133], v[162:163] op_sel:[0,0,0] op_sel_hi:[0,1,1]
    v_pk_mul_f32 v[164:165], v[220:221], v[136:137] op_sel:[1,0] op_sel_hi:[1,1]
    v_pk_mul_f32 v[166:167], v[222:223], v[136:137] op_sel:[1,0] op_sel_hi:[1,1]
    v_pk_fma_f32 v[136:137], v[222:223], v[140:141], v[164:165] op_sel:[1,0,0] op_sel_hi:[1,1,1] neg_lo:[1,0,0] neg_hi:[1,0,0]
    v_pk_fma_f32 v[140:141], v[220:221], v[140:141], v[166:167] op_sel:[1,0,0] op_sel_hi:[1,1,1]
    v_pk_mul_f32 v[160:161], v[220:221], v[130:131] op_sel:[0,0] op_sel_hi:[0,1]
    v_pk_mul_f32 v[162:163], v[222:223], v[130:131] op_sel:[0,0] op_sel_hi:[0,1]
    v_pk_fma_f32 v[130:131], v[222:223], v[134:135], v[160:161] op_sel:[0,0,0] op_sel_hi:[0,1,1] neg_lo:[1,0,0] neg_hi:[1,0,0]
    v_pk_fma_f32 v[134:135], v[220:221], v[134:135], v[162:163] op_sel:[0,0,0] op_sel_hi:[0,1,1]
    v_pk_mul_f32 v[164:165], v[220:221], v[138:139] op_sel:[1,0] op_sel_hi:[1,1]
    v_pk_mul_f32 v[166:167], v[222:223], v[138:139] op_sel:[1,0] op_sel_hi:[1,1]
    v_pk_fma_f32 v[138:139], v[222:223], v[142:143], v[164:165] op_sel:[1,0,0] op_sel_hi:[1,1,1] neg_lo:[1,0,0] neg_hi:[1,0,0]
    v_pk_fma_f32 v[142:143], v[220:221], v[142:143], v[166:167] op_sel:[1,0,0] op_sel_hi:[1,1,1]
    s_waitcnt vmcnt(15)
    v_max3_u32 v164, v144, v145, v146
    s_waitcnt vmcnt(14)
    v_max3_u32 v164, v164, v147, v148
    v_max3_u32 v164, v164, v149, v150
    s_waitcnt vmcnt(13)
    v_max3_u32 v164, v164, v151, v152
    v_max3_u32 v164, v164, v153, v154
    s_waitcnt vmcnt(12)
    v_max3_u32 v164, v164, v155, v156
    v_max3_u32 v164, v164, v157, v158
    v_max_u32 v164, v164, v159
    v_cmp_eq_u32 vcc, -1, v164
    s_nop 1
    s_cbranch_vccnz L_slow_19
L_lbok_18:
    v_pk_fma_f32 v[148:149], v[188:189], v[144:145], v[148:149]
    v_pk_fma_f32 v[150:151], v[188:189], v[146:147], v[150:151]
    v_pk_fma_f32 v[148:149], v[190:191], v[146:147], v[148:149] neg_lo:[1,0,0] neg_hi:[1,0,0]
    v_pk_fma_f32 v[150:151], v[190:191], v[144:145], v[150:151]
    v_pk_fma_f32 v[152:153], v[188:189], v[148:149], v[152:153]
    v_pk_fma_f32 v[154:155], v[188:189], v[150:151], v[154:155]
    v_pk_fma_f32 v[152:153], v[190:191], v[150:151], v[152:153] neg_lo:[1,0,0] neg_hi:[1,0,0]
    v_pk_fma_f32 v[154:155], v[190:191], v[148:149], v[154:155]
    v_pk_fma_f32 v[156:157], v[188:189], v[152:153], v[156:157]
    v_pk_fma_f32 v[158:159], v[188:189], v[154:155], v[158:159]
    v_pk_fma_f32 v[156:157], v[190:191], v[154:155], v[156:157] neg_lo:[1,0,0] neg_hi:[1,0,0]
    v_pk_fma_f32 v[158:159], v[190:191], v[152:153], v[158:159]
    v_pk_mul_f32 v[144:145], v[240:241], v[156:157]
    v_pk_mul_f32 v[146:147], v[240:241], v[158:159]
    v_pk_fma_f32 v[144:145], v[242:243], v[158:159], v[144:145] neg_lo:[1,0,0] neg_hi:[1,0,0]
    v_pk_fma_f32 v[146:147], v[242:243], v[156:157], v[146:147]
    v_mov_b64 v[148:149], v[144:145]
    v_mov_b64 v[150:151], v[146:147]
    s_nop 0
    v_permlane32_swap_b32 v144, v148
    v_permlane32_swap_b32 v145, v149
    v_permlane32_swap_b32 v146, v150
    v_permlane32_swap_b32 v147, v151
    v_pk_add_f32 v[144:145], v[144:145], v[148:149]
    v_pk_add_f32 v[146:147], v[146:147], v[150:151]
    v_mov_b64 v[148:149], v[144:145]
    v_mov_b64 v[150:151], v[146:147]
    s_nop 0
    v_permlane16_swap_b32 v144, v148
    v_permlane16_swap_b32 v145, v149
    v_permlane16_swap_b32 v146, v150
    v_permlane16_swap_b32 v147, v151
    v_pk_add_f32 v[144:145], v[144:145], v[148:149]
    v_pk_add_f32 v[146:147], v[146:147], v[150:151]
    v_pk_fma_f32 v[180:181], v[236:237], v[144:145], v[180:181]
    v_pk_fma_f32 v[182:183], v[236:237], v[146:147], v[182:183]
    v_pk_fma_f32 v[180:181], v[238:239], v[146:147], v[180:181] neg_lo:[1,0,0] neg_hi:[1,0,0]
    v_pk_fma_f32 v[182:183], v[238:239], v[144:145], v[182:183]
    v_pk_fma_f32 v[184:185], v[224:225], v[180:181], v[184:185]
    v_pk_fma_f32 v[186:187], v[224:225], v[182:183], v[186:187]
    v_pk_fma_f32 v[184:185], v[226:227], v[182:183], v[184:185] neg_lo:[1,0,0] neg_hi:[1,0,0]
    v_pk_fma_f32 v[186:187], v[226:227], v[180:181], v[186:187]
    v_swap_b32 v181, v184
    v_swap_b32 v183, v186
    s_add_u32 s75, s94, 2867200
    v_pk_fma_f32 v[0:1], v[216:217], v[180:181], v[0:1] op_sel:[0,0,0] op_sel_hi:[0,1,1]
    v_pk_fma_f32 v[4:5], v[216:217], v[182:183], v[4:5] op_sel:[0,0,0] op_sel_hi:[0,1,1]
    v_pk_fma_f32 v[0:1], v[218:219], v[182:183], v[0:1] op_sel:[0,0,0] op_sel_hi:[0,1,1] neg_lo:[1,0,0] neg_hi:[1,0,0]
    v_pk_fma_f32 v[4:5], v[218:219], v[180:181], v[4:5] op_sel:[0,0,0] op_sel_hi:[0,1,1]
    v_pk_fma_f32 v[8:9], v[216:217], v[184:185], v[8:9] op_sel:[1,0,0] op_sel_hi:[1,1,1]
    v_pk_fma_f32 v[12:13], v[216:217], v[186:187], v[12:13] op_sel:[1,0,0] op_sel_hi:[1,1,1]
    v_pk_fma_f32 v[8:9], v[218:219], v[186:187], v[8:9] op_sel:[1,0,0] op_sel_hi:[1,1,1] neg_lo:[1,0,0] neg_hi:[1,0,0]
    v_pk_fma_f32 v[12:13], v[218:219], v[184:185], v[12:13] op_sel:[1,0,0] op_sel_hi:[1,1,1]
    v_pk_fma_f32 v[2:3], v[216:217], v[0:1], v[2:3] op_sel:[0,0,0] op_sel_hi:[0,1,1]
    v_pk_fma_f32 v[6:7], v[216:217], v[4:5], v[6:7] op_sel:[0,0,0] op_sel_hi:[0,1,1]
    v_pk_fma_f32 v[2:3], v[218:219], v[4:5], v[2:3] op_sel:[0,0,0] op_sel_hi:[0,1,1] neg_lo:[1,0,0] neg_hi:[1,0,0]
    v_pk_fma_f32 v[6:7], v[218:219], v[0:1], v[6:7] op_sel:[0,0,0] op_sel_hi:[0,1,1]
    v_pk_fma_f32 v[10:11], v[216:217], v[8:9], v[10:11] op_sel:[1,0,0] op_sel_hi:[1,1,1]
    v_pk_fma_f32 v[14:15], v[216:217], v[12:13], v[14:15] op_sel:[1,0,0] op_sel_hi:[1,1,1]
    v_pk_fma_f32 v[10:11], v[218:219], v[12:13], v[10:11] op_sel:[1,0,0] op_sel_hi:[1,1,1] neg_lo:[1,0,0] neg_hi:[1,0,0]
    v_pk_fma_f32 v[14:15], v[218:219], v[8:9], v[14:15] op_sel:[1,0,0] op_sel_hi:[1,1,1]
    s_add_u32 s98, s98, 20480
    s_add_u32 m0, s81, 129024
    s_nop 0
    buffer_load_dwordx4 v253, s[52:55], s98 offen offset:0 lds
    v_pk_fma_f32 v[16:17], v[216:217], v[2:3], v[16:17] op_sel:[0,0,0] op_sel_hi:[0,1,1]
    v_pk_fma_f32 v[20:21], v[216:217], v[6:7], v[20:21] op_sel:[0,0,0] op_sel_hi:[0,1,1]
    v_pk_fma_f32 v[16:17], v[218:219], v[6:7], v[16:17] op_sel:[0,0,0] op_sel_hi:[0,1,1] neg_lo:[1,0,0] neg_hi:[1,0,0]
    v_pk_fma_f32 v[20:21], v[218:219], v[2:3], v[20:21] op_sel:[0,0,0] op_sel_hi:[0,1,1]
    v_pk_fma_f32 v[24:25], v[216:217], v[10:11], v[24:25] op_sel:[1,0,0] op_sel_hi:[1,1,1]
    v_pk_fma_f32 v[28:29], v[216:217], v[14:15], v[28:29] op_sel:[1,0,0] op_sel_hi:[1,1,1]
    v_pk_fma_f32 v[24:25], v[218:219], v[14:15], v[24:25] op_sel:[1,0,0] op_sel_hi:[1,1,1] neg_lo:[1,0,0] neg_hi:[1,0,0]
    v_pk_fma_f32 v[28:29], v[218:219], v[10:11], v[28:29] op_sel:[1,0,0] op_sel_hi:[1,1,1]
    v_pk_fma_f32 v[18:19], v[216:217], v[16:17], v[18:19] op_sel:[0,0,0] op_sel_hi:[0,1,1]
    v_pk_fma_f32 v[22:23], v[216:217], v[20:21], v[22:23] op_sel:[0,0,0] op_sel_hi:[0,1,1]
    v_pk_fma_f32 v[18:19], v[218:219], v[20:21], v[18:19] op_sel:[0,0,0] op_sel_hi:[0,1,1] neg_lo:[1,0,0] neg_hi:[1,0,0]
    v_pk_fma_f32 v[22:23], v[218:219], v[16:17], v[22:23] op_sel:[0,0,0] op_sel_hi:[0,1,1]
    v_pk_fma_f32 v[26:27], v[216:217], v[24:25], v[26:27] op_sel:[1,0,0] op_sel_hi:[1,1,1]
    v_pk_fma_f32 v[30:31], v[216:217], v[28:29], v[30:31] op_sel:[1,0,0] op_sel_hi:[1,1,1]
    v_pk_fma_f32 v[26:27], v[218:219], v[28:29], v[26:27] op_sel:[1,0,0] op_sel_hi:[1,1,1] neg_lo:[1,0,0] neg_hi:[1,0,0]
    v_pk_fma_f32 v[30:31], v[218:219], v[24:25], v[30:31] op_sel:[1,0,0] op_sel_hi:[1,1,1]
    buffer_load_dwordx4 v254, s[52:55], s98 offen offset:1024 lds
    v_cvt_pk_bf16_f32 v144, v0, v2
    v_cvt_pk_bf16_f32 v145, v16, v18
    v_cvt_pk_bf16_f32 v148, v8, v10
    v_cvt_pk_bf16_f32 v149, v24, v26
    v_mfma_f32_16x16x16_bf16 v[152:155], v[144:145], v[192:193], 0
    v_cvt_pk_bf16_f32 v146, -v4, -v6
    v_cvt_pk_bf16_f32 v147, -v20, -v22
    v_mfma_f32_16x16x16_bf16 v[160:163], v[148:149], v[192:193], 0
    v_cvt_pk_bf16_f32 v150, -v12, -v14
    v_cvt_pk_bf16_f32 v151, -v28, -v30
    v_mfma_f32_16x16x16_bf16 v[156:159], v[146:147], v[192:193], 0
    s_nop 0
    v_mfma_f32_16x16x16_bf16 v[164:167], v[150:151], v[192:193], 0
    v_pk_fma_f32 v[32:33], v[216:217], v[18:19], v[32:33] op_sel:[0,0,0] op_sel_hi:[0,1,1]
    v_pk_fma_f32 v[36:37], v[216:217], v[22:23], v[36:37] op_sel:[0,0,0] op_sel_hi:[0,1,1]
    v_pk_fma_f32 v[32:33], v[218:219], v[22:23], v[32:33] op_sel:[0,0,0] op_sel_hi:[0,1,1] neg_lo:[1,0,0] neg_hi:[1,0,0]
    v_pk_fma_f32 v[36:37], v[218:219], v[18:19], v[36:37] op_sel:[0,0,0] op_sel_hi:[0,1,1]
    v_pk_fma_f32 v[40:41], v[216:217], v[26:27], v[40:41] op_sel:[1,0,0] op_sel_hi:[1,1,1]
    v_pk_fma_f32 v[44:45], v[216:217], v[30:31], v[44:45] op_sel:[1,0,0] op_sel_hi:[1,1,1]
    v_pk_fma_f32 v[40:41], v[218:219], v[30:31], v[40:41] op_sel:[1,0,0] op_sel_hi:[1,1,1] neg_lo:[1,0,0] neg_hi:[1,0,0]
    v_pk_fma_f32 v[44:45], v[218:219], v[26:27], v[44:45] op_sel:[1,0,0] op_sel_hi:[1,1,1]
    v_pk_fma_f32 v[34:35], v[216:217], v[32:33], v[34:35] op_sel:[0,0,0] op_sel_hi:[0,1,1]
    v_pk_fma_f32 v[38:39], v[216:217], v[36:37], v[38:39] op_sel:[0,0,0] op_sel_hi:[0,1,1]
    v_pk_fma_f32 v[34:35], v[218:219], v[36:37], v[34:35] op_sel:[0,0,0] op_sel_hi:[0,1,1] neg_lo:[1,0,0] neg_hi:[1,0,0]
    v_pk_fma_f32 v[38:39], v[218:219], v[32:33], v[38:39] op_sel:[0,0,0] op_sel_hi:[0,1,1]
    v_pk_fma_f32 v[42:43], v[216:217], v[40:41], v[42:43] op_sel:[1,0,0] op_sel_hi:[1,1,1]
    v_pk_fma_f32 v[46:47], v[216:217], v[44:45], v[46:47] op_sel:[1,0,0] op_sel_hi:[1,1,1]
    v_pk_fma_f32 v[42:43], v[218:219], v[44:45], v[42:43] op_sel:[1,0,0] op_sel_hi:[1,1,1] neg_lo:[1,0,0] neg_hi:[1,0,0]
    v_pk_fma_f32 v[46:47], v[218:219], v[40:41], v[46:47] op_sel:[1,0,0] op_sel_hi:[1,1,1]
    v_cvt_pk_bf16_f32 v144, v17, v19
    v_cvt_pk_bf16_f32 v145, v33, v35
    v_cvt_pk_bf16_f32 v168, v152, v153
    v_cvt_pk_bf16_f32 v169, v154, v155
    v_mfma_f32_16x16x16_bf16 v[152:155], v[144:145], v[192:193], 0
    v_cvt_pk_bf16_f32 v148, v25, v27
    v_cvt_pk_bf16_f32 v149, v41, v43
    v_cvt_pk_bf16_f32 v170, v160, v161
    v_cvt_pk_bf16_f32 v171, v162, v163
    v_mfma_f32_16x16x16_bf16 v[160:163], v[148:149], v[192:193], 0
    buffer_store_dwordx4 v[168:171], v200, s[48:51], s94 offen sc1
    v_cvt_pk_bf16_f32 v146, -v21, -v23
    v_cvt_pk_bf16_f32 v147, -v37, -v39
    v_cvt_pk_bf16_f32 v172, v156, v157
    v_cvt_pk_bf16_f32 v173, v158, v159
    v_mfma_f32_16x16x16_bf16 v[156:159], v[146:147], v[192:193], 0
    v_cvt_pk_bf16_f32 v150, -v29, -v31
    v_cvt_pk_bf16_f32 v151, -v45, -v47
    v_cvt_pk_bf16_f32 v174, v164, v165
    v_cvt_pk_bf16_f32 v175, v166, v167
    v_mfma_f32_16x16x16_bf16 v[164:167], v[150:151], v[192:193], 0
    buffer_store_dwordx4 v[172:175], v200, s[48:51], s75 offen sc1
    v_pk_fma_f32 v[48:49], v[216:217], v[34:35], v[48:49] op_sel:[0,0,0] op_sel_hi:[0,1,1]
    v_pk_fma_f32 v[52:53], v[216:217], v[38:39], v[52:53] op_sel:[0,0,0] op_sel_hi:[0,1,1]
    v_pk_fma_f32 v[48:49], v[218:219], v[38:39], v[48:49] op_sel:[0,0,0] op_sel_hi:[0,1,1] neg_lo:[1,0,0] neg_hi:[1,0,0]
    v_pk_fma_f32 v[52:53], v[218:219], v[34:35], v[52:53] op_sel:[0,0,0] op_sel_hi:[0,1,1]
    v_pk_fma_f32 v[56:57], v[216:217], v[42:43], v[56:57] op_sel:[1,0,0] op_sel_hi:[1,1,1]
    v_pk_fma_f32 v[60:61], v[216:217], v[46:47], v[60:61] op_sel:[1,0,0] op_sel_hi:[1,1,1]
    v_pk_fma_f32 v[56:57], v[218:219], v[46:47], v[56:57] op_sel:[1,0,0] op_sel_hi:[1,1,1] neg_lo:[1,0,0] neg_hi:[1,0,0]
    v_pk_fma_f32 v[60:61], v[218:219], v[42:43], v[60:61] op_sel:[1,0,0] op_sel_hi:[1,1,1]
    v_pk_fma_f32 v[50:51], v[216:217], v[48:49], v[50:51] op_sel:[0,0,0] op_sel_hi:[0,1,1]
    v_pk_fma_f32 v[54:55], v[216:217], v[52:53], v[54:55] op_sel:[0,0,0] op_sel_hi:[0,1,1]
    v_pk_fma_f32 v[50:51], v[218:219], v[52:53], v[50:51] op_sel:[0,0,0] op_sel_hi:[0,1,1] neg_lo:[1,0,0] neg_hi:[1,0,0]
    v_pk_fma_f32 v[54:55], v[218:219], v[48:49], v[54:55] op_sel:[0,0,0] op_sel_hi:[0,1,1]
    v_pk_fma_f32 v[58:59], v[216:217], v[56:57], v[58:59] op_sel:[1,0,0] op_sel_hi:[1,1,1]
    v_pk_fma_f32 v[62:63], v[216:217], v[60:61], v[62:63] op_sel:[1,0,0] op_sel_hi:[1,1,1]
    v_pk_fma_f32 v[58:59], v[218:219], v[60:61], v[58:59] op_sel:[1,0,0] op_sel_hi:[1,1,1] neg_lo:[1,0,0] neg_hi:[1,0,0]
    v_pk_fma_f32 v[62:63], v[218:219], v[56:57], v[62:63] op_sel:[1,0,0] op_sel_hi:[1,1,1]
    v_cvt_pk_bf16_f32 v144, v32, v34
    v_cvt_pk_bf16_f32 v145, v48, v50
    v_cvt_pk_bf16_f32 v168, v152, v153
    v_cvt_pk_bf16_f32 v169, v154, v155
    v_mfma_f32_16x16x16_bf16 v[152:155], v[144:145], v[192:193], 0
    v_cvt_pk_bf16_f32 v148, v40, v42
    v_cvt_pk_bf16_f32 v149, v56, v58
    v_cvt_pk_bf16_f32 v170, v160, v161
    v_cvt_pk_bf16_f32 v171, v162, v163
    v_mfma_f32_16x16x16_bf16 v[160:163], v[148:149], v[192:193], 0
    buffer_store_dwordx4 v[168:171], v205, s[48:51], s94 offen sc1
    v_cvt_pk_bf16_f32 v146, -v36, -v38
    v_cvt_pk_bf16_f32 v147, -v52, -v54
    v_cvt_pk_bf16_f32 v172, v156, v157
    v_cvt_pk_bf16_f32 v173, v158, v159
    v_mfma_f32_16x16x16_bf16 v[156:159], v[146:147], v[192:193], 0
    v_cvt_pk_bf16_f32 v150, -v44, -v46
    v_cvt_pk_bf16_f32 v151, -v60, -v62
    v_cvt_pk_bf16_f32 v174, v164, v165
    v_cvt_pk_bf16_f32 v175, v166, v167
    v_mfma_f32_16x16x16_bf16 v[164:167], v[150:151], v[192:193], 0
    buffer_store_dwordx4 v[172:175], v205, s[48:51], s75 offen sc1
    v_pk_fma_f32 v[64:65], v[216:217], v[50:51], v[64:65] op_sel:[0,0,0] op_sel_hi:[0,1,1]
    v_pk_fma_f32 v[68:69], v[216:217], v[54:55], v[68:69] op_sel:[0,0,0] op_sel_hi:[0,1,1]
    v_pk_fma_f32 v[64:65], v[218:219], v[54:55], v[64:65] op_sel:[0,0,0] op_sel_hi:[0,1,1] neg_lo:[1,0,0] neg_hi:[1,0,0]
    v_pk_fma_f32 v[68:69], v[218:219], v[50:51], v[68:69] op_sel:[0,0,0] op_sel_hi:[0,1,1]
    v_pk_fma_f32 v[72:73], v[216:217], v[58:59], v[72:73] op_sel:[1,0,0] op_sel_hi:[1,1,1]
    v_pk_fma_f32 v[76:77], v[216:217], v[62:63], v[76:77] op_sel:[1,0,0] op_sel_hi:[1,1,1]
    v_pk_fma_f32 v[72:73], v[218:219], v[62:63], v[72:73] op_sel:[1,0,0] op_sel_hi:[1,1,1] neg_lo:[1,0,0] neg_hi:[1,0,0]
    v_pk_fma_f32 v[76:77], v[218:219], v[58:59], v[76:77] op_sel:[1,0,0] op_sel_hi:[1,1,1]
    v_pk_fma_f32 v[66:67], v[216:217], v[64:65], v[66:67] op_sel:[0,0,0] op_sel_hi:[0,1,1]
    v_pk_fma_f32 v[70:71], v[216:217], v[68:69], v[70:71] op_sel:[0,0,0] op_sel_hi:[0,1,1]
    v_pk_fma_f32 v[66:67], v[218:219], v[68:69], v[66:67] op_sel:[0,0,0] op_sel_hi:[0,1,1] neg_lo:[1,0,0] neg_hi:[1,0,0]
    v_pk_fma_f32 v[70:71], v[218:219], v[64:65], v[70:71] op_sel:[0,0,0] op_sel_hi:[0,1,1]
    v_pk_fma_f32 v[74:75], v[216:217], v[72:73], v[74:75] op_sel:[1,0,0] op_sel_hi:[1,1,1]
    v_pk_fma_f32 v[78:79], v[216:217], v[76:77], v[78:79] op_sel:[1,0,0] op_sel_hi:[1,1,1]
    v_pk_fma_f32 v[74:75], v[218:219], v[76:77], v[74:75] op_sel:[1,0,0] op_sel_hi:[1,1,1] neg_lo:[1,0,0] neg_hi:[1,0,0]
    v_pk_fma_f32 v[78:79], v[218:219], v[72:73], v[78:79] op_sel:[1,0,0] op_sel_hi:[1,1,1]
    v_cvt_pk_bf16_f32 v144, v49, v51
    v_cvt_pk_bf16_f32 v145, v65, v67
    v_cvt_pk_bf16_f32 v168, v152, v153
    v_cvt_pk_bf16_f32 v169, v154, v155
    v_mfma_f32_16x16x16_bf16 v[152:155], v[144:145], v[192:193], 0
    v_cvt_pk_bf16_f32 v148, v57, v59
    v_cvt_pk_bf16_f32 v149, v73, v75
    v_cvt_pk_bf16_f32 v170, v160, v161
    v_cvt_pk_bf16_f32 v171, v162, v163
    v_mfma_f32_16x16x16_bf16 v[160:163], v[148:149], v[192:193], 0
    buffer_store_dwordx4 v[168:171], v201, s[48:51], s94 offen sc1
    v_cvt_pk_bf16_f32 v146, -v53, -v55
    v_cvt_pk_bf16_f32 v147, -v69, -v71
    v_cvt_pk_bf16_f32 v172, v156, v157
    v_cvt_pk_bf16_f32 v173, v158, v159
    v_mfma_f32_16x16x16_bf16 v[156:159], v[146:147], v[192:193], 0
    v_cvt_pk_bf16_f32 v150, -v61, -v63
    v_cvt_pk_bf16_f32 v151, -v77, -v79
    v_cvt_pk_bf16_f32 v174, v164, v165
    v_cvt_pk_bf16_f32 v175, v166, v167
    v_mfma_f32_16x16x16_bf16 v[164:167], v[150:151], v[192:193], 0
    buffer_store_dwordx4 v[172:175], v201, s[48:51], s75 offen sc1
    v_pk_fma_f32 v[80:81], v[216:217], v[66:67], v[80:81] op_sel:[0,0,0] op_sel_hi:[0,1,1]
    v_pk_fma_f32 v[84:85], v[216:217], v[70:71], v[84:85] op_sel:[0,0,0] op_sel_hi:[0,1,1]
    v_pk_fma_f32 v[80:81], v[218:219], v[70:71], v[80:81] op_sel:[0,0,0] op_sel_hi:[0,1,1] neg_lo:[1,0,0] neg_hi:[1,0,0]
    v_pk_fma_f32 v[84:85], v[218:219], v[66:67], v[84:85] op_sel:[0,0,0] op_sel_hi:[0,1,1]
    v_pk_fma_f32 v[88:89], v[216:217], v[74:75], v[88:89] op_sel:[1,0,0] op_sel_hi:[1,1,1]
    v_pk_fma_f32 v[92:93], v[216:217], v[78:79], v[92:93] op_sel:[1,0,0] op_sel_hi:[1,1,1]
    v_pk_fma_f32 v[88:89], v[218:219], v[78:79], v[88:89] op_sel:[1,0,0] op_sel_hi:[1,1,1] neg_lo:[1,0,0] neg_hi:[1,0,0]
    v_pk_fma_f32 v[92:93], v[218:219], v[74:75], v[92:93] op_sel:[1,0,0] op_sel_hi:[1,1,1]
    v_pk_fma_f32 v[82:83], v[216:217], v[80:81], v[82:83] op_sel:[0,0,0] op_sel_hi:[0,1,1]
    v_pk_fma_f32 v[86:87], v[216:217], v[84:85], v[86:87] op_sel:[0,0,0] op_sel_hi:[0,1,1]
    v_pk_fma_f32 v[82:83], v[218:219], v[84:85], v[82:83] op_sel:[0,0,0] op_sel_hi:[0,1,1] neg_lo:[1,0,0] neg_hi:[1,0,0]
    v_pk_fma_f32 v[86:87], v[218:219], v[80:81], v[86:87] op_sel:[0,0,0] op_sel_hi:[0,1,1]
    v_pk_fma_f32 v[90:91], v[216:217], v[88:89], v[90:91] op_sel:[1,0,0] op_sel_hi:[1,1,1]
    v_pk_fma_f32 v[94:95], v[216:217], v[92:93], v[94:95] op_sel:[1,0,0] op_sel_hi:[1,1,1]
    v_pk_fma_f32 v[90:91], v[218:219], v[92:93], v[90:91] op_sel:[1,0,0] op_sel_hi:[1,1,1] neg_lo:[1,0,0] neg_hi:[1,0,0]
    v_pk_fma_f32 v[94:95], v[218:219], v[88:89], v[94:95] op_sel:[1,0,0] op_sel_hi:[1,1,1]
    v_cvt_pk_bf16_f32 v144, v64, v66
    v_cvt_pk_bf16_f32 v145, v80, v82
    v_cvt_pk_bf16_f32 v168, v152, v153
    v_cvt_pk_bf16_f32 v169, v154, v155
    v_mfma_f32_16x16x16_bf16 v[152:155], v[144:145], v[192:193], 0
    v_cvt_pk_bf16_f32 v148, v72, v74
    v_cvt_pk_bf16_f32 v149, v88, v90
    v_cvt_pk_bf16_f32 v170, v160, v161
    v_cvt_pk_bf16_f32 v171, v162, v163
    v_mfma_f32_16x16x16_bf16 v[160:163], v[148:149], v[192:193], 0
    buffer_store_dwordx4 v[168:171], v206, s[48:51], s94 offen sc1
    v_cvt_pk_bf16_f32 v146, -v68, -v70
    v_cvt_pk_bf16_f32 v147, -v84, -v86
    v_cvt_pk_bf16_f32 v172, v156, v157
    v_cvt_pk_bf16_f32 v173, v158, v159
    v_mfma_f32_16x16x16_bf16 v[156:159], v[146:147], v[192:193], 0
    v_cvt_pk_bf16_f32 v150, -v76, -v78
    v_cvt_pk_bf16_f32 v151, -v92, -v94
    v_cvt_pk_bf16_f32 v174, v164, v165
    v_cvt_pk_bf16_f32 v175, v166, v167
    v_mfma_f32_16x16x16_bf16 v[164:167], v[150:151], v[192:193], 0
    buffer_store_dwordx4 v[172:175], v206, s[48:51], s75 offen sc1
    v_pk_fma_f32 v[96:97], v[216:217], v[82:83], v[96:97] op_sel:[0,0,0] op_sel_hi:[0,1,1]
    v_pk_fma_f32 v[100:101], v[216:217], v[86:87], v[100:101] op_sel:[0,0,0] op_sel_hi:[0,1,1]
    v_pk_fma_f32 v[96:97], v[218:219], v[86:87], v[96:97] op_sel:[0,0,0] op_sel_hi:[0,1,1] neg_lo:[1,0,0] neg_hi:[1,0,0]
    v_pk_fma_f32 v[100:101], v[218:219], v[82:83], v[100:101] op_sel:[0,0,0] op_sel_hi:[0,1,1]
    v_pk_fma_f32 v[104:105], v[216:217], v[90:91], v[104:105] op_sel:[1,0,0] op_sel_hi:[1,1,1]
    v_pk_fma_f32 v[108:109], v[216:217], v[94:95], v[108:109] op_sel:[1,0,0] op_sel_hi:[1,1,1]
    v_pk_fma_f32 v[104:105], v[218:219], v[94:95], v[104:105] op_sel:[1,0,0] op_sel_hi:[1,1,1] neg_lo:[1,0,0] neg_hi:[1,0,0]
    v_pk_fma_f32 v[108:109], v[218:219], v[90:91], v[108:109] op_sel:[1,0,0] op_sel_hi:[1,1,1]
    v_pk_fma_f32 v[98:99], v[216:217], v[96:97], v[98:99] op_sel:[0,0,0] op_sel_hi:[0,1,1]
    v_pk_fma_f32 v[102:103], v[216:217], v[100:101], v[102:103] op_sel:[0,0,0] op_sel_hi:[0,1,1]
    v_pk_fma_f32 v[98:99], v[218:219], v[100:101], v[98:99] op_sel:[0,0,0] op_sel_hi:[0,1,1] neg_lo:[1,0,0] neg_hi:[1,0,0]
    v_pk_fma_f32 v[102:103], v[218:219], v[96:97], v[102:103] op_sel:[0,0,0] op_sel_hi:[0,1,1]
    v_pk_fma_f32 v[106:107], v[216:217], v[104:105], v[106:107] op_sel:[1,0,0] op_sel_hi:[1,1,1]
    v_pk_fma_f32 v[110:111], v[216:217], v[108:109], v[110:111] op_sel:[1,0,0] op_sel_hi:[1,1,1]
    v_pk_fma_f32 v[106:107], v[218:219], v[108:109], v[106:107] op_sel:[1,0,0] op_sel_hi:[1,1,1] neg_lo:[1,0,0] neg_hi:[1,0,0]
    v_pk_fma_f32 v[110:111], v[218:219], v[104:105], v[110:111] op_sel:[1,0,0] op_sel_hi:[1,1,1]
    v_cvt_pk_bf16_f32 v144, v81, v83
    v_cvt_pk_bf16_f32 v145, v97, v99
    v_cvt_pk_bf16_f32 v168, v152, v153
    v_cvt_pk_bf16_f32 v169, v154, v155
    v_mfma_f32_16x16x16_bf16 v[152:155], v[144:145], v[192:193], 0
    v_cvt_pk_bf16_f32 v148, v89, v91
    v_cvt_pk_bf16_f32 v149, v105, v107
    v_cvt_pk_bf16_f32 v170, v160, v161
    v_cvt_pk_bf16_f32 v171, v162, v163
    v_mfma_f32_16x16x16_bf16 v[160:163], v[148:149], v[192:193], 0
    buffer_store_dwordx4 v[168:171], v202, s[48:51], s94 offen sc1
    v_cvt_pk_bf16_f32 v146, -v85, -v87
    v_cvt_pk_bf16_f32 v147, -v101, -v103
    v_cvt_pk_bf16_f32 v172, v156, v157
    v_cvt_pk_bf16_f32 v173, v158, v159
    v_mfma_f32_16x16x16_bf16 v[156:159], v[146:147], v[192:193], 0
    v_cvt_pk_bf16_f32 v150, -v93, -v95
    v_cvt_pk_bf16_f32 v151, -v109, -v111
    v_cvt_pk_bf16_f32 v174, v164, v165
    v_cvt_pk_bf16_f32 v175, v166, v167
    v_mfma_f32_16x16x16_bf16 v[164:167], v[150:151], v[192:193], 0
    buffer_store_dwordx4 v[172:175], v202, s[48:51], s75 offen sc1
    v_pk_fma_f32 v[112:113], v[216:217], v[98:99], v[112:113] op_sel:[0,0,0] op_sel_hi:[0,1,1]
    v_pk_fma_f32 v[116:117], v[216:217], v[102:103], v[116:117] op_sel:[0,0,0] op_sel_hi:[0,1,1]
    v_pk_fma_f32 v[112:113], v[218:219], v[102:103], v[112:113] op_sel:[0,0,0] op_sel_hi:[0,1,1] neg_lo:[1,0,0] neg_hi:[1,0,0]
    v_pk_fma_f32 v[116:117], v[218:219], v[98:99], v[116:117] op_sel:[0,0,0] op_sel_hi:[0,1,1]
    v_pk_fma_f32 v[120:121], v[216:217], v[106:107], v[120:121] op_sel:[1,0,0] op_sel_hi:[1,1,1]
    v_pk_fma_f32 v[124:125], v[216:217], v[110:111], v[124:125] op_sel:[1,0,0] op_sel_hi:[1,1,1]
    v_pk_fma_f32 v[120:121], v[218:219], v[110:111], v[120:121] op_sel:[1,0,0] op_sel_hi:[1,1,1] neg_lo:[1,0,0] neg_hi:[1,0,0]
    v_pk_fma_f32 v[124:125], v[218:219], v[106:107], v[124:125] op_sel:[1,0,0] op_sel_hi:[1,1,1]
    v_pk_fma_f32 v[114:115], v[216:217], v[112:113], v[114:115] op_sel:[0,0,0] op_sel_hi:[0,1,1]
    v_pk_fma_f32 v[118:119], v[216:217], v[116:117], v[118:119] op_sel:[0,0,0] op_sel_hi:[0,1,1]
    v_pk_fma_f32 v[114:115], v[218:219], v[116:117], v[114:115] op_sel:[0,0,0] op_sel_hi:[0,1,1] neg_lo:[1,0,0] neg_hi:[1,0,0]
    v_pk_fma_f32 v[118:119], v[218:219], v[112:113], v[118:119] op_sel:[0,0,0] op_sel_hi:[0,1,1]
    v_pk_fma_f32 v[122:123], v[216:217], v[120:121], v[122:123] op_sel:[1,0,0] op_sel_hi:[1,1,1]
    v_pk_fma_f32 v[126:127], v[216:217], v[124:125], v[126:127] op_sel:[1,0,0] op_sel_hi:[1,1,1]
    v_pk_fma_f32 v[122:123], v[218:219], v[124:125], v[122:123] op_sel:[1,0,0] op_sel_hi:[1,1,1] neg_lo:[1,0,0] neg_hi:[1,0,0]
    v_pk_fma_f32 v[126:127], v[218:219], v[120:121], v[126:127] op_sel:[1,0,0] op_sel_hi:[1,1,1]
    buffer_load_dword v252, v248, s[48:51], 0 offen sc1
    v_cvt_pk_bf16_f32 v144, v96, v98
    v_cvt_pk_bf16_f32 v145, v112, v114
    v_cvt_pk_bf16_f32 v168, v152, v153
    v_cvt_pk_bf16_f32 v169, v154, v155
    v_mfma_f32_16x16x16_bf16 v[152:155], v[144:145], v[192:193], 0
    v_cvt_pk_bf16_f32 v148, v104, v106
    v_cvt_pk_bf16_f32 v149, v120, v122
    v_cvt_pk_bf16_f32 v170, v160, v161
    v_cvt_pk_bf16_f32 v171, v162, v163
    v_mfma_f32_16x16x16_bf16 v[160:163], v[148:149], v[192:193], 0
    buffer_store_dwordx4 v[168:171], v207, s[48:51], s94 offen sc1
    v_cvt_pk_bf16_f32 v146, -v100, -v102
    v_cvt_pk_bf16_f32 v147, -v116, -v118
    v_cvt_pk_bf16_f32 v172, v156, v157
    v_cvt_pk_bf16_f32 v173, v158, v159
    v_mfma_f32_16x16x16_bf16 v[156:159], v[146:147], v[192:193], 0
    v_cvt_pk_bf16_f32 v150, -v108, -v110
    v_cvt_pk_bf16_f32 v151, -v124, -v126
    v_cvt_pk_bf16_f32 v174, v164, v165
    v_cvt_pk_bf16_f32 v175, v166, v167
    v_mfma_f32_16x16x16_bf16 v[164:167], v[150:151], v[192:193], 0
    buffer_store_dwordx4 v[172:175], v207, s[48:51], s75 offen sc1
    v_pk_fma_f32 v[128:129], v[216:217], v[114:115], v[128:129] op_sel:[0,0,0] op_sel_hi:[0,1,1]
    v_pk_fma_f32 v[132:133], v[216:217], v[118:119], v[132:133] op_sel:[0,0,0] op_sel_hi:[0,1,1]
    v_pk_fma_f32 v[128:129], v[218:219], v[118:119], v[128:129] op_sel:[0,0,0] op_sel_hi:[0,1,1] neg_lo:[1,0,0] neg_hi:[1,0,0]
    v_pk_fma_f32 v[132:133], v[218:219], v[114:115], v[132:133] op_sel:[0,0,0] op_sel_hi:[0,1,1]
    v_pk_fma_f32 v[136:137], v[216:217], v[122:123], v[136:137] op_sel:[1,0,0] op_sel_hi:[1,1,1]
    v_pk_fma_f32 v[140:141], v[216:217], v[126:127], v[140:141] op_sel:[1,0,0] op_sel_hi:[1,1,1]
    v_pk_fma_f32 v[136:137], v[218:219], v[126:127], v[136:137] op_sel:[1,0,0] op_sel_hi:[1,1,1] neg_lo:[1,0,0] neg_hi:[1,0,0]
    v_pk_fma_f32 v[140:141], v[218:219], v[122:123], v[140:141] op_sel:[1,0,0] op_sel_hi:[1,1,1]
    v_pk_fma_f32 v[130:131], v[216:217], v[128:129], v[130:131] op_sel:[0,0,0] op_sel_hi:[0,1,1]
    v_pk_fma_f32 v[134:135], v[216:217], v[132:133], v[134:135] op_sel:[0,0,0] op_sel_hi:[0,1,1]
    v_pk_fma_f32 v[130:131], v[218:219], v[132:133], v[130:131] op_sel:[0,0,0] op_sel_hi:[0,1,1] neg_lo:[1,0,0] neg_hi:[1,0,0]
    v_pk_fma_f32 v[134:135], v[218:219], v[128:129], v[134:135] op_sel:[0,0,0] op_sel_hi:[0,1,1]
    v_pk_fma_f32 v[138:139], v[216:217], v[136:137], v[138:139] op_sel:[1,0,0] op_sel_hi:[1,1,1]
    v_pk_fma_f32 v[142:143], v[216:217], v[140:141], v[142:143] op_sel:[1,0,0] op_sel_hi:[1,1,1]
    v_pk_fma_f32 v[138:139], v[218:219], v[140:141], v[138:139] op_sel:[1,0,0] op_sel_hi:[1,1,1] neg_lo:[1,0,0] neg_hi:[1,0,0]
    v_pk_fma_f32 v[142:143], v[218:219], v[136:137], v[142:143] op_sel:[1,0,0] op_sel_hi:[1,1,1]
    v_cvt_pk_bf16_f32 v144, v128, v130
    v_cvt_pk_bf16_f32 v145, v1, v3
    v_cvt_pk_bf16_f32 v168, v152, v153
    v_cvt_pk_bf16_f32 v169, v154, v155
    v_mfma_f32_16x16x16_bf16 v[152:155], v[144:145], v[192:193], 0
    v_cvt_pk_bf16_f32 v148, v136, v138
    v_cvt_pk_bf16_f32 v149, v9, v11
    v_cvt_pk_bf16_f32 v170, v160, v161
    v_cvt_pk_bf16_f32 v171, v162, v163
    v_mfma_f32_16x16x16_bf16 v[160:163], v[148:149], v[192:193], 0
    buffer_store_dwordx4 v[168:171], v203, s[48:51], s94 offen sc1
    v_cvt_pk_bf16_f32 v146, -v132, -v134
    v_cvt_pk_bf16_f32 v147, -v5, -v7
    v_cvt_pk_bf16_f32 v172, v156, v157
    v_cvt_pk_bf16_f32 v173, v158, v159
    v_mfma_f32_16x16x16_bf16 v[156:159], v[146:147], v[192:193], 0
    v_cvt_pk_bf16_f32 v150, -v140, -v142
    v_cvt_pk_bf16_f32 v151, -v13, -v15
    v_cvt_pk_bf16_f32 v174, v164, v165
    v_cvt_pk_bf16_f32 v175, v166, v167
    v_mfma_f32_16x16x16_bf16 v[164:167], v[150:151], v[192:193], 0
    buffer_store_dwordx4 v[172:175], v203, s[48:51], s75 offen sc1
    v_cvt_pk_bf16_f32 v144, v113, v115
    v_cvt_pk_bf16_f32 v145, v129, v131
    v_cvt_pk_bf16_f32 v168, v152, v153
    v_cvt_pk_bf16_f32 v169, v154, v155
    v_mfma_f32_16x16x16_bf16 v[152:155], v[144:145], v[192:193], 0
    v_cvt_pk_bf16_f32 v148, v121, v123
    v_cvt_pk_bf16_f32 v149, v137, v139
    v_cvt_pk_bf16_f32 v170, v160, v161
    v_cvt_pk_bf16_f32 v171, v162, v163
    v_mfma_f32_16x16x16_bf16 v[160:163], v[148:149], v[192:193], 0
    buffer_store_dwordx4 v[168:171], v204, s[48:51], s94 offen sc1
    v_cvt_pk_bf16_f32 v146, -v117, -v119
    v_cvt_pk_bf16_f32 v147, -v133, -v135
    v_cvt_pk_bf16_f32 v172, v156, v157
    v_cvt_pk_bf16_f32 v173, v158, v159
    v_mfma_f32_16x16x16_bf16 v[156:159], v[146:147], v[192:193], 0
    v_cvt_pk_bf16_f32 v150, -v125, -v127
    v_cvt_pk_bf16_f32 v151, -v141, -v143
    v_cvt_pk_bf16_f32 v174, v164, v165
    v_cvt_pk_bf16_f32 v175, v166, v167
    v_mfma_f32_16x16x16_bf16 v[164:167], v[150:151], v[192:193], 0
    buffer_store_dwordx4 v[172:175], v204, s[48:51], s75 offen sc1
    v_cvt_pk_bf16_f32 v168, v152, v153
    v_cvt_pk_bf16_f32 v169, v154, v155
    v_cvt_pk_bf16_f32 v170, v160, v161
    v_cvt_pk_bf16_f32 v171, v162, v163
    buffer_store_dwordx4 v[168:171], v208, s[48:51], s94 offen sc1
    v_cvt_pk_bf16_f32 v172, v156, v157
    v_cvt_pk_bf16_f32 v173, v158, v159
    v_cvt_pk_bf16_f32 v174, v164, v165
    v_cvt_pk_bf16_f32 v175, v166, v167
    buffer_store_dwordx4 v[172:175], v208, s[48:51], s75 offen sc1
    s_mov_b32 s77, 143360
    s_mov_b32 s70, 0xffff0000
    s_lshl_b32 s73, s63, 12
    s_add_u32 s73, s73, 2351104
    s_mul_i32 s76, s60, 1720320
    s_add_u32 s76, s76, s73
    s_add_u32 s86, s60, 1
    s_and_b32 s86, s86, 3
    s_lshl_b32 s86, s86, 10
    s_waitcnt vmcnt(8)
    v_cmp_ne_u32 vcc, s82, v252
    s_nop 1
    s_cbranch_vccnz L_slow_22
L_ok_20:
    s_add_u32 s78, s86, s76
    buffer_load_dwordx4 v[0:3], v213, s[48:51], s78 offen sc1
    s_add_u32 s78, s78, s77
    buffer_load_dwordx4 v[4:7], v213, s[48:51], s78 offen sc1
    s_add_u32 s78, s78, s77
    buffer_load_dwordx4 v[8:11], v213, s[48:51], s78 offen sc1
    s_add_u32 s78, s78, s77
    buffer_load_dwordx4 v[12:15], v213, s[48:51], s78 offen sc1
    s_add_u32 s78, s78, s77
    buffer_load_dwordx4 v[16:19], v213, s[48:51], s78 offen sc1
    s_add_u32 s78, s78, s77
    buffer_load_dwordx4 v[20:23], v213, s[48:51], s78 offen sc1
    s_add_u32 s78, s78, s77
    buffer_load_dwordx4 v[24:27], v213, s[48:51], s78 offen sc1
    s_add_u32 s78, s78, s77
    buffer_load_dwordx4 v[28:31], v213, s[48:51], s78 offen sc1
    s_add_u32 s78, s78, s77
    buffer_load_dwordx4 v[32:35], v213, s[48:51], s78 offen sc1
    s_add_u32 s78, s78, s77
    buffer_load_dwordx4 v[36:39], v213, s[48:51], s78 offen sc1
    s_mul_i32 s90, s60, 286720
    s_sub_u32 s90, s76, s90
    s_add_u32 s90, s90, 6881280
    s_add_u32 s87, s60, 2
    s_and_b32 s87, s87, 3
    s_lshl_b32 s87, s87, 10
    s_add_u32 s88, s60, 3
    s_and_b32 s88, s88, 3
    s_lshl_b32 s88, s88, 10
    s_add_u32 s89, s60, 4
    s_and_b32 s89, s89, 3
    s_lshl_b32 s89, s89, 10
    v_and_b32 v236, 15, v215
    v_lshrrev_b32 v237, 4, v215
    v_lshl_add_u32 v238, v237, 2, v236
    v_and_b32 v238, 15, v238
    v_lshlrev_b32 v238, 4, v238
    v_lshl_add_u32 v238, v237, 8, v238
    v_add_u32 v204, s81, v238
    s_xor_b32 s73, s60, 2
    s_mul_i32 s73, s73, 10240
    v_add_u32 v205, s73, v238
    s_add_u32 s73, s60, 1
    s_and_b32 s73, s73, 3
    s_mul_i32 s73, s73, 10240
    s_sub_u32 s91, s81, s73
    s_sub_u32 s83, 40960, s91
    s_and_b32 s75, s64, 1
    v_lshrrev_b32 v236, 2, v215
    v_and_b32 v237, 3, v215
    v_lshl_add_u32 v238, v237, 2, v236
    v_and_b32 v238, 15, v238
    v_lshlrev_b32 v238, 4, v238
    v_lshl_add_u32 v238, v237, 8, v238
    s_xor_b32 s74, s75, 1
    s_lshl_b32 s74, s74, 7
    v_lshl_add_u32 v63, v237, 3, s74
    s_add_u32 s74, s73, 4096
    v_add_u32 v206, s74, v238
    v_lshrrev_b32 v239, 3, v215
    v_lshl_add_u32 v238, v237, 2, v239
    v_and_b32 v238, 15, v238
    v_lshlrev_b32 v238, 4, v238
    v_and_b32 v237, 7, v215
    v_lshl_add_u32 v238, v237, 8, v238
    s_lshl_b32 s74, s75, 5
    v_lshl_add_u32 v208, v237, 3, s74
    v_add_u32 v212, s73, v238
    v_xor_b32 v214, 128, v212
    v_lshlrev_b32 v62, 4, v239
    s_lshl_b32 s73, s63, 2
    s_add_u32 s73, s73, s60
    s_mul_i32 s74, s73, 57
    s_lshr_b32 s74, s74, 9
    s_mul_i32 s74, s74, 9
    s_sub_u32 s74, s73, s74
    s_mul_i32 s74, s74, 12
    s_cmp_lt_u32 s73, 126
    s_cselect_b32 s74, s74, 0
    s_cselect_b32 s71, 32, 0
    v_lshl_add_u32 v238, s73, 4, v236
    v_lshlrev_b32 v244, 4, v238
    s_lshl_b32 s73, s73, 4
    s_sub_u32 s73, s73, s74
    s_mul_i32 s73, s73, 1280
    s_mul_i32 s74, s64, 160
    s_add_u32 s73, s73, s74
    v_lshrrev_b32 v238, 4, v215
    v_mad_u32_u24 v238, v238, s71, v236
    v_mul_u32_u24 v238, 1280, v238
    v_add3_u32 v240, v238, v63, s73
    v_lshrrev_b32 v238, 5, v215
    v_mad_u32_u24 v238, v238, s71, v239
    v_mul_u32_u24 v238, 1280, v238
    v_add3_u32 v207, v238, v208, s73
    s_add_u32 s72, s71, 4
    s_mul_i32 s72, s72, 2560
    s_lshl_b32 s71, s72, 1
    v_min_u32 v238, 39, v215
    v_lshl_add_u32 v209, v238, 2, s74
    v_xor_b32 v241, 64, v249
    v_add_u32 v210, 81920, v249
    v_add_u32 v211, 81920, v241
    ds_read_b128 v[144:147], v249 offset:0
    ds_read_b128 v[148:151], v249 offset:2048
L_padS5:
    s_cbranch_execz L_retS
    ds_read_b128 v[152:155], v249 offset:4096
    ds_read_b128 v[156:159], v249 offset:6144
    ds_read_b128 v[160:163], v249 offset:8192
    ds_read_b128 v[164:167], v241 offset:0
    ds_read_b128 v[168:171], v241 offset:2048
    ds_read_b128 v[172:175], v241 offset:4096
    ds_read_b128 v[176:179], v241 offset:6144
    ds_read_b128 v[180:183], v241 offset:8192
    v_mov_b32 v255, s82
    v_lshlrev_b32 v239, 2, v215
    s_waitcnt vmcnt(10)
    s_mov_b64 exec, 0xffff
    buffer_store_dword v255, v239, s[48:51], s95 offen sc1
    s_mov_b64 exec, -1
    s_waitcnt vmcnt(10)
    v_mfma_f32_16x16x32_bf16 v[64:67], a[0:3], v[0:3], 0
    s_add_u32 s78, s78, s77
    s_waitcnt vmcnt(9)
    v_mfma_f32_16x16x32_bf16 v[64:67], a[20:23], v[4:7], v[64:67]
    buffer_load_dwordx4 v[40:43], v213, s[48:51], s78 offen sc1
    v_mfma_f32_16x16x32_bf16 v[68:71], a[24:27], v[4:7], 0
    ds_read_b128 v[184:187], v249 offset:40960
    v_mfma_f32_16x16x32_bf16 v[68:71], a[4:7], v[0:3], v[68:71]
    global_load_dword v209, v209, s[20:21]
    v_mfma_f32_16x16x32_bf16 v[72:75], a[8:11], v[0:3], 0
    ds_read_b128 v[188:191], v249 offset:43008
    v_mfma_f32_16x16x32_bf16 v[72:75], a[28:31], v[4:7], v[72:75]
    s_add_u32 s78, s78, s77
    ds_read_b128 v[192:195], v249 offset:45056
    v_mfma_f32_16x16x32_bf16 v[76:79], a[32:35], v[4:7], 0
    buffer_load_dwordx4 v[44:47], v213, s[48:51], s78 offen sc1
    v_mfma_f32_16x16x32_bf16 v[76:79], a[12:15], v[0:3], v[76:79]
    s_add_u32 s98, s98, s97
    s_add_u32 m0, s81, 131072
    ds_read_b128 v[196:199], v249 offset:47104
    v_mfma_f32_16x16x32_bf16 v[80:83], a[16:19], v[0:3], 0
    buffer_load_dwordx4 v253, s[52:55], s98 offen offset:0 lds
    v_mfma_f32_16x16x32_bf16 v[80:83], a[36:39], v[4:7], v[80:83]
    s_waitcnt vmcnt(12)
    ds_read_b128 v[200:203], v249 offset:49152
    v_mfma_f32_16x16x32_bf16 v[64:67], a[40:43], v[8:11], v[64:67]
    s_add_u32 s78, s87, s76
    s_waitcnt vmcnt(11)
    ds_read_b128 v[216:219], v241 offset:40960
    v_mfma_f32_16x16x32_bf16 v[64:67], a[60:63], v[12:15], v[64:67]
    buffer_load_dwordx4 v[0:3], v213, s[48:51], s78 offen sc1
    v_mfma_f32_16x16x32_bf16 v[68:71], a[64:67], v[12:15], v[68:71]
    ds_read_b128 v[220:223], v241 offset:43008
    v_mfma_f32_16x16x32_bf16 v[68:71], a[44:47], v[8:11], v[68:71]
    buffer_load_dwordx4 v254, s[52:55], s98 offen offset:1024 lds
    v_mfma_f32_16x16x32_bf16 v[72:75], a[48:51], v[8:11], v[72:75]
    ds_read_b128 v[224:227], v241 offset:45056
    v_mfma_f32_16x16x32_bf16 v[72:75], a[68:71], v[12:15], v[72:75]
    s_add_u32 s78, s78, s77
    ds_read_b128 v[228:231], v241 offset:47104
    v_mfma_f32_16x16x32_bf16 v[76:79], a[72:75], v[12:15], v[76:79]
    buffer_load_dwordx4 v[4:7], v213, s[48:51], s78 offen sc1
    v_mfma_f32_16x16x32_bf16 v[76:79], a[52:55], v[8:11], v[76:79]
    s_add_u32 s98, s96, 512
    s_add_u32 m0, s81, 0
    ds_read_b128 v[232:235], v241 offset:49152
    v_mfma_f32_16x16x32_bf16 v[80:83], a[56:59], v[8:11], v[80:83]
    s_waitcnt lgkmcnt(10)
    buffer_load_dwordx4 v253, s[52:55], s98 offen offset:0 lds
    v_mfma_f32_16x16x32_bf16 v[80:83], a[76:79], v[12:15], v[80:83]
    s_waitcnt vmcnt(14)
    v_mfma_f32_16x16x32_bf16 v[64:67], a[80:83], v[16:19], v[64:67]
    s_add_u32 s78, s78, s77
    s_waitcnt vmcnt(13)
    v_mfma_f32_16x16x32_bf16 v[64:67], a[100:103], v[20:23], v[64:67]
    buffer_load_dwordx4 v[8:11], v213, s[48:51], s78 offen sc1
    v_mfma_f32_16x16x32_bf16 v[68:71], a[104:107], v[20:23], v[68:71]
    v_mfma_f32_16x16x32_bf16 v[68:71], a[84:87], v[16:19], v[68:71]
    v_mfma_f32_16x16x32_bf16 v[72:75], a[88:91], v[16:19], v[72:75]
    v_mfma_f32_16x16x32_bf16 v[72:75], a[108:111], v[20:23], v[72:75]
    s_add_u32 s78, s78, s77
    v_mfma_f32_16x16x32_bf16 v[76:79], a[112:115], v[20:23], v[76:79]
    buffer_load_dwordx4 v[12:15], v213, s[48:51], s78 offen sc1
    v_mfma_f32_16x16x32_bf16 v[76:79], a[92:95], v[16:19], v[76:79]
    v_mfma_f32_16x16x32_bf16 v[80:83], a[96:99], v[16:19], v[80:83]
    buffer_load_dwordx4 v254, s[52:55], s98 offen offset:1024 lds
    v_mfma_f32_16x16x32_bf16 v[80:83], a[116:119], v[20:23], v[80:83]
    s_waitcnt vmcnt(15)
    v_mfma_f32_16x16x32_bf16 v[64:67], a[120:123], v[24:27], v[64:67]
    s_add_u32 s78, s78, s77
    s_waitcnt vmcnt(14)
    v_mfma_f32_16x16x32_bf16 v[64:67], a[140:143], v[28:31], v[64:67]
    buffer_load_dwordx4 v[16:19], v213, s[48:51], s78 offen sc1
    v_mfma_f32_16x16x32_bf16 v[68:71], a[144:147], v[28:31], v[68:71]
    s_add_u32 s98, s98, 20480
    s_add_u32 m0, s81, 2048
    v_mfma_f32_16x16x32_bf16 v[68:71], a[124:127], v[24:27], v[68:71]
    buffer_load_dwordx4 v253, s[52:55], s98 offen offset:0 lds
    v_mfma_f32_16x16x32_bf16 v[72:75], a[128:131], v[24:27], v[72:75]
    v_mfma_f32_16x16x32_bf16 v[72:75], a[148:151], v[28:31], v[72:75]
    s_add_u32 s78, s78, s77
    v_mfma_f32_16x16x32_bf16 v[76:79], a[152:155], v[28:31], v[76:79]
    buffer_load_dwordx4 v[20:23], v213, s[48:51], s78 offen sc1
    v_mfma_f32_16x16x32_bf16 v[76:79], a[132:135], v[24:27], v[76:79]
    v_mfma_f32_16x16x32_bf16 v[80:83], a[136:139], v[24:27], v[80:83]
    buffer_load_dwordx4 v254, s[52:55], s98 offen offset:1024 lds
    v_mfma_f32_16x16x32_bf16 v[80:83], a[156:159], v[28:31], v[80:83]
    s_waitcnt vmcnt(17)
    v_mfma_f32_16x16x32_bf16 v[64:67], a[160:163], v[32:35], v[64:67]
    s_add_u32 s78, s78, s77
    s_waitcnt vmcnt(16)
    v_mfma_f32_16x16x32_bf16 v[64:67], a[180:183], v[36:39], v[64:67]
    buffer_load_dwordx4 v[24:27], v213, s[48:51], s78 offen sc1
    v_mfma_f32_16x16x32_bf16 v[68:71], a[184:187], v[36:39], v[68:71]
    v_mfma_f32_16x16x32_bf16 v[68:71], a[164:167], v[32:35], v[68:71]
    v_mfma_f32_16x16x32_bf16 v[72:75], a[168:171], v[32:35], v[72:75]
    v_mfma_f32_16x16x32_bf16 v[72:75], a[188:191], v[36:39], v[72:75]
    s_add_u32 s78, s78, s77
    v_mfma_f32_16x16x32_bf16 v[76:79], a[192:195], v[36:39], v[76:79]
    buffer_load_dwordx4 v[28:31], v213, s[48:51], s78 offen sc1
    v_mfma_f32_16x16x32_bf16 v[76:79], a[172:175], v[32:35], v[76:79]
    s_add_u32 s98, s98, 20480
    s_add_u32 m0, s81, 4096
    v_mfma_f32_16x16x32_bf16 v[80:83], a[176:179], v[32:35], v[80:83]
    buffer_load_dwordx4 v253, s[52:55], s98 offen offset:0 lds
    v_mfma_f32_16x16x32_bf16 v[80:83], a[196:199], v[36:39], v[80:83]
    s_waitcnt vmcnt(17)
    v_mfma_f32_16x16x32_bf16 v[64:67], a[200:203], v[40:43], v[64:67]
    s_add_u32 s78, s78, s77
    s_waitcnt vmcnt(15)
    v_mfma_f32_16x16x32_bf16 v[64:67], a[220:223], v[44:47], v[64:67]
    buffer_load_dwordx4 v[32:35], v213, s[48:51], s78 offen sc1
    v_mfma_f32_16x16x32_bf16 v[68:71], a[224:227], v[44:47], v[68:71]
    v_mfma_f32_16x16x32_bf16 v[68:71], a[204:207], v[40:43], v[68:71]
    buffer_load_dwordx4 v[244:247], v244, s[48:51], 0 offen sc1
    v_mfma_f32_16x16x32_bf16 v[72:75], a[208:211], v[40:43], v[72:75]
    v_mfma_f32_16x16x32_bf16 v[72:75], a[228:231], v[44:47], v[72:75]
    s_add_u32 s78, s78, s77
    v_mfma_f32_16x16x32_bf16 v[76:79], a[232:235], v[44:47], v[76:79]
    buffer_load_dwordx4 v[36:39], v213, s[48:51], s78 offen sc1
    v_mfma_f32_16x16x32_bf16 v[76:79], a[212:215], v[40:43], v[76:79]
    v_mfma_f32_16x16x32_bf16 v[80:83], a[216:219], v[40:43], v[80:83]
    buffer_load_dwordx4 v254, s[52:55], s98 offen offset:1024 lds
    v_mfma_f32_16x16x32_bf16 v[80:83], a[236:239], v[44:47], v[80:83]
    s_waitcnt vmcnt(17)
    v_mfma_f32_16x16x32_bf16 v[84:87], a[0:3], v[0:3], 0
    s_add_u32 s78, s78, s77
    s_waitcnt vmcnt(15)
    v_mfma_f32_16x16x32_bf16 v[84:87], a[20:23], v[4:7], v[84:87]
    buffer_load_dwordx4 v[40:43], v213, s[48:51], s78 offen sc1
    v_mfma_f32_16x16x32_bf16 v[88:91], a[24:27], v[4:7], 0
    v_mfma_f32_16x16x32_bf16 v[88:91], a[4:7], v[0:3], v[88:91]
    ds_write_b64 v204, v[64:65] offset:40960
    v_mfma_f32_16x16x32_bf16 v[92:95], a[8:11], v[0:3], 0
    v_mfma_f32_16x16x32_bf16 v[92:95], a[28:31], v[4:7], v[92:95]
    s_add_u32 s78, s78, s77
    ds_write_b64 v204, v[66:67] offset:40968
    v_mfma_f32_16x16x32_bf16 v[96:99], a[32:35], v[4:7], 0
    buffer_load_dwordx4 v[44:47], v213, s[48:51], s78 offen sc1
    v_mfma_f32_16x16x32_bf16 v[96:99], a[12:15], v[0:3], v[96:99]
    v_mfma_f32_16x16x32_bf16 v[100:103], a[16:19], v[0:3], 0
    ds_write_b64 v204, v[68:69] offset:41984
    v_mfma_f32_16x16x32_bf16 v[100:103], a[36:39], v[4:7], v[100:103]
    s_add_u32 s78, s88, s76
    s_waitcnt vmcnt(15)
    v_mfma_f32_16x16x32_bf16 v[84:87], a[40:43], v[8:11], v[84:87]
    s_waitcnt vmcnt(14)
    ds_write_b64 v204, v[70:71] offset:41992
    v_mfma_f32_16x16x32_bf16 v[84:87], a[60:63], v[12:15], v[84:87]
    buffer_load_dwordx4 v[0:3], v213, s[48:51], s78 offen sc1
    v_mfma_f32_16x16x32_bf16 v[88:91], a[64:67], v[12:15], v[88:91]
    v_mfma_f32_16x16x32_bf16 v[88:91], a[44:47], v[8:11], v[88:91]
    ds_write_b64 v204, v[72:73] offset:43008
    v_mfma_f32_16x16x32_bf16 v[92:95], a[48:51], v[8:11], v[92:95]
    v_mfma_f32_16x16x32_bf16 v[92:95], a[68:71], v[12:15], v[92:95]
    s_add_u32 s78, s78, s77
    ds_write_b64 v204, v[74:75] offset:43016
    v_mfma_f32_16x16x32_bf16 v[96:99], a[72:75], v[12:15], v[96:99]
    buffer_load_dwordx4 v[4:7], v213, s[48:51], s78 offen sc1
    v_mfma_f32_16x16x32_bf16 v[96:99], a[52:55], v[8:11], v[96:99]
    v_mfma_f32_16x16x32_bf16 v[100:103], a[56:59], v[8:11], v[100:103]
    ds_write_b64 v204, v[76:77] offset:44032
    v_mfma_f32_16x16x32_bf16 v[100:103], a[76:79], v[12:15], v[100:103]
    s_add_u32 s78, s78, s77
    s_waitcnt vmcnt(14)
    v_mfma_f32_16x16x32_bf16 v[84:87], a[80:83], v[16:19], v[84:87]
    s_waitcnt vmcnt(12)
    ds_write_b64 v204, v[78:79] offset:44040
    v_mfma_f32_16x16x32_bf16 v[84:87], a[100:103], v[20:23], v[84:87]
    buffer_load_dwordx4 v[8:11], v213, s[48:51], s78 offen sc1
    v_mfma_f32_16x16x32_bf16 v[88:91], a[104:107], v[20:23], v[88:91]
    v_mfma_f32_16x16x32_bf16 v[88:91], a[84:87], v[16:19], v[88:91]
    ds_write_b64 v204, v[80:81] offset:45056
    v_mfma_f32_16x16x32_bf16 v[92:95], a[88:91], v[16:19], v[92:95]
    v_mfma_f32_16x16x32_bf16 v[92:95], a[108:111], v[20:23], v[92:95]
    s_add_u32 s78, s78, s77
    ds_write_b64 v204, v[82:83] offset:45064
    v_mfma_f32_16x16x32_bf16 v[96:99], a[112:115], v[20:23], v[96:99]
    buffer_load_dwordx4 v[12:15], v213, s[48:51], s78 offen sc1
    v_mfma_f32_16x16x32_bf16 v[96:99], a[92:95], v[16:19], v[96:99]
    v_mfma_f32_16x16x32_bf16 v[100:103], a[96:99], v[16:19], v[100:103]
    v_mfma_f32_16x16x32_bf16 v[100:103], a[116:119], v[20:23], v[100:103]
    s_waitcnt lgkmcnt(0)
    s_barrier
    s_waitcnt vmcnt(12)
    v_mfma_f32_16x16x32_bf16 v[84:87], a[120:123], v[24:27], v[84:87]
    s_add_u32 s78, s78, s77
    s_waitcnt vmcnt(11)
    ds_read_b128 v[64:67], v205 offset:40960
    v_mfma_f32_16x16x32_bf16 v[84:87], a[140:143], v[28:31], v[84:87]
    buffer_load_dwordx4 v[16:19], v213, s[48:51], s78 offen sc1
    v_mfma_f32_16x16x32_bf16 v[88:91], a[144:147], v[28:31], v[88:91]
    ds_read_b128 v[68:71], v205 offset:41984
    v_mfma_f32_16x16x32_bf16 v[88:91], a[124:127], v[24:27], v[88:91]
    ds_read_b128 v[72:75], v205 offset:43008
    v_mfma_f32_16x16x32_bf16 v[92:95], a[128:131], v[24:27], v[92:95]
    ds_read_b128 v[76:79], v205 offset:44032
    v_mfma_f32_16x16x32_bf16 v[92:95], a[148:151], v[28:31], v[92:95]
    s_add_u32 s78, s78, s77
    ds_read_b128 v[80:83], v205 offset:45056
    v_mfma_f32_16x16x32_bf16 v[96:99], a[152:155], v[28:31], v[96:99]
    s_add_u32 s98, s98, 20480
    buffer_load_dwordx4 v[20:23], v213, s[48:51], s78 offen sc1
    v_mfma_f32_16x16x32_bf16 v[96:99], a[132:135], v[24:27], v[96:99]
    s_add_u32 m0, s81, 6144
    ds_bpermute_b32 v126, v208, v209 offset:0
    v_mfma_f32_16x16x32_bf16 v[100:103], a[136:139], v[24:27], v[100:103]
    s_add_u32 s78, s78, s77
    buffer_load_dwordx4 v253, s[52:55], s98 offen offset:0 lds
    v_mfma_f32_16x16x32_bf16 v[100:103], a[156:159], v[28:31], v[100:103]
    s_waitcnt vmcnt(12)
    ds_bpermute_b32 v127, v208, v209 offset:4
    v_mfma_f32_16x16x32_bf16 v[84:87], a[160:163], v[32:35], v[84:87]
    s_waitcnt vmcnt(10)
    ds_bpermute_b32 v130, v208, v209 offset:0
    v_mfma_f32_16x16x32_bf16 v[84:87], a[180:183], v[36:39], v[84:87]
    buffer_load_dwordx4 v[24:27], v213, s[48:51], s78 offen sc1
    v_mfma_f32_16x16x32_bf16 v[88:91], a[184:187], v[36:39], v[88:91]
    ds_bpermute_b32 v131, v208, v209 offset:4
    v_mfma_f32_16x16x32_bf16 v[88:91], a[164:167], v[32:35], v[88:91]
    buffer_load_dwordx4 v254, s[52:55], s98 offen offset:1024 lds
    v_mfma_f32_16x16x32_bf16 v[92:95], a[168:171], v[32:35], v[92:95]
    ds_bpermute_b32 v134, v208, v209 offset:64
    v_mfma_f32_16x16x32_bf16 v[92:95], a[188:191], v[36:39], v[92:95]
    s_add_u32 s78, s78, s77
    ds_bpermute_b32 v135, v208, v209 offset:68
    v_mfma_f32_16x16x32_bf16 v[96:99], a[192:195], v[36:39], v[96:99]
    s_add_u32 s98, s98, s97
    buffer_load_dwordx4 v[28:31], v213, s[48:51], s78 offen sc1
    v_mfma_f32_16x16x32_bf16 v[96:99], a[172:175], v[32:35], v[96:99]
    s_add_u32 m0, s81, 8192
    ds_bpermute_b32 v138, v208, v209 offset:64
    v_mfma_f32_16x16x32_bf16 v[100:103], a[176:179], v[32:35], v[100:103]
    s_add_u32 s78, s78, s77
    buffer_load_dwordx4 v253, s[52:55], s98 offen offset:0 lds
    v_mfma_f32_16x16x32_bf16 v[100:103], a[196:199], v[36:39], v[100:103]
    s_waitcnt vmcnt(12)
    ds_bpermute_b32 v139, v208, v209 offset:68
    v_mfma_f32_16x16x32_bf16 v[84:87], a[200:203], v[40:43], v[84:87]
    s_waitcnt vmcnt(11)
    ds_bpermute_b32 v142, v63, v209 offset:0
    v_mfma_f32_16x16x32_bf16 v[84:87], a[220:223], v[44:47], v[84:87]
    buffer_load_dwordx4 v[32:35], v213, s[48:51], s78 offen sc1
    v_mfma_f32_16x16x32_bf16 v[88:91], a[224:227], v[44:47], v[88:91]
    ds_bpermute_b32 v143, v63, v209 offset:4
    v_mfma_f32_16x16x32_bf16 v[88:91], a[204:207], v[40:43], v[88:91]
    buffer_load_dwordx4 v254, s[52:55], s98 offen offset:1024 lds
    v_mfma_f32_16x16x32_bf16 v[92:95], a[208:211], v[40:43], v[92:95]
    v_mul_f32 v246, 1060205080, v246
    v_mfma_f32_16x16x32_bf16 v[92:95], a[228:231], v[44:47], v[92:95]
    s_add_u32 s78, s78, s77
    v_mul_f32 v245, v244, v246
    v_mfma_f32_16x16x32_bf16 v[96:99], a[232:235], v[44:47], v[96:99]
    buffer_load_dwordx4 v[36:39], v213, s[48:51], s78 offen sc1
    v_mfma_f32_16x16x32_bf16 v[96:99], a[212:215], v[40:43], v[96:99]
    s_waitcnt lgkmcnt(9)
    v_lshlrev_b32 v124, 16, v126
    v_and_b32 v125, s70, v126
    v_mfma_f32_16x16x32_bf16 v[100:103], a[216:219], v[40:43], v[100:103]
    s_waitcnt lgkmcnt(8)
    v_lshlrev_b32 v126, 16, v127
    v_and_b32 v127, s70, v127
    v_mfma_f32_16x16x32_bf16 v[100:103], a[236:239], v[44:47], v[100:103]
    s_waitcnt vmcnt(13) lgkmcnt(7)
    v_lshlrev_b32 v128, 16, v130
    v_and_b32 v129, s70, v130
    v_mfma_f32_16x16x32_bf16 v[64:67], a[0:3], v[0:3], v[64:67]
    s_waitcnt vmcnt(12) lgkmcnt(6)
    v_lshlrev_b32 v130, 16, v131
    v_and_b32 v131, s70, v131
    v_mfma_f32_16x16x32_bf16 v[64:67], a[20:23], v[4:7], v[64:67]
    s_add_u32 s78, s78, s77
    buffer_load_dwordx4 v[40:43], v213, s[48:51], s78 offen sc1
    v_mfma_f32_16x16x32_bf16 v[68:71], a[24:27], v[4:7], v[68:71]
    s_waitcnt lgkmcnt(5)
    v_lshlrev_b32 v132, 16, v134
    v_and_b32 v133, s70, v134
    v_mfma_f32_16x16x32_bf16 v[68:71], a[4:7], v[0:3], v[68:71]
    ds_write_b64 v204, v[84:85] offset:46080
    v_mfma_f32_16x16x32_bf16 v[72:75], a[8:11], v[0:3], v[72:75]
    s_waitcnt lgkmcnt(5)
    v_lshlrev_b32 v134, 16, v135
    v_and_b32 v135, s70, v135
    v_mfma_f32_16x16x32_bf16 v[72:75], a[28:31], v[4:7], v[72:75]
    s_add_u32 s78, s78, s77
    ds_write_b64 v204, v[86:87] offset:46088
    v_mfma_f32_16x16x32_bf16 v[76:79], a[32:35], v[4:7], v[76:79]
    buffer_load_dwordx4 v[44:47], v213, s[48:51], s78 offen sc1
    v_mfma_f32_16x16x32_bf16 v[76:79], a[12:15], v[0:3], v[76:79]
    s_waitcnt lgkmcnt(5)
    v_lshlrev_b32 v136, 16, v138
    v_and_b32 v137, s70, v138
    v_mfma_f32_16x16x32_bf16 v[80:83], a[16:19], v[0:3], v[80:83]
    s_add_u32 s78, s89, s76
    ds_write_b64 v204, v[88:89] offset:47104
    v_mfma_f32_16x16x32_bf16 v[80:83], a[36:39], v[4:7], v[80:83]
    s_waitcnt vmcnt(13) lgkmcnt(5)
    v_lshlrev_b32 v138, 16, v139
    v_and_b32 v139, s70, v139
    v_mfma_f32_16x16x32_bf16 v[64:67], a[40:43], v[8:11], v[64:67]
    s_waitcnt vmcnt(12)
    ds_write_b64 v204, v[90:91] offset:47112
    v_mfma_f32_16x16x32_bf16 v[64:67], a[60:63], v[12:15], v[64:67]
    buffer_load_dwordx4 v[0:3], v213, s[48:51], s78 offen sc1
    v_mfma_f32_16x16x32_bf16 v[68:71], a[64:67], v[12:15], v[68:71]
    s_waitcnt lgkmcnt(5)
    v_lshlrev_b32 v140, 16, v142
    v_and_b32 v141, s70, v142
    v_mfma_f32_16x16x32_bf16 v[68:71], a[44:47], v[8:11], v[68:71]
    ds_write_b64 v204, v[92:93] offset:48128
    v_mfma_f32_16x16x32_bf16 v[72:75], a[48:51], v[8:11], v[72:75]
    s_waitcnt lgkmcnt(5)
    v_lshlrev_b32 v142, 16, v143
    v_and_b32 v143, s70, v143
    v_mfma_f32_16x16x32_bf16 v[72:75], a[68:71], v[12:15], v[72:75]
    s_add_u32 s78, s78, s77
    ds_write_b64 v204, v[94:95] offset:48136
    v_mfma_f32_16x16x32_bf16 v[76:79], a[72:75], v[12:15], v[76:79]
    buffer_load_dwordx4 v[4:7], v213, s[48:51], s78 offen sc1
    v_mfma_f32_16x16x32_bf16 v[76:79], a[52:55], v[8:11], v[76:79]
    v_mfma_f32_16x16x32_bf16 v[80:83], a[56:59], v[8:11], v[80:83]
    ds_write_b64 v204, v[96:97] offset:49152
    v_mfma_f32_16x16x32_bf16 v[80:83], a[76:79], v[12:15], v[80:83]
    s_add_u32 s78, s78, s77
    s_waitcnt vmcnt(13)
    v_mfma_f32_16x16x32_bf16 v[64:67], a[80:83], v[16:19], v[64:67]
    s_waitcnt vmcnt(12)
    ds_write_b64 v204, v[98:99] offset:49160
    v_mfma_f32_16x16x32_bf16 v[64:67], a[100:103], v[20:23], v[64:67]
    buffer_load_dwordx4 v[8:11], v213, s[48:51], s78 offen sc1
    v_mfma_f32_16x16x32_bf16 v[68:71], a[104:107], v[20:23], v[68:71]
    v_mfma_f32_16x16x32_bf16 v[68:71], a[84:87], v[16:19], v[68:71]
    ds_write_b64 v204, v[100:101] offset:50176
    v_mfma_f32_16x16x32_bf16 v[72:75], a[88:91], v[16:19], v[72:75]
    v_mfma_f32_16x16x32_bf16 v[72:75], a[108:111], v[20:23], v[72:75]
    s_add_u32 s78, s78, s77
    ds_write_b64 v204, v[102:103] offset:50184
    v_mfma_f32_16x16x32_bf16 v[76:79], a[112:115], v[20:23], v[76:79]
    buffer_load_dwordx4 v[12:15], v213, s[48:51], s78 offen sc1
    v_mfma_f32_16x16x32_bf16 v[76:79], a[92:95], v[16:19], v[76:79]
    buffer_load_dword v252, v250, s[48:51], 0 offen sc1
    v_mfma_f32_16x16x32_bf16 v[80:83], a[96:99], v[16:19], v[80:83]
    v_mfma_f32_16x16x32_bf16 v[80:83], a[116:119], v[20:23], v[80:83]
    s_waitcnt lgkmcnt(0)
    s_barrier
    s_waitcnt vmcnt(13)
    v_mfma_f32_16x16x32_bf16 v[64:67], a[120:123], v[24:27], v[64:67]
    s_add_u32 s78, s78, s77
    s_waitcnt vmcnt(11)
    ds_read_b128 v[84:87], v205 offset:46080
    v_mfma_f32_16x16x32_bf16 v[64:67], a[140:143], v[28:31], v[64:67]
    buffer_load_dwordx4 v[16:19], v213, s[48:51], s78 offen sc1
    v_mfma_f32_16x16x32_bf16 v[68:71], a[144:147], v[28:31], v[68:71]
    ds_read_b128 v[88:91], v205 offset:47104
    v_mfma_f32_16x16x32_bf16 v[68:71], a[124:127], v[24:27], v[68:71]
    ds_read_b128 v[92:95], v205 offset:48128
    v_mfma_f32_16x16x32_bf16 v[72:75], a[128:131], v[24:27], v[72:75]
    ds_read_b128 v[96:99], v205 offset:49152
    v_mfma_f32_16x16x32_bf16 v[72:75], a[148:151], v[28:31], v[72:75]
    s_add_u32 s78, s78, s77
    ds_read_b128 v[100:103], v205 offset:50176
    v_mfma_f32_16x16x32_bf16 v[76:79], a[152:155], v[28:31], v[76:79]
    buffer_load_dwordx4 v[20:23], v213, s[48:51], s78 offen sc1
    v_mfma_f32_16x16x32_bf16 v[76:79], a[132:135], v[24:27], v[76:79]
    ds_bpermute_b32 v58, v62, v245 offset:0
    v_mfma_f32_16x16x32_bf16 v[80:83], a[136:139], v[24:27], v[80:83]
    s_add_u32 s78, s78, s77
    buffer_load_dwordx2 v[48:49], v207, s[36:39], 0 offen offset:0
    v_mfma_f32_16x16x32_bf16 v[80:83], a[156:159], v[28:31], v[80:83]
    s_waitcnt vmcnt(12)
    ds_bpermute_b32 v59, v62, v246 offset:0
    v_mfma_f32_16x16x32_bf16 v[64:67], a[160:163], v[32:35], v[64:67]
    s_waitcnt vmcnt(10)
    ds_bpermute_b32 v60, v62, v245 offset:128
    v_mfma_f32_16x16x32_bf16 v[64:67], a[180:183], v[36:39], v[64:67]
    buffer_load_dwordx4 v[24:27], v213, s[48:51], s78 offen sc1
    v_mfma_f32_16x16x32_bf16 v[68:71], a[184:187], v[36:39], v[68:71]
    ds_bpermute_b32 v61, v62, v246 offset:128
    v_mfma_f32_16x16x32_bf16 v[68:71], a[164:167], v[32:35], v[68:71]
    buffer_load_dwordx2 v[50:51], v207, s[36:39], s72 offen offset:0
    v_mfma_f32_16x16x32_bf16 v[72:75], a[168:171], v[32:35], v[72:75]
    v_mfma_f32_16x16x32_bf16 v[72:75], a[188:191], v[36:39], v[72:75]
    s_add_u32 s78, s78, s77
    v_mfma_f32_16x16x32_bf16 v[76:79], a[192:195], v[36:39], v[76:79]
    buffer_load_dwordx4 v[28:31], v213, s[48:51], s78 offen sc1
    v_mfma_f32_16x16x32_bf16 v[76:79], a[172:175], v[32:35], v[76:79]
    v_mfma_f32_16x16x32_bf16 v[80:83], a[176:179], v[32:35], v[80:83]
    buffer_load_dwordx2 v[52:53], v207, s[36:39], 0 offen offset:64
    v_mfma_f32_16x16x32_bf16 v[80:83], a[196:199], v[36:39], v[80:83]
    s_waitcnt vmcnt(13)
    v_mfma_f32_16x16x32_bf16 v[64:67], a[200:203], v[40:43], v[64:67]
    s_add_u32 s78, s78, s77
    s_waitcnt vmcnt(12)
    v_mfma_f32_16x16x32_bf16 v[64:67], a[220:223], v[44:47], v[64:67]
    buffer_load_dwordx4 v[32:35], v213, s[48:51], s78 offen sc1
    v_mfma_f32_16x16x32_bf16 v[68:71], a[224:227], v[44:47], v[68:71]
    v_mfma_f32_16x16x32_bf16 v[68:71], a[204:207], v[40:43], v[68:71]
    buffer_load_dwordx2 v[54:55], v207, s[36:39], s72 offen offset:64
    v_mfma_f32_16x16x32_bf16 v[72:75], a[208:211], v[40:43], v[72:75]
    v_mfma_f32_16x16x32_bf16 v[72:75], a[228:231], v[44:47], v[72:75]
    s_add_u32 s78, s78, s77
    v_mfma_f32_16x16x32_bf16 v[76:79], a[232:235], v[44:47], v[76:79]
    buffer_load_dwordx4 v[36:39], v213, s[48:51], s78 offen sc1
    v_mfma_f32_16x16x32_bf16 v[76:79], a[212:215], v[40:43], v[76:79]
    s_waitcnt lgkmcnt(4)
    v_mfma_f32_16x16x32_bf16 v[80:83], a[216:219], v[40:43], v[80:83]
    buffer_load_dwordx2 v[56:57], v240, s[36:39], 0 offen offset:0
    v_mfma_f32_16x16x32_bf16 v[80:83], a[236:239], v[44:47], v[80:83]
    s_waitcnt vmcnt(15)
    v_mfma_f32_16x16x32_bf16 v[84:87], a[0:3], v[0:3], v[84:87]
    s_add_u32 s78, s78, s77
    s_waitcnt vmcnt(14)
    v_mfma_f32_16x16x32_bf16 v[84:87], a[20:23], v[4:7], v[84:87]
    buffer_load_dwordx4 v[40:43], v213, s[48:51], s78 offen sc1
    v_mfma_f32_16x16x32_bf16 v[88:91], a[24:27], v[4:7], v[88:91]
    v_mfma_f32_16x16x32_bf16 v[88:91], a[4:7], v[0:3], v[88:91]
    ds_write_b128 v204, v[64:67] offset:40960
    v_mfma_f32_16x16x32_bf16 v[92:95], a[8:11], v[0:3], v[92:95]
    s_waitcnt vmcnt(12)
    v_cmp_ne_u32 vcc, s82, v252
    v_mfma_f32_16x16x32_bf16 v[92:95], a[28:31], v[4:7], v[92:95]
    s_add_u32 s78, s78, s77
    v_mfma_f32_16x16x32_bf16 v[96:99], a[32:35], v[4:7], v[96:99]
    buffer_load_dwordx4 v[44:47], v213, s[48:51], s78 offen sc1
    v_mfma_f32_16x16x32_bf16 v[96:99], a[12:15], v[0:3], v[96:99]
    s_cbranch_vccnz L_slow_26
L_ok_24:
    v_mfma_f32_16x16x32_bf16 v[100:103], a[16:19], v[0:3], v[100:103]
    ds_write_b128 v204, v[68:71] offset:41984
    v_mfma_f32_16x16x32_bf16 v[100:103], a[36:39], v[4:7], v[100:103]
    v_mfma_f32_16x16x32_bf16 v[84:87], a[40:43], v[8:11], v[84:87]
    s_add_u32 s78, s86, s90
    ds_read_b128 a[0:3], v210 offset:0
    v_mfma_f32_16x16x32_bf16 v[84:87], a[60:63], v[12:15], v[84:87]
    buffer_load_dwordx4 v[0:3], v213, s[48:51], s78 offen sc1
    v_mfma_f32_16x16x32_bf16 v[88:91], a[64:67], v[12:15], v[88:91]
    v_mfma_f32_16x16x32_bf16 v[88:91], a[44:47], v[8:11], v[88:91]
    ds_write_b128 v204, v[72:75] offset:43008
    v_mfma_f32_16x16x32_bf16 v[92:95], a[48:51], v[8:11], v[92:95]
    v_mfma_f32_16x16x32_bf16 v[92:95], a[68:71], v[12:15], v[92:95]
    s_add_u32 s78, s78, s77
    ds_read_b128 a[4:7], v210 offset:2048
    v_mfma_f32_16x16x32_bf16 v[96:99], a[72:75], v[12:15], v[96:99]
    buffer_load_dwordx4 v[4:7], v213, s[48:51], s78 offen sc1
    v_mfma_f32_16x16x32_bf16 v[96:99], a[52:55], v[8:11], v[96:99]
    v_mfma_f32_16x16x32_bf16 v[100:103], a[56:59], v[8:11], v[100:103]
    ds_write_b128 v204, v[76:79] offset:44032
    v_mfma_f32_16x16x32_bf16 v[100:103], a[76:79], v[12:15], v[100:103]
    s_waitcnt vmcnt(14)
    v_mfma_f32_16x16x32_bf16 v[84:87], a[80:83], v[16:19], v[84:87]
    s_add_u32 s78, s78, s77
    s_waitcnt vmcnt(13)
    ds_read_b128 a[8:11], v210 offset:4096
    v_mfma_f32_16x16x32_bf16 v[84:87], a[100:103], v[20:23], v[84:87]
    buffer_load_dwordx4 v[8:11], v213, s[48:51], s78 offen sc1
    v_mfma_f32_16x16x32_bf16 v[88:91], a[104:107], v[20:23], v[88:91]
    v_mfma_f32_16x16x32_bf16 v[88:91], a[84:87], v[16:19], v[88:91]
    ds_write_b128 v204, v[80:83] offset:45056
    v_mfma_f32_16x16x32_bf16 v[92:95], a[88:91], v[16:19], v[92:95]
    v_mfma_f32_16x16x32_bf16 v[92:95], a[108:111], v[20:23], v[92:95]
    s_add_u32 s78, s78, s77
    ds_read_b128 a[12:15], v210 offset:6144
    v_mfma_f32_16x16x32_bf16 v[96:99], a[112:115], v[20:23], v[96:99]
    buffer_load_dwordx4 v[12:15], v213, s[48:51], s78 offen sc1
    v_mfma_f32_16x16x32_bf16 v[96:99], a[92:95], v[16:19], v[96:99]
    s_add_u32 s78, s78, s77
    v_mfma_f32_16x16x32_bf16 v[100:103], a[96:99], v[16:19], v[100:103]
    s_waitcnt vmcnt(14)
    v_lshlrev_b32 v236, 16, v48
    v_and_b32 v237, s70, v48
    v_mfma_f32_16x16x32_bf16 v[100:103], a[116:119], v[20:23], v[100:103]
    s_waitcnt lgkmcnt(1)
    s_barrier
    s_waitcnt vmcnt(13)
    v_mfma_f32_16x16x32_bf16 v[84:87], a[120:123], v[24:27], v[84:87]
    s_waitcnt vmcnt(11)
    ds_read_b128 v[104:107], v212 offset:40960
    v_lshlrev_b32 v238, 16, v49
    v_mfma_f32_16x16x32_bf16 v[84:87], a[140:143], v[28:31], v[84:87]
    buffer_load_dwordx4 v[16:19], v213, s[48:51], s78 offen sc1
    v_mfma_f32_16x16x32_bf16 v[88:91], a[144:147], v[28:31], v[88:91]
    ds_read_b128 v[108:111], v214 offset:40960
    v_and_b32 v239, s70, v49
    v_mfma_f32_16x16x32_bf16 v[88:91], a[124:127], v[24:27], v[88:91]
    ds_read_b128 v[112:115], v212 offset:43008
    v_fma_f32 v236, v236, v59, -v58
    v_mfma_f32_16x16x32_bf16 v[92:95], a[128:131], v[24:27], v[92:95]
    ds_read_b128 v[116:119], v214 offset:43008
    v_fma_f32 v237, v237, v59, -v58
    v_mfma_f32_16x16x32_bf16 v[92:95], a[148:151], v[28:31], v[92:95]
    s_add_u32 s78, s78, s77
    ds_read_b128 v[120:123], v206 offset:40960
    v_fma_f32 v238, v238, v59, -v58
    v_mfma_f32_16x16x32_bf16 v[96:99], a[152:155], v[28:31], v[96:99]
    buffer_load_dwordx4 v[20:23], v213, s[48:51], s78 offen sc1
    v_mfma_f32_16x16x32_bf16 v[96:99], a[132:135], v[24:27], v[96:99]
    v_add_u32 v212, s91, v212
    v_add_u32 v214, s91, v214
    v_mfma_f32_16x16x32_bf16 v[100:103], a[136:139], v[24:27], v[100:103]
    s_add_u32 s78, s78, s77
    v_add_u32 v206, s91, v206
    v_fma_f32 v239, v239, v59, -v58
    v_mfma_f32_16x16x32_bf16 v[100:103], a[156:159], v[28:31], v[100:103]
    s_waitcnt vmcnt(11)
    ds_read_b128 a[16:19], v210 offset:8192
    v_mul_f32 v124, v124, v236
    v_mfma_f32_16x16x32_bf16 v[84:87], a[160:163], v[32:35], v[84:87]
    s_waitcnt vmcnt(9)
    ds_read_b128 a[20:23], v211 offset:0
    v_mul_f32 v125, v125, v237
    v_mfma_f32_16x16x32_bf16 v[84:87], a[180:183], v[36:39], v[84:87]
    buffer_load_dwordx4 v[24:27], v213, s[48:51], s78 offen sc1
    v_mfma_f32_16x16x32_bf16 v[88:91], a[184:187], v[36:39], v[88:91]
    ds_read_b128 a[24:27], v211 offset:2048
    v_mul_f32 v126, v126, v238
    v_mfma_f32_16x16x32_bf16 v[88:91], a[164:167], v[32:35], v[88:91]
    ds_read_b128 a[28:31], v211 offset:4096
    v_mul_f32 v127, v127, v239
    v_mfma_f32_16x16x32_bf16 v[92:95], a[168:171], v[32:35], v[92:95]
    ds_read_b128 a[32:35], v211 offset:6144
    v_lshlrev_b32 v236, 16, v50
    v_mfma_f32_16x16x32_bf16 v[92:95], a[188:191], v[36:39], v[92:95]
    s_add_u32 s78, s78, s77
    ds_read_b128 a[36:39], v211 offset:8192
    v_and_b32 v237, s70, v50
    v_mfma_f32_16x16x32_bf16 v[96:99], a[192:195], v[36:39], v[96:99]
    buffer_load_dwordx4 v[28:31], v213, s[48:51], s78 offen sc1
    v_mfma_f32_16x16x32_bf16 v[96:99], a[172:175], v[32:35], v[96:99]
    ds_read_b128 a[40:43], v210 offset:40960
    v_lshlrev_b32 v238, 16, v51
    v_mfma_f32_16x16x32_bf16 v[100:103], a[176:179], v[32:35], v[100:103]
    s_add_u32 s78, s78, s77
    ds_read_b128 a[44:47], v210 offset:43008
    v_and_b32 v239, s70, v51
    v_mfma_f32_16x16x32_bf16 v[100:103], a[196:199], v[36:39], v[100:103]
    s_waitcnt vmcnt(9)
    ds_read_b128 a[48:51], v210 offset:45056
    v_fma_f32 v236, v236, v61, -v60
    v_mfma_f32_16x16x32_bf16 v[84:87], a[200:203], v[40:43], v[84:87]
    s_waitcnt vmcnt(8)
    ds_read_b128 a[52:55], v210 offset:47104
    v_fma_f32 v237, v237, v61, -v60
    v_mfma_f32_16x16x32_bf16 v[84:87], a[220:223], v[44:47], v[84:87]
    buffer_load_dwordx4 v[32:35], v213, s[48:51], s78 offen sc1
    v_mfma_f32_16x16x32_bf16 v[88:91], a[224:227], v[44:47], v[88:91]
    ds_read_b128 a[56:59], v210 offset:49152
    v_fma_f32 v238, v238, v61, -v60
    v_mfma_f32_16x16x32_bf16 v[88:91], a[204:207], v[40:43], v[88:91]
    ds_read_b128 a[60:63], v211 offset:40960
    v_fma_f32 v239, v239, v61, -v60
    v_mfma_f32_16x16x32_bf16 v[92:95], a[208:211], v[40:43], v[92:95]
    ds_read_b128 a[64:67], v211 offset:43008
    v_mul_f32 v128, v128, v236
    v_mfma_f32_16x16x32_bf16 v[92:95], a[228:231], v[44:47], v[92:95]
    s_add_u32 s78, s78, s77
    ds_read_b128 a[68:71], v211 offset:45056
    v_mul_f32 v129, v129, v237
    v_mfma_f32_16x16x32_bf16 v[96:99], a[232:235], v[44:47], v[96:99]
    buffer_load_dwordx4 v[36:39], v213, s[48:51], s78 offen sc1
    v_mfma_f32_16x16x32_bf16 v[96:99], a[212:215], v[40:43], v[96:99]
    ds_read_b128 a[72:75], v211 offset:47104
    v_mul_f32 v130, v130, v238
    v_mfma_f32_16x16x32_bf16 v[100:103], a[216:219], v[40:43], v[100:103]
    ds_read_b128 a[76:79], v211 offset:49152
    v_mul_f32 v131, v131, v239
    v_mfma_f32_16x16x32_bf16 v[100:103], a[236:239], v[44:47], v[100:103]
    s_add_u32 s78, s87, s90
    s_waitcnt vmcnt(9)
    ds_read_b128 a[80:83], v249 offset:0
    v_mfma_f32_16x16x32_bf16 a[120:123], v[144:147], v[0:3], 0
    s_waitcnt vmcnt(8)
    ds_read_b128 a[84:87], v249 offset:2048
    v_lshlrev_b32 v236, 16, v52
    v_mfma_f32_16x16x32_bf16 a[120:123], v[164:167], v[4:7], a[120:123]
    buffer_load_dwordx4 v[40:43], v213, s[48:51], s78 offen sc1
    v_mfma_f32_16x16x32_bf16 a[124:127], v[168:171], v[4:7], 0
    ds_read_b128 a[88:91], v249 offset:4096
    v_and_b32 v237, s70, v52
    v_mfma_f32_16x16x32_bf16 a[124:127], v[148:151], v[0:3], a[124:127]
    ds_read_b128 a[92:95], v249 offset:6144
L_padS6:
    s_cbranch_execz L_retS
    v_lshlrev_b32 v238, 16, v53
    v_mfma_f32_16x16x32_bf16 a[128:131], v[152:155], v[0:3], 0
    ds_read_b128 a[96:99], v249 offset:8192
    v_and_b32 v239, s70, v53
    v_mfma_f32_16x16x32_bf16 a[128:131], v[172:175], v[4:7], a[128:131]
    s_add_u32 s78, s78, s77
    ds_read_b128 a[100:103], v241 offset:0
    v_fma_f32 v236, v236, v59, -v58
    v_mfma_f32_16x16x32_bf16 a[132:135], v[176:179], v[4:7], 0
    buffer_load_dwordx4 v[44:47], v213, s[48:51], s78 offen sc1
    v_mfma_f32_16x16x32_bf16 a[132:135], v[156:159], v[0:3], a[132:135]
    ds_read_b128 a[104:107], v241 offset:2048
    v_fma_f32 v237, v237, v59, -v58
    v_mfma_f32_16x16x32_bf16 a[136:139], v[160:163], v[0:3], 0
    s_add_u32 s78, s78, s77
    ds_read_b128 a[108:111], v241 offset:4096
    v_fma_f32 v238, v238, v59, -v58
    v_mfma_f32_16x16x32_bf16 a[136:139], v[180:183], v[4:7], a[136:139]
    s_waitcnt vmcnt(9)
    ds_read_b128 a[112:115], v241 offset:6144
    v_fma_f32 v239, v239, v59, -v58
    v_mfma_f32_16x16x32_bf16 a[120:123], v[184:187], v[8:11], a[120:123]
    s_waitcnt vmcnt(8)
    ds_read_b128 a[116:119], v241 offset:8192
    v_mul_f32 v132, v132, v236
    v_mfma_f32_16x16x32_bf16 a[120:123], v[216:219], v[12:15], a[120:123]
    buffer_load_dwordx4 v[0:3], v213, s[48:51], s78 offen sc1
    v_mfma_f32_16x16x32_bf16 a[124:127], v[220:223], v[12:15], a[124:127]
    v_mul_f32 v133, v133, v237
    v_mul_f32 v134, v134, v238
    v_mfma_f32_16x16x32_bf16 a[124:127], v[188:191], v[8:11], a[124:127]
    ds_write_b128 v204, v[84:87] offset:46080
    v_mfma_f32_16x16x32_bf16 a[128:131], v[192:195], v[8:11], a[128:131]
    v_add_u32 v205, 40960, v205
    v_mul_f32 v135, v135, v239
    v_mfma_f32_16x16x32_bf16 a[128:131], v[224:227], v[12:15], a[128:131]
    s_add_u32 s78, s78, s77
    v_lshlrev_b32 v236, 16, v54
    v_and_b32 v237, s70, v54
    v_mfma_f32_16x16x32_bf16 a[132:135], v[228:231], v[12:15], a[132:135]
    buffer_load_dwordx4 v[4:7], v213, s[48:51], s78 offen sc1
    v_mfma_f32_16x16x32_bf16 a[132:135], v[196:199], v[8:11], a[132:135]
    v_lshlrev_b32 v238, 16, v55
    v_and_b32 v239, s70, v55
    v_mfma_f32_16x16x32_bf16 a[136:139], v[200:203], v[8:11], a[136:139]
    s_add_u32 s78, s78, s77
    ds_write_b128 v204, v[88:91] offset:47104
    v_mfma_f32_16x16x32_bf16 a[136:139], v[232:235], v[12:15], a[136:139]
    s_waitcnt vmcnt(9)
    v_fma_f32 v236, v236, v61, -v60
    v_fma_f32 v237, v237, v61, -v60
    v_mfma_f32_16x16x32_bf16 a[120:123], a[0:3], v[16:19], a[120:123]
    s_waitcnt vmcnt(8) lgkmcnt(15)
    v_fma_f32 v238, v238, v61, -v60
    v_fma_f32 v239, v239, v61, -v60
    v_mfma_f32_16x16x32_bf16 a[120:123], a[20:23], v[20:23], a[120:123]
    s_waitcnt lgkmcnt(15)
    buffer_load_dwordx4 v[8:11], v213, s[48:51], s78 offen sc1
    v_mfma_f32_16x16x32_bf16 a[124:127], a[24:27], v[20:23], a[124:127]
    v_mul_f32 v136, v136, v236
    v_mul_f32 v137, v137, v237
    v_mfma_f32_16x16x32_bf16 a[124:127], a[4:7], v[16:19], a[124:127]
    s_add_u32 s78, s78, s77
    ds_write_b128 v204, v[92:95] offset:48128
    v_mfma_f32_16x16x32_bf16 a[128:131], a[8:11], v[16:19], a[128:131]
    s_waitcnt lgkmcnt(15)
    v_mul_f32 v138, v138, v238
    v_mul_f32 v139, v139, v239
    v_mfma_f32_16x16x32_bf16 a[128:131], a[28:31], v[20:23], a[128:131]
    s_waitcnt lgkmcnt(14)
    ds_read_b128 v[64:67], v212 offset:46080
    v_lshlrev_b32 v236, 16, v56
    v_mfma_f32_16x16x32_bf16 a[132:135], a[32:35], v[20:23], a[132:135]
    buffer_load_dwordx4 v[12:15], v213, s[48:51], s78 offen sc1
    v_mfma_f32_16x16x32_bf16 a[132:135], a[12:15], v[16:19], a[132:135]
    s_add_u32 s78, s78, s77
    ds_read_b128 v[68:71], v214 offset:46080
    v_and_b32 v237, s70, v56
    v_mfma_f32_16x16x32_bf16 a[136:139], a[16:19], v[16:19], a[136:139]
    s_waitcnt lgkmcnt(14)
    ds_write_b128 v204, v[96:99] offset:49152
    v_mfma_f32_16x16x32_bf16 a[136:139], a[36:39], v[20:23], a[136:139]
    s_waitcnt vmcnt(9) lgkmcnt(15)
    v_lshlrev_b32 v238, 16, v57
    v_and_b32 v239, s70, v57
    v_mfma_f32_16x16x32_bf16 a[120:123], a[40:43], v[24:27], a[120:123]
    s_waitcnt vmcnt(8) lgkmcnt(15)
    v_fma_f32 v236, v236, v246, -v245
    v_fma_f32 v237, v237, v246, -v245
    v_mfma_f32_16x16x32_bf16 a[120:123], a[60:63], v[28:31], a[120:123]
    s_waitcnt lgkmcnt(15)
    buffer_load_dwordx4 v[16:19], v213, s[48:51], s78 offen sc1
    v_mfma_f32_16x16x32_bf16 a[124:127], a[64:67], v[28:31], a[124:127]
    s_waitcnt lgkmcnt(2)
    v_add_f32 v104, v104, v64
    v_add_f32 v105, v105, v65
    v_mfma_f32_16x16x32_bf16 a[124:127], a[44:47], v[24:27], a[124:127]
    ds_write_b128 v204, v[100:103] offset:50176
    v_mfma_f32_16x16x32_bf16 a[128:131], a[48:51], v[24:27], a[128:131]
    s_add_u32 s78, s78, s77
    v_add_f32 v106, v106, v66
    v_add_f32 v107, v107, v67
    v_mfma_f32_16x16x32_bf16 a[128:131], a[68:71], v[28:31], a[128:131]
    s_waitcnt lgkmcnt(2)
    ds_read_b128 v[72:75], v212 offset:48128
    v_add_f32 v108, v108, v68
    v_mfma_f32_16x16x32_bf16 a[132:135], a[72:75], v[28:31], a[132:135]
    buffer_load_dwordx4 v[20:23], v213, s[48:51], s78 offen sc1
    v_mfma_f32_16x16x32_bf16 a[132:135], a[52:55], v[24:27], a[132:135]
    ds_read_b128 v[76:79], v214 offset:48128
    v_add_f32 v109, v109, v69
    v_mfma_f32_16x16x32_bf16 a[136:139], a[56:59], v[24:27], a[136:139]
    s_add_u32 s78, s78, s77
    v_add_f32 v110, v110, v70
    v_add_f32 v111, v111, v71
    v_mfma_f32_16x16x32_bf16 a[136:139], a[76:79], v[28:31], a[136:139]
    s_waitcnt vmcnt(9)
    ds_read_b128 v[80:83], v206 offset:46080
    v_fma_f32 v238, v238, v246, -v245
    v_mfma_f32_16x16x32_bf16 a[120:123], a[80:83], v[32:35], a[120:123]
    s_waitcnt vmcnt(8)
    v_add_u32 v204, 40960, v204
    v_add_u32 v212, s83, v212
    v_mfma_f32_16x16x32_bf16 a[120:123], a[100:103], v[36:39], a[120:123]
    buffer_load_dwordx4 v[24:27], v213, s[48:51], s78 offen sc1
    v_mfma_f32_16x16x32_bf16 a[124:127], a[104:107], v[36:39], a[124:127]
    v_add_u32 v214, s83, v214
    v_add_u32 v206, s83, v206
    v_mfma_f32_16x16x32_bf16 a[124:127], a[84:87], v[32:35], a[124:127]
    s_waitcnt lgkmcnt(2)
    v_add_f32 v112, v112, v72
    v_add_f32 v113, v113, v73
    v_mfma_f32_16x16x32_bf16 a[128:131], a[88:91], v[32:35], a[128:131]
    s_add_u32 s78, s78, s77
    v_add_f32 v114, v114, v74
    v_add_f32 v115, v115, v75
    v_mfma_f32_16x16x32_bf16 a[128:131], a[108:111], v[36:39], a[128:131]
    s_waitcnt lgkmcnt(1)
    v_add_f32 v116, v116, v76
    v_add_f32 v117, v117, v77
    v_mfma_f32_16x16x32_bf16 a[132:135], a[112:115], v[36:39], a[132:135]
    buffer_load_dwordx4 v[28:31], v213, s[48:51], s78 offen sc1
    v_mfma_f32_16x16x32_bf16 a[132:135], a[92:95], v[32:35], a[132:135]
    s_add_u32 s78, s88, s90
    v_add_f32 v118, v118, v78
    v_add_f32 v119, v119, v79
    v_mfma_f32_16x16x32_bf16 a[136:139], a[96:99], v[32:35], a[136:139]
    s_waitcnt lgkmcnt(0)
    v_add_f32 v120, v120, v80
    v_add_f32 v121, v121, v81
    v_mfma_f32_16x16x32_bf16 a[136:139], a[116:119], v[36:39], a[136:139]
    s_waitcnt vmcnt(9)
    v_add_f32 v122, v122, v82
    v_add_f32 v123, v123, v83
    v_mfma_f32_16x16x32_bf16 a[140:143], v[144:147], v[40:43], 0
    s_waitcnt vmcnt(8)
    v_exp_f32 v64, -v104
    v_mfma_f32_16x16x32_bf16 a[140:143], v[164:167], v[44:47], a[140:143]
    buffer_load_dwordx4 v[32:35], v213, s[48:51], s78 offen sc1
    v_mfma_f32_16x16x32_bf16 a[144:147], v[168:171], v[44:47], 0
    v_exp_f32 v65, -v105
    v_mfma_f32_16x16x32_bf16 a[144:147], v[148:151], v[40:43], a[144:147]
    ds_write_b128 v204, a[120:123] offset:40960
    v_mfma_f32_16x16x32_bf16 a[148:151], v[152:155], v[40:43], 0
    v_exp_f32 v66, -v106
    v_mfma_f32_16x16x32_bf16 a[148:151], v[172:175], v[44:47], a[148:151]
    s_add_u32 s78, s78, s77
    v_exp_f32 v67, -v107
    v_mfma_f32_16x16x32_bf16 a[152:155], v[176:179], v[44:47], 0
    buffer_load_dwordx4 v[36:39], v213, s[48:51], s78 offen sc1
    v_mfma_f32_16x16x32_bf16 a[152:155], v[156:159], v[40:43], a[152:155]
    v_exp_f32 v68, -v108
    v_mfma_f32_16x16x32_bf16 a[156:159], v[160:163], v[40:43], 0
    s_add_u32 s78, s78, s77
    ds_write_b128 v204, a[124:127] offset:41984
    v_mfma_f32_16x16x32_bf16 a[156:159], v[180:183], v[44:47], a[156:159]
    s_waitcnt vmcnt(9)
    v_exp_f32 v69, -v109
    v_mfma_f32_16x16x32_bf16 a[140:143], v[184:187], v[0:3], a[140:143]
    s_waitcnt vmcnt(8)
    v_exp_f32 v70, -v110
    v_mfma_f32_16x16x32_bf16 a[140:143], v[216:219], v[4:7], a[140:143]
    buffer_load_dwordx4 v[40:43], v213, s[48:51], s78 offen sc1
    v_mfma_f32_16x16x32_bf16 a[144:147], v[220:223], v[4:7], a[144:147]
    v_exp_f32 v71, -v111
    v_mfma_f32_16x16x32_bf16 a[144:147], v[188:191], v[0:3], a[144:147]
    ds_write_b128 v204, a[128:131] offset:43008
    v_mfma_f32_16x16x32_bf16 a[148:151], v[192:195], v[0:3], a[148:151]
    v_add_f32 v64, 1.0, v64
    v_add_f32 v65, 1.0, v65
    v_mfma_f32_16x16x32_bf16 a[148:151], v[224:227], v[4:7], a[148:151]
    s_add_u32 s78, s78, s77
    v_rcp_f32 v64, v64
    v_mfma_f32_16x16x32_bf16 a[152:155], v[228:231], v[4:7], a[152:155]
    buffer_load_dwordx4 v[44:47], v213, s[48:51], s78 offen sc1
    v_mfma_f32_16x16x32_bf16 a[152:155], v[196:199], v[0:3], a[152:155]
    v_rcp_f32 v65, v65
    v_mfma_f32_16x16x32_bf16 a[156:159], v[200:203], v[0:3], a[156:159]
    s_add_u32 s78, s78, s77
    ds_write_b128 v204, a[132:135] offset:44032
    v_mfma_f32_16x16x32_bf16 a[156:159], v[232:235], v[4:7], a[156:159]
    s_waitcnt vmcnt(9)
    v_mul_f32 v64, v104, v64
    v_mul_f32 v65, v105, v65
    v_mfma_f32_16x16x32_bf16 a[140:143], a[0:3], v[8:11], a[140:143]
    s_waitcnt vmcnt(8)
    v_exp_f32 v72, -v112
    v_mfma_f32_16x16x32_bf16 a[140:143], a[20:23], v[12:15], a[140:143]
    buffer_load_dwordx4 v[0:3], v213, s[48:51], s78 offen sc1
    v_mfma_f32_16x16x32_bf16 a[144:147], a[24:27], v[12:15], a[144:147]
    v_exp_f32 v73, -v113
    v_mfma_f32_16x16x32_bf16 a[144:147], a[4:7], v[8:11], a[144:147]
    ds_write_b128 v204, a[136:139] offset:45056
    v_mfma_f32_16x16x32_bf16 a[148:151], a[8:11], v[8:11], a[148:151]
    v_add_f32 v66, 1.0, v66
    v_add_f32 v67, 1.0, v67
    v_mfma_f32_16x16x32_bf16 a[148:151], a[28:31], v[12:15], a[148:151]
    s_add_u32 s78, s78, s77
    v_rcp_f32 v66, v66
    v_mfma_f32_16x16x32_bf16 a[152:155], a[32:35], v[12:15], a[152:155]
    buffer_load_dwordx4 v[4:7], v213, s[48:51], s78 offen sc1
    v_mfma_f32_16x16x32_bf16 a[152:155], a[12:15], v[8:11], a[152:155]
    v_rcp_f32 v67, v67
    v_mfma_f32_16x16x32_bf16 a[156:159], a[16:19], v[8:11], a[156:159]
    s_add_u32 s78, s78, s77
    v_mul_f32 v66, v106, v66
    v_mul_f32 v67, v107, v67
    v_mfma_f32_16x16x32_bf16 a[156:159], a[36:39], v[12:15], a[156:159]
    s_waitcnt lgkmcnt(0)
    s_barrier
    s_waitcnt vmcnt(9)
    v_mfma_f32_16x16x32_bf16 a[140:143], a[40:43], v[16:19], a[140:143]
    s_waitcnt vmcnt(8)
    ds_read_b128 a[120:123], v205 offset:40960
    v_add_f32 v68, 1.0, v68
    v_mfma_f32_16x16x32_bf16 a[140:143], a[60:63], v[20:23], a[140:143]
    buffer_load_dwordx4 v[8:11], v213, s[48:51], s78 offen sc1
    v_mfma_f32_16x16x32_bf16 a[144:147], a[64:67], v[20:23], a[144:147]
    ds_read_b128 a[124:127], v205 offset:41984
    v_add_f32 v69, 1.0, v69
    v_mfma_f32_16x16x32_bf16 a[144:147], a[44:47], v[16:19], a[144:147]
    ds_read_b128 a[128:131], v205 offset:43008
    v_add_f32 v70, 1.0, v70
    v_mfma_f32_16x16x32_bf16 a[148:151], a[48:51], v[16:19], a[148:151]
    ds_read_b128 a[132:135], v205 offset:44032
    v_add_f32 v71, 1.0, v71
    v_mfma_f32_16x16x32_bf16 a[148:151], a[68:71], v[20:23], a[148:151]
    s_add_u32 s78, s78, s77
    ds_read_b128 a[136:139], v205 offset:45056
    v_add_f32 v72, 1.0, v72
    v_mfma_f32_16x16x32_bf16 a[152:155], a[72:75], v[20:23], a[152:155]
    buffer_load_dwordx4 v[12:15], v213, s[48:51], s78 offen sc1
    v_mfma_f32_16x16x32_bf16 a[152:155], a[52:55], v[16:19], a[152:155]
    v_rcp_f32 v68, v68
    v_mfma_f32_16x16x32_bf16 a[156:159], a[56:59], v[16:19], a[156:159]
    s_add_u32 s78, s78, s77
    v_rcp_f32 v69, v69
    v_mfma_f32_16x16x32_bf16 a[156:159], a[76:79], v[20:23], a[156:159]
    s_waitcnt vmcnt(9)
    v_rcp_f32 v70, v70
    v_mfma_f32_16x16x32_bf16 a[140:143], a[80:83], v[24:27], a[140:143]
    s_waitcnt vmcnt(8)
    v_rcp_f32 v71, v71
    v_mfma_f32_16x16x32_bf16 a[140:143], a[100:103], v[28:31], a[140:143]
    buffer_load_dwordx4 v[16:19], v213, s[48:51], s78 offen sc1
    v_mfma_f32_16x16x32_bf16 a[144:147], a[104:107], v[28:31], a[144:147]
    v_rcp_f32 v72, v72
    v_mfma_f32_16x16x32_bf16 a[144:147], a[84:87], v[24:27], a[144:147]
    v_exp_f32 v74, -v114
    v_mfma_f32_16x16x32_bf16 a[148:151], a[88:91], v[24:27], a[148:151]
    v_exp_f32 v75, -v115
    v_mfma_f32_16x16x32_bf16 a[148:151], a[108:111], v[28:31], a[148:151]
    s_add_u32 s78, s78, s77
    v_mul_f32 v68, v108, v68
    v_mul_f32 v69, v109, v69
    v_mfma_f32_16x16x32_bf16 a[152:155], a[112:115], v[28:31], a[152:155]
    buffer_load_dwordx4 v[20:23], v213, s[48:51], s78 offen sc1
    v_mfma_f32_16x16x32_bf16 a[152:155], a[92:95], v[24:27], a[152:155]
    s_waitcnt lgkmcnt(0)
    v_exp_f32 v76, -v116
    v_mfma_f32_16x16x32_bf16 a[156:159], a[96:99], v[24:27], a[156:159]
    s_add_u32 s78, s89, s90
    v_exp_f32 v77, -v117
    v_mfma_f32_16x16x32_bf16 a[156:159], a[116:119], v[28:31], a[156:159]
    s_waitcnt vmcnt(9)
    v_mul_f32 v70, v110, v70
    v_mul_f32 v71, v111, v71
    v_mfma_f32_16x16x32_bf16 a[120:123], v[144:147], v[32:35], a[120:123]
    s_waitcnt vmcnt(8)
    v_exp_f32 v78, -v118
    v_mfma_f32_16x16x32_bf16 a[120:123], v[164:167], v[36:39], a[120:123]
    buffer_load_dwordx4 v[24:27], v213, s[48:51], s78 offen sc1
    v_mfma_f32_16x16x32_bf16 a[124:127], v[168:171], v[36:39], a[124:127]
    v_exp_f32 v79, -v119
    v_mfma_f32_16x16x32_bf16 a[124:127], v[148:151], v[32:35], a[124:127]
    ds_write_b128 v204, a[140:143] offset:46080
    v_mfma_f32_16x16x32_bf16 a[128:131], v[152:155], v[32:35], a[128:131]
    v_mul_f32 v72, v112, v72
    v_add_f32 v73, 1.0, v73
    v_mfma_f32_16x16x32_bf16 a[128:131], v[172:175], v[36:39], a[128:131]
    s_add_u32 s78, s78, s77
    v_rcp_f32 v73, v73
    v_mfma_f32_16x16x32_bf16 a[132:135], v[176:179], v[36:39], a[132:135]
    buffer_load_dwordx4 v[28:31], v213, s[48:51], s78 offen sc1
    v_mfma_f32_16x16x32_bf16 a[132:135], v[156:159], v[32:35], a[132:135]
    v_exp_f32 v80, -v120
    v_mfma_f32_16x16x32_bf16 a[136:139], v[160:163], v[32:35], a[136:139]
    s_add_u32 s78, s78, s77
    ds_write_b128 v204, a[144:147] offset:47104
    v_mfma_f32_16x16x32_bf16 a[136:139], v[180:183], v[36:39], a[136:139]
    s_waitcnt vmcnt(9)
    v_mul_f32 v73, v113, v73
    v_add_f32 v74, 1.0, v74
    v_mfma_f32_16x16x32_bf16 a[120:123], v[184:187], v[40:43], a[120:123]
    s_waitcnt vmcnt(8)
    v_rcp_f32 v74, v74
    v_mfma_f32_16x16x32_bf16 a[120:123], v[216:219], v[44:47], a[120:123]
    buffer_load_dwordx4 v[32:35], v213, s[48:51], s78 offen sc1
    v_mfma_f32_16x16x32_bf16 a[124:127], v[220:223], v[44:47], a[124:127]
    v_exp_f32 v81, -v121
    v_mfma_f32_16x16x32_bf16 a[124:127], v[188:191], v[40:43], a[124:127]
    ds_write_b128 v204, a[148:151] offset:48128
    v_mfma_f32_16x16x32_bf16 a[128:131], v[192:195], v[40:43], a[128:131]
    v_mul_f32 v74, v114, v74
    v_add_f32 v75, 1.0, v75
    v_mfma_f32_16x16x32_bf16 a[128:131], v[224:227], v[44:47], a[128:131]
    s_add_u32 s78, s78, s77
    v_rcp_f32 v75, v75
    v_mfma_f32_16x16x32_bf16 a[132:135], v[228:231], v[44:47], a[132:135]
    buffer_load_dwordx4 v[36:39], v213, s[48:51], s78 offen sc1
    v_mfma_f32_16x16x32_bf16 a[132:135], v[196:199], v[40:43], a[132:135]
    v_exp_f32 v82, -v122
    v_mfma_f32_16x16x32_bf16 a[136:139], v[200:203], v[40:43], a[136:139]
    s_add_u32 s78, s78, s77
    ds_write_b128 v204, a[152:155] offset:49152
    v_mfma_f32_16x16x32_bf16 a[136:139], v[232:235], v[44:47], a[136:139]
    s_waitcnt vmcnt(9)
    v_mul_f32 v75, v115, v75
    v_add_f32 v76, 1.0, v76
    v_mfma_f32_16x16x32_bf16 a[120:123], a[0:3], v[0:3], a[120:123]
    s_waitcnt vmcnt(8)
    v_rcp_f32 v76, v76
    v_mfma_f32_16x16x32_bf16 a[120:123], a[20:23], v[4:7], a[120:123]
    buffer_load_dwordx4 v[40:43], v213, s[48:51], s78 offen sc1
    v_mfma_f32_16x16x32_bf16 a[124:127], a[24:27], v[4:7], a[124:127]
    v_exp_f32 v83, -v123
    v_mfma_f32_16x16x32_bf16 a[124:127], a[4:7], v[0:3], a[124:127]
    ds_write_b128 v204, a[156:159] offset:50176
    v_mfma_f32_16x16x32_bf16 a[128:131], a[8:11], v[0:3], a[128:131]
    v_mul_f32 v76, v116, v76
    v_add_f32 v77, 1.0, v77
    v_mfma_f32_16x16x32_bf16 a[128:131], a[28:31], v[4:7], a[128:131]
    s_add_u32 s78, s78, s77
    v_rcp_f32 v77, v77
    v_mfma_f32_16x16x32_bf16 a[132:135], a[32:35], v[4:7], a[132:135]
    buffer_load_dwordx4 v[44:47], v213, s[48:51], s78 offen sc1
    v_mfma_f32_16x16x32_bf16 a[132:135], a[12:15], v[0:3], a[132:135]
    v_mul_f32 v77, v117, v77
    v_add_f32 v78, 1.0, v78
    v_mfma_f32_16x16x32_bf16 a[136:139], a[16:19], v[0:3], a[136:139]
    s_add_u32 s78, s78, s77
    v_rcp_f32 v78, v78
    v_mfma_f32_16x16x32_bf16 a[136:139], a[36:39], v[4:7], a[136:139]
    s_waitcnt lgkmcnt(0)
    s_barrier
    s_waitcnt vmcnt(9)
    v_mfma_f32_16x16x32_bf16 a[120:123], a[40:43], v[8:11], a[120:123]
    s_waitcnt vmcnt(8)
    ds_read_b128 a[140:143], v205 offset:46080
    v_mul_f32 v78, v118, v78
    v_mfma_f32_16x16x32_bf16 a[120:123], a[60:63], v[12:15], a[120:123]
    buffer_load_dwordx4 v[0:3], v213, s[48:51], s78 offen sc1
    v_mfma_f32_16x16x32_bf16 a[124:127], a[64:67], v[12:15], a[124:127]
    ds_read_b128 a[144:147], v205 offset:47104
    v_add_f32 v79, 1.0, v79
    v_mfma_f32_16x16x32_bf16 a[124:127], a[44:47], v[8:11], a[124:127]
    ds_read_b128 a[148:151], v205 offset:48128
    v_add_f32 v80, 1.0, v80
    v_mfma_f32_16x16x32_bf16 a[128:131], a[48:51], v[8:11], a[128:131]
    ds_read_b128 a[152:155], v205 offset:49152
    v_add_f32 v81, 1.0, v81
    v_mfma_f32_16x16x32_bf16 a[128:131], a[68:71], v[12:15], a[128:131]
    s_add_u32 s78, s78, s77
    ds_read_b128 a[156:159], v205 offset:50176
    v_add_f32 v82, 1.0, v82
    v_mfma_f32_16x16x32_bf16 a[132:135], a[72:75], v[12:15], a[132:135]
    buffer_load_dwordx4 v[4:7], v213, s[48:51], s78 offen sc1
    v_mfma_f32_16x16x32_bf16 a[132:135], a[52:55], v[8:11], a[132:135]
    v_rcp_f32 v79, v79
    v_mfma_f32_16x16x32_bf16 a[136:139], a[56:59], v[8:11], a[136:139]
    s_add_u32 s78, s78, s77
    v_rcp_f32 v80, v80
    v_mfma_f32_16x16x32_bf16 a[136:139], a[76:79], v[12:15], a[136:139]
    s_waitcnt vmcnt(9)
    v_rcp_f32 v81, v81
    v_mfma_f32_16x16x32_bf16 a[120:123], a[80:83], v[16:19], a[120:123]
    s_waitcnt vmcnt(8)
    v_rcp_f32 v82, v82
    v_mfma_f32_16x16x32_bf16 a[120:123], a[100:103], v[20:23], a[120:123]
    buffer_load_dwordx4 v[8:11], v213, s[48:51], s78 offen sc1
    v_mfma_f32_16x16x32_bf16 a[124:127], a[104:107], v[20:23], a[124:127]
    v_mul_f32 v79, v119, v79
    v_mul_f32 v80, v120, v80
    v_mfma_f32_16x16x32_bf16 a[124:127], a[84:87], v[16:19], a[124:127]
    v_mul_f32 v81, v121, v81
    v_mul_f32 v82, v122, v82
    v_mfma_f32_16x16x32_bf16 a[128:131], a[88:91], v[16:19], a[128:131]
    v_add_f32 v83, 1.0, v83
    v_fma_f32 v239, v239, v246, -v245
    v_mfma_f32_16x16x32_bf16 a[128:131], a[108:111], v[20:23], a[128:131]
    s_add_u32 s78, s78, s77
    v_rcp_f32 v83, v83
    v_mfma_f32_16x16x32_bf16 a[132:135], a[112:115], v[20:23], a[132:135]
    buffer_load_dwordx4 v[12:15], v213, s[48:51], s78 offen sc1
    v_mfma_f32_16x16x32_bf16 a[132:135], a[92:95], v[16:19], a[132:135]
    s_waitcnt lgkmcnt(0)
    v_mul_f32 v83, v123, v83
    v_mul_f32 v140, v140, v236
    v_mfma_f32_16x16x32_bf16 a[136:139], a[96:99], v[16:19], a[136:139]
    v_mul_f32 v141, v141, v237
    v_mul_f32 v142, v142, v238
    v_mfma_f32_16x16x32_bf16 a[136:139], a[116:119], v[20:23], a[136:139]
    s_waitcnt vmcnt(9)
    v_mul_f32 v143, v143, v239
    v_lshlrev_b32 v207, 1, v207
    v_mfma_f32_16x16x32_bf16 a[140:143], v[144:147], v[24:27], a[140:143]
    s_waitcnt vmcnt(8)
    v_lshlrev_b32 v240, 1, v240
    v_lshlrev_b32 v84, 16, v48
    v_mfma_f32_16x16x32_bf16 a[140:143], v[164:167], v[28:31], a[140:143]
    v_and_b32 v85, s70, v48
    v_lshlrev_b32 v86, 16, v49
    v_mfma_f32_16x16x32_bf16 a[144:147], v[168:171], v[28:31], a[144:147]
    ds_write_b128 v204, a[120:123] offset:40960
    v_mfma_f32_16x16x32_bf16 a[144:147], v[148:151], v[24:27], a[144:147]
    v_and_b32 v87, s70, v49
    v_lshlrev_b32 v88, 16, v50
    v_mfma_f32_16x16x32_bf16 a[148:151], v[152:155], v[24:27], a[148:151]
    v_and_b32 v89, s70, v50
    v_lshlrev_b32 v90, 16, v51
    v_mfma_f32_16x16x32_bf16 a[148:151], v[172:175], v[28:31], a[148:151]
    s_waitcnt vmcnt(7)
    ds_write_b128 v204, a[124:127] offset:41984
    v_mfma_f32_16x16x32_bf16 a[140:143], v[184:187], v[32:35], a[140:143]
    s_waitcnt vmcnt(6)
    v_and_b32 v91, s70, v51
    v_lshlrev_b32 v92, 16, v52
    v_mfma_f32_16x16x32_bf16 a[140:143], v[216:219], v[36:39], a[140:143]
    v_and_b32 v93, s70, v52
    v_lshlrev_b32 v94, 16, v53
    v_mfma_f32_16x16x32_bf16 a[144:147], v[220:223], v[36:39], a[144:147]
    ds_write_b128 v204, a[128:131] offset:43008
    v_mfma_f32_16x16x32_bf16 a[144:147], v[188:191], v[32:35], a[144:147]
    v_and_b32 v95, s70, v53
    v_lshlrev_b32 v96, 16, v54
    v_mfma_f32_16x16x32_bf16 a[148:151], v[192:195], v[32:35], a[148:151]
    v_and_b32 v97, s70, v54
    v_lshlrev_b32 v98, 16, v55
    v_mfma_f32_16x16x32_bf16 a[148:151], v[224:227], v[36:39], a[148:151]
    s_waitcnt vmcnt(5)
    ds_write_b128 v204, a[132:135] offset:44032
    v_mfma_f32_16x16x32_bf16 a[140:143], a[0:3], v[40:43], a[140:143]
    s_waitcnt vmcnt(4)
    v_and_b32 v99, s70, v55
    v_lshlrev_b32 v100, 16, v56
    v_mfma_f32_16x16x32_bf16 a[140:143], a[20:23], v[44:47], a[140:143]
    v_and_b32 v101, s70, v56
    v_lshlrev_b32 v102, 16, v57
    v_and_b32 v103, s70, v57
    v_mfma_f32_16x16x32_bf16 a[144:147], a[24:27], v[44:47], a[144:147]
    ds_write_b128 v204, a[136:139] offset:45056
    v_mfma_f32_16x16x32_bf16 a[144:147], a[4:7], v[40:43], a[144:147]
    v_fmac_f32 v84, v124, v64
    v_fmac_f32 v85, v125, v65
    v_mfma_f32_16x16x32_bf16 a[148:151], a[8:11], v[40:43], a[148:151]
    v_fmac_f32 v86, v126, v66
    v_fmac_f32 v87, v127, v67
    v_mfma_f32_16x16x32_bf16 a[148:151], a[28:31], v[44:47], a[148:151]
    s_waitcnt vmcnt(3)
    v_fmac_f32 v88, v128, v68
    v_fmac_f32 v89, v129, v69
    v_mfma_f32_16x16x32_bf16 a[140:143], a[40:43], v[0:3], a[140:143]
    s_waitcnt vmcnt(2)
    v_fmac_f32 v90, v130, v70
    v_fmac_f32 v91, v131, v71
    v_mfma_f32_16x16x32_bf16 a[140:143], a[60:63], v[4:7], a[140:143]
    s_waitcnt lgkmcnt(0)
    s_barrier
    v_mfma_f32_16x16x32_bf16 a[144:147], a[64:67], v[4:7], a[144:147]
    ds_read_b128 v[104:107], v212 offset:40960
    v_fmac_f32 v92, v132, v72
    v_mfma_f32_16x16x32_bf16 a[144:147], a[44:47], v[0:3], a[144:147]
    ds_read_b128 v[108:111], v214 offset:40960
    v_fmac_f32 v93, v133, v73
    v_mfma_f32_16x16x32_bf16 a[148:151], a[48:51], v[0:3], a[148:151]
    ds_read_b128 v[112:115], v212 offset:43008
    v_fmac_f32 v94, v134, v74
    v_mfma_f32_16x16x32_bf16 a[148:151], a[68:71], v[4:7], a[148:151]
    s_waitcnt vmcnt(1)
    ds_read_b128 v[116:119], v214 offset:43008
    v_fmac_f32 v95, v135, v75
    v_mfma_f32_16x16x32_bf16 a[140:143], a[80:83], v[8:11], a[140:143]
    s_waitcnt vmcnt(0)
    ds_read_b128 v[120:123], v206 offset:40960
    v_fmac_f32 v96, v136, v76
    v_mfma_f32_16x16x32_bf16 a[140:143], a[100:103], v[12:15], a[140:143]
    v_fmac_f32 v97, v137, v77
    v_fmac_f32 v98, v138, v78
    v_mfma_f32_16x16x32_bf16 a[144:147], a[104:107], v[12:15], a[144:147]
    v_add_u32 v212, s91, v212
    v_add_u32 v214, s91, v214
    v_mfma_f32_16x16x32_bf16 a[144:147], a[84:87], v[8:11], a[144:147]
    v_add_u32 v206, s91, v206
    v_fmac_f32 v99, v139, v79
    v_mfma_f32_16x16x32_bf16 a[148:151], a[88:91], v[8:11], a[148:151]
    v_fmac_f32 v100, v140, v80
    v_fmac_f32 v101, v141, v81
    v_mfma_f32_16x16x32_bf16 a[148:151], a[108:111], v[12:15], a[148:151]
    v_fmac_f32 v102, v142, v82
    v_fmac_f32 v103, v143, v83
    v_mfma_f32_16x16x32_bf16 a[152:155], a[112:115], v[12:15], a[152:155]
    s_waitcnt lgkmcnt(4)
    v_fmac_f32 v84, v104, v64
    v_fmac_f32 v85, v105, v65
    v_mfma_f32_16x16x32_bf16 a[152:155], a[92:95], v[8:11], a[152:155]
    ds_write_b128 v204, a[140:143] offset:46080
    v_mfma_f32_16x16x32_bf16 a[152:155], a[72:75], v[4:7], a[152:155]
    v_fmac_f32 v86, v106, v66
    v_fmac_f32 v87, v107, v67
    v_mfma_f32_16x16x32_bf16 a[152:155], a[52:55], v[0:3], a[152:155]
    ds_write_b128 v204, a[144:147] offset:47104
    v_mfma_f32_16x16x32_bf16 a[152:155], a[32:35], v[44:47], a[152:155]
    s_waitcnt lgkmcnt(5)
    v_fmac_f32 v88, v108, v68
    v_fmac_f32 v89, v109, v69
    v_mfma_f32_16x16x32_bf16 a[152:155], a[12:15], v[40:43], a[152:155]
    ds_read_b128 v[124:127], v212 offset:46080
    v_fmac_f32 v90, v110, v70
    v_mfma_f32_16x16x32_bf16 a[152:155], v[228:231], v[36:39], a[152:155]
    ds_read_b128 v[128:131], v214 offset:46080
    v_fmac_f32 v91, v111, v71
    v_mfma_f32_16x16x32_bf16 a[152:155], v[196:199], v[32:35], a[152:155]
    v_mfma_f32_16x16x32_bf16 a[152:155], v[176:179], v[28:31], a[152:155]
    ds_write_b128 v204, a[148:151] offset:48128
    v_mfma_f32_16x16x32_bf16 a[152:155], v[156:159], v[24:27], a[152:155]
    v_mfma_f32_16x16x32_bf16 a[156:159], v[160:163], v[24:27], a[156:159]
    v_mfma_f32_16x16x32_bf16 a[156:159], v[180:183], v[28:31], a[156:159]
    s_waitcnt lgkmcnt(2)
    v_fmac_f32 v84, v124, v64
    v_fmac_f32 v85, v125, v65
    v_mfma_f32_16x16x32_bf16 a[156:159], v[200:203], v[32:35], a[156:159]
    v_fmac_f32 v86, v126, v66
    v_fmac_f32 v87, v127, v67
    v_mfma_f32_16x16x32_bf16 a[156:159], v[232:235], v[36:39], a[156:159]
    s_waitcnt lgkmcnt(1)
    v_fmac_f32 v88, v128, v68
    v_fmac_f32 v89, v129, v69
    v_mfma_f32_16x16x32_bf16 a[156:159], a[16:19], v[40:43], a[156:159]
    v_fmac_f32 v90, v130, v70
    v_fmac_f32 v91, v131, v71
    v_mfma_f32_16x16x32_bf16 a[156:159], a[36:39], v[44:47], a[156:159]
    ds_write_b128 v204, a[152:155] offset:49152
    v_mfma_f32_16x16x32_bf16 a[156:159], a[56:59], v[0:3], a[156:159]
    buffer_store_dwordx4 v[84:87], v207, s[56:59], 0 offen offset:0 sc0 sc1
    v_mfma_f32_16x16x32_bf16 a[156:159], a[76:79], v[4:7], a[156:159]
    ds_read_b128 v[132:135], v212 offset:48128
    v_mfma_f32_16x16x32_bf16 a[156:159], a[96:99], v[8:11], a[156:159]
    ds_read_b128 v[136:139], v214 offset:48128
    v_mfma_f32_16x16x32_bf16 a[156:159], a[116:119], v[12:15], a[156:159]
    buffer_store_dwordx4 v[88:91], v207, s[56:59], s71 offen offset:0 sc0 sc1
    v_pk_fma_f32 v[92:93], v[112:113], v[72:73], v[92:93]
    v_pk_fma_f32 v[94:95], v[114:115], v[74:75], v[94:95]
    v_pk_fma_f32 v[96:97], v[116:117], v[76:77], v[96:97]
    v_pk_fma_f32 v[98:99], v[118:119], v[78:79], v[98:99]
    v_pk_fma_f32 v[100:101], v[120:121], v[80:81], v[100:101]
    v_pk_fma_f32 v[102:103], v[122:123], v[82:83], v[102:103]
    s_nop 0
    ds_write_b128 v204, a[156:159] offset:50176
    ds_read_b128 v[140:143], v206 offset:46080
    s_waitcnt lgkmcnt(3)
    v_pk_fma_f32 v[92:93], v[132:133], v[72:73], v[92:93]
    v_pk_fma_f32 v[94:95], v[134:135], v[74:75], v[94:95]
    buffer_store_dwordx4 v[92:95], v207, s[56:59], 0 offen offset:128 sc0 sc1
    s_waitcnt lgkmcnt(2)
    v_pk_fma_f32 v[96:97], v[136:137], v[76:77], v[96:97]
    v_pk_fma_f32 v[98:99], v[138:139], v[78:79], v[98:99]
    buffer_store_dwordx4 v[96:99], v207, s[56:59], s71 offen offset:128 sc0 sc1
    s_waitcnt lgkmcnt(0)
    v_pk_fma_f32 v[100:101], v[140:141], v[80:81], v[100:101]
    v_pk_fma_f32 v[102:103], v[142:143], v[82:83], v[102:103]
    buffer_store_dwordx4 v[100:103], v240, s[56:59], 0 offen offset:0 sc0 sc1
    s_endpgm
L_slow_15:
    s_mov_b32 s80, 0x80000
L_spin_14:
    s_sleep 2
    buffer_load_dword v252, v213, s[48:51], s73 offen sc1
    s_waitcnt vmcnt(0)
    v_cmp_ne_u32 vcc, s82, v252
    s_sub_u32 s80, s80, 1
    s_cmp_eq_u32 s80, 0
    s_cbranch_scc1 L_done_16
    s_nop 1
    s_cbranch_vccnz L_spin_14
L_done_16:
    s_mov_b64 exec, -1
    s_branch L_ok_13
L_slow_19:
    s_mov_b32 s80, 0x80000
L_lb_17:
    buffer_load_dwordx4 v[144:147], v194, s[48:51], s79 offen offset:0 sc1
    buffer_load_dwordx4 v[148:151], v195, s[48:51], s79 offen offset:1024 sc1
    buffer_load_dwordx4 v[152:155], v196, s[48:51], s79 offen offset:2048 sc1
    buffer_load_dwordx4 v[156:159], v197, s[48:51], s79 offen offset:3072 sc1
    s_waitcnt vmcnt(0)
    v_max3_u32 v164, v144, v145, v146
    v_max3_u32 v164, v164, v147, v148
    v_max3_u32 v164, v164, v149, v150
    v_max3_u32 v164, v164, v151, v152
    v_max3_u32 v164, v164, v153, v154
    v_max3_u32 v164, v164, v155, v156
    v_max3_u32 v164, v164, v157, v158
    v_max_u32 v164, v164, v159
    v_cmp_eq_u32 vcc, -1, v164
    s_sub_u32 s80, s80, 1
    s_cmp_eq_u32 s80, 0
    s_cbranch_scc1 L_lbok_18
    s_nop 1
    s_cbranch_vccnz L_lb_17
    s_branch L_lbok_18
L_slow_22:
    s_mov_b32 s80, 0x80000
L_spin_21:
    s_sleep 2
    buffer_load_dword v252, v248, s[48:51], 0 offen sc1
    s_waitcnt vmcnt(0)
    v_cmp_ne_u32 vcc, s82, v252
    s_sub_u32 s80, s80, 1
    s_cmp_eq_u32 s80, 0
    s_cbranch_scc1 L_done_23
    s_nop 1
    s_cbranch_vccnz L_spin_21
L_done_23:
    s_mov_b64 exec, -1
    s_branch L_ok_20
L_slow_26:
    s_mov_b32 s80, 0x80000
L_spin_25:
    s_sleep 2
    buffer_load_dword v252, v250, s[48:51], 0 offen sc1
    s_waitcnt vmcnt(0)
    v_cmp_ne_u32 vcc, s82, v252
    s_sub_u32 s80, s80, 1
    s_cmp_eq_u32 s80, 0
    s_cbranch_scc1 L_done_27
    s_nop 1
    s_cbranch_vccnz L_spin_25
L_done_27:
    s_mov_b64 exec, -1
    s_branch L_ok_24
    s_endpgm
L_code_end:
.section .rodata,"a"
.p2align 6
.amdhsa_kernel recurrent_scan__ssm_conv_s5__glu_gated_glu__prompt_kernel
  .amdhsa_next_free_vgpr 512
  .amdhsa_next_free_sgpr 102
  .amdhsa_accum_offset 256
  .amdhsa_group_segment_fixed_size 0
  .amdhsa_kernarg_size 128
  .amdhsa_user_sgpr_count 2
  .amdhsa_user_sgpr_kernarg_segment_ptr 1
  .amdhsa_system_sgpr_workgroup_id_x 1
  .amdhsa_float_denorm_mode_32 3
.end_amdhsa_kernel
```
